```python
import torch

def _softmax(x, axis=-1):
    return torch.softmax(x, dim=axis)
def _gelu(x):
    return torch.nn.functional.gelu(x, approximate="tanh")
def _silu(x):
    return torch.nn.functional.silu(x)
def _sigmoid(x):
    return torch.sigmoid(x)
def _layernorm(x, axis=-1, eps=1e-5):
    m = x.mean(dim=axis, keepdim=True)
    v = x.var(dim=axis, keepdim=True, unbiased=False)
    return (x - m) / torch.sqrt(v + eps)
def _scatter_add(tgt, idx, src, axis=0):
    return tgt.clone().index_add_(axis, idx, src)
def _segment_sum(src, seg, n):
    out = torch.zeros((n,) + src.shape[1:], dtype=src.dtype)
    return out.index_add_(0, seg, src)
def _pad(x, pw):
    flat = tuple(v for pair in reversed(pw) for v in pair)
    return torch.nn.functional.pad(x, flat)

kernel_name = 'concat_heads__gqa_block_cached__mha_block_cached__near_ridge'

def setup_inputs():

    _w = (lambda a: (lambda t: t.to(torch.bfloat16) if t.is_floating_point() else t)(torch.as_tensor(a)))
    def _A_setup():
        B, Sq, D = 16, 48, 448
        Hq, Hkv, Sk, Dh = 16, 8, 512, 256
        assert Hq % Hkv == 0, (Hq, Hkv)
        return {
            "x": _w((lambda *s: torch.randn(*s, dtype=torch.bfloat16) * 0.8)(B, Sq, D)),
            "k_cache": _w((lambda *s: torch.randn(*s, dtype=torch.bfloat16) * 0.8)(B, Hkv, Sk, Dh)),
            "v_cache": _w((lambda *s: torch.randn(*s, dtype=torch.bfloat16) * 0.05)(B, Hkv, Sk, Dh)),
            "wq": _w((lambda *s: torch.randn(*s, dtype=torch.bfloat16) * 0.8)(D, Hq * Dh) * (D ** -0.5)),
            "wo": _w((lambda *s: torch.randn(*s, dtype=torch.bfloat16) * 0.05)(Hq * Dh, D) * ((Hq * Dh) ** -0.5)),
        }
    _A_in = _A_setup()

    def _B_setup():
        B, Sq, D = 16, 48, 448
        H, Sk, Dh = 16, 512, 256
        return {
            "x": _w((lambda *s: torch.randn(*s, dtype=torch.bfloat16) * 0.8)(B, Sq, D)),
            "k_cache": _w((lambda *s: torch.randn(*s, dtype=torch.bfloat16) * 0.8)(B, H, Sk, Dh)),
            "v_cache": _w((lambda *s: torch.randn(*s, dtype=torch.bfloat16) * 0.05)(B, H, Sk, Dh)),
            "wq": _w((lambda *s: torch.randn(*s, dtype=torch.bfloat16) * 0.8)(D, H * Dh) * (D ** -0.5)),
            "wo": _w((lambda *s: torch.randn(*s, dtype=torch.bfloat16) * 0.05)(H * Dh, D) * ((H * Dh) ** -0.5)),
        }
    _B_in = _B_setup()

    return {
        "A_x": _A_in["x"],
        "A_k_cache": _A_in["k_cache"],
        "A_v_cache": _A_in["v_cache"],
        "A_wq": _A_in["wq"],
        "A_wo": _A_in["wo"],
        "B_x": _B_in["x"],
        "B_k_cache": _B_in["k_cache"],
        "B_v_cache": _B_in["v_cache"],
        "B_wq": _B_in["wq"],
        "B_wo": _B_in["wo"],
    }

def reference(A_x, A_k_cache, A_v_cache, A_wq, A_wo, B_x, B_k_cache, B_v_cache, B_wq, B_wo):
    def _A_ref(x, k_cache, v_cache, wq, wo):
        B, Sq, D = x.shape
        Hq, Dh = 16, 256
        Hkv = k_cache.shape[1]
        rep = Hq // Hkv
        q = (lambda x, *d: x.permute(*d))((x @ wq).reshape(B, Sq, Hq, Dh), 0, 2, 1, 3)
        k = (lambda x, n, axis: torch.repeat_interleave(x, n, dim=axis))(k_cache, rep, axis=1)
        v = (lambda x, n, axis: torch.repeat_interleave(x, n, dim=axis))(v_cache, rep, axis=1)
        scores = torch.einsum("bhqd,bhkd->bhqk", q, k) * (Dh ** -0.5)
        p = _softmax(scores, axis=-1)
        o = torch.einsum("bhqk,bhkd->bhqd", p, v)
        return (lambda x, *d: x.permute(*d))(o, 0, 2, 1, 3).reshape(B, Sq, Hq * Dh) @ wo

    def _B_ref(x, k_cache, v_cache, wq, wo):
        B, Sq, D = x.shape
        H, Dh = 16, 256
        q = (lambda x, *d: x.permute(*d))((x @ wq).reshape(B, Sq, H, Dh), 0, 2, 1, 3)
        scores = torch.einsum("bhqd,bhkd->bhqk", q, k_cache) * (Dh ** -0.5)
        p = _softmax(scores, axis=-1)
        o = torch.einsum("bhqk,bhkd->bhqd", p, v_cache)
        return (lambda x, *d: x.permute(*d))(o, 0, 2, 1, 3).reshape(B, Sq, H * Dh) @ wo

    a = _A_ref(A_x, A_k_cache, A_v_cache, A_wq, A_wo)
    b = _B_ref(B_x, B_k_cache, B_v_cache, B_wq, B_wo)
    return torch.concatenate([a, b], axis=-1)
```

```asm
; @launch grid=(256,1,1) block=(256,1,1) lds=154624
.amdgcn_target "amdgcn-amd-amdhsa--gfx950"
.text
.globl concat_heads__gqa_block_cached__mha_block_cached__near_ridge_kernel
.p2align 8
.type concat_heads__gqa_block_cached__mha_block_cached__near_ridge_kernel,@function
concat_heads__gqa_block_cached__mha_block_cached__near_ridge_kernel:
  s_cmp_ge_u32 s2, 256
  s_cbranch_scc1 L_end
  s_load_dwordx2 s[58:59], s[0:1], 96
  s_load_dwordx4 s[92:95], s[0:1], 80
  s_load_dwordx2 s[86:87], s[0:1], 40
  s_load_dwordx2 s[88:89], s[0:1], 72
  s_load_dwordx4 s[76:79], s[0:1], 48
  s_memrealtime s[90:91]
  s_cmp_lt_u32 s2, 128
  s_cselect_b32 s7, 40, 0
  s_add_u32 s0, s0, s7
  s_addc_u32 s1, s1, 0
  s_load_dwordx8 s[48:55], s[0:1], 0
  s_load_dwordx2 s[56:57], s[0:1], 32
  s_and_b32 s3, s2, 7
  s_lshr_b32 s5, s2, 3
  s_and_b32 s5, s5, 15
  v_lshrrev_b32 v43, 6, v0
  v_and_b32 v0, 63, v0
  v_readfirstlane_b32 s32, v43
  v_and_b32 v1, 15, v0
  v_lshrrev_b32 v2, 4, v0
  s_mul_i32 s33, s32, 24576
  s_lshl_b32 s34, s32, 13
  s_mov_b32 s35, 0
  s_mov_b32 s38, 229376
  s_getpc_b64 s[80:81]
L_pc:
  s_sub_u32 s80, s80, L_pc-concat_heads__gqa_block_cached__mha_block_cached__near_ridge_kernel
  s_subb_u32 s81, s81, 0
  s_mov_b32 s82, L_end-concat_heads__gqa_block_cached__mha_block_cached__near_ridge_kernel
  s_mov_b32 s83, 0x20000
  s_lshr_b32 s84, s2, 3
  s_lshl_b32 s84, s84, 2
  s_add_u32 s84, s84, s32
  s_lshl_b32 s84, s84, 10
  v_lshlrev_b32 v15, 4, v0
  s_mov_b32 m0, 150528
  s_nop 0
  buffer_load_dwordx4 v15, s[80:83], s84 offen lds
  s_cmp_lt_u32 s2, 128
  s_cbranch_scc0 L_pathA
  s_and_b32 s6, s5, 1
  s_lshl_b32 s39, s3, 1
  s_add_u32 s6, s6, s39
  s_lshr_b32 s7, s5, 1
  v_lshrrev_b32 v43, 3, v0
  v_lshlrev_b32 v44, 1, v2
  v_and_b32 v45, 7, v0
  v_xor_b32 v44, v44, v45
  v_lshlrev_b32 v44, 4, v44
  v_mul_u32_u24 v43, 896, v43
  v_add_u32 v40, v43, v44
  s_lshl_b32 s39, s32, 7
  v_lshrrev_b32 v43, 3, v0
  v_and_b32 v44, 1, v2
  v_lshlrev_b32 v44, 1, v44
  v_and_b32 v45, 7, v0
  v_xor_b32 v44, v44, v45
  v_lshlrev_b32 v44, 4, v44
  v_lshl_add_u32 v43, v43, 13, v44
  v_add_u32 v24, s39, v43
  v_xor_b32 v43, 64, v24
  v_add_u32 v25, 64512, v43
  v_add_u32 v26, 129024, v24
  v_add_u32 v27, 193536, v43
  s_cmp_eq_u32 s7, 7
  s_cselect_b32 s39, 0, s7
  s_lshl_b32 s36, s39, 19
  s_mul_i32 s42, s39, 6144
  s_mul_i32 s40, s7, 43008
  s_lshl_b32 s41, s6, 9
  s_sub_u32 s44, 3670016, s41
  s_waitcnt lgkmcnt(0)
  s_add_u32 s24, s48, s40
  s_addc_u32 s25, s49, 0
  s_mov_b32 s26, 387072
  s_mov_b32 s27, 0x20000
  s_add_u32 s16, s54, s41
  s_addc_u32 s17, s55, 0
  s_mov_b32 s18, s44
  s_mov_b32 s19, 0x20000
  s_add_u32 m0, s33, 0
  s_add_u32 s46, s36, 262144
  buffer_load_dwordx4 v24, s[16:19], s36 offen offset:0 lds
  buffer_load_dwordx4 v25, s[16:19], s36 offen offset:1024 lds
  buffer_load_dwordx4 v26, s[16:19], s36 offen offset:2048 lds
  buffer_load_dwordx4 v27, s[16:19], s36 offen offset:3072 lds
  s_add_u32 m0, s33, 4096
  s_nop 0
  buffer_load_dwordx4 v24, s[16:19], s46 offen offset:0 lds
  buffer_load_dwordx4 v25, s[16:19], s46 offen offset:1024 lds
  buffer_load_dwordx4 v26, s[16:19], s46 offen offset:2048 lds
  buffer_load_dwordx4 v27, s[16:19], s46 offen offset:3072 lds
  s_add_u32 s36, s36, 524288
  s_cmp_eq_u32 s36, 3670016
  s_cselect_b32 s36, 0, s36
  s_mov_b32 s39, s32
  s_mul_i32 s40, s32, 7168
  s_lshl_b32 s41, s32, 10
  s_add_u32 m0, s41, 98304
  s_add_u32 s39, s39, 4
  buffer_load_dwordx4 v40, s[24:27], s40 offen lds
  s_cmp_ge_u32 s39, 6
  s_cselect_b32 s41, 6, 0
  s_cselect_b32 s44, 42880, 0
  s_sub_u32 s39, s39, s41
  s_add_u32 s40, s40, 28672
  s_sub_u32 s40, s40, s44
  s_add_u32 m0, m0, 4096
  s_add_u32 s39, s39, 4
  buffer_load_dwordx4 v40, s[24:27], s40 offen lds
  s_cmp_ge_u32 s39, 6
  s_cselect_b32 s41, 6, 0
  s_cselect_b32 s44, 42880, 0
  s_sub_u32 s39, s39, s41
  s_add_u32 s40, s40, 28672
  s_sub_u32 s40, s40, s44
  s_add_u32 m0, m0, 4096
  s_add_u32 s39, s39, 4
  buffer_load_dwordx4 v40, s[24:27], s40 offen lds
  s_cmp_ge_u32 s39, 6
  s_cselect_b32 s41, 6, 0
  s_cselect_b32 s44, 42880, 0
  s_sub_u32 s39, s39, s41
  s_add_u32 s40, s40, 28672
  s_sub_u32 s40, s40, s44
  s_add_u32 m0, m0, 4096
  s_add_u32 s39, s39, 4
  buffer_load_dwordx4 v40, s[24:27], s40 offen lds
  s_cmp_ge_u32 s39, 6
  s_cselect_b32 s41, 6, 0
  s_cselect_b32 s44, 42880, 0
  s_sub_u32 s39, s39, s41
  s_add_u32 s40, s40, 28672
  s_sub_u32 s40, s40, s44
  s_add_u32 m0, m0, 4096
  s_add_u32 s39, s39, 4
  buffer_load_dwordx4 v40, s[24:27], s40 offen lds
  s_cmp_ge_u32 s39, 6
  s_cselect_b32 s41, 6, 0
  s_cselect_b32 s44, 42880, 0
  s_sub_u32 s39, s39, s41
  s_add_u32 s40, s40, 28672
  s_sub_u32 s40, s40, s44
  s_add_u32 m0, m0, 4096
  s_add_u32 s39, s39, 4
  buffer_load_dwordx4 v40, s[24:27], s40 offen lds
  s_cmp_ge_u32 s39, 6
  s_cselect_b32 s41, 6, 0
  s_cselect_b32 s44, 42880, 0
  s_sub_u32 s39, s39, s41
  s_add_u32 s40, s40, 28672
  s_sub_u32 s40, s40, s44
  s_add_u32 m0, m0, 4096
  s_add_u32 s39, s39, 4
  buffer_load_dwordx4 v40, s[24:27], s40 offen lds
  s_cmp_ge_u32 s39, 6
  s_cselect_b32 s41, 6, 0
  s_cselect_b32 s44, 42880, 0
  s_sub_u32 s39, s39, s41
  s_add_u32 s40, s40, 28672
  s_sub_u32 s40, s40, s44
  s_add_u32 m0, m0, 4096
  s_add_u32 s39, s39, 4
  buffer_load_dwordx4 v40, s[24:27], s40 offen lds
  s_cmp_ge_u32 s39, 6
  s_cselect_b32 s41, 6, 0
  s_cselect_b32 s44, 42880, 0
  s_sub_u32 s39, s39, s41
  s_add_u32 s40, s40, 28672
  s_sub_u32 s40, s40, s44
  s_add_u32 m0, m0, 4096
  s_add_u32 s39, s39, 4
  buffer_load_dwordx4 v40, s[24:27], s40 offen lds
  s_cmp_ge_u32 s39, 6
  s_cselect_b32 s41, 6, 0
  s_cselect_b32 s44, 42880, 0
  s_sub_u32 s39, s39, s41
  s_add_u32 s40, s40, 28672
  s_sub_u32 s40, s40, s44
  s_add_u32 m0, m0, 4096
  s_add_u32 s39, s39, 4
  buffer_load_dwordx4 v40, s[24:27], s40 offen lds
  s_cmp_ge_u32 s39, 6
  s_cselect_b32 s41, 6, 0
  s_cselect_b32 s44, 42880, 0
  s_sub_u32 s39, s39, s41
  s_add_u32 s40, s40, 28672
  s_sub_u32 s40, s40, s44
  s_add_u32 m0, m0, 4096
  s_add_u32 s39, s39, 4
  buffer_load_dwordx4 v40, s[24:27], s40 offen lds
  s_add_u32 m0, s33, 8192
  s_add_u32 s46, s36, 262144
  buffer_load_dwordx4 v24, s[16:19], s36 offen offset:0 lds
  buffer_load_dwordx4 v25, s[16:19], s36 offen offset:1024 lds
  buffer_load_dwordx4 v26, s[16:19], s36 offen offset:2048 lds
  buffer_load_dwordx4 v27, s[16:19], s36 offen offset:3072 lds
  s_add_u32 m0, s33, 12288
  s_nop 0
  buffer_load_dwordx4 v24, s[16:19], s46 offen offset:0 lds
  buffer_load_dwordx4 v25, s[16:19], s46 offen offset:1024 lds
  buffer_load_dwordx4 v26, s[16:19], s46 offen offset:2048 lds
  buffer_load_dwordx4 v27, s[16:19], s46 offen offset:3072 lds
  s_add_u32 s36, s36, 524288
  s_cmp_eq_u32 s36, 3670016
  s_cselect_b32 s36, 0, s36
  s_lshl_b32 s39, s7, 5
  s_add_u32 s39, s39, s6
  s_mul_i32 s40, s7, 16
  s_add_u32 s40, s40, s6
  s_lshl_b32 s40, s40, 18
  s_add_u32 s8, s50, s40
  s_addc_u32 s9, s51, 0
  s_mov_b32 s10, 33816576
  s_mov_b32 s11, 0x20000
  s_add_u32 s12, s52, s40
  s_addc_u32 s13, s53, 0
  s_mov_b32 s14, 33816576
  s_mov_b32 s15, 0x20000
  s_mul_i32 s40, s6, 229376
  s_add_u32 s20, s56, s40
  s_addc_u32 s21, s57, 0
  s_mov_b32 s22, 229376
  s_mov_b32 s23, 0x20000
  s_add_u32 s39, s39, 128
  s_mul_i32 s40, s39, 43136
  s_add_u32 s28, s58, s40
  s_addc_u32 s29, s59, 0
  s_mov_b32 s30, 733312
  s_mov_b32 s31, 0x20000
  s_mul_i32 s37, s7, 28672
  s_mul_i32 s43, s7, 3072
  s_lshl_b32 s39, s7, 3
  s_add_u32 s94, s94, s39
  s_addc_u32 s95, s95, 0
  s_add_u32 s94, s94, 128
  s_addc_u32 s95, s95, 0
  s_cmp_eq_u32 s32, 3
  s_cbranch_scc0 L_notagB
  s_cmp_eq_u32 s6, 0
  s_cbranch_scc0 L_notagB
  s_or_b32 s90, s90, 1
  v_mov_b32 v46, s90
  v_mov_b32 v47, s91
  v_mov_b32 v45, 0
  s_mov_b64 exec, 1
  global_store_dwordx2 v45, v[46:47], s[94:95] sc1
  s_mov_b64 exec, -1
  s_nop 1
L_notagB:
  v_lshlrev_b32 v3, 4, v0
  v_add_u32 v3, 98304, v3
  v_lshrrev_b32 v46, 2, v1
  v_and_b32 v47, 3, v1
  v_and_b32 v44, 6, v1
  v_xor_b32 v44, v44, v2
  v_lshlrev_b32 v44, 4, v44
  v_lshl_add_u32 v44, v1, 7, v44
  v_add_u32 v41, 98304, v44
  v_lshrrev_b32 v46, 2, v1
  v_and_b32 v47, 3, v1
  s_add_u32 m0, s33, 16384
  s_add_u32 s46, s36, 262144
  buffer_load_dwordx4 v24, s[16:19], s36 offen offset:0 lds
  v_lshl_add_u32 v43, v2, 2, v46
  v_lshrrev_b32 v44, 1, v43
  v_and_b32 v44, 3, v44
  v_lshlrev_b32 v44, 5, v44
  v_lshl_add_u32 v44, v43, 7, v44
  v_lshl_add_u32 v44, v47, 3, v44
  v_add_u32 v8, s33, v44
  v_xor_b32 v9, 32, v8
  v_xor_b32 v10, 64, v8
  v_xor_b32 v11, 96, v8
  v_lshl_add_u32 v43, v2, 2, v46
  buffer_load_dwordx4 v25, s[16:19], s36 offen offset:1024 lds
  v_lshl_add_u32 v28, v2, 9, v8
  v_lshl_add_u32 v29, v2, 9, v9
  v_lshl_add_u32 v30, v2, 9, v10
  v_lshl_add_u32 v31, v2, 9, v11
  v_mul_u32_u24 v44, 224, v43
  v_lshl_add_u32 v44, v47, 3, v44
  v_add_u32 v12, s33, v44
  v_and_b32 v43, 1, v2
  s_mul_i32 s39, s32, 6144
  s_add_u32 s39, s39, 98304
  v_lshrrev_b32 v45, 1, v2
  v_lshlrev_b32 v44, 8, v45
  buffer_load_dwordx4 v26, s[16:19], s36 offen offset:2048 lds
  v_lshl_add_u32 v44, v1, 4, v44
  v_lshl_add_u32 v44, v43, 3, v44
  v_add_u32 v42, s39, v44
  v_xor_b32 v44, v2, v1
  v_lshlrev_b32 v44, 4, v44
  v_lshl_add_u32 v44, v1, 8, v44
  v_add_u32 v20, s33, v44
  v_xor_b32 v21, 64, v20
  v_xor_b32 v22, 128, v20
  v_xor_b32 v23, 192, v20
  s_lshl_b32 s39, s32, 7
  v_lshrrev_b32 v43, 3, v0
  buffer_load_dwordx4 v27, s[16:19], s36 offen offset:3072 lds
  v_and_b32 v44, 7, v0
  v_lshlrev_b32 v45, 1, v2
  v_xor_b32 v44, v44, v45
  v_lshlrev_b32 v44, 4, v44
  v_lshl_add_u32 v43, v43, 9, v44
  v_add_u32 v4, s39, v43
  v_add_u32 v5, 3072, v4
  v_add_u32 v6, 6144, v4
  v_add_u32 v7, 9216, v4
  v_lshlrev_b32 v44, 4, v1
  v_add_u32 v14, 147456, v44
  s_add_u32 m0, s33, 20480
  s_nop 0
  buffer_load_dwordx4 v24, s[16:19], s46 offen offset:0 lds
  s_lshl_b32 s39, s32, 2
  v_add_u32 v13, s39, v14
  s_mov_b32 s100, 0x3db8aa3b
  s_mov_b32 s101, 0xbdb8aa3b
  v_add_u32 v43, 0, v2
  v_xor_b32 v44, v43, v1
  v_lshlrev_b32 v44, 4, v44
  v_lshl_add_u32 v16, v43, 9, v44
  v_add_u32 v43, 4, v2
  v_xor_b32 v44, v43, v1
  v_lshlrev_b32 v44, 4, v44
  v_lshl_add_u32 v17, v43, 9, v44
  v_subrev_u32 v17, 1024, v17
  buffer_load_dwordx4 v25, s[16:19], s46 offen offset:1024 lds
  v_add_u32 v43, 8, v2
  v_xor_b32 v44, v43, v1
  v_lshlrev_b32 v44, 4, v44
  v_lshl_add_u32 v18, v43, 9, v44
  v_subrev_u32 v18, 2048, v18
  v_add_u32 v43, 12, v2
  v_xor_b32 v44, v43, v1
  v_lshlrev_b32 v44, 4, v44
  v_lshl_add_u32 v19, v43, 9, v44
  v_subrev_u32 v19, 3072, v19
  s_mul_i32 s39, s32, 224
  s_movk_i32 s40, 4682
  buffer_load_dwordx4 v26, s[16:19], s46 offen offset:2048 lds
  s_mov_b32 s41, 0x40000000
  v_add_u32 v43, 0, v0
  v_mul_u32_u24 v44, s40, v43
  v_lshrrev_b32 v44, 16, v44
  v_mul_u32_u24 v45, 14, v44
  v_sub_u32 v45, v43, v45
  v_lshlrev_b32 v45, 4, v45
  v_mul_u32_u24 v44, 896, v44
  v_add3_u32 v36, v44, v45, s39
  v_add_u32 v43, 64, v0
  v_mul_u32_u24 v44, s40, v43
  v_lshrrev_b32 v44, 16, v44
  buffer_load_dwordx4 v27, s[16:19], s46 offen offset:3072 lds
  s_add_u32 s36, s36, 524288
  s_cmp_eq_u32 s36, 3670016
  s_cselect_b32 s36, 0, s36
  v_mul_u32_u24 v45, 14, v44
  v_sub_u32 v45, v43, v45
  v_lshlrev_b32 v45, 4, v45
  v_mul_u32_u24 v44, 896, v44
  v_add3_u32 v37, v44, v45, s39
  v_subrev_u32 v37, 1024, v37
  v_add_u32 v43, 128, v0
  v_mul_u32_u24 v44, s40, v43
  v_lshrrev_b32 v44, 16, v44
  v_mul_u32_u24 v45, 14, v44
  v_sub_u32 v45, v43, v45
  v_lshlrev_b32 v45, 4, v45
  v_mul_u32_u24 v44, 896, v44
  v_add3_u32 v38, v44, v45, s39
  v_subrev_u32 v38, 2048, v38
  v_add_u32 v43, 192, v0
  v_mul_u32_u24 v44, s40, v43
  v_lshrrev_b32 v44, 16, v44
  v_mul_u32_u24 v45, 14, v44
  v_sub_u32 v45, v43, v45
  v_lshlrev_b32 v45, 4, v45
  v_mul_u32_u24 v44, 896, v44
  v_add3_u32 v39, v44, v45, s39
  v_subrev_u32 v39, 3072, v39
  v_mov_b32 v43, s41
  v_cmp_gt_u32 vcc, 32, v0
  s_nop 1
  v_cndmask_b32 v39, v43, v39, vcc
  v_lshlrev_b32 v33, 4, v0
  v_lshlrev_b32 v35, 3, v0
  s_waitcnt vmcnt(27)
  s_waitcnt vmcnt(16)
  s_barrier
  v_add_u32 v15, s42, v41
  s_add_u32 s42, s42, 6144
  s_cmp_eq_u32 s42, 43008
  s_cselect_b32 s42, 0, s42
  v_xor_b32 v43, 64, v15
  ds_read_b128 v[208:211], v15 offset:0
  ds_read_b64_tr_b16 a[0:1], v28 offset:0
  ds_read_b64_tr_b16 a[2:3], v28 offset:512
  ds_read_b128 v[212:215], v15 offset:2048
  ds_read_b64_tr_b16 a[4:5], v29 offset:0
  ds_read_b64_tr_b16 a[6:7], v29 offset:512
  ds_read_b128 v[216:219], v15 offset:4096
  ds_read_b128 v[220:223], v43 offset:0
  ds_read_b128 v[224:227], v43 offset:2048
  ds_read_b128 v[228:231], v43 offset:4096
  ds_read_b64_tr_b16 a[8:9], v30 offset:0
  ds_read_b64_tr_b16 a[10:11], v30 offset:512
  ds_read_b64_tr_b16 a[12:13], v31 offset:0
  ds_read_b64_tr_b16 a[14:15], v31 offset:512
  ds_read_b64_tr_b16 a[16:17], v28 offset:4096
  ds_read_b64_tr_b16 a[18:19], v28 offset:4608
  ds_read_b64_tr_b16 a[20:21], v29 offset:4096
  ds_read_b64_tr_b16 a[22:23], v29 offset:4608
  ds_read_b64_tr_b16 a[24:25], v30 offset:4096
  ds_read_b64_tr_b16 a[26:27], v30 offset:4608
  ds_read_b64_tr_b16 a[28:29], v31 offset:4096
  ds_read_b64_tr_b16 a[30:31], v31 offset:4608
  s_waitcnt lgkmcnt(0)
  v_mfma_f32_16x16x32_bf16 v[160:163], a[0:3], v[208:211], 0
  s_add_u32 m0, s33, 0
  s_add_u32 s46, s36, 262144
  buffer_load_dwordx4 v24, s[16:19], s36 offen offset:0 lds
  s_waitcnt vmcnt(9)
  v_mfma_f32_16x16x32_bf16 v[164:167], a[0:3], v[212:215], 0
  v_add_u32 v15, s42, v41
  s_add_u32 s42, s42, 6144
  s_cmp_eq_u32 s42, 43008
  s_cselect_b32 s42, 0, s42
  v_xor_b32 v43, 64, v15
  ds_read_b128 v[232:235], v15 offset:0
  ds_read_b64_tr_b16 a[32:33], v28 offset:8192
  v_mfma_f32_16x16x32_bf16 v[168:171], a[0:3], v[216:219], 0
  buffer_load_dwordx4 v25, s[16:19], s36 offen offset:1024 lds
  ds_read_b64_tr_b16 a[34:35], v28 offset:8704
  v_mfma_f32_16x16x32_bf16 v[172:175], a[4:7], v[208:211], 0
  ds_read_b128 v[236:239], v15 offset:2048
  v_mfma_f32_16x16x32_bf16 v[176:179], a[4:7], v[212:215], 0
  buffer_load_dwordx4 v26, s[16:19], s36 offen offset:2048 lds
  ds_read_b64_tr_b16 a[36:37], v29 offset:8192
  v_mfma_f32_16x16x32_bf16 v[180:183], a[4:7], v[216:219], 0
  ds_read_b64_tr_b16 a[38:39], v29 offset:8704
  v_mfma_f32_16x16x32_bf16 v[184:187], a[8:11], v[208:211], 0
  buffer_load_dwordx4 v27, s[16:19], s36 offen offset:3072 lds
  ds_read_b128 v[240:243], v15 offset:4096
  v_mfma_f32_16x16x32_bf16 v[188:191], a[8:11], v[212:215], 0
  ds_read_b128 v[244:247], v43 offset:0
  v_mfma_f32_16x16x32_bf16 v[192:195], a[8:11], v[216:219], 0
  s_add_u32 m0, s33, 4096
  s_nop 0
  buffer_load_dwordx4 v24, s[16:19], s46 offen offset:0 lds
  ds_read_b128 v[248:251], v43 offset:2048
  v_mfma_f32_16x16x32_bf16 v[196:199], a[12:15], v[208:211], 0
  ds_read_b128 v[252:255], v43 offset:4096
  v_mfma_f32_16x16x32_bf16 v[200:203], a[12:15], v[212:215], 0
  buffer_load_dwordx4 v25, s[16:19], s46 offen offset:1024 lds
  ds_read_b64_tr_b16 a[40:41], v30 offset:8192
  v_mfma_f32_16x16x32_bf16 v[204:207], a[12:15], v[216:219], 0
  ds_read_b64_tr_b16 a[42:43], v30 offset:8704
  ds_read_b64_tr_b16 a[44:45], v31 offset:8192
  v_mfma_f32_16x16x32_bf16 v[160:163], a[16:19], v[220:223], v[160:163]
  buffer_load_dwordx4 v26, s[16:19], s46 offen offset:2048 lds
  ds_read_b64_tr_b16 a[46:47], v31 offset:8704
  v_mfma_f32_16x16x32_bf16 v[164:167], a[16:19], v[224:227], v[164:167]
  ds_read_b64_tr_b16 a[48:49], v28 offset:12288
  v_mfma_f32_16x16x32_bf16 v[168:171], a[16:19], v[228:231], v[168:171]
  buffer_load_dwordx4 v27, s[16:19], s46 offen offset:3072 lds
  s_add_u32 s36, s36, 524288
  s_cmp_eq_u32 s36, 3670016
  s_cselect_b32 s36, 0, s36
  ds_read_b64_tr_b16 a[50:51], v28 offset:12800
  v_mfma_f32_16x16x32_bf16 v[172:175], a[20:23], v[220:223], v[172:175]
  ds_read_b64_tr_b16 a[52:53], v29 offset:12288
  v_mfma_f32_16x16x32_bf16 v[176:179], a[20:23], v[224:227], v[176:179]
  ds_read_b64_tr_b16 a[54:55], v29 offset:12800
  v_mfma_f32_16x16x32_bf16 v[180:183], a[20:23], v[228:231], v[180:183]
  ds_read_b64_tr_b16 a[56:57], v30 offset:12288
  v_mfma_f32_16x16x32_bf16 v[184:187], a[24:27], v[220:223], v[184:187]
  ds_read_b64_tr_b16 a[58:59], v30 offset:12800
  v_mfma_f32_16x16x32_bf16 v[188:191], a[24:27], v[224:227], v[188:191]
  ds_read_b64_tr_b16 a[60:61], v31 offset:12288
  v_mfma_f32_16x16x32_bf16 v[192:195], a[24:27], v[228:231], v[192:195]
  ds_read_b64_tr_b16 a[62:63], v31 offset:12800
  v_mfma_f32_16x16x32_bf16 v[196:199], a[28:31], v[220:223], v[196:199]
  v_mfma_f32_16x16x32_bf16 v[200:203], a[28:31], v[224:227], v[200:203]
  v_mfma_f32_16x16x32_bf16 v[204:207], a[28:31], v[228:231], v[204:207]
  s_waitcnt lgkmcnt(0)
  v_mfma_f32_16x16x32_bf16 v[160:163], a[32:35], v[232:235], v[160:163]
  s_add_u32 m0, s33, 8192
  s_add_u32 s46, s36, 262144
  buffer_load_dwordx4 v24, s[16:19], s36 offen offset:0 lds
  s_waitcnt vmcnt(9)
  v_mfma_f32_16x16x32_bf16 v[164:167], a[32:35], v[236:239], v[164:167]
  v_add_u32 v15, s42, v41
  s_add_u32 s42, s42, 6144
  s_cmp_eq_u32 s42, 43008
  s_cselect_b32 s42, 0, s42
  v_xor_b32 v43, 64, v15
  ds_read_b128 v[208:211], v15 offset:0
  ds_read_b64_tr_b16 a[64:65], v28 offset:16384
  v_mfma_f32_16x16x32_bf16 v[168:171], a[32:35], v[240:243], v[168:171]
  buffer_load_dwordx4 v25, s[16:19], s36 offen offset:1024 lds
  ds_read_b64_tr_b16 a[66:67], v28 offset:16896
  v_mfma_f32_16x16x32_bf16 v[172:175], a[36:39], v[232:235], v[172:175]
  ds_read_b128 v[212:215], v15 offset:2048
  v_mfma_f32_16x16x32_bf16 v[176:179], a[36:39], v[236:239], v[176:179]
  buffer_load_dwordx4 v26, s[16:19], s36 offen offset:2048 lds
  ds_read_b64_tr_b16 a[68:69], v29 offset:16384
  v_mfma_f32_16x16x32_bf16 v[180:183], a[36:39], v[240:243], v[180:183]
  ds_read_b64_tr_b16 a[70:71], v29 offset:16896
  v_mfma_f32_16x16x32_bf16 v[184:187], a[40:43], v[232:235], v[184:187]
  buffer_load_dwordx4 v27, s[16:19], s36 offen offset:3072 lds
  ds_read_b128 v[216:219], v15 offset:4096
  v_mfma_f32_16x16x32_bf16 v[188:191], a[40:43], v[236:239], v[188:191]
  ds_read_b128 v[220:223], v43 offset:0
  v_mfma_f32_16x16x32_bf16 v[192:195], a[40:43], v[240:243], v[192:195]
  s_add_u32 m0, s33, 12288
  s_nop 0
  buffer_load_dwordx4 v24, s[16:19], s46 offen offset:0 lds
  ds_read_b128 v[224:227], v43 offset:2048
  v_mfma_f32_16x16x32_bf16 v[196:199], a[44:47], v[232:235], v[196:199]
  ds_read_b128 v[228:231], v43 offset:4096
  v_mfma_f32_16x16x32_bf16 v[200:203], a[44:47], v[236:239], v[200:203]
  buffer_load_dwordx4 v25, s[16:19], s46 offen offset:1024 lds
  ds_read_b64_tr_b16 a[72:73], v30 offset:16384
  v_mfma_f32_16x16x32_bf16 v[204:207], a[44:47], v[240:243], v[204:207]
  ds_read_b64_tr_b16 a[74:75], v30 offset:16896
  ds_read_b64_tr_b16 a[76:77], v31 offset:16384
  v_mfma_f32_16x16x32_bf16 v[160:163], a[48:51], v[244:247], v[160:163]
  buffer_load_dwordx4 v26, s[16:19], s46 offen offset:2048 lds
  ds_read_b64_tr_b16 a[78:79], v31 offset:16896
  v_mfma_f32_16x16x32_bf16 v[164:167], a[48:51], v[248:251], v[164:167]
  ds_read_b64_tr_b16 a[80:81], v28 offset:20480
  v_mfma_f32_16x16x32_bf16 v[168:171], a[48:51], v[252:255], v[168:171]
  buffer_load_dwordx4 v27, s[16:19], s46 offen offset:3072 lds
  s_add_u32 s36, s36, 524288
  s_cmp_eq_u32 s36, 3670016
  s_cselect_b32 s36, 0, s36
  ds_read_b64_tr_b16 a[82:83], v28 offset:20992
  v_mfma_f32_16x16x32_bf16 v[172:175], a[52:55], v[244:247], v[172:175]
  ds_read_b64_tr_b16 a[84:85], v29 offset:20480
  v_mfma_f32_16x16x32_bf16 v[176:179], a[52:55], v[248:251], v[176:179]
  ds_read_b64_tr_b16 a[86:87], v29 offset:20992
  v_mfma_f32_16x16x32_bf16 v[180:183], a[52:55], v[252:255], v[180:183]
  ds_read_b64_tr_b16 a[88:89], v30 offset:20480
  v_mfma_f32_16x16x32_bf16 v[184:187], a[56:59], v[244:247], v[184:187]
  ds_read_b64_tr_b16 a[90:91], v30 offset:20992
  v_mfma_f32_16x16x32_bf16 v[188:191], a[56:59], v[248:251], v[188:191]
  ds_read_b64_tr_b16 a[92:93], v31 offset:20480
  v_mfma_f32_16x16x32_bf16 v[192:195], a[56:59], v[252:255], v[192:195]
  ds_read_b64_tr_b16 a[94:95], v31 offset:20992
  v_mfma_f32_16x16x32_bf16 v[196:199], a[60:63], v[244:247], v[196:199]
  v_mfma_f32_16x16x32_bf16 v[200:203], a[60:63], v[248:251], v[200:203]
  v_mfma_f32_16x16x32_bf16 v[204:207], a[60:63], v[252:255], v[204:207]
  s_waitcnt lgkmcnt(0)
  v_mfma_f32_16x16x32_bf16 v[160:163], a[64:67], v[208:211], v[160:163]
  s_add_u32 m0, s33, 16384
  s_add_u32 s46, s36, 262144
  buffer_load_dwordx4 v24, s[16:19], s36 offen offset:0 lds
  s_waitcnt vmcnt(9)
  v_mfma_f32_16x16x32_bf16 v[164:167], a[64:67], v[212:215], v[164:167]
  v_add_u32 v15, s42, v41
  s_add_u32 s42, s42, 6144
  s_cmp_eq_u32 s42, 43008
  s_cselect_b32 s42, 0, s42
  v_xor_b32 v43, 64, v15
  ds_read_b128 v[232:235], v15 offset:0
  ds_read_b64_tr_b16 a[96:97], v28 offset:0
  v_mfma_f32_16x16x32_bf16 v[168:171], a[64:67], v[216:219], v[168:171]
  buffer_load_dwordx4 v25, s[16:19], s36 offen offset:1024 lds
  ds_read_b64_tr_b16 a[98:99], v28 offset:512
  v_mfma_f32_16x16x32_bf16 v[172:175], a[68:71], v[208:211], v[172:175]
  ds_read_b128 v[236:239], v15 offset:2048
  v_mfma_f32_16x16x32_bf16 v[176:179], a[68:71], v[212:215], v[176:179]
  buffer_load_dwordx4 v26, s[16:19], s36 offen offset:2048 lds
  ds_read_b64_tr_b16 a[100:101], v29 offset:0
  v_mfma_f32_16x16x32_bf16 v[180:183], a[68:71], v[216:219], v[180:183]
  ds_read_b64_tr_b16 a[102:103], v29 offset:512
  v_mfma_f32_16x16x32_bf16 v[184:187], a[72:75], v[208:211], v[184:187]
  buffer_load_dwordx4 v27, s[16:19], s36 offen offset:3072 lds
  ds_read_b128 v[240:243], v15 offset:4096
  v_mfma_f32_16x16x32_bf16 v[188:191], a[72:75], v[212:215], v[188:191]
  ds_read_b128 v[244:247], v43 offset:0
  v_mfma_f32_16x16x32_bf16 v[192:195], a[72:75], v[216:219], v[192:195]
  s_add_u32 m0, s33, 20480
  s_nop 0
  buffer_load_dwordx4 v24, s[16:19], s46 offen offset:0 lds
  ds_read_b128 v[248:251], v43 offset:2048
  v_mfma_f32_16x16x32_bf16 v[196:199], a[76:79], v[208:211], v[196:199]
  ds_read_b128 v[252:255], v43 offset:4096
  v_mfma_f32_16x16x32_bf16 v[200:203], a[76:79], v[212:215], v[200:203]
  buffer_load_dwordx4 v25, s[16:19], s46 offen offset:1024 lds
  ds_read_b64_tr_b16 a[104:105], v30 offset:0
  v_mfma_f32_16x16x32_bf16 v[204:207], a[76:79], v[216:219], v[204:207]
  ds_read_b64_tr_b16 a[106:107], v30 offset:512
  ds_read_b64_tr_b16 a[108:109], v31 offset:0
  v_mfma_f32_16x16x32_bf16 v[160:163], a[80:83], v[220:223], v[160:163]
  buffer_load_dwordx4 v26, s[16:19], s46 offen offset:2048 lds
  ds_read_b64_tr_b16 a[110:111], v31 offset:512
  v_mfma_f32_16x16x32_bf16 v[164:167], a[80:83], v[224:227], v[164:167]
  ds_read_b64_tr_b16 a[112:113], v28 offset:4096
  v_mfma_f32_16x16x32_bf16 v[168:171], a[80:83], v[228:231], v[168:171]
  buffer_load_dwordx4 v27, s[16:19], s46 offen offset:3072 lds
  s_add_u32 s36, s36, 524288
  s_cmp_eq_u32 s36, 3670016
  s_cselect_b32 s36, 0, s36
  ds_read_b64_tr_b16 a[114:115], v28 offset:4608
  v_mfma_f32_16x16x32_bf16 v[172:175], a[84:87], v[220:223], v[172:175]
  ds_read_b64_tr_b16 a[116:117], v29 offset:4096
  v_mfma_f32_16x16x32_bf16 v[176:179], a[84:87], v[224:227], v[176:179]
  ds_read_b64_tr_b16 a[118:119], v29 offset:4608
  v_mfma_f32_16x16x32_bf16 v[180:183], a[84:87], v[228:231], v[180:183]
  ds_read_b64_tr_b16 a[120:121], v30 offset:4096
  v_mfma_f32_16x16x32_bf16 v[184:187], a[88:91], v[220:223], v[184:187]
  ds_read_b64_tr_b16 a[122:123], v30 offset:4608
  v_mfma_f32_16x16x32_bf16 v[188:191], a[88:91], v[224:227], v[188:191]
  ds_read_b64_tr_b16 a[124:125], v31 offset:4096
  v_mfma_f32_16x16x32_bf16 v[192:195], a[88:91], v[228:231], v[192:195]
  ds_read_b64_tr_b16 a[126:127], v31 offset:4608
  v_mfma_f32_16x16x32_bf16 v[196:199], a[92:95], v[220:223], v[196:199]
  v_mfma_f32_16x16x32_bf16 v[200:203], a[92:95], v[224:227], v[200:203]
  v_mfma_f32_16x16x32_bf16 v[204:207], a[92:95], v[228:231], v[204:207]
  s_waitcnt lgkmcnt(0)
  v_mfma_f32_16x16x32_bf16 v[160:163], a[96:99], v[232:235], v[160:163]
  s_add_u32 m0, s33, 0
  s_add_u32 s46, s36, 262144
  buffer_load_dwordx4 v24, s[16:19], s36 offen offset:0 lds
  s_waitcnt vmcnt(9)
  v_mfma_f32_16x16x32_bf16 v[164:167], a[96:99], v[236:239], v[164:167]
  v_add_u32 v15, s42, v41
  s_add_u32 s42, s42, 6144
  s_cmp_eq_u32 s42, 43008
  s_cselect_b32 s42, 0, s42
  v_xor_b32 v43, 64, v15
  ds_read_b128 v[208:211], v15 offset:0
  ds_read_b64_tr_b16 a[128:129], v28 offset:8192
  v_mfma_f32_16x16x32_bf16 v[168:171], a[96:99], v[240:243], v[168:171]
  buffer_load_dwordx4 v25, s[16:19], s36 offen offset:1024 lds
  ds_read_b64_tr_b16 a[130:131], v28 offset:8704
  v_mfma_f32_16x16x32_bf16 v[172:175], a[100:103], v[232:235], v[172:175]
  ds_read_b128 v[212:215], v15 offset:2048
  v_mfma_f32_16x16x32_bf16 v[176:179], a[100:103], v[236:239], v[176:179]
  buffer_load_dwordx4 v26, s[16:19], s36 offen offset:2048 lds
  ds_read_b64_tr_b16 a[132:133], v29 offset:8192
  v_mfma_f32_16x16x32_bf16 v[180:183], a[100:103], v[240:243], v[180:183]
  ds_read_b64_tr_b16 a[134:135], v29 offset:8704
  v_mfma_f32_16x16x32_bf16 v[184:187], a[104:107], v[232:235], v[184:187]
  buffer_load_dwordx4 v27, s[16:19], s36 offen offset:3072 lds
  ds_read_b128 v[216:219], v15 offset:4096
  v_mfma_f32_16x16x32_bf16 v[188:191], a[104:107], v[236:239], v[188:191]
  ds_read_b128 v[220:223], v43 offset:0
  v_mfma_f32_16x16x32_bf16 v[192:195], a[104:107], v[240:243], v[192:195]
  s_add_u32 m0, s33, 4096
  s_nop 0
  buffer_load_dwordx4 v24, s[16:19], s46 offen offset:0 lds
  ds_read_b128 v[224:227], v43 offset:2048
  v_mfma_f32_16x16x32_bf16 v[196:199], a[108:111], v[232:235], v[196:199]
  ds_read_b128 v[228:231], v43 offset:4096
  v_mfma_f32_16x16x32_bf16 v[200:203], a[108:111], v[236:239], v[200:203]
  buffer_load_dwordx4 v25, s[16:19], s46 offen offset:1024 lds
  ds_read_b64_tr_b16 a[136:137], v30 offset:8192
  v_mfma_f32_16x16x32_bf16 v[204:207], a[108:111], v[240:243], v[204:207]
  ds_read_b64_tr_b16 a[138:139], v30 offset:8704
  ds_read_b64_tr_b16 a[140:141], v31 offset:8192
  v_mfma_f32_16x16x32_bf16 v[160:163], a[112:115], v[244:247], v[160:163]
  buffer_load_dwordx4 v26, s[16:19], s46 offen offset:2048 lds
  ds_read_b64_tr_b16 a[142:143], v31 offset:8704
  v_mfma_f32_16x16x32_bf16 v[164:167], a[112:115], v[248:251], v[164:167]
  ds_read_b64_tr_b16 a[144:145], v28 offset:12288
  v_mfma_f32_16x16x32_bf16 v[168:171], a[112:115], v[252:255], v[168:171]
  buffer_load_dwordx4 v27, s[16:19], s46 offen offset:3072 lds
  s_add_u32 s36, s36, 524288
  s_cmp_eq_u32 s36, 3670016
  s_cselect_b32 s36, 0, s36
  ds_read_b64_tr_b16 a[146:147], v28 offset:12800
  v_mfma_f32_16x16x32_bf16 v[172:175], a[116:119], v[244:247], v[172:175]
  ds_read_b64_tr_b16 a[148:149], v29 offset:12288
  v_mfma_f32_16x16x32_bf16 v[176:179], a[116:119], v[248:251], v[176:179]
  ds_read_b64_tr_b16 a[150:151], v29 offset:12800
  v_mfma_f32_16x16x32_bf16 v[180:183], a[116:119], v[252:255], v[180:183]
  ds_read_b64_tr_b16 a[152:153], v30 offset:12288
  v_mfma_f32_16x16x32_bf16 v[184:187], a[120:123], v[244:247], v[184:187]
  ds_read_b64_tr_b16 a[154:155], v30 offset:12800
  v_mfma_f32_16x16x32_bf16 v[188:191], a[120:123], v[248:251], v[188:191]
  ds_read_b64_tr_b16 a[156:157], v31 offset:12288
  v_mfma_f32_16x16x32_bf16 v[192:195], a[120:123], v[252:255], v[192:195]
  ds_read_b64_tr_b16 a[158:159], v31 offset:12800
  v_mfma_f32_16x16x32_bf16 v[196:199], a[124:127], v[244:247], v[196:199]
  v_mfma_f32_16x16x32_bf16 v[200:203], a[124:127], v[248:251], v[200:203]
  v_mfma_f32_16x16x32_bf16 v[204:207], a[124:127], v[252:255], v[204:207]
  s_waitcnt lgkmcnt(0)
  v_mfma_f32_16x16x32_bf16 v[160:163], a[128:131], v[208:211], v[160:163]
  s_waitcnt vmcnt(8)
  v_mfma_f32_16x16x32_bf16 v[164:167], a[128:131], v[212:215], v[164:167]
  v_add_u32 v15, s42, v41
  s_add_u32 s42, s42, 6144
  s_cmp_eq_u32 s42, 43008
  s_cselect_b32 s42, 0, s42
  v_xor_b32 v43, 64, v15
  ds_read_b128 v[232:235], v15 offset:0
  ds_read_b64_tr_b16 a[160:161], v28 offset:16384
  v_mfma_f32_16x16x32_bf16 v[168:171], a[128:131], v[216:219], v[168:171]
  ds_read_b64_tr_b16 a[162:163], v28 offset:16896
  v_mfma_f32_16x16x32_bf16 v[172:175], a[132:135], v[208:211], v[172:175]
  ds_read_b128 v[236:239], v15 offset:2048
  v_mfma_f32_16x16x32_bf16 v[176:179], a[132:135], v[212:215], v[176:179]
  ds_read_b64_tr_b16 a[164:165], v29 offset:16384
  v_mfma_f32_16x16x32_bf16 v[180:183], a[132:135], v[216:219], v[180:183]
  ds_read_b64_tr_b16 a[166:167], v29 offset:16896
  v_mfma_f32_16x16x32_bf16 v[184:187], a[136:139], v[208:211], v[184:187]
  ds_read_b128 v[240:243], v15 offset:4096
  v_mfma_f32_16x16x32_bf16 v[188:191], a[136:139], v[212:215], v[188:191]
  ds_read_b128 v[244:247], v43 offset:0
  v_mfma_f32_16x16x32_bf16 v[192:195], a[136:139], v[216:219], v[192:195]
  ds_read_b128 v[248:251], v43 offset:2048
  v_mfma_f32_16x16x32_bf16 v[196:199], a[140:143], v[208:211], v[196:199]
  ds_read_b128 v[252:255], v43 offset:4096
  v_mfma_f32_16x16x32_bf16 v[200:203], a[140:143], v[212:215], v[200:203]
  ds_read_b64_tr_b16 a[168:169], v30 offset:16384
  v_mfma_f32_16x16x32_bf16 v[204:207], a[140:143], v[216:219], v[204:207]
  ds_read_b64_tr_b16 a[170:171], v30 offset:16896
  ds_read_b64_tr_b16 a[172:173], v31 offset:16384
  v_mfma_f32_16x16x32_bf16 v[160:163], a[144:147], v[220:223], v[160:163]
  ds_read_b64_tr_b16 a[174:175], v31 offset:16896
  v_mfma_f32_16x16x32_bf16 v[164:167], a[144:147], v[224:227], v[164:167]
  ds_read_b64_tr_b16 a[176:177], v28 offset:20480
  v_mfma_f32_16x16x32_bf16 v[168:171], a[144:147], v[228:231], v[168:171]
  ds_read_b64_tr_b16 a[178:179], v28 offset:20992
  v_mfma_f32_16x16x32_bf16 v[172:175], a[148:151], v[220:223], v[172:175]
  ds_read_b64_tr_b16 a[180:181], v29 offset:20480
  v_mfma_f32_16x16x32_bf16 v[176:179], a[148:151], v[224:227], v[176:179]
  ds_read_b64_tr_b16 a[182:183], v29 offset:20992
  v_mfma_f32_16x16x32_bf16 v[180:183], a[148:151], v[228:231], v[180:183]
  ds_read_b64_tr_b16 a[184:185], v30 offset:20480
  v_mfma_f32_16x16x32_bf16 v[184:187], a[152:155], v[220:223], v[184:187]
  ds_read_b64_tr_b16 a[186:187], v30 offset:20992
  v_mfma_f32_16x16x32_bf16 v[188:191], a[152:155], v[224:227], v[188:191]
  ds_read_b64_tr_b16 a[188:189], v31 offset:20480
  v_mfma_f32_16x16x32_bf16 v[192:195], a[152:155], v[228:231], v[192:195]
  ds_read_b64_tr_b16 a[190:191], v31 offset:20992
  v_mfma_f32_16x16x32_bf16 v[196:199], a[156:159], v[220:223], v[196:199]
  v_mfma_f32_16x16x32_bf16 v[200:203], a[156:159], v[224:227], v[200:203]
  v_mfma_f32_16x16x32_bf16 v[204:207], a[156:159], v[228:231], v[204:207]
  s_waitcnt lgkmcnt(0)
  v_mfma_f32_16x16x32_bf16 v[160:163], a[160:163], v[232:235], v[160:163]
  s_waitcnt vmcnt(0)
  v_mfma_f32_16x16x32_bf16 v[164:167], a[160:163], v[236:239], v[164:167]
  v_add_u32 v15, s42, v41
  s_add_u32 s42, s42, 6144
  s_cmp_eq_u32 s42, 43008
  s_cselect_b32 s42, 0, s42
  v_xor_b32 v43, 64, v15
  ds_read_b128 v[208:211], v15 offset:0
  ds_read_b64_tr_b16 a[192:193], v28 offset:0
  v_mfma_f32_16x16x32_bf16 v[168:171], a[160:163], v[240:243], v[168:171]
  ds_read_b64_tr_b16 a[194:195], v28 offset:512
  v_mfma_f32_16x16x32_bf16 v[172:175], a[164:167], v[232:235], v[172:175]
  ds_read_b128 v[212:215], v15 offset:2048
  v_mfma_f32_16x16x32_bf16 v[176:179], a[164:167], v[236:239], v[176:179]
  ds_read_b64_tr_b16 a[196:197], v29 offset:0
  v_mfma_f32_16x16x32_bf16 v[180:183], a[164:167], v[240:243], v[180:183]
  ds_read_b64_tr_b16 a[198:199], v29 offset:512
  v_mfma_f32_16x16x32_bf16 v[184:187], a[168:171], v[232:235], v[184:187]
  ds_read_b128 v[216:219], v15 offset:4096
  v_mfma_f32_16x16x32_bf16 v[188:191], a[168:171], v[236:239], v[188:191]
  ds_read_b128 v[220:223], v43 offset:0
  v_mfma_f32_16x16x32_bf16 v[192:195], a[168:171], v[240:243], v[192:195]
  ds_read_b128 v[224:227], v43 offset:2048
  v_mfma_f32_16x16x32_bf16 v[196:199], a[172:175], v[232:235], v[196:199]
  ds_read_b128 v[228:231], v43 offset:4096
  v_mfma_f32_16x16x32_bf16 v[200:203], a[172:175], v[236:239], v[200:203]
  ds_read_b64_tr_b16 a[200:201], v30 offset:0
  v_mfma_f32_16x16x32_bf16 v[204:207], a[172:175], v[240:243], v[204:207]
  ds_read_b64_tr_b16 a[202:203], v30 offset:512
  ds_read_b64_tr_b16 a[204:205], v31 offset:0
  v_mfma_f32_16x16x32_bf16 v[160:163], a[176:179], v[244:247], v[160:163]
  ds_read_b64_tr_b16 a[206:207], v31 offset:512
  v_mfma_f32_16x16x32_bf16 v[164:167], a[176:179], v[248:251], v[164:167]
  ds_read_b64_tr_b16 a[208:209], v28 offset:4096
  v_mfma_f32_16x16x32_bf16 v[168:171], a[176:179], v[252:255], v[168:171]
  ds_read_b64_tr_b16 a[210:211], v28 offset:4608
  v_mfma_f32_16x16x32_bf16 v[172:175], a[180:183], v[244:247], v[172:175]
  ds_read_b64_tr_b16 a[212:213], v29 offset:4096
  v_mfma_f32_16x16x32_bf16 v[176:179], a[180:183], v[248:251], v[176:179]
  ds_read_b64_tr_b16 a[214:215], v29 offset:4608
  v_mfma_f32_16x16x32_bf16 v[180:183], a[180:183], v[252:255], v[180:183]
  ds_read_b64_tr_b16 a[216:217], v30 offset:4096
  v_mfma_f32_16x16x32_bf16 v[184:187], a[184:187], v[244:247], v[184:187]
  ds_read_b64_tr_b16 a[218:219], v30 offset:4608
  v_mfma_f32_16x16x32_bf16 v[188:191], a[184:187], v[248:251], v[188:191]
  ds_read_b64_tr_b16 a[220:221], v31 offset:4096
  v_mfma_f32_16x16x32_bf16 v[192:195], a[184:187], v[252:255], v[192:195]
  ds_read_b64_tr_b16 a[222:223], v31 offset:4608
  v_mfma_f32_16x16x32_bf16 v[196:199], a[188:191], v[244:247], v[196:199]
  v_mfma_f32_16x16x32_bf16 v[200:203], a[188:191], v[248:251], v[200:203]
  v_mfma_f32_16x16x32_bf16 v[204:207], a[188:191], v[252:255], v[204:207]
  s_waitcnt lgkmcnt(0)
  s_barrier
  s_mov_b32 s39, s32
  s_mul_i32 s40, s32, 7168
  s_add_u32 s40, s40, 344064
  s_lshl_b32 s41, s32, 10
  s_add_u32 m0, s41, 98304
  s_add_u32 s39, s39, 4
  buffer_load_dwordx4 v40, s[24:27], s40 offen lds
  s_cmp_ge_u32 s39, 6
  s_cselect_b32 s41, 6, 0
  s_cselect_b32 s44, 42880, 0
  s_sub_u32 s39, s39, s41
  s_add_u32 s40, s40, 28672
  s_sub_u32 s40, s40, s44
  s_add_u32 m0, m0, 4096
  s_add_u32 s39, s39, 4
  buffer_load_dwordx4 v40, s[24:27], s40 offen lds
  s_cmp_ge_u32 s39, 6
  s_cselect_b32 s41, 6, 0
  s_cselect_b32 s44, 42880, 0
  s_sub_u32 s39, s39, s41
  s_add_u32 s40, s40, 28672
  s_sub_u32 s40, s40, s44
  s_add_u32 m0, m0, 4096
  s_add_u32 s39, s39, 4
  buffer_load_dwordx4 v40, s[24:27], s40 offen lds
  s_cmp_ge_u32 s39, 6
  s_cselect_b32 s41, 6, 0
  s_cselect_b32 s44, 42880, 0
  s_sub_u32 s39, s39, s41
  s_add_u32 s40, s40, 28672
  s_sub_u32 s40, s40, s44
  s_add_u32 m0, m0, 4096
  s_add_u32 s39, s39, 4
  buffer_load_dwordx4 v40, s[24:27], s40 offen lds
  s_cmp_ge_u32 s39, 6
  s_cselect_b32 s41, 6, 0
  s_cselect_b32 s44, 42880, 0
  s_sub_u32 s39, s39, s41
  s_add_u32 s40, s40, 28672
  s_sub_u32 s40, s40, s44
  s_add_u32 m0, m0, 4096
  s_add_u32 s39, s39, 4
  buffer_load_dwordx4 v40, s[24:27], s40 offen lds
  s_cmp_ge_u32 s39, 6
  s_cselect_b32 s41, 6, 0
  s_cselect_b32 s44, 42880, 0
  s_sub_u32 s39, s39, s41
  s_add_u32 s40, s40, 28672
  s_sub_u32 s40, s40, s44
  s_add_u32 m0, m0, 4096
  s_add_u32 s39, s39, 4
  buffer_load_dwordx4 v40, s[24:27], s40 offen lds
  s_cmp_ge_u32 s39, 6
  s_cselect_b32 s41, 6, 0
  s_cselect_b32 s44, 42880, 0
  s_sub_u32 s39, s39, s41
  s_add_u32 s40, s40, 28672
  s_sub_u32 s40, s40, s44
  s_add_u32 m0, m0, 4096
  s_add_u32 s39, s39, 4
  buffer_load_dwordx4 v40, s[24:27], s40 offen lds
  s_cmp_ge_u32 s39, 6
  s_cselect_b32 s41, 6, 0
  s_cselect_b32 s44, 42880, 0
  s_sub_u32 s39, s39, s41
  s_add_u32 s40, s40, 28672
  s_sub_u32 s40, s40, s44
  s_add_u32 m0, m0, 4096
  s_add_u32 s39, s39, 4
  buffer_load_dwordx4 v40, s[24:27], s40 offen lds
  s_cmp_ge_u32 s39, 6
  s_cselect_b32 s41, 6, 0
  s_cselect_b32 s44, 42880, 0
  s_sub_u32 s39, s39, s41
  s_add_u32 s40, s40, 28672
  s_sub_u32 s40, s40, s44
  s_add_u32 m0, m0, 4096
  s_add_u32 s39, s39, 4
  buffer_load_dwordx4 v40, s[24:27], s40 offen lds
  s_cmp_ge_u32 s39, 6
  s_cselect_b32 s41, 6, 0
  s_cselect_b32 s44, 42880, 0
  s_sub_u32 s39, s39, s41
  s_add_u32 s40, s40, 28672
  s_sub_u32 s40, s40, s44
  s_add_u32 m0, m0, 4096
  s_add_u32 s39, s39, 4
  buffer_load_dwordx4 v40, s[24:27], s40 offen lds
  s_cmp_ge_u32 s39, 6
  s_cselect_b32 s41, 6, 0
  s_cselect_b32 s44, 42880, 0
  s_sub_u32 s39, s39, s41
  s_add_u32 s40, s40, 28672
  s_sub_u32 s40, s40, s44
  s_add_u32 m0, m0, 4096
  s_add_u32 s39, s39, 4
  buffer_load_dwordx4 v40, s[24:27], s40 offen lds
  s_add_u32 m0, s33, 8192
  s_add_u32 s46, s34, 256
  buffer_load_dwordx4 v16, s[8:11], s34 offen offset:0 nt lds
  buffer_load_dwordx4 v17, s[8:11], s34 offen offset:1024 nt lds
  buffer_load_dwordx4 v18, s[8:11], s34 offen offset:2048 nt lds
  buffer_load_dwordx4 v19, s[8:11], s34 offen offset:3072 nt lds
  v_mfma_f32_16x16x32_bf16 v[160:163], a[192:195], v[208:211], v[160:163]
  v_mfma_f32_16x16x32_bf16 v[164:167], a[192:195], v[212:215], v[164:167]
  v_mfma_f32_16x16x32_bf16 v[168:171], a[192:195], v[216:219], v[168:171]
  v_mfma_f32_16x16x32_bf16 v[172:175], a[196:199], v[208:211], v[172:175]
  v_mfma_f32_16x16x32_bf16 v[176:179], a[196:199], v[212:215], v[176:179]
  v_mfma_f32_16x16x32_bf16 v[180:183], a[196:199], v[216:219], v[180:183]
  v_mfma_f32_16x16x32_bf16 v[184:187], a[200:203], v[208:211], v[184:187]
  v_mfma_f32_16x16x32_bf16 v[188:191], a[200:203], v[212:215], v[188:191]
  v_mfma_f32_16x16x32_bf16 v[192:195], a[200:203], v[216:219], v[192:195]
  v_mfma_f32_16x16x32_bf16 v[196:199], a[204:207], v[208:211], v[196:199]
  v_mfma_f32_16x16x32_bf16 v[200:203], a[204:207], v[212:215], v[200:203]
  v_mfma_f32_16x16x32_bf16 v[204:207], a[204:207], v[216:219], v[204:207]
  v_mfma_f32_16x16x32_bf16 v[160:163], a[208:211], v[220:223], v[160:163]
  s_add_u32 m0, s33, 12288
  s_nop 0
  buffer_load_dwordx4 v16, s[8:11], s46 offen offset:0 nt lds
  v_mfma_f32_16x16x32_bf16 v[164:167], a[208:211], v[224:227], v[164:167]
  v_mfma_f32_16x16x32_bf16 v[168:171], a[208:211], v[228:231], v[168:171]
  v_mfma_f32_16x16x32_bf16 v[172:175], a[212:215], v[220:223], v[172:175]
  v_mfma_f32_16x16x32_bf16 v[176:179], a[212:215], v[224:227], v[176:179]
  v_mfma_f32_16x16x32_bf16 v[180:183], a[212:215], v[228:231], v[180:183]
  v_mfma_f32_16x16x32_bf16 v[184:187], a[216:219], v[220:223], v[184:187]
  v_mfma_f32_16x16x32_bf16 v[188:191], a[216:219], v[224:227], v[188:191]
  v_mfma_f32_16x16x32_bf16 v[192:195], a[216:219], v[228:231], v[192:195]
  v_mfma_f32_16x16x32_bf16 v[196:199], a[220:223], v[220:223], v[196:199]
  v_mfma_f32_16x16x32_bf16 v[200:203], a[220:223], v[224:227], v[200:203]
  v_mfma_f32_16x16x32_bf16 v[204:207], a[220:223], v[228:231], v[204:207]
  s_nop 5
  v_cvt_pk_bf16_f32 v160, v160, v161
  v_cvt_pk_bf16_f32 v161, v162, v163
  v_cvt_pk_bf16_f32 v164, v164, v165
  v_cvt_pk_bf16_f32 v165, v166, v167
  buffer_load_dwordx4 v17, s[8:11], s46 offen offset:1024 nt lds
  v_cvt_pk_bf16_f32 v168, v168, v169
  v_cvt_pk_bf16_f32 v169, v170, v171
  v_cvt_pk_bf16_f32 v172, v172, v173
  v_cvt_pk_bf16_f32 v173, v174, v175
  v_cvt_pk_bf16_f32 v176, v176, v177
  v_cvt_pk_bf16_f32 v177, v178, v179
  v_cvt_pk_bf16_f32 v180, v180, v181
  v_cvt_pk_bf16_f32 v181, v182, v183
  v_cvt_pk_bf16_f32 v184, v184, v185
  v_cvt_pk_bf16_f32 v185, v186, v187
  v_cvt_pk_bf16_f32 v188, v188, v189
  v_cvt_pk_bf16_f32 v189, v190, v191
  v_cvt_pk_bf16_f32 v192, v192, v193
  v_cvt_pk_bf16_f32 v193, v194, v195
  v_cvt_pk_bf16_f32 v196, v196, v197
  v_cvt_pk_bf16_f32 v197, v198, v199
  v_cvt_pk_bf16_f32 v200, v200, v201
  v_cvt_pk_bf16_f32 v201, v202, v203
  v_cvt_pk_bf16_f32 v204, v204, v205
  v_cvt_pk_bf16_f32 v205, v206, v207
  s_waitcnt vmcnt(6)
  s_barrier
  v_add_u32 v15, s42, v41
  s_add_u32 s42, s42, 6144
  s_cmp_eq_u32 s42, 43008
  s_cselect_b32 s42, 0, s42
  v_xor_b32 v43, 64, v15
  ds_read_b128 v[48:51], v15 offset:0
  ds_read_b128 v[52:55], v15 offset:2048
  ds_read_b128 v[56:59], v15 offset:4096
  s_waitcnt lgkmcnt(0)
  v_mfma_f32_16x16x32_bf16 v[208:211], a[0:3], v[48:51], 0
  ds_read_b128 v[60:63], v43 offset:0
  v_mfma_f32_16x16x32_bf16 v[212:215], a[0:3], v[52:55], 0
  buffer_load_dwordx4 v18, s[8:11], s46 offen offset:2048 nt lds
  v_mfma_f32_16x16x32_bf16 v[216:219], a[0:3], v[56:59], 0
  ds_read_b128 v[64:67], v43 offset:2048
  v_mfma_f32_16x16x32_bf16 v[220:223], a[4:7], v[48:51], 0
  v_mfma_f32_16x16x32_bf16 v[224:227], a[4:7], v[52:55], 0
  ds_read_b128 v[68:71], v43 offset:4096
  v_mfma_f32_16x16x32_bf16 v[228:231], a[4:7], v[56:59], 0
  v_mfma_f32_16x16x32_bf16 v[232:235], a[8:11], v[48:51], 0
  v_mfma_f32_16x16x32_bf16 v[236:239], a[8:11], v[52:55], 0
  v_mfma_f32_16x16x32_bf16 v[240:243], a[8:11], v[56:59], 0
  v_mfma_f32_16x16x32_bf16 v[244:247], a[12:15], v[48:51], 0
  v_mfma_f32_16x16x32_bf16 v[248:251], a[12:15], v[52:55], 0
  v_mfma_f32_16x16x32_bf16 v[252:255], a[12:15], v[56:59], 0
  s_waitcnt lgkmcnt(0)
  v_mfma_f32_16x16x32_bf16 v[208:211], a[16:19], v[60:63], v[208:211]
  v_add_u32 v15, s42, v41
  s_add_u32 s42, s42, 6144
  s_cmp_eq_u32 s42, 43008
  s_cselect_b32 s42, 0, s42
  v_xor_b32 v43, 64, v15
  ds_read_b128 v[48:51], v15 offset:0
  buffer_load_dwordx4 v19, s[8:11], s46 offen offset:3072 nt lds
  s_add_u32 s34, s34, 32768
  v_mfma_f32_16x16x32_bf16 v[212:215], a[16:19], v[64:67], v[212:215]
  v_mfma_f32_16x16x32_bf16 v[216:219], a[16:19], v[68:71], v[216:219]
  ds_read_b128 v[52:55], v15 offset:2048
  v_mfma_f32_16x16x32_bf16 v[220:223], a[20:23], v[60:63], v[220:223]
  v_mfma_f32_16x16x32_bf16 v[224:227], a[20:23], v[64:67], v[224:227]
  ds_read_b128 v[56:59], v15 offset:4096
  v_mfma_f32_16x16x32_bf16 v[228:231], a[20:23], v[68:71], v[228:231]
  v_mfma_f32_16x16x32_bf16 v[232:235], a[24:27], v[60:63], v[232:235]
  v_mfma_f32_16x16x32_bf16 v[236:239], a[24:27], v[64:67], v[236:239]
  v_mfma_f32_16x16x32_bf16 v[240:243], a[24:27], v[68:71], v[240:243]
  v_mfma_f32_16x16x32_bf16 v[244:247], a[28:31], v[60:63], v[244:247]
  v_mfma_f32_16x16x32_bf16 v[248:251], a[28:31], v[64:67], v[248:251]
  v_mfma_f32_16x16x32_bf16 v[252:255], a[28:31], v[68:71], v[252:255]
  s_waitcnt lgkmcnt(0)
  v_mfma_f32_16x16x32_bf16 v[208:211], a[32:35], v[48:51], v[208:211]
  s_add_u32 m0, s33, 16384
  s_add_u32 s46, s34, 256
  buffer_load_dwordx4 v16, s[8:11], s34 offen offset:0 nt lds
  ds_read_b128 v[60:63], v43 offset:0
  v_mfma_f32_16x16x32_bf16 v[212:215], a[32:35], v[52:55], v[212:215]
  v_mfma_f32_16x16x32_bf16 v[216:219], a[32:35], v[56:59], v[216:219]
  ds_read_b128 v[64:67], v43 offset:2048
  v_mfma_f32_16x16x32_bf16 v[220:223], a[36:39], v[48:51], v[220:223]
  v_mfma_f32_16x16x32_bf16 v[224:227], a[36:39], v[52:55], v[224:227]
  ds_read_b128 v[68:71], v43 offset:4096
  v_mfma_f32_16x16x32_bf16 v[228:231], a[36:39], v[56:59], v[228:231]
  v_mfma_f32_16x16x32_bf16 v[232:235], a[40:43], v[48:51], v[232:235]
  v_mfma_f32_16x16x32_bf16 v[236:239], a[40:43], v[52:55], v[236:239]
  v_mfma_f32_16x16x32_bf16 v[240:243], a[40:43], v[56:59], v[240:243]
  v_mfma_f32_16x16x32_bf16 v[244:247], a[44:47], v[48:51], v[244:247]
  v_mfma_f32_16x16x32_bf16 v[248:251], a[44:47], v[52:55], v[248:251]
  v_mfma_f32_16x16x32_bf16 v[252:255], a[44:47], v[56:59], v[252:255]
  s_waitcnt lgkmcnt(0)
  v_mfma_f32_16x16x32_bf16 v[208:211], a[48:51], v[60:63], v[208:211]
  buffer_load_dwordx4 v17, s[8:11], s34 offen offset:1024 nt lds
  v_add_u32 v15, s42, v41
  s_add_u32 s42, s42, 6144
  s_cmp_eq_u32 s42, 43008
  s_cselect_b32 s42, 0, s42
  v_xor_b32 v43, 64, v15
  ds_read_b128 v[48:51], v15 offset:0
  v_mfma_f32_16x16x32_bf16 v[212:215], a[48:51], v[64:67], v[212:215]
  v_mfma_f32_16x16x32_bf16 v[216:219], a[48:51], v[68:71], v[216:219]
  ds_read_b128 v[52:55], v15 offset:2048
  v_mfma_f32_16x16x32_bf16 v[220:223], a[52:55], v[60:63], v[220:223]
  v_mfma_f32_16x16x32_bf16 v[224:227], a[52:55], v[64:67], v[224:227]
  ds_read_b128 v[56:59], v15 offset:4096
  v_mfma_f32_16x16x32_bf16 v[228:231], a[52:55], v[68:71], v[228:231]
  v_mfma_f32_16x16x32_bf16 v[232:235], a[56:59], v[60:63], v[232:235]
  v_mfma_f32_16x16x32_bf16 v[236:239], a[56:59], v[64:67], v[236:239]
  v_mfma_f32_16x16x32_bf16 v[240:243], a[56:59], v[68:71], v[240:243]
  v_mfma_f32_16x16x32_bf16 v[244:247], a[60:63], v[60:63], v[244:247]
  v_mfma_f32_16x16x32_bf16 v[248:251], a[60:63], v[64:67], v[248:251]
  v_mfma_f32_16x16x32_bf16 v[252:255], a[60:63], v[68:71], v[252:255]
  buffer_load_dwordx4 v18, s[8:11], s34 offen offset:2048 nt lds
  s_waitcnt lgkmcnt(0)
  v_mfma_f32_16x16x32_bf16 v[208:211], a[64:67], v[48:51], v[208:211]
  ds_read_b128 v[60:63], v43 offset:0
  v_mfma_f32_16x16x32_bf16 v[212:215], a[64:67], v[52:55], v[212:215]
  v_mfma_f32_16x16x32_bf16 v[216:219], a[64:67], v[56:59], v[216:219]
  ds_read_b128 v[64:67], v43 offset:2048
  v_mfma_f32_16x16x32_bf16 v[220:223], a[68:71], v[48:51], v[220:223]
  v_mfma_f32_16x16x32_bf16 v[224:227], a[68:71], v[52:55], v[224:227]
  ds_read_b128 v[68:71], v43 offset:4096
  v_mfma_f32_16x16x32_bf16 v[228:231], a[68:71], v[56:59], v[228:231]
  v_mfma_f32_16x16x32_bf16 v[232:235], a[72:75], v[48:51], v[232:235]
  v_mfma_f32_16x16x32_bf16 v[236:239], a[72:75], v[52:55], v[236:239]
  v_mfma_f32_16x16x32_bf16 v[240:243], a[72:75], v[56:59], v[240:243]
  v_mfma_f32_16x16x32_bf16 v[244:247], a[76:79], v[48:51], v[244:247]
  v_mfma_f32_16x16x32_bf16 v[248:251], a[76:79], v[52:55], v[248:251]
  v_mfma_f32_16x16x32_bf16 v[252:255], a[76:79], v[56:59], v[252:255]
  buffer_load_dwordx4 v19, s[8:11], s34 offen offset:3072 nt lds
  s_waitcnt lgkmcnt(0)
  v_mfma_f32_16x16x32_bf16 v[208:211], a[80:83], v[60:63], v[208:211]
  v_add_u32 v15, s42, v41
  s_add_u32 s42, s42, 6144
  s_cmp_eq_u32 s42, 43008
  s_cselect_b32 s42, 0, s42
  v_xor_b32 v43, 64, v15
  ds_read_b128 v[48:51], v15 offset:0
  v_mfma_f32_16x16x32_bf16 v[212:215], a[80:83], v[64:67], v[212:215]
  v_mfma_f32_16x16x32_bf16 v[216:219], a[80:83], v[68:71], v[216:219]
  ds_read_b128 v[52:55], v15 offset:2048
  v_mfma_f32_16x16x32_bf16 v[220:223], a[84:87], v[60:63], v[220:223]
  v_mfma_f32_16x16x32_bf16 v[224:227], a[84:87], v[64:67], v[224:227]
  ds_read_b128 v[56:59], v15 offset:4096
  v_mfma_f32_16x16x32_bf16 v[228:231], a[84:87], v[68:71], v[228:231]
  v_mfma_f32_16x16x32_bf16 v[232:235], a[88:91], v[60:63], v[232:235]
  v_mfma_f32_16x16x32_bf16 v[236:239], a[88:91], v[64:67], v[236:239]
  v_mfma_f32_16x16x32_bf16 v[240:243], a[88:91], v[68:71], v[240:243]
  v_mfma_f32_16x16x32_bf16 v[244:247], a[92:95], v[60:63], v[244:247]
  v_mfma_f32_16x16x32_bf16 v[248:251], a[92:95], v[64:67], v[248:251]
  s_add_u32 m0, s33, 20480
  s_nop 0
  buffer_load_dwordx4 v16, s[8:11], s46 offen offset:0 nt lds
  v_mfma_f32_16x16x32_bf16 v[252:255], a[92:95], v[68:71], v[252:255]
  s_waitcnt lgkmcnt(0)
  v_mfma_f32_16x16x32_bf16 v[208:211], a[96:99], v[48:51], v[208:211]
  ds_read_b128 v[60:63], v43 offset:0
  v_mfma_f32_16x16x32_bf16 v[212:215], a[96:99], v[52:55], v[212:215]
  v_mfma_f32_16x16x32_bf16 v[216:219], a[96:99], v[56:59], v[216:219]
  ds_read_b128 v[64:67], v43 offset:2048
  v_mfma_f32_16x16x32_bf16 v[220:223], a[100:103], v[48:51], v[220:223]
  v_mfma_f32_16x16x32_bf16 v[224:227], a[100:103], v[52:55], v[224:227]
  ds_read_b128 v[68:71], v43 offset:4096
  v_mfma_f32_16x16x32_bf16 v[228:231], a[100:103], v[56:59], v[228:231]
  v_mfma_f32_16x16x32_bf16 v[232:235], a[104:107], v[48:51], v[232:235]
  v_mfma_f32_16x16x32_bf16 v[236:239], a[104:107], v[52:55], v[236:239]
  v_mfma_f32_16x16x32_bf16 v[240:243], a[104:107], v[56:59], v[240:243]
  v_mfma_f32_16x16x32_bf16 v[244:247], a[108:111], v[48:51], v[244:247]
  v_mfma_f32_16x16x32_bf16 v[248:251], a[108:111], v[52:55], v[248:251]
  buffer_load_dwordx4 v17, s[8:11], s46 offen offset:1024 nt lds
  v_mfma_f32_16x16x32_bf16 v[252:255], a[108:111], v[56:59], v[252:255]
  s_waitcnt lgkmcnt(0)
  v_mfma_f32_16x16x32_bf16 v[208:211], a[112:115], v[60:63], v[208:211]
  v_add_u32 v15, s42, v41
  s_add_u32 s42, s42, 6144
  s_cmp_eq_u32 s42, 43008
  s_cselect_b32 s42, 0, s42
  v_xor_b32 v43, 64, v15
  ds_read_b128 v[48:51], v15 offset:0
  v_mfma_f32_16x16x32_bf16 v[212:215], a[112:115], v[64:67], v[212:215]
  v_mfma_f32_16x16x32_bf16 v[216:219], a[112:115], v[68:71], v[216:219]
  ds_read_b128 v[52:55], v15 offset:2048
  v_mfma_f32_16x16x32_bf16 v[220:223], a[116:119], v[60:63], v[220:223]
  v_mfma_f32_16x16x32_bf16 v[224:227], a[116:119], v[64:67], v[224:227]
  ds_read_b128 v[56:59], v15 offset:4096
  v_mfma_f32_16x16x32_bf16 v[228:231], a[116:119], v[68:71], v[228:231]
  v_mfma_f32_16x16x32_bf16 v[232:235], a[120:123], v[60:63], v[232:235]
  v_mfma_f32_16x16x32_bf16 v[236:239], a[120:123], v[64:67], v[236:239]
  v_mfma_f32_16x16x32_bf16 v[240:243], a[120:123], v[68:71], v[240:243]
  v_mfma_f32_16x16x32_bf16 v[244:247], a[124:127], v[60:63], v[244:247]
  buffer_load_dwordx4 v18, s[8:11], s46 offen offset:2048 nt lds
  v_mfma_f32_16x16x32_bf16 v[248:251], a[124:127], v[64:67], v[248:251]
  v_mfma_f32_16x16x32_bf16 v[252:255], a[124:127], v[68:71], v[252:255]
  s_waitcnt lgkmcnt(0)
  v_mfma_f32_16x16x32_bf16 v[208:211], a[128:131], v[48:51], v[208:211]
  ds_read_b128 v[60:63], v43 offset:0
  v_mfma_f32_16x16x32_bf16 v[212:215], a[128:131], v[52:55], v[212:215]
  v_mfma_f32_16x16x32_bf16 v[216:219], a[128:131], v[56:59], v[216:219]
  ds_read_b128 v[64:67], v43 offset:2048
  v_mfma_f32_16x16x32_bf16 v[220:223], a[132:135], v[48:51], v[220:223]
  v_mfma_f32_16x16x32_bf16 v[224:227], a[132:135], v[52:55], v[224:227]
  ds_read_b128 v[68:71], v43 offset:4096
  v_mfma_f32_16x16x32_bf16 v[228:231], a[132:135], v[56:59], v[228:231]
  v_mfma_f32_16x16x32_bf16 v[232:235], a[136:139], v[48:51], v[232:235]
  v_mfma_f32_16x16x32_bf16 v[236:239], a[136:139], v[52:55], v[236:239]
  v_mfma_f32_16x16x32_bf16 v[240:243], a[136:139], v[56:59], v[240:243]
  v_mfma_f32_16x16x32_bf16 v[244:247], a[140:143], v[48:51], v[244:247]
  buffer_load_dwordx4 v19, s[8:11], s46 offen offset:3072 nt lds
  s_add_u32 s34, s34, 32768
  v_mfma_f32_16x16x32_bf16 v[248:251], a[140:143], v[52:55], v[248:251]
  v_mfma_f32_16x16x32_bf16 v[252:255], a[140:143], v[56:59], v[252:255]
  s_waitcnt lgkmcnt(0)
  v_mfma_f32_16x16x32_bf16 v[208:211], a[144:147], v[60:63], v[208:211]
  v_add_u32 v15, s42, v41
  s_add_u32 s42, s42, 6144
  s_cmp_eq_u32 s42, 43008
  s_cselect_b32 s42, 0, s42
  v_xor_b32 v43, 64, v15
  ds_read_b128 v[48:51], v15 offset:0
  v_mfma_f32_16x16x32_bf16 v[212:215], a[144:147], v[64:67], v[212:215]
  v_mfma_f32_16x16x32_bf16 v[216:219], a[144:147], v[68:71], v[216:219]
  ds_read_b128 v[52:55], v15 offset:2048
  v_mfma_f32_16x16x32_bf16 v[220:223], a[148:151], v[60:63], v[220:223]
  v_mfma_f32_16x16x32_bf16 v[224:227], a[148:151], v[64:67], v[224:227]
  ds_read_b128 v[56:59], v15 offset:4096
  v_mfma_f32_16x16x32_bf16 v[228:231], a[148:151], v[68:71], v[228:231]
  v_mfma_f32_16x16x32_bf16 v[232:235], a[152:155], v[60:63], v[232:235]
  v_mfma_f32_16x16x32_bf16 v[236:239], a[152:155], v[64:67], v[236:239]
  v_mfma_f32_16x16x32_bf16 v[240:243], a[152:155], v[68:71], v[240:243]
  s_add_u32 m0, s33, 0
  s_add_u32 s46, s34, 256
  buffer_load_dwordx4 v16, s[8:11], s34 offen offset:0 nt lds
  v_mfma_f32_16x16x32_bf16 v[244:247], a[156:159], v[60:63], v[244:247]
  v_mfma_f32_16x16x32_bf16 v[248:251], a[156:159], v[64:67], v[248:251]
  v_mfma_f32_16x16x32_bf16 v[252:255], a[156:159], v[68:71], v[252:255]
  s_waitcnt lgkmcnt(0)
  v_mfma_f32_16x16x32_bf16 v[208:211], a[160:163], v[48:51], v[208:211]
  ds_read_b128 v[60:63], v43 offset:0
  v_mfma_f32_16x16x32_bf16 v[212:215], a[160:163], v[52:55], v[212:215]
  v_mfma_f32_16x16x32_bf16 v[216:219], a[160:163], v[56:59], v[216:219]
  ds_read_b128 v[64:67], v43 offset:2048
  v_mfma_f32_16x16x32_bf16 v[220:223], a[164:167], v[48:51], v[220:223]
  v_mfma_f32_16x16x32_bf16 v[224:227], a[164:167], v[52:55], v[224:227]
  ds_read_b128 v[68:71], v43 offset:4096
  v_mfma_f32_16x16x32_bf16 v[228:231], a[164:167], v[56:59], v[228:231]
  v_mfma_f32_16x16x32_bf16 v[232:235], a[168:171], v[48:51], v[232:235]
  v_mfma_f32_16x16x32_bf16 v[236:239], a[168:171], v[52:55], v[236:239]
  v_mfma_f32_16x16x32_bf16 v[240:243], a[168:171], v[56:59], v[240:243]
  buffer_load_dwordx4 v17, s[8:11], s34 offen offset:1024 nt lds
  v_mfma_f32_16x16x32_bf16 v[244:247], a[172:175], v[48:51], v[244:247]
  v_mfma_f32_16x16x32_bf16 v[248:251], a[172:175], v[52:55], v[248:251]
  v_mfma_f32_16x16x32_bf16 v[252:255], a[172:175], v[56:59], v[252:255]
  s_waitcnt lgkmcnt(0)
  v_mfma_f32_16x16x32_bf16 v[208:211], a[176:179], v[60:63], v[208:211]
  v_add_u32 v15, s42, v41
  s_add_u32 s42, s42, 6144
  s_cmp_eq_u32 s42, 43008
  s_cselect_b32 s42, 0, s42
  v_xor_b32 v43, 64, v15
  ds_read_b128 v[48:51], v15 offset:0
  v_mfma_f32_16x16x32_bf16 v[212:215], a[176:179], v[64:67], v[212:215]
  v_mfma_f32_16x16x32_bf16 v[216:219], a[176:179], v[68:71], v[216:219]
  ds_read_b128 v[52:55], v15 offset:2048
  v_mfma_f32_16x16x32_bf16 v[220:223], a[180:183], v[60:63], v[220:223]
  v_mfma_f32_16x16x32_bf16 v[224:227], a[180:183], v[64:67], v[224:227]
  ds_read_b128 v[56:59], v15 offset:4096
  v_mfma_f32_16x16x32_bf16 v[228:231], a[180:183], v[68:71], v[228:231]
  v_mfma_f32_16x16x32_bf16 v[232:235], a[184:187], v[60:63], v[232:235]
  v_mfma_f32_16x16x32_bf16 v[236:239], a[184:187], v[64:67], v[236:239]
  buffer_load_dwordx4 v18, s[8:11], s34 offen offset:2048 nt lds
  v_mfma_f32_16x16x32_bf16 v[240:243], a[184:187], v[68:71], v[240:243]
  v_mfma_f32_16x16x32_bf16 v[244:247], a[188:191], v[60:63], v[244:247]
  v_mfma_f32_16x16x32_bf16 v[248:251], a[188:191], v[64:67], v[248:251]
  v_mfma_f32_16x16x32_bf16 v[252:255], a[188:191], v[68:71], v[252:255]
  s_waitcnt lgkmcnt(0)
  v_mfma_f32_16x16x32_bf16 v[208:211], a[192:195], v[48:51], v[208:211]
  ds_read_b128 v[60:63], v43 offset:0
  v_mfma_f32_16x16x32_bf16 v[212:215], a[192:195], v[52:55], v[212:215]
  v_mfma_f32_16x16x32_bf16 v[216:219], a[192:195], v[56:59], v[216:219]
  ds_read_b128 v[64:67], v43 offset:2048
  v_mfma_f32_16x16x32_bf16 v[220:223], a[196:199], v[48:51], v[220:223]
  v_mfma_f32_16x16x32_bf16 v[224:227], a[196:199], v[52:55], v[224:227]
  ds_read_b128 v[68:71], v43 offset:4096
  v_mfma_f32_16x16x32_bf16 v[228:231], a[196:199], v[56:59], v[228:231]
  v_mfma_f32_16x16x32_bf16 v[232:235], a[200:203], v[48:51], v[232:235]
  v_mfma_f32_16x16x32_bf16 v[236:239], a[200:203], v[52:55], v[236:239]
  buffer_load_dwordx4 v19, s[8:11], s34 offen offset:3072 nt lds
  v_mfma_f32_16x16x32_bf16 v[240:243], a[200:203], v[56:59], v[240:243]
  v_mfma_f32_16x16x32_bf16 v[244:247], a[204:207], v[48:51], v[244:247]
  v_mfma_f32_16x16x32_bf16 v[248:251], a[204:207], v[52:55], v[248:251]
  v_mfma_f32_16x16x32_bf16 v[252:255], a[204:207], v[56:59], v[252:255]
  s_waitcnt lgkmcnt(0)
  s_barrier
  v_mfma_f32_16x16x32_bf16 v[208:211], a[208:211], v[60:63], v[208:211]
  ds_write_b64 v42, v[160:161] offset:0
  v_mfma_f32_16x16x32_bf16 v[212:215], a[208:211], v[64:67], v[212:215]
  ds_write_b64 v42, v[164:165] offset:1024
  v_mfma_f32_16x16x32_bf16 v[216:219], a[208:211], v[68:71], v[216:219]
  ds_write_b64 v42, v[168:169] offset:2048
  v_mfma_f32_16x16x32_bf16 v[220:223], a[212:215], v[60:63], v[220:223]
  s_add_u32 m0, s33, 4096
  s_nop 0
  buffer_load_dwordx4 v16, s[8:11], s46 offen offset:0 nt lds
  ds_write_b64 v42, v[172:173] offset:512
  v_mfma_f32_16x16x32_bf16 v[224:227], a[212:215], v[64:67], v[224:227]
  ds_write_b64 v42, v[176:177] offset:1536
  v_mfma_f32_16x16x32_bf16 v[228:231], a[212:215], v[68:71], v[228:231]
  ds_write_b64 v42, v[180:181] offset:2560
  v_mfma_f32_16x16x32_bf16 v[232:235], a[216:219], v[60:63], v[232:235]
  ds_write_b64 v42, v[184:185] offset:3072
  v_mfma_f32_16x16x32_bf16 v[236:239], a[216:219], v[64:67], v[236:239]
  ds_write_b64 v42, v[188:189] offset:4096
  v_mfma_f32_16x16x32_bf16 v[240:243], a[216:219], v[68:71], v[240:243]
  ds_write_b64 v42, v[192:193] offset:5120
  v_mfma_f32_16x16x32_bf16 v[244:247], a[220:223], v[60:63], v[244:247]
  ds_write_b64 v42, v[196:197] offset:3584
  v_mfma_f32_16x16x32_bf16 v[248:251], a[220:223], v[64:67], v[248:251]
  ds_write_b64 v42, v[200:201] offset:4608
  v_mfma_f32_16x16x32_bf16 v[252:255], a[220:223], v[68:71], v[252:255]
  ds_write_b64 v42, v[204:205] offset:5632
  s_nop 7
  v_cvt_pk_bf16_f32 v208, v208, v209
  v_cvt_pk_bf16_f32 v209, v210, v211
  buffer_load_dwordx4 v17, s[8:11], s46 offen offset:1024 nt lds
  v_cvt_pk_bf16_f32 v212, v212, v213
  v_cvt_pk_bf16_f32 v213, v214, v215
  v_cvt_pk_bf16_f32 v216, v216, v217
  v_cvt_pk_bf16_f32 v217, v218, v219
  v_cvt_pk_bf16_f32 v220, v220, v221
  v_cvt_pk_bf16_f32 v221, v222, v223
  v_cvt_pk_bf16_f32 v224, v224, v225
  v_cvt_pk_bf16_f32 v225, v226, v227
  v_cvt_pk_bf16_f32 v228, v228, v229
  v_cvt_pk_bf16_f32 v229, v230, v231
  v_cvt_pk_bf16_f32 v232, v232, v233
  v_cvt_pk_bf16_f32 v233, v234, v235
  v_cvt_pk_bf16_f32 v236, v236, v237
  v_cvt_pk_bf16_f32 v237, v238, v239
  v_cvt_pk_bf16_f32 v240, v240, v241
  v_cvt_pk_bf16_f32 v241, v242, v243
  v_cvt_pk_bf16_f32 v244, v244, v245
  v_cvt_pk_bf16_f32 v245, v246, v247
  v_cvt_pk_bf16_f32 v248, v248, v249
  v_cvt_pk_bf16_f32 v249, v250, v251
  v_cvt_pk_bf16_f32 v252, v252, v253
  v_cvt_pk_bf16_f32 v253, v254, v255
  v_accvgpr_write_b32 a224, v208
  v_accvgpr_write_b32 a225, v209
  v_accvgpr_write_b32 a226, v212
  v_accvgpr_write_b32 a227, v213
  v_accvgpr_write_b32 a228, v216
  v_accvgpr_write_b32 a229, v217
  v_accvgpr_write_b32 a230, v220
  v_accvgpr_write_b32 a231, v221
  v_accvgpr_write_b32 a232, v224
  v_accvgpr_write_b32 a233, v225
  v_accvgpr_write_b32 a234, v228
  v_accvgpr_write_b32 a235, v229
  v_accvgpr_write_b32 a236, v232
  v_accvgpr_write_b32 a237, v233
  v_accvgpr_write_b32 a238, v236
  v_accvgpr_write_b32 a239, v237
  v_accvgpr_write_b32 a240, v240
  v_accvgpr_write_b32 a241, v241
  v_accvgpr_write_b32 a242, v244
  v_accvgpr_write_b32 a243, v245
  v_accvgpr_write_b32 a244, v248
  v_accvgpr_write_b32 a245, v249
  v_accvgpr_write_b32 a246, v252
  v_accvgpr_write_b32 a247, v253
  s_lshl_b32 s39, s7, 12
  s_add_u32 s39, s39, 21037056
  s_add_u32 s24, s58, s39
  s_addc_u32 s25, s59, 0
  s_mov_b32 s26, 4096
  s_mov_b32 s27, 0x20000
  s_waitcnt lgkmcnt(0)
  buffer_load_dwordx4 v18, s[8:11], s46 offen offset:2048 nt lds
  s_barrier
  ds_read_b128 v[80:83], v3 offset:0
  ds_read_b128 v[84:87], v3 offset:1024
  ds_read_b128 v[88:91], v3 offset:2048
  ds_read_b128 v[92:95], v3 offset:3072
  ds_read_b128 v[96:99], v3 offset:4096
  ds_read_b128 v[100:103], v3 offset:5120
  ds_read_b128 v[104:107], v3 offset:6144
  ds_read_b128 v[108:111], v3 offset:7168
  ds_read_b128 v[112:115], v3 offset:8192
  buffer_load_dwordx4 v19, s[8:11], s46 offen offset:3072 nt lds
  s_add_u32 s34, s34, 32768
  ds_read_b128 v[116:119], v3 offset:9216
  ds_read_b128 v[120:123], v3 offset:10240
  ds_read_b128 v[124:127], v3 offset:11264
  s_waitcnt lgkmcnt(0)
  ds_read_b128 v[128:131], v3 offset:12288
  ds_read_b128 v[132:135], v3 offset:13312
  ds_read_b128 v[136:139], v3 offset:14336
  ds_read_b128 v[140:143], v3 offset:15360
  ds_read_b128 v[144:147], v3 offset:16384
  ds_read_b128 v[148:151], v3 offset:17408
  ds_read_b128 v[152:155], v3 offset:18432
  ds_read_b128 v[156:159], v3 offset:19456
  ds_read_b128 v[24:27], v3 offset:20480
  ds_read_b128 v[28:31], v3 offset:21504
  ds_read_b128 a[248:251], v3 offset:22528
  ds_read_b128 a[252:255], v3 offset:23552
  s_waitcnt lgkmcnt(0)
  s_waitcnt vmcnt(16)
  ds_read_b128 v[48:51], v20 offset:8192
  ds_read_b128 v[52:55], v21 offset:8192
  ds_read_b128 v[56:59], v22 offset:8192
  ds_read_b128 v[60:63], v23 offset:8192
  ds_read_b128 v[64:67], v20 offset:12288
  ds_read_b128 v[68:71], v21 offset:12288
  ds_read_b128 v[72:75], v22 offset:12288
  ds_read_b128 v[76:79], v23 offset:12288
  s_waitcnt lgkmcnt(7)
  v_mfma_f32_16x16x32_bf16 v[160:163], v[48:51], v[80:83], 0
  v_mfma_f32_16x16x32_bf16 v[164:167], v[48:51], v[84:87], 0
  v_mfma_f32_16x16x32_bf16 v[168:171], v[48:51], v[88:91], 0
  s_waitcnt lgkmcnt(6)
  v_mfma_f32_16x16x32_bf16 v[160:163], v[52:55], v[92:95], v[160:163]
  v_mfma_f32_16x16x32_bf16 v[164:167], v[52:55], v[96:99], v[164:167]
  v_mfma_f32_16x16x32_bf16 v[168:171], v[52:55], v[100:103], v[168:171]
  s_waitcnt lgkmcnt(5)
  v_mfma_f32_16x16x32_bf16 v[160:163], v[56:59], v[104:107], v[160:163]
  v_mfma_f32_16x16x32_bf16 v[164:167], v[56:59], v[108:111], v[164:167]
  v_mfma_f32_16x16x32_bf16 v[168:171], v[56:59], v[112:115], v[168:171]
  s_waitcnt lgkmcnt(4)
  v_mfma_f32_16x16x32_bf16 v[160:163], v[60:63], v[116:119], v[160:163]
  v_mfma_f32_16x16x32_bf16 v[164:167], v[60:63], v[120:123], v[164:167]
  v_mfma_f32_16x16x32_bf16 v[168:171], v[60:63], v[124:127], v[168:171]
  s_waitcnt lgkmcnt(3)
  v_mfma_f32_16x16x32_bf16 v[160:163], v[64:67], v[128:131], v[160:163]
  v_mfma_f32_16x16x32_bf16 v[164:167], v[64:67], v[132:135], v[164:167]
  v_mfma_f32_16x16x32_bf16 v[168:171], v[64:67], v[136:139], v[168:171]
  s_waitcnt lgkmcnt(2)
  v_mfma_f32_16x16x32_bf16 v[160:163], v[68:71], v[140:143], v[160:163]
  v_mfma_f32_16x16x32_bf16 v[164:167], v[68:71], v[144:147], v[164:167]
  v_mfma_f32_16x16x32_bf16 v[168:171], v[68:71], v[148:151], v[168:171]
  s_waitcnt lgkmcnt(1)
  v_mfma_f32_16x16x32_bf16 v[160:163], v[72:75], v[152:155], v[160:163]
  v_mfma_f32_16x16x32_bf16 v[164:167], v[72:75], v[156:159], v[164:167]
  v_mfma_f32_16x16x32_bf16 v[168:171], v[72:75], v[24:27], v[168:171]
  s_waitcnt lgkmcnt(0)
  v_mfma_f32_16x16x32_bf16 v[160:163], v[76:79], v[28:31], v[160:163]
  s_add_u32 m0, s33, 8192
  s_add_u32 s46, s34, 256
  buffer_load_dwordx4 v16, s[8:11], s34 offen offset:0 nt lds
  v_mfma_f32_16x16x32_bf16 v[164:167], v[76:79], a[248:251], v[164:167]
  v_mfma_f32_16x16x32_bf16 v[168:171], v[76:79], a[252:255], v[168:171]
  s_waitcnt vmcnt(9)
  ds_read_b128 v[48:51], v20 offset:16384
  ds_read_b128 v[52:55], v21 offset:16384
  ds_read_b128 v[56:59], v22 offset:16384
  ds_read_b128 v[60:63], v23 offset:16384
  ds_read_b128 v[64:67], v20 offset:20480
  ds_read_b128 v[68:71], v21 offset:20480
  ds_read_b128 v[72:75], v22 offset:20480
  ds_read_b128 v[76:79], v23 offset:20480
  s_waitcnt lgkmcnt(7)
  v_mfma_f32_16x16x32_bf16 v[172:175], v[48:51], v[80:83], 0
  v_mfma_f32_16x16x32_bf16 v[176:179], v[48:51], v[84:87], 0
  v_mfma_f32_16x16x32_bf16 v[180:183], v[48:51], v[88:91], 0
  s_waitcnt lgkmcnt(6)
  v_mfma_f32_16x16x32_bf16 v[172:175], v[52:55], v[92:95], v[172:175]
  v_mfma_f32_16x16x32_bf16 v[176:179], v[52:55], v[96:99], v[176:179]
  v_mfma_f32_16x16x32_bf16 v[180:183], v[52:55], v[100:103], v[180:183]
  s_waitcnt lgkmcnt(5)
  v_mfma_f32_16x16x32_bf16 v[172:175], v[56:59], v[104:107], v[172:175]
  buffer_load_dwordx4 v17, s[8:11], s34 offen offset:1024 nt lds
  v_mfma_f32_16x16x32_bf16 v[176:179], v[56:59], v[108:111], v[176:179]
  v_mfma_f32_16x16x32_bf16 v[180:183], v[56:59], v[112:115], v[180:183]
  s_waitcnt lgkmcnt(4)
  v_mfma_f32_16x16x32_bf16 v[172:175], v[60:63], v[116:119], v[172:175]
  v_mfma_f32_16x16x32_bf16 v[176:179], v[60:63], v[120:123], v[176:179]
  v_mfma_f32_16x16x32_bf16 v[180:183], v[60:63], v[124:127], v[180:183]
  s_waitcnt lgkmcnt(3)
  v_mfma_f32_16x16x32_bf16 v[172:175], v[64:67], v[128:131], v[172:175]
  v_mfma_f32_16x16x32_bf16 v[176:179], v[64:67], v[132:135], v[176:179]
  buffer_load_dwordx4 v18, s[8:11], s34 offen offset:2048 nt lds
  v_mfma_f32_16x16x32_bf16 v[180:183], v[64:67], v[136:139], v[180:183]
  s_waitcnt lgkmcnt(2)
  v_mfma_f32_16x16x32_bf16 v[172:175], v[68:71], v[140:143], v[172:175]
  v_mfma_f32_16x16x32_bf16 v[176:179], v[68:71], v[144:147], v[176:179]
  v_mfma_f32_16x16x32_bf16 v[180:183], v[68:71], v[148:151], v[180:183]
  s_waitcnt lgkmcnt(1)
  v_mfma_f32_16x16x32_bf16 v[172:175], v[72:75], v[152:155], v[172:175]
  v_mfma_f32_16x16x32_bf16 v[176:179], v[72:75], v[156:159], v[176:179]
  v_mfma_f32_16x16x32_bf16 v[180:183], v[72:75], v[24:27], v[180:183]
  buffer_load_dwordx4 v19, s[8:11], s34 offen offset:3072 nt lds
  s_waitcnt lgkmcnt(0)
  v_mfma_f32_16x16x32_bf16 v[172:175], v[76:79], v[28:31], v[172:175]
  v_mfma_f32_16x16x32_bf16 v[176:179], v[76:79], a[248:251], v[176:179]
  v_mfma_f32_16x16x32_bf16 v[180:183], v[76:79], a[252:255], v[180:183]
  s_add_u32 m0, s33, 12288
  s_nop 0
  buffer_load_dwordx4 v16, s[8:11], s46 offen offset:0 nt lds
  buffer_load_dwordx4 v17, s[8:11], s46 offen offset:1024 nt lds
  buffer_load_dwordx4 v18, s[8:11], s46 offen offset:2048 nt lds
  buffer_load_dwordx4 v19, s[8:11], s46 offen offset:3072 nt lds
  s_add_u32 s34, s34, 32768
  s_waitcnt vmcnt(8)
  ds_read_b128 v[48:51], v20 offset:0
  ds_read_b128 v[52:55], v21 offset:0
  ds_read_b128 v[56:59], v22 offset:0
  ds_read_b128 v[60:63], v23 offset:0
  ds_read_b128 v[64:67], v20 offset:4096
  ds_read_b128 v[68:71], v21 offset:4096
  ds_read_b128 v[72:75], v22 offset:4096
  ds_read_b128 v[76:79], v23 offset:4096
  s_waitcnt lgkmcnt(7)
  v_mfma_f32_16x16x32_bf16 v[184:187], v[48:51], v[80:83], 0
  v_mfma_f32_16x16x32_bf16 v[188:191], v[48:51], v[84:87], 0
  v_mfma_f32_16x16x32_bf16 v[192:195], v[48:51], v[88:91], 0
  s_waitcnt lgkmcnt(6)
  v_mfma_f32_16x16x32_bf16 v[184:187], v[52:55], v[92:95], v[184:187]
  v_mfma_f32_16x16x32_bf16 v[188:191], v[52:55], v[96:99], v[188:191]
  v_mfma_f32_16x16x32_bf16 v[192:195], v[52:55], v[100:103], v[192:195]
  s_waitcnt lgkmcnt(5)
  v_mfma_f32_16x16x32_bf16 v[184:187], v[56:59], v[104:107], v[184:187]
  s_add_u32 m0, s33, 16384
  s_add_u32 s46, s34, 256
  buffer_load_dwordx4 v16, s[8:11], s34 offen offset:0 nt lds
  v_mfma_f32_16x16x32_bf16 v[188:191], v[56:59], v[108:111], v[188:191]
  v_mfma_f32_16x16x32_bf16 v[192:195], v[56:59], v[112:115], v[192:195]
  s_waitcnt lgkmcnt(4)
  v_mfma_f32_16x16x32_bf16 v[184:187], v[60:63], v[116:119], v[184:187]
  v_mfma_f32_16x16x32_bf16 v[188:191], v[60:63], v[120:123], v[188:191]
  v_mfma_f32_16x16x32_bf16 v[192:195], v[60:63], v[124:127], v[192:195]
  s_waitcnt lgkmcnt(3)
  v_mfma_f32_16x16x32_bf16 v[184:187], v[64:67], v[128:131], v[184:187]
  v_mfma_f32_16x16x32_bf16 v[188:191], v[64:67], v[132:135], v[188:191]
  buffer_load_dwordx4 v17, s[8:11], s34 offen offset:1024 nt lds
  v_mfma_f32_16x16x32_bf16 v[192:195], v[64:67], v[136:139], v[192:195]
  s_waitcnt lgkmcnt(2)
  v_mfma_f32_16x16x32_bf16 v[184:187], v[68:71], v[140:143], v[184:187]
  v_mfma_f32_16x16x32_bf16 v[188:191], v[68:71], v[144:147], v[188:191]
  v_mfma_f32_16x16x32_bf16 v[192:195], v[68:71], v[148:151], v[192:195]
  s_waitcnt lgkmcnt(1)
  v_mfma_f32_16x16x32_bf16 v[184:187], v[72:75], v[152:155], v[184:187]
  v_mfma_f32_16x16x32_bf16 v[188:191], v[72:75], v[156:159], v[188:191]
  v_mfma_f32_16x16x32_bf16 v[192:195], v[72:75], v[24:27], v[192:195]
  buffer_load_dwordx4 v18, s[8:11], s34 offen offset:2048 nt lds
  s_waitcnt lgkmcnt(0)
  v_mfma_f32_16x16x32_bf16 v[184:187], v[76:79], v[28:31], v[184:187]
  v_mfma_f32_16x16x32_bf16 v[188:191], v[76:79], a[248:251], v[188:191]
  v_mfma_f32_16x16x32_bf16 v[192:195], v[76:79], a[252:255], v[192:195]
  buffer_load_dwordx4 v19, s[8:11], s34 offen offset:3072 nt lds
  s_add_u32 m0, s33, 20480
  s_nop 0
  buffer_load_dwordx4 v16, s[8:11], s46 offen offset:0 nt lds
  buffer_load_dwordx4 v17, s[8:11], s46 offen offset:1024 nt lds
  buffer_load_dwordx4 v18, s[8:11], s46 offen offset:2048 nt lds
  buffer_load_dwordx4 v19, s[8:11], s46 offen offset:3072 nt lds
  s_add_u32 s34, s34, 32768
  s_waitcnt vmcnt(8)
  ds_read_b128 v[48:51], v20 offset:8192
  ds_read_b128 v[52:55], v21 offset:8192
  ds_read_b128 v[56:59], v22 offset:8192
  ds_read_b128 v[60:63], v23 offset:8192
  ds_read_b128 v[64:67], v20 offset:12288
  ds_read_b128 v[68:71], v21 offset:12288
  ds_read_b128 v[72:75], v22 offset:12288
  ds_read_b128 v[76:79], v23 offset:12288
  s_waitcnt lgkmcnt(7)
  v_mfma_f32_16x16x32_bf16 v[196:199], v[48:51], v[80:83], 0
  v_mfma_f32_16x16x32_bf16 v[200:203], v[48:51], v[84:87], 0
  v_mfma_f32_16x16x32_bf16 v[204:207], v[48:51], v[88:91], 0
  s_waitcnt lgkmcnt(6)
  v_mfma_f32_16x16x32_bf16 v[196:199], v[52:55], v[92:95], v[196:199]
  v_mfma_f32_16x16x32_bf16 v[200:203], v[52:55], v[96:99], v[200:203]
  v_mfma_f32_16x16x32_bf16 v[204:207], v[52:55], v[100:103], v[204:207]
  s_waitcnt lgkmcnt(5)
  v_mfma_f32_16x16x32_bf16 v[196:199], v[56:59], v[104:107], v[196:199]
  s_add_u32 m0, s33, 0
  s_add_u32 s46, s34, 256
  buffer_load_dwordx4 v16, s[8:11], s34 offen offset:0 nt lds
  v_mfma_f32_16x16x32_bf16 v[200:203], v[56:59], v[108:111], v[200:203]
  v_mfma_f32_16x16x32_bf16 v[204:207], v[56:59], v[112:115], v[204:207]
  s_waitcnt lgkmcnt(4)
  v_mfma_f32_16x16x32_bf16 v[196:199], v[60:63], v[116:119], v[196:199]
  v_mfma_f32_16x16x32_bf16 v[200:203], v[60:63], v[120:123], v[200:203]
  v_mfma_f32_16x16x32_bf16 v[204:207], v[60:63], v[124:127], v[204:207]
  s_waitcnt lgkmcnt(3)
  v_mfma_f32_16x16x32_bf16 v[196:199], v[64:67], v[128:131], v[196:199]
  v_mfma_f32_16x16x32_bf16 v[200:203], v[64:67], v[132:135], v[200:203]
  buffer_load_dwordx4 v17, s[8:11], s34 offen offset:1024 nt lds
  v_mfma_f32_16x16x32_bf16 v[204:207], v[64:67], v[136:139], v[204:207]
  s_waitcnt lgkmcnt(2)
  v_mfma_f32_16x16x32_bf16 v[196:199], v[68:71], v[140:143], v[196:199]
  v_mfma_f32_16x16x32_bf16 v[200:203], v[68:71], v[144:147], v[200:203]
  v_mfma_f32_16x16x32_bf16 v[204:207], v[68:71], v[148:151], v[204:207]
  s_waitcnt lgkmcnt(1)
  v_mfma_f32_16x16x32_bf16 v[196:199], v[72:75], v[152:155], v[196:199]
  v_mfma_f32_16x16x32_bf16 v[200:203], v[72:75], v[156:159], v[200:203]
  v_mfma_f32_16x16x32_bf16 v[204:207], v[72:75], v[24:27], v[204:207]
  buffer_load_dwordx4 v18, s[8:11], s34 offen offset:2048 nt lds
  s_waitcnt lgkmcnt(0)
  v_mfma_f32_16x16x32_bf16 v[196:199], v[76:79], v[28:31], v[196:199]
  v_mfma_f32_16x16x32_bf16 v[200:203], v[76:79], a[248:251], v[200:203]
  v_mfma_f32_16x16x32_bf16 v[204:207], v[76:79], a[252:255], v[204:207]
  buffer_load_dwordx4 v19, s[8:11], s34 offen offset:3072 nt lds
  s_add_u32 m0, s33, 4096
  s_nop 0
  buffer_load_dwordx4 v16, s[8:11], s46 offen offset:0 nt lds
  buffer_load_dwordx4 v17, s[8:11], s46 offen offset:1024 nt lds
  buffer_load_dwordx4 v18, s[8:11], s46 offen offset:2048 nt lds
  buffer_load_dwordx4 v19, s[8:11], s46 offen offset:3072 nt lds
  s_add_u32 s34, s34, 32768
  s_waitcnt vmcnt(8)
  ds_read_b128 v[48:51], v20 offset:16384
  ds_read_b128 v[52:55], v21 offset:16384
  ds_read_b128 v[56:59], v22 offset:16384
  ds_read_b128 v[60:63], v23 offset:16384
  ds_read_b128 v[64:67], v20 offset:20480
  ds_read_b128 v[68:71], v21 offset:20480
  ds_read_b128 v[72:75], v22 offset:20480
  ds_read_b128 v[76:79], v23 offset:20480
  s_waitcnt lgkmcnt(7)
  v_mfma_f32_16x16x32_bf16 v[208:211], v[48:51], v[80:83], 0
  v_mfma_f32_16x16x32_bf16 v[212:215], v[48:51], v[84:87], 0
  v_mfma_f32_16x16x32_bf16 v[216:219], v[48:51], v[88:91], 0
  s_waitcnt lgkmcnt(6)
  v_mfma_f32_16x16x32_bf16 v[208:211], v[52:55], v[92:95], v[208:211]
  v_mfma_f32_16x16x32_bf16 v[212:215], v[52:55], v[96:99], v[212:215]
  v_mfma_f32_16x16x32_bf16 v[216:219], v[52:55], v[100:103], v[216:219]
  s_waitcnt lgkmcnt(5)
  v_mfma_f32_16x16x32_bf16 v[208:211], v[56:59], v[104:107], v[208:211]
  s_add_u32 m0, s33, 8192
  s_add_u32 s46, s34, 256
  buffer_load_dwordx4 v16, s[8:11], s34 offen offset:0 nt lds
  v_mfma_f32_16x16x32_bf16 v[212:215], v[56:59], v[108:111], v[212:215]
  v_mfma_f32_16x16x32_bf16 v[216:219], v[56:59], v[112:115], v[216:219]
  s_waitcnt lgkmcnt(4)
  v_mfma_f32_16x16x32_bf16 v[208:211], v[60:63], v[116:119], v[208:211]
  v_mfma_f32_16x16x32_bf16 v[212:215], v[60:63], v[120:123], v[212:215]
  v_mfma_f32_16x16x32_bf16 v[216:219], v[60:63], v[124:127], v[216:219]
  s_waitcnt lgkmcnt(3)
  v_mfma_f32_16x16x32_bf16 v[208:211], v[64:67], v[128:131], v[208:211]
  v_mfma_f32_16x16x32_bf16 v[212:215], v[64:67], v[132:135], v[212:215]
  buffer_load_dwordx4 v17, s[8:11], s34 offen offset:1024 nt lds
  v_mfma_f32_16x16x32_bf16 v[216:219], v[64:67], v[136:139], v[216:219]
  s_waitcnt lgkmcnt(2)
  v_mfma_f32_16x16x32_bf16 v[208:211], v[68:71], v[140:143], v[208:211]
  v_mfma_f32_16x16x32_bf16 v[212:215], v[68:71], v[144:147], v[212:215]
  v_mfma_f32_16x16x32_bf16 v[216:219], v[68:71], v[148:151], v[216:219]
  s_waitcnt lgkmcnt(1)
  v_mfma_f32_16x16x32_bf16 v[208:211], v[72:75], v[152:155], v[208:211]
  v_mfma_f32_16x16x32_bf16 v[212:215], v[72:75], v[156:159], v[212:215]
  v_mfma_f32_16x16x32_bf16 v[216:219], v[72:75], v[24:27], v[216:219]
  buffer_load_dwordx4 v18, s[8:11], s34 offen offset:2048 nt lds
  s_waitcnt lgkmcnt(0)
  v_mfma_f32_16x16x32_bf16 v[208:211], v[76:79], v[28:31], v[208:211]
  v_mfma_f32_16x16x32_bf16 v[212:215], v[76:79], a[248:251], v[212:215]
  v_mfma_f32_16x16x32_bf16 v[216:219], v[76:79], a[252:255], v[216:219]
  buffer_load_dwordx4 v19, s[8:11], s34 offen offset:3072 nt lds
  s_add_u32 m0, s33, 12288
  s_nop 0
  buffer_load_dwordx4 v16, s[8:11], s46 offen offset:0 nt lds
  buffer_load_dwordx4 v17, s[8:11], s46 offen offset:1024 nt lds
  buffer_load_dwordx4 v18, s[8:11], s46 offen offset:2048 nt lds
  buffer_load_dwordx4 v19, s[8:11], s46 offen offset:3072 nt lds
  s_add_u32 s34, s34, 32768
  s_waitcnt vmcnt(8)
  ds_read_b128 v[48:51], v20 offset:0
  ds_read_b128 v[52:55], v21 offset:0
  ds_read_b128 v[56:59], v22 offset:0
  ds_read_b128 v[60:63], v23 offset:0
  ds_read_b128 v[64:67], v20 offset:4096
  ds_read_b128 v[68:71], v21 offset:4096
  ds_read_b128 v[72:75], v22 offset:4096
  ds_read_b128 v[76:79], v23 offset:4096
  s_waitcnt lgkmcnt(7)
  v_mfma_f32_16x16x32_bf16 v[220:223], v[48:51], v[80:83], 0
  v_mfma_f32_16x16x32_bf16 v[224:227], v[48:51], v[84:87], 0
  v_mfma_f32_16x16x32_bf16 v[228:231], v[48:51], v[88:91], 0
  s_waitcnt lgkmcnt(6)
  v_mfma_f32_16x16x32_bf16 v[220:223], v[52:55], v[92:95], v[220:223]
  v_mfma_f32_16x16x32_bf16 v[224:227], v[52:55], v[96:99], v[224:227]
  v_mfma_f32_16x16x32_bf16 v[228:231], v[52:55], v[100:103], v[228:231]
  s_waitcnt lgkmcnt(5)
  v_mfma_f32_16x16x32_bf16 v[220:223], v[56:59], v[104:107], v[220:223]
  s_add_u32 m0, s33, 16384
  s_add_u32 s46, s34, 256
  buffer_load_dwordx4 v16, s[8:11], s34 offen offset:0 nt lds
  v_mfma_f32_16x16x32_bf16 v[224:227], v[56:59], v[108:111], v[224:227]
  v_mfma_f32_16x16x32_bf16 v[228:231], v[56:59], v[112:115], v[228:231]
  s_waitcnt lgkmcnt(4)
  v_mfma_f32_16x16x32_bf16 v[220:223], v[60:63], v[116:119], v[220:223]
  v_mfma_f32_16x16x32_bf16 v[224:227], v[60:63], v[120:123], v[224:227]
  v_mfma_f32_16x16x32_bf16 v[228:231], v[60:63], v[124:127], v[228:231]
  s_waitcnt lgkmcnt(3)
  v_mfma_f32_16x16x32_bf16 v[220:223], v[64:67], v[128:131], v[220:223]
  v_mfma_f32_16x16x32_bf16 v[224:227], v[64:67], v[132:135], v[224:227]
  buffer_load_dwordx4 v17, s[8:11], s34 offen offset:1024 nt lds
  v_mfma_f32_16x16x32_bf16 v[228:231], v[64:67], v[136:139], v[228:231]
  s_waitcnt lgkmcnt(2)
  v_mfma_f32_16x16x32_bf16 v[220:223], v[68:71], v[140:143], v[220:223]
  v_mfma_f32_16x16x32_bf16 v[224:227], v[68:71], v[144:147], v[224:227]
  v_mfma_f32_16x16x32_bf16 v[228:231], v[68:71], v[148:151], v[228:231]
  s_waitcnt lgkmcnt(1)
  v_mfma_f32_16x16x32_bf16 v[220:223], v[72:75], v[152:155], v[220:223]
  v_mfma_f32_16x16x32_bf16 v[224:227], v[72:75], v[156:159], v[224:227]
  v_mfma_f32_16x16x32_bf16 v[228:231], v[72:75], v[24:27], v[228:231]
  buffer_load_dwordx4 v18, s[8:11], s34 offen offset:2048 nt lds
  s_waitcnt lgkmcnt(0)
  v_mfma_f32_16x16x32_bf16 v[220:223], v[76:79], v[28:31], v[220:223]
  v_mfma_f32_16x16x32_bf16 v[224:227], v[76:79], a[248:251], v[224:227]
  v_mfma_f32_16x16x32_bf16 v[228:231], v[76:79], a[252:255], v[228:231]
  buffer_load_dwordx4 v19, s[8:11], s34 offen offset:3072 nt lds
  s_add_u32 m0, s33, 20480
  s_nop 0
  buffer_load_dwordx4 v16, s[8:11], s46 offen offset:0 nt lds
  buffer_load_dwordx4 v17, s[8:11], s46 offen offset:1024 nt lds
  buffer_load_dwordx4 v18, s[8:11], s46 offen offset:2048 nt lds
  buffer_load_dwordx4 v19, s[8:11], s46 offen offset:3072 nt lds
  s_add_u32 s34, s34, 33325056
  s_waitcnt vmcnt(8)
  ds_read_b128 v[48:51], v20 offset:8192
  ds_read_b128 v[52:55], v21 offset:8192
  ds_read_b128 v[56:59], v22 offset:8192
  ds_read_b128 v[60:63], v23 offset:8192
  ds_read_b128 v[64:67], v20 offset:12288
  ds_read_b128 v[68:71], v21 offset:12288
  ds_read_b128 v[72:75], v22 offset:12288
  ds_read_b128 v[76:79], v23 offset:12288
  s_waitcnt lgkmcnt(7)
  v_mfma_f32_16x16x32_bf16 v[232:235], v[48:51], v[80:83], 0
  v_mfma_f32_16x16x32_bf16 v[236:239], v[48:51], v[84:87], 0
  v_mfma_f32_16x16x32_bf16 v[240:243], v[48:51], v[88:91], 0
  s_waitcnt lgkmcnt(6)
  v_mfma_f32_16x16x32_bf16 v[232:235], v[52:55], v[92:95], v[232:235]
  v_mfma_f32_16x16x32_bf16 v[236:239], v[52:55], v[96:99], v[236:239]
  v_mfma_f32_16x16x32_bf16 v[240:243], v[52:55], v[100:103], v[240:243]
  s_waitcnt lgkmcnt(5)
  v_mfma_f32_16x16x32_bf16 v[232:235], v[56:59], v[104:107], v[232:235]
  s_add_u32 m0, s33, 0
  s_add_u32 s46, s35, 32768
  buffer_load_dwordx4 v4, s[12:15], s35 offen offset:0 nt lds
  v_mfma_f32_16x16x32_bf16 v[236:239], v[56:59], v[108:111], v[236:239]
  v_mfma_f32_16x16x32_bf16 v[240:243], v[56:59], v[112:115], v[240:243]
  s_waitcnt lgkmcnt(4)
  v_mfma_f32_16x16x32_bf16 v[232:235], v[60:63], v[116:119], v[232:235]
  v_mfma_f32_16x16x32_bf16 v[236:239], v[60:63], v[120:123], v[236:239]
  v_mfma_f32_16x16x32_bf16 v[240:243], v[60:63], v[124:127], v[240:243]
  s_waitcnt lgkmcnt(3)
  v_mfma_f32_16x16x32_bf16 v[232:235], v[64:67], v[128:131], v[232:235]
  v_mfma_f32_16x16x32_bf16 v[236:239], v[64:67], v[132:135], v[236:239]
  buffer_load_dwordx4 v5, s[12:15], s35 offen offset:1024 nt lds
  v_mfma_f32_16x16x32_bf16 v[240:243], v[64:67], v[136:139], v[240:243]
  s_waitcnt lgkmcnt(2)
  v_mfma_f32_16x16x32_bf16 v[232:235], v[68:71], v[140:143], v[232:235]
  v_mfma_f32_16x16x32_bf16 v[236:239], v[68:71], v[144:147], v[236:239]
  v_mfma_f32_16x16x32_bf16 v[240:243], v[68:71], v[148:151], v[240:243]
  s_waitcnt lgkmcnt(1)
  v_mfma_f32_16x16x32_bf16 v[232:235], v[72:75], v[152:155], v[232:235]
  v_mfma_f32_16x16x32_bf16 v[236:239], v[72:75], v[156:159], v[236:239]
  v_mfma_f32_16x16x32_bf16 v[240:243], v[72:75], v[24:27], v[240:243]
  buffer_load_dwordx4 v6, s[12:15], s35 offen offset:2048 nt lds
  s_waitcnt lgkmcnt(0)
  v_mfma_f32_16x16x32_bf16 v[232:235], v[76:79], v[28:31], v[232:235]
  v_mfma_f32_16x16x32_bf16 v[236:239], v[76:79], a[248:251], v[236:239]
  v_mfma_f32_16x16x32_bf16 v[240:243], v[76:79], a[252:255], v[240:243]
  buffer_load_dwordx4 v7, s[12:15], s35 offen offset:3072 nt lds
  s_add_u32 m0, s33, 4096
  s_nop 0
  buffer_load_dwordx4 v4, s[12:15], s46 offen offset:0 nt lds
  buffer_load_dwordx4 v5, s[12:15], s46 offen offset:1024 nt lds
  buffer_load_dwordx4 v6, s[12:15], s46 offen offset:2048 nt lds
  buffer_load_dwordx4 v7, s[12:15], s46 offen offset:3072 nt lds
  s_add_u32 s35, s35, 16384
  s_waitcnt vmcnt(8)
  ds_read_b128 v[48:51], v20 offset:16384
  ds_read_b128 v[52:55], v21 offset:16384
  ds_read_b128 v[56:59], v22 offset:16384
  ds_read_b128 v[60:63], v23 offset:16384
  ds_read_b128 v[64:67], v20 offset:20480
  ds_read_b128 v[68:71], v21 offset:20480
  ds_read_b128 v[72:75], v22 offset:20480
  ds_read_b128 v[76:79], v23 offset:20480
  s_waitcnt lgkmcnt(7)
  v_mfma_f32_16x16x32_bf16 v[244:247], v[48:51], v[80:83], 0
  v_mfma_f32_16x16x32_bf16 v[248:251], v[48:51], v[84:87], 0
  v_mfma_f32_16x16x32_bf16 v[252:255], v[48:51], v[88:91], 0
  s_waitcnt lgkmcnt(6)
  v_mfma_f32_16x16x32_bf16 v[244:247], v[52:55], v[92:95], v[244:247]
  v_mfma_f32_16x16x32_bf16 v[248:251], v[52:55], v[96:99], v[248:251]
  v_mfma_f32_16x16x32_bf16 v[252:255], v[52:55], v[100:103], v[252:255]
  s_waitcnt lgkmcnt(5)
  v_mfma_f32_16x16x32_bf16 v[244:247], v[56:59], v[104:107], v[244:247]
  s_add_u32 m0, s33, 8192
  s_add_u32 s46, s35, 32768
  buffer_load_dwordx4 v4, s[12:15], s35 offen offset:0 nt lds
  v_mfma_f32_16x16x32_bf16 v[248:251], v[56:59], v[108:111], v[248:251]
  v_mfma_f32_16x16x32_bf16 v[252:255], v[56:59], v[112:115], v[252:255]
  s_waitcnt lgkmcnt(4)
  v_mfma_f32_16x16x32_bf16 v[244:247], v[60:63], v[116:119], v[244:247]
  v_mfma_f32_16x16x32_bf16 v[248:251], v[60:63], v[120:123], v[248:251]
  v_mfma_f32_16x16x32_bf16 v[252:255], v[60:63], v[124:127], v[252:255]
  s_waitcnt lgkmcnt(3)
  v_mfma_f32_16x16x32_bf16 v[244:247], v[64:67], v[128:131], v[244:247]
  v_mfma_f32_16x16x32_bf16 v[248:251], v[64:67], v[132:135], v[248:251]
  buffer_load_dwordx4 v5, s[12:15], s35 offen offset:1024 nt lds
  v_mfma_f32_16x16x32_bf16 v[252:255], v[64:67], v[136:139], v[252:255]
  s_waitcnt lgkmcnt(2)
  v_mfma_f32_16x16x32_bf16 v[244:247], v[68:71], v[140:143], v[244:247]
  v_mfma_f32_16x16x32_bf16 v[248:251], v[68:71], v[144:147], v[248:251]
  v_mfma_f32_16x16x32_bf16 v[252:255], v[68:71], v[148:151], v[252:255]
  s_waitcnt lgkmcnt(1)
  v_mfma_f32_16x16x32_bf16 v[244:247], v[72:75], v[152:155], v[244:247]
  v_mfma_f32_16x16x32_bf16 v[248:251], v[72:75], v[156:159], v[248:251]
  v_mfma_f32_16x16x32_bf16 v[252:255], v[72:75], v[24:27], v[252:255]
  buffer_load_dwordx4 v6, s[12:15], s35 offen offset:2048 nt lds
  s_waitcnt lgkmcnt(0)
  v_mfma_f32_16x16x32_bf16 v[244:247], v[76:79], v[28:31], v[244:247]
  v_mfma_f32_16x16x32_bf16 v[248:251], v[76:79], a[248:251], v[248:251]
  v_mfma_f32_16x16x32_bf16 v[252:255], v[76:79], a[252:255], v[252:255]
  s_nop 7
  v_max3_f32 v48, v160, v161, v162
  v_max3_f32 v50, v164, v165, v166
  v_max3_f32 v52, v168, v169, v170
  v_max3_f32 v48, v48, v163, v172
  v_max3_f32 v50, v50, v167, v176
  v_max3_f32 v52, v52, v171, v180
  v_max3_f32 v48, v48, v173, v174
  v_max3_f32 v50, v50, v177, v178
  v_max3_f32 v52, v52, v181, v182
  v_max3_f32 v48, v48, v175, v184
  v_max3_f32 v50, v50, v179, v188
  v_max3_f32 v52, v52, v183, v192
  v_max3_f32 v48, v48, v185, v186
  buffer_load_dwordx4 v7, s[12:15], s35 offen offset:3072 nt lds
  v_max3_f32 v50, v50, v189, v190
  v_max3_f32 v52, v52, v193, v194
  v_max3_f32 v48, v48, v187, v196
  v_max3_f32 v50, v50, v191, v200
  v_max3_f32 v52, v52, v195, v204
  v_max3_f32 v48, v48, v197, v198
  v_max3_f32 v50, v50, v201, v202
  v_max3_f32 v52, v52, v205, v206
  v_max3_f32 v48, v48, v199, v208
  v_max3_f32 v50, v50, v203, v212
  v_max3_f32 v52, v52, v207, v216
  v_max3_f32 v48, v48, v209, v210
  v_max3_f32 v50, v50, v213, v214
  v_max3_f32 v52, v52, v217, v218
  v_max3_f32 v48, v48, v211, v220
  v_max3_f32 v50, v50, v215, v224
  v_max3_f32 v52, v52, v219, v228
  v_max3_f32 v48, v48, v221, v222
  v_max3_f32 v50, v50, v225, v226
  v_max3_f32 v52, v52, v229, v230
  v_max3_f32 v48, v48, v223, v232
  v_max3_f32 v50, v50, v227, v236
  v_max3_f32 v52, v52, v231, v240
  v_max3_f32 v48, v48, v233, v234
  v_max3_f32 v50, v50, v237, v238
  v_max3_f32 v52, v52, v241, v242
  v_max3_f32 v48, v48, v235, v244
  v_max3_f32 v50, v50, v239, v248
  s_add_u32 m0, s33, 12288
  s_nop 0
  buffer_load_dwordx4 v4, s[12:15], s46 offen offset:0 nt lds
  v_max3_f32 v52, v52, v243, v252
  v_max3_f32 v48, v48, v245, v246
  v_max3_f32 v50, v50, v249, v250
  v_max3_f32 v52, v52, v253, v254
  v_max_f32 v48, v48, v247
  v_max_f32 v50, v50, v251
  v_max_f32 v52, v52, v255
  v_mov_b32 v49, v48
  v_mov_b32 v51, v50
  v_mov_b32 v53, v52
  s_nop 1
  v_permlane32_swap_b32 v49, v48
  v_permlane32_swap_b32 v51, v50
  v_permlane32_swap_b32 v53, v52
  s_nop 1
  v_max_f32 v48, v48, v49
  v_max_f32 v50, v50, v51
  v_max_f32 v52, v52, v53
  v_mov_b32 v49, v48
  v_mov_b32 v51, v50
  v_mov_b32 v53, v52
  s_nop 1
  v_permlane16_swap_b32 v49, v48
  v_permlane16_swap_b32 v51, v50
  v_permlane16_swap_b32 v53, v52
  s_nop 1
  v_max_f32 v48, v48, v49
  buffer_load_dwordx4 v5, s[12:15], s46 offen offset:1024 nt lds
  v_max_f32 v50, v50, v51
  v_max_f32 v52, v52, v53
  ds_write_b32 v13, v48 offset:0
  ds_write_b32 v13, v50 offset:256
  ds_write_b32 v13, v52 offset:512
  s_waitcnt lgkmcnt(0)
  s_barrier
  buffer_load_dwordx4 v6, s[12:15], s46 offen offset:2048 nt lds
  ds_read_b128 v[60:63], v14 offset:0
  ds_read_b128 v[64:67], v14 offset:256
  ds_read_b128 v[68:71], v14 offset:512
  s_waitcnt lgkmcnt(0)
  v_max3_f32 v48, v60, v61, v62
  v_max3_f32 v50, v64, v65, v66
  v_max3_f32 v52, v68, v69, v70
  v_max_f32 v48, v48, v63
  v_max_f32 v50, v50, v67
  v_max_f32 v52, v52, v71
  v_mul_f32 v48, s101, v48
  v_mul_f32 v50, s101, v50
  buffer_load_dwordx4 v7, s[12:15], s46 offen offset:3072 nt lds
  s_add_u32 s35, s35, 49152
  v_mul_f32 v52, s101, v52
  v_pk_fma_f32 v[160:161], v[160:161], s[100:101], v[48:49] op_sel_hi:[1,0,0]
  v_pk_fma_f32 v[164:165], v[164:165], s[100:101], v[50:51] op_sel_hi:[1,0,0]
  v_pk_fma_f32 v[168:169], v[168:169], s[100:101], v[52:53] op_sel_hi:[1,0,0]
  v_pk_fma_f32 v[162:163], v[162:163], s[100:101], v[48:49] op_sel_hi:[1,0,0]
  v_pk_fma_f32 v[166:167], v[166:167], s[100:101], v[50:51] op_sel_hi:[1,0,0]
  v_pk_fma_f32 v[170:171], v[170:171], s[100:101], v[52:53] op_sel_hi:[1,0,0]
  v_exp_f32 v160, v160
  v_exp_f32 v161, v161
  v_exp_f32 v164, v164
  v_exp_f32 v165, v165
  v_exp_f32 v168, v168
  v_exp_f32 v169, v169
  v_pk_fma_f32 v[172:173], v[172:173], s[100:101], v[48:49] op_sel_hi:[1,0,0]
  v_pk_fma_f32 v[176:177], v[176:177], s[100:101], v[50:51] op_sel_hi:[1,0,0]
  v_pk_fma_f32 v[180:181], v[180:181], s[100:101], v[52:53] op_sel_hi:[1,0,0]
  v_exp_f32 v162, v162
  v_exp_f32 v163, v163
  v_exp_f32 v166, v166
  s_add_u32 m0, s33, 16384
  s_add_u32 s46, s35, 32768
  buffer_load_dwordx4 v4, s[12:15], s35 offen offset:0 nt lds
  v_exp_f32 v167, v167
  v_exp_f32 v170, v170
  v_exp_f32 v171, v171
  v_pk_fma_f32 v[174:175], v[174:175], s[100:101], v[48:49] op_sel_hi:[1,0,0]
  v_pk_fma_f32 v[178:179], v[178:179], s[100:101], v[50:51] op_sel_hi:[1,0,0]
  v_pk_fma_f32 v[182:183], v[182:183], s[100:101], v[52:53] op_sel_hi:[1,0,0]
  v_exp_f32 v172, v172
  v_exp_f32 v173, v173
  v_exp_f32 v176, v176
  v_exp_f32 v177, v177
  v_exp_f32 v180, v180
  v_exp_f32 v181, v181
  v_pk_add_f32 v[54:55], v[160:161], v[162:163]
  v_pk_add_f32 v[56:57], v[164:165], v[166:167]
  v_pk_add_f32 v[58:59], v[168:169], v[170:171]
  v_pk_fma_f32 v[184:185], v[184:185], s[100:101], v[48:49] op_sel_hi:[1,0,0]
  v_pk_fma_f32 v[188:189], v[188:189], s[100:101], v[50:51] op_sel_hi:[1,0,0]
  v_pk_fma_f32 v[192:193], v[192:193], s[100:101], v[52:53] op_sel_hi:[1,0,0]
  v_exp_f32 v174, v174
  buffer_load_dwordx4 v5, s[12:15], s35 offen offset:1024 nt lds
  v_exp_f32 v175, v175
  v_exp_f32 v178, v178
  v_exp_f32 v179, v179
  v_exp_f32 v182, v182
  v_exp_f32 v183, v183
  v_pk_add_f32 v[54:55], v[54:55], v[172:173]
  v_pk_add_f32 v[56:57], v[56:57], v[176:177]
  v_pk_add_f32 v[58:59], v[58:59], v[180:181]
  v_pk_fma_f32 v[186:187], v[186:187], s[100:101], v[48:49] op_sel_hi:[1,0,0]
  v_pk_fma_f32 v[190:191], v[190:191], s[100:101], v[50:51] op_sel_hi:[1,0,0]
  v_pk_fma_f32 v[194:195], v[194:195], s[100:101], v[52:53] op_sel_hi:[1,0,0]
  v_exp_f32 v184, v184
  v_exp_f32 v185, v185
  v_exp_f32 v188, v188
  v_exp_f32 v189, v189
  v_exp_f32 v192, v192
  v_exp_f32 v193, v193
  buffer_load_dwordx4 v6, s[12:15], s35 offen offset:2048 nt lds
  v_pk_add_f32 v[54:55], v[54:55], v[174:175]
  v_pk_add_f32 v[56:57], v[56:57], v[178:179]
  v_pk_add_f32 v[58:59], v[58:59], v[182:183]
  s_waitcnt vmcnt(11)
  ds_read_b64_tr_b16 v[80:81], v8 offset:0
  ds_read_b64_tr_b16 v[82:83], v8 offset:4096
  ds_read_b64_tr_b16 v[84:85], v9 offset:0
  ds_read_b64_tr_b16 v[86:87], v9 offset:4096
  ds_read_b64_tr_b16 v[88:89], v10 offset:0
  ds_read_b64_tr_b16 v[90:91], v10 offset:4096
  ds_read_b64_tr_b16 v[92:93], v11 offset:0
  ds_read_b64_tr_b16 v[94:95], v11 offset:4096
  ds_read_b64_tr_b16 v[96:97], v8 offset:2048
  ds_read_b64_tr_b16 v[98:99], v8 offset:6144
  ds_read_b64_tr_b16 v[100:101], v9 offset:2048
  ds_read_b64_tr_b16 v[102:103], v9 offset:6144
  ds_read_b64_tr_b16 v[104:105], v10 offset:2048
  ds_read_b64_tr_b16 v[106:107], v10 offset:6144
  ds_read_b64_tr_b16 v[108:109], v11 offset:2048
  ds_read_b64_tr_b16 v[110:111], v11 offset:6144
  v_pk_fma_f32 v[196:197], v[196:197], s[100:101], v[48:49] op_sel_hi:[1,0,0]
  buffer_load_dwordx4 v7, s[12:15], s35 offen offset:3072 nt lds
  v_pk_fma_f32 v[200:201], v[200:201], s[100:101], v[50:51] op_sel_hi:[1,0,0]
  v_pk_fma_f32 v[204:205], v[204:205], s[100:101], v[52:53] op_sel_hi:[1,0,0]
  v_exp_f32 v186, v186
  v_exp_f32 v187, v187
  v_exp_f32 v190, v190
  v_exp_f32 v191, v191
  v_exp_f32 v194, v194
  v_exp_f32 v195, v195
  v_pk_add_f32 v[54:55], v[54:55], v[184:185]
  v_pk_add_f32 v[56:57], v[56:57], v[188:189]
  v_pk_add_f32 v[58:59], v[58:59], v[192:193]
  s_waitcnt lgkmcnt(0)
  s_add_u32 m0, s33, 20480
  s_nop 0
  buffer_load_dwordx4 v4, s[12:15], s46 offen offset:0 nt lds
  v_pk_fma_f32 v[198:199], v[198:199], s[100:101], v[48:49] op_sel_hi:[1,0,0]
  v_pk_fma_f32 v[202:203], v[202:203], s[100:101], v[50:51] op_sel_hi:[1,0,0]
  v_pk_fma_f32 v[206:207], v[206:207], s[100:101], v[52:53] op_sel_hi:[1,0,0]
  v_exp_f32 v196, v196
  v_exp_f32 v197, v197
  v_exp_f32 v200, v200
  v_exp_f32 v201, v201
  v_exp_f32 v204, v204
  v_exp_f32 v205, v205
  v_pk_add_f32 v[54:55], v[54:55], v[186:187]
  v_pk_add_f32 v[56:57], v[56:57], v[190:191]
  v_pk_add_f32 v[58:59], v[58:59], v[194:195]
  v_pk_fma_f32 v[208:209], v[208:209], s[100:101], v[48:49] op_sel_hi:[1,0,0]
  v_pk_fma_f32 v[212:213], v[212:213], s[100:101], v[50:51] op_sel_hi:[1,0,0]
  v_pk_fma_f32 v[216:217], v[216:217], s[100:101], v[52:53] op_sel_hi:[1,0,0]
  v_exp_f32 v198, v198
  v_exp_f32 v199, v199
  v_exp_f32 v202, v202
  v_exp_f32 v203, v203
  buffer_load_dwordx4 v5, s[12:15], s46 offen offset:1024 nt lds
  v_exp_f32 v206, v206
  v_exp_f32 v207, v207
  v_pk_add_f32 v[54:55], v[54:55], v[196:197]
  v_pk_add_f32 v[56:57], v[56:57], v[200:201]
  v_pk_add_f32 v[58:59], v[58:59], v[204:205]
  v_pk_fma_f32 v[210:211], v[210:211], s[100:101], v[48:49] op_sel_hi:[1,0,0]
  v_pk_fma_f32 v[214:215], v[214:215], s[100:101], v[50:51] op_sel_hi:[1,0,0]
  v_pk_fma_f32 v[218:219], v[218:219], s[100:101], v[52:53] op_sel_hi:[1,0,0]
  v_exp_f32 v208, v208
  v_exp_f32 v209, v209
  v_exp_f32 v212, v212
  v_exp_f32 v213, v213
  v_exp_f32 v216, v216
  v_exp_f32 v217, v217
  v_pk_add_f32 v[54:55], v[54:55], v[198:199]
  v_pk_add_f32 v[56:57], v[56:57], v[202:203]
  v_pk_add_f32 v[58:59], v[58:59], v[206:207]
  v_pk_fma_f32 v[220:221], v[220:221], s[100:101], v[48:49] op_sel_hi:[1,0,0]
  v_pk_fma_f32 v[224:225], v[224:225], s[100:101], v[50:51] op_sel_hi:[1,0,0]
  v_pk_fma_f32 v[228:229], v[228:229], s[100:101], v[52:53] op_sel_hi:[1,0,0]
  buffer_load_dwordx4 v6, s[12:15], s46 offen offset:2048 nt lds
  v_exp_f32 v210, v210
  v_exp_f32 v211, v211
  v_exp_f32 v214, v214
  v_exp_f32 v215, v215
  v_exp_f32 v218, v218
  v_exp_f32 v219, v219
  v_pk_add_f32 v[54:55], v[54:55], v[208:209]
  v_pk_add_f32 v[56:57], v[56:57], v[212:213]
  v_pk_add_f32 v[58:59], v[58:59], v[216:217]
  v_pk_fma_f32 v[222:223], v[222:223], s[100:101], v[48:49] op_sel_hi:[1,0,0]
  v_pk_fma_f32 v[226:227], v[226:227], s[100:101], v[50:51] op_sel_hi:[1,0,0]
  v_pk_fma_f32 v[230:231], v[230:231], s[100:101], v[52:53] op_sel_hi:[1,0,0]
  v_exp_f32 v220, v220
  v_exp_f32 v221, v221
  v_exp_f32 v224, v224
  v_exp_f32 v225, v225
  v_exp_f32 v228, v228
  buffer_load_dwordx4 v7, s[12:15], s46 offen offset:3072 nt lds
  s_add_u32 s35, s35, 16384
  v_exp_f32 v229, v229
  v_pk_add_f32 v[54:55], v[54:55], v[210:211]
  v_pk_add_f32 v[56:57], v[56:57], v[214:215]
  v_pk_add_f32 v[58:59], v[58:59], v[218:219]
  v_pk_fma_f32 v[232:233], v[232:233], s[100:101], v[48:49] op_sel_hi:[1,0,0]
  v_pk_fma_f32 v[236:237], v[236:237], s[100:101], v[50:51] op_sel_hi:[1,0,0]
  v_pk_fma_f32 v[240:241], v[240:241], s[100:101], v[52:53] op_sel_hi:[1,0,0]
  v_exp_f32 v222, v222
  v_exp_f32 v223, v223
  v_exp_f32 v226, v226
  v_exp_f32 v227, v227
  v_exp_f32 v230, v230
  v_exp_f32 v231, v231
  v_pk_add_f32 v[54:55], v[54:55], v[220:221]
  v_pk_add_f32 v[56:57], v[56:57], v[224:225]
  v_pk_add_f32 v[58:59], v[58:59], v[228:229]
  v_pk_fma_f32 v[234:235], v[234:235], s[100:101], v[48:49] op_sel_hi:[1,0,0]
  v_pk_fma_f32 v[238:239], v[238:239], s[100:101], v[50:51] op_sel_hi:[1,0,0]
  v_pk_fma_f32 v[242:243], v[242:243], s[100:101], v[52:53] op_sel_hi:[1,0,0]
  v_exp_f32 v232, v232
  s_add_u32 m0, s33, 0
  s_add_u32 s46, s35, 32768
  buffer_load_dwordx4 v4, s[12:15], s35 offen offset:0 nt lds
  v_exp_f32 v233, v233
  v_exp_f32 v236, v236
  v_exp_f32 v237, v237
  v_exp_f32 v240, v240
  v_exp_f32 v241, v241
  v_pk_add_f32 v[54:55], v[54:55], v[222:223]
  v_pk_add_f32 v[56:57], v[56:57], v[226:227]
  v_pk_add_f32 v[58:59], v[58:59], v[230:231]
  s_waitcnt vmcnt(9)
  ds_read_b64_tr_b16 v[112:113], v8 offset:8192
  ds_read_b64_tr_b16 v[114:115], v8 offset:12288
  ds_read_b64_tr_b16 v[116:117], v9 offset:8192
  ds_read_b64_tr_b16 v[118:119], v9 offset:12288
  ds_read_b64_tr_b16 v[120:121], v10 offset:8192
  ds_read_b64_tr_b16 v[122:123], v10 offset:12288
  ds_read_b64_tr_b16 v[124:125], v11 offset:8192
  ds_read_b64_tr_b16 v[126:127], v11 offset:12288
  ds_read_b64_tr_b16 v[128:129], v8 offset:10240
  ds_read_b64_tr_b16 v[130:131], v8 offset:14336
  buffer_load_dwordx4 v5, s[12:15], s35 offen offset:1024 nt lds
  ds_read_b64_tr_b16 v[132:133], v9 offset:10240
  ds_read_b64_tr_b16 v[134:135], v9 offset:14336
  ds_read_b64_tr_b16 v[136:137], v10 offset:10240
  ds_read_b64_tr_b16 v[138:139], v10 offset:14336
  ds_read_b64_tr_b16 v[140:141], v11 offset:10240
  ds_read_b64_tr_b16 v[142:143], v11 offset:14336
  v_pk_fma_f32 v[244:245], v[244:245], s[100:101], v[48:49] op_sel_hi:[1,0,0]
  v_pk_fma_f32 v[248:249], v[248:249], s[100:101], v[50:51] op_sel_hi:[1,0,0]
  v_pk_fma_f32 v[252:253], v[252:253], s[100:101], v[52:53] op_sel_hi:[1,0,0]
  v_exp_f32 v234, v234
  v_exp_f32 v235, v235
  v_exp_f32 v238, v238
  v_exp_f32 v239, v239
  v_exp_f32 v242, v242
  v_exp_f32 v243, v243
  v_pk_add_f32 v[54:55], v[54:55], v[232:233]
  v_pk_add_f32 v[56:57], v[56:57], v[236:237]
  v_pk_add_f32 v[58:59], v[58:59], v[240:241]
  s_waitcnt lgkmcnt(0)
  buffer_load_dwordx4 v6, s[12:15], s35 offen offset:2048 nt lds
  v_pk_fma_f32 v[246:247], v[246:247], s[100:101], v[48:49] op_sel_hi:[1,0,0]
  v_pk_fma_f32 v[250:251], v[250:251], s[100:101], v[50:51] op_sel_hi:[1,0,0]
  v_pk_fma_f32 v[254:255], v[254:255], s[100:101], v[52:53] op_sel_hi:[1,0,0]
  v_exp_f32 v244, v244
  v_exp_f32 v245, v245
  v_exp_f32 v248, v248
  v_exp_f32 v249, v249
  v_exp_f32 v252, v252
  v_exp_f32 v253, v253
  v_pk_add_f32 v[54:55], v[54:55], v[234:235]
  v_pk_add_f32 v[56:57], v[56:57], v[238:239]
  v_pk_add_f32 v[58:59], v[58:59], v[242:243]
  v_exp_f32 v246, v246
  v_exp_f32 v247, v247
  v_exp_f32 v250, v250
  v_exp_f32 v251, v251
  v_exp_f32 v254, v254
  buffer_load_dwordx4 v7, s[12:15], s35 offen offset:3072 nt lds
  v_exp_f32 v255, v255
  v_pk_add_f32 v[54:55], v[54:55], v[244:245]
  v_pk_add_f32 v[56:57], v[56:57], v[248:249]
  v_pk_add_f32 v[58:59], v[58:59], v[252:253]
  s_nop 0
  v_pk_add_f32 v[54:55], v[54:55], v[246:247]
  v_pk_add_f32 v[56:57], v[56:57], v[250:251]
  v_pk_add_f32 v[58:59], v[58:59], v[254:255]
  v_add_f32 v54, v54, v55
  v_add_f32 v56, v56, v57
  v_add_f32 v58, v58, v59
  v_mov_b32 v49, v54
  v_mov_b32 v51, v56
  v_mov_b32 v53, v58
  s_nop 1
  v_permlane32_swap_b32 v49, v54
  v_permlane32_swap_b32 v51, v56
  v_permlane32_swap_b32 v53, v58
  s_nop 1
  v_add_f32 v54, v54, v49
  v_add_f32 v56, v56, v51
  v_add_f32 v58, v58, v53
  v_mov_b32 v49, v54
  v_mov_b32 v51, v56
  v_mov_b32 v53, v58
  s_nop 1
  s_add_u32 m0, s33, 4096
  s_nop 0
  buffer_load_dwordx4 v4, s[12:15], s46 offen offset:0 nt lds
  v_permlane16_swap_b32 v49, v54
  v_permlane16_swap_b32 v51, v56
  v_permlane16_swap_b32 v53, v58
  s_nop 1
  v_add_f32 v54, v54, v49
  v_add_f32 v56, v56, v51
  v_add_f32 v58, v58, v53
  ds_write_b32 v13, v54 offset:1536
  ds_write_b32 v13, v56 offset:1792
  ds_write_b32 v13, v58 offset:2048
  s_mul_i32 s39, s32, 3072
  v_add_u32 v15, s39, v3
  v_cvt_pk_bf16_f32 v175, v174, v175
  v_cvt_pk_bf16_f32 v174, v172, v173
  v_cvt_pk_bf16_f32 v172, v160, v161
  v_cvt_pk_bf16_f32 v173, v162, v163
  ds_write_b128 v15, v[172:175] offset:0
  v_cvt_pk_bf16_f32 v179, v178, v179
  v_cvt_pk_bf16_f32 v178, v176, v177
  v_cvt_pk_bf16_f32 v176, v164, v165
  v_cvt_pk_bf16_f32 v177, v166, v167
  ds_write_b128 v15, v[176:179] offset:1024
  buffer_load_dwordx4 v5, s[12:15], s46 offen offset:1024 nt lds
  v_cvt_pk_bf16_f32 v183, v182, v183
  v_cvt_pk_bf16_f32 v182, v180, v181
  v_cvt_pk_bf16_f32 v180, v168, v169
  v_cvt_pk_bf16_f32 v181, v170, v171
  ds_write_b128 v15, v[180:183] offset:2048
  v_cvt_pk_bf16_f32 v199, v198, v199
  v_cvt_pk_bf16_f32 v198, v196, v197
  v_cvt_pk_bf16_f32 v196, v184, v185
  v_cvt_pk_bf16_f32 v197, v186, v187
  ds_write_b128 v15, v[196:199] offset:12288
  v_cvt_pk_bf16_f32 v203, v202, v203
  v_cvt_pk_bf16_f32 v202, v200, v201
  v_cvt_pk_bf16_f32 v200, v188, v189
  v_cvt_pk_bf16_f32 v201, v190, v191
  ds_write_b128 v15, v[200:203] offset:13312
  v_cvt_pk_bf16_f32 v207, v206, v207
  v_cvt_pk_bf16_f32 v206, v204, v205
  v_cvt_pk_bf16_f32 v204, v192, v193
  v_cvt_pk_bf16_f32 v205, v194, v195
  buffer_load_dwordx4 v6, s[12:15], s46 offen offset:2048 nt lds
  ds_write_b128 v15, v[204:207] offset:14336
  v_cvt_pk_bf16_f32 v223, v222, v223
  v_cvt_pk_bf16_f32 v222, v220, v221
  v_cvt_pk_bf16_f32 v220, v208, v209
  v_cvt_pk_bf16_f32 v221, v210, v211
  ds_write_b128 v15, v[220:223] offset:24576
  v_cvt_pk_bf16_f32 v227, v226, v227
  v_cvt_pk_bf16_f32 v226, v224, v225
  v_cvt_pk_bf16_f32 v224, v212, v213
  v_cvt_pk_bf16_f32 v225, v214, v215
  ds_write_b128 v15, v[224:227] offset:25600
  v_cvt_pk_bf16_f32 v231, v230, v231
  v_cvt_pk_bf16_f32 v230, v228, v229
  v_cvt_pk_bf16_f32 v228, v216, v217
  v_cvt_pk_bf16_f32 v229, v218, v219
  ds_write_b128 v15, v[228:231] offset:26624
  buffer_load_dwordx4 v7, s[12:15], s46 offen offset:3072 nt lds
  s_add_u32 s35, s35, 49152
  v_cvt_pk_bf16_f32 v247, v246, v247
  v_cvt_pk_bf16_f32 v246, v244, v245
  v_cvt_pk_bf16_f32 v244, v232, v233
  v_cvt_pk_bf16_f32 v245, v234, v235
  ds_write_b128 v15, v[244:247] offset:36864
  v_cvt_pk_bf16_f32 v251, v250, v251
  v_cvt_pk_bf16_f32 v250, v248, v249
  v_cvt_pk_bf16_f32 v248, v236, v237
  v_cvt_pk_bf16_f32 v249, v238, v239
  ds_write_b128 v15, v[248:251] offset:37888
  v_cvt_pk_bf16_f32 v255, v254, v255
  v_cvt_pk_bf16_f32 v254, v252, v253
  v_cvt_pk_bf16_f32 v252, v240, v241
  v_cvt_pk_bf16_f32 v253, v242, v243
  ds_write_b128 v15, v[252:255] offset:38912
  s_waitcnt lgkmcnt(0)
  s_add_u32 m0, s33, 8192
  s_add_u32 s46, s35, 32768
  buffer_load_dwordx4 v4, s[12:15], s35 offen offset:0 nt lds
  s_barrier
  ds_read_b128 v[208:211], v3 offset:0
  ds_read_b128 v[212:215], v3 offset:1024
  ds_read_b128 v[216:219], v3 offset:2048
  ds_read_b128 v[220:223], v3 offset:3072
  ds_read_b128 v[224:227], v3 offset:4096
  ds_read_b128 v[228:231], v3 offset:5120
  s_waitcnt lgkmcnt(0)
  buffer_load_dwordx4 v5, s[12:15], s35 offen offset:1024 nt lds
  v_mfma_f32_16x16x32_bf16 v[160:163], v[80:83], v[208:211], 0
  v_mfma_f32_16x16x32_bf16 v[164:167], v[80:83], v[212:215], 0
  v_mfma_f32_16x16x32_bf16 v[168:171], v[80:83], v[216:219], 0
  v_mfma_f32_16x16x32_bf16 v[172:175], v[84:87], v[208:211], 0
  v_mfma_f32_16x16x32_bf16 v[176:179], v[84:87], v[212:215], 0
  v_mfma_f32_16x16x32_bf16 v[180:183], v[84:87], v[216:219], 0
  v_mfma_f32_16x16x32_bf16 v[184:187], v[88:91], v[208:211], 0
  buffer_load_dwordx4 v6, s[12:15], s35 offen offset:2048 nt lds
  v_mfma_f32_16x16x32_bf16 v[188:191], v[88:91], v[212:215], 0
  v_mfma_f32_16x16x32_bf16 v[192:195], v[88:91], v[216:219], 0
  v_mfma_f32_16x16x32_bf16 v[196:199], v[92:95], v[208:211], 0
  v_mfma_f32_16x16x32_bf16 v[200:203], v[92:95], v[212:215], 0
  v_mfma_f32_16x16x32_bf16 v[204:207], v[92:95], v[216:219], 0
  v_mfma_f32_16x16x32_bf16 v[160:163], v[96:99], v[220:223], v[160:163]
  v_mfma_f32_16x16x32_bf16 v[164:167], v[96:99], v[224:227], v[164:167]
  buffer_load_dwordx4 v7, s[12:15], s35 offen offset:3072 nt lds
  v_mfma_f32_16x16x32_bf16 v[168:171], v[96:99], v[228:231], v[168:171]
  v_mfma_f32_16x16x32_bf16 v[172:175], v[100:103], v[220:223], v[172:175]
  v_mfma_f32_16x16x32_bf16 v[176:179], v[100:103], v[224:227], v[176:179]
  v_mfma_f32_16x16x32_bf16 v[180:183], v[100:103], v[228:231], v[180:183]
  v_mfma_f32_16x16x32_bf16 v[184:187], v[104:107], v[220:223], v[184:187]
  v_mfma_f32_16x16x32_bf16 v[188:191], v[104:107], v[224:227], v[188:191]
  v_mfma_f32_16x16x32_bf16 v[192:195], v[104:107], v[228:231], v[192:195]
  s_add_u32 m0, s33, 12288
  s_nop 0
  buffer_load_dwordx4 v4, s[12:15], s46 offen offset:0 nt lds
  v_mfma_f32_16x16x32_bf16 v[196:199], v[108:111], v[220:223], v[196:199]
  v_mfma_f32_16x16x32_bf16 v[200:203], v[108:111], v[224:227], v[200:203]
  v_mfma_f32_16x16x32_bf16 v[204:207], v[108:111], v[228:231], v[204:207]
  ds_read_b128 v[208:211], v3 offset:6144
  ds_read_b128 v[212:215], v3 offset:7168
  ds_read_b128 v[216:219], v3 offset:8192
  ds_read_b128 v[220:223], v3 offset:9216
  ds_read_b128 v[224:227], v3 offset:10240
  ds_read_b128 v[228:231], v3 offset:11264
  s_waitcnt lgkmcnt(0)
  buffer_load_dwordx4 v5, s[12:15], s46 offen offset:1024 nt lds
  s_waitcnt vmcnt(14)
  v_mfma_f32_16x16x32_bf16 v[160:163], v[112:115], v[208:211], v[160:163]
  ds_read_b64_tr_b16 v[80:81], v8 offset:16384
  v_mfma_f32_16x16x32_bf16 v[164:167], v[112:115], v[212:215], v[164:167]
  ds_read_b64_tr_b16 v[82:83], v8 offset:20480
  v_mfma_f32_16x16x32_bf16 v[168:171], v[112:115], v[216:219], v[168:171]
  ds_read_b64_tr_b16 v[84:85], v9 offset:16384
  v_mfma_f32_16x16x32_bf16 v[172:175], v[116:119], v[208:211], v[172:175]
  ds_read_b64_tr_b16 v[86:87], v9 offset:20480
  v_mfma_f32_16x16x32_bf16 v[176:179], v[116:119], v[212:215], v[176:179]
  v_mfma_f32_16x16x32_bf16 v[180:183], v[116:119], v[216:219], v[180:183]
  buffer_load_dwordx4 v6, s[12:15], s46 offen offset:2048 nt lds
  ds_read_b64_tr_b16 v[88:89], v10 offset:16384
  v_mfma_f32_16x16x32_bf16 v[184:187], v[120:123], v[208:211], v[184:187]
  ds_read_b64_tr_b16 v[90:91], v10 offset:20480
  v_mfma_f32_16x16x32_bf16 v[188:191], v[120:123], v[212:215], v[188:191]
  ds_read_b64_tr_b16 v[92:93], v11 offset:16384
  v_mfma_f32_16x16x32_bf16 v[192:195], v[120:123], v[216:219], v[192:195]
  ds_read_b64_tr_b16 v[94:95], v11 offset:20480
  v_mfma_f32_16x16x32_bf16 v[196:199], v[124:127], v[208:211], v[196:199]
  v_mfma_f32_16x16x32_bf16 v[200:203], v[124:127], v[212:215], v[200:203]
  ds_read_b64_tr_b16 v[96:97], v8 offset:18432
  buffer_load_dwordx4 v7, s[12:15], s46 offen offset:3072 nt lds
  s_add_u32 s35, s35, 16384
  v_mfma_f32_16x16x32_bf16 v[204:207], v[124:127], v[216:219], v[204:207]
  ds_read_b64_tr_b16 v[98:99], v8 offset:22528
  v_mfma_f32_16x16x32_bf16 v[160:163], v[128:131], v[220:223], v[160:163]
  ds_read_b64_tr_b16 v[100:101], v9 offset:18432
  v_mfma_f32_16x16x32_bf16 v[164:167], v[128:131], v[224:227], v[164:167]
  ds_read_b64_tr_b16 v[102:103], v9 offset:22528
  v_mfma_f32_16x16x32_bf16 v[168:171], v[128:131], v[228:231], v[168:171]
  v_mfma_f32_16x16x32_bf16 v[172:175], v[132:135], v[220:223], v[172:175]
  ds_read_b64_tr_b16 v[104:105], v10 offset:18432
  v_mfma_f32_16x16x32_bf16 v[176:179], v[132:135], v[224:227], v[176:179]
  ds_read_b64_tr_b16 v[106:107], v10 offset:22528
  v_mfma_f32_16x16x32_bf16 v[180:183], v[132:135], v[228:231], v[180:183]
  ds_read_b64_tr_b16 v[108:109], v11 offset:18432
  v_mfma_f32_16x16x32_bf16 v[184:187], v[136:139], v[220:223], v[184:187]
  ds_read_b64_tr_b16 v[110:111], v11 offset:22528
  v_mfma_f32_16x16x32_bf16 v[188:191], v[136:139], v[224:227], v[188:191]
  v_mfma_f32_16x16x32_bf16 v[192:195], v[136:139], v[228:231], v[192:195]
  v_mfma_f32_16x16x32_bf16 v[196:199], v[140:143], v[220:223], v[196:199]
  v_mfma_f32_16x16x32_bf16 v[200:203], v[140:143], v[224:227], v[200:203]
  v_mfma_f32_16x16x32_bf16 v[204:207], v[140:143], v[228:231], v[204:207]
  s_waitcnt lgkmcnt(0)
  ds_read_b128 v[208:211], v3 offset:12288
  s_add_u32 m0, s33, 16384
  s_add_u32 s46, s35, 32768
  buffer_load_dwordx4 v4, s[12:15], s35 offen offset:0 nt lds
  ds_read_b128 v[212:215], v3 offset:13312
  ds_read_b128 v[216:219], v3 offset:14336
  ds_read_b128 v[220:223], v3 offset:15360
  ds_read_b128 v[224:227], v3 offset:16384
  ds_read_b128 v[228:231], v3 offset:17408
  s_waitcnt lgkmcnt(0)
  v_mfma_f32_16x16x32_bf16 v[160:163], v[80:83], v[208:211], v[160:163]
  v_mfma_f32_16x16x32_bf16 v[164:167], v[80:83], v[212:215], v[164:167]
  buffer_load_dwordx4 v5, s[12:15], s35 offen offset:1024 nt lds
  v_mfma_f32_16x16x32_bf16 v[168:171], v[80:83], v[216:219], v[168:171]
  v_mfma_f32_16x16x32_bf16 v[172:175], v[84:87], v[208:211], v[172:175]
  v_mfma_f32_16x16x32_bf16 v[176:179], v[84:87], v[212:215], v[176:179]
  v_mfma_f32_16x16x32_bf16 v[180:183], v[84:87], v[216:219], v[180:183]
  v_mfma_f32_16x16x32_bf16 v[184:187], v[88:91], v[208:211], v[184:187]
  v_mfma_f32_16x16x32_bf16 v[188:191], v[88:91], v[212:215], v[188:191]
  v_mfma_f32_16x16x32_bf16 v[192:195], v[88:91], v[216:219], v[192:195]
  buffer_load_dwordx4 v6, s[12:15], s35 offen offset:2048 nt lds
  v_mfma_f32_16x16x32_bf16 v[196:199], v[92:95], v[208:211], v[196:199]
  v_mfma_f32_16x16x32_bf16 v[200:203], v[92:95], v[212:215], v[200:203]
  v_mfma_f32_16x16x32_bf16 v[204:207], v[92:95], v[216:219], v[204:207]
  v_mfma_f32_16x16x32_bf16 v[160:163], v[96:99], v[220:223], v[160:163]
  v_mfma_f32_16x16x32_bf16 v[164:167], v[96:99], v[224:227], v[164:167]
  v_mfma_f32_16x16x32_bf16 v[168:171], v[96:99], v[228:231], v[168:171]
  v_mfma_f32_16x16x32_bf16 v[172:175], v[100:103], v[220:223], v[172:175]
  buffer_load_dwordx4 v7, s[12:15], s35 offen offset:3072 nt lds
  v_mfma_f32_16x16x32_bf16 v[176:179], v[100:103], v[224:227], v[176:179]
  v_mfma_f32_16x16x32_bf16 v[180:183], v[100:103], v[228:231], v[180:183]
  v_mfma_f32_16x16x32_bf16 v[184:187], v[104:107], v[220:223], v[184:187]
  v_mfma_f32_16x16x32_bf16 v[188:191], v[104:107], v[224:227], v[188:191]
  v_mfma_f32_16x16x32_bf16 v[192:195], v[104:107], v[228:231], v[192:195]
  v_mfma_f32_16x16x32_bf16 v[196:199], v[108:111], v[220:223], v[196:199]
  v_mfma_f32_16x16x32_bf16 v[200:203], v[108:111], v[224:227], v[200:203]
  s_add_u32 m0, s33, 20480
  s_nop 0
  buffer_load_dwordx4 v4, s[12:15], s46 offen offset:0 nt lds
  v_mfma_f32_16x16x32_bf16 v[204:207], v[108:111], v[228:231], v[204:207]
  ds_read_b128 v[208:211], v3 offset:18432
  ds_read_b128 v[212:215], v3 offset:19456
  ds_read_b128 v[216:219], v3 offset:20480
  ds_read_b128 v[220:223], v3 offset:21504
  ds_read_b128 v[224:227], v3 offset:22528
  ds_read_b128 v[228:231], v3 offset:23552
  s_waitcnt vmcnt(13)
  ds_read_b64_tr_b16 v[112:113], v8 offset:0
  ds_read_b64_tr_b16 v[114:115], v8 offset:4096
  ds_read_b64_tr_b16 v[116:117], v9 offset:0
  ds_read_b64_tr_b16 v[118:119], v9 offset:4096
  ds_read_b64_tr_b16 v[120:121], v10 offset:0
  ds_read_b64_tr_b16 v[122:123], v10 offset:4096
  ds_read_b64_tr_b16 v[124:125], v11 offset:0
  ds_read_b64_tr_b16 v[126:127], v11 offset:4096
  ds_read_b64_tr_b16 v[128:129], v8 offset:2048
  ds_read_b64_tr_b16 v[130:131], v8 offset:6144
  ds_read_b64_tr_b16 v[132:133], v9 offset:2048
  ds_read_b64_tr_b16 v[134:135], v9 offset:6144
  s_waitcnt lgkmcnt(10)
  v_mfma_f32_16x16x32_bf16 v[160:163], v[112:115], v[208:211], v[160:163]
  v_mfma_f32_16x16x32_bf16 v[164:167], v[112:115], v[212:215], v[164:167]
  v_mfma_f32_16x16x32_bf16 v[168:171], v[112:115], v[216:219], v[168:171]
  ds_read_b64_tr_b16 v[136:137], v10 offset:2048
  ds_read_b64_tr_b16 v[138:139], v10 offset:6144
  s_waitcnt lgkmcnt(10)
  v_mfma_f32_16x16x32_bf16 v[172:175], v[116:119], v[208:211], v[172:175]
  v_mfma_f32_16x16x32_bf16 v[176:179], v[116:119], v[212:215], v[176:179]
  v_mfma_f32_16x16x32_bf16 v[180:183], v[116:119], v[216:219], v[180:183]
  ds_read_b64_tr_b16 v[140:141], v11 offset:2048
  ds_read_b64_tr_b16 v[142:143], v11 offset:6144
  s_waitcnt lgkmcnt(10)
  v_mfma_f32_16x16x32_bf16 v[184:187], v[120:123], v[208:211], v[184:187]
  buffer_load_dwordx4 v5, s[12:15], s46 offen offset:1024 nt lds
  v_mfma_f32_16x16x32_bf16 v[188:191], v[120:123], v[212:215], v[188:191]
  v_mfma_f32_16x16x32_bf16 v[192:195], v[120:123], v[216:219], v[192:195]
  s_waitcnt lgkmcnt(8)
  v_mfma_f32_16x16x32_bf16 v[196:199], v[124:127], v[208:211], v[196:199]
  v_mfma_f32_16x16x32_bf16 v[200:203], v[124:127], v[212:215], v[200:203]
  v_mfma_f32_16x16x32_bf16 v[204:207], v[124:127], v[216:219], v[204:207]
  s_waitcnt lgkmcnt(6)
  v_mfma_f32_16x16x32_bf16 v[160:163], v[128:131], v[220:223], v[160:163]
  v_mfma_f32_16x16x32_bf16 v[164:167], v[128:131], v[224:227], v[164:167]
  buffer_load_dwordx4 v6, s[12:15], s46 offen offset:2048 nt lds
  v_mfma_f32_16x16x32_bf16 v[168:171], v[128:131], v[228:231], v[168:171]
  s_waitcnt lgkmcnt(4)
  v_mfma_f32_16x16x32_bf16 v[172:175], v[132:135], v[220:223], v[172:175]
  v_mfma_f32_16x16x32_bf16 v[176:179], v[132:135], v[224:227], v[176:179]
  v_mfma_f32_16x16x32_bf16 v[180:183], v[132:135], v[228:231], v[180:183]
  s_waitcnt lgkmcnt(2)
  v_mfma_f32_16x16x32_bf16 v[184:187], v[136:139], v[220:223], v[184:187]
  v_mfma_f32_16x16x32_bf16 v[188:191], v[136:139], v[224:227], v[188:191]
  v_mfma_f32_16x16x32_bf16 v[192:195], v[136:139], v[228:231], v[192:195]
  buffer_load_dwordx4 v7, s[12:15], s46 offen offset:3072 nt lds
  s_add_u32 s35, s35, 49152
  s_waitcnt lgkmcnt(0)
  v_mfma_f32_16x16x32_bf16 v[196:199], v[140:143], v[220:223], v[196:199]
  v_mfma_f32_16x16x32_bf16 v[200:203], v[140:143], v[224:227], v[200:203]
  v_mfma_f32_16x16x32_bf16 v[204:207], v[140:143], v[228:231], v[204:207]
  ds_read_b128 v[208:211], v3 offset:24576
  ds_read_b128 v[212:215], v3 offset:25600
  ds_read_b128 v[216:219], v3 offset:26624
  ds_read_b128 v[220:223], v3 offset:27648
  ds_read_b128 v[224:227], v3 offset:28672
  ds_read_b128 v[228:231], v3 offset:29696
  s_cmp_eq_u32 s32, 3
  s_cbranch_scc0 L_tagldB
  s_load_dwordx2 s[90:91], s[94:95], 0
L_tagldB:
  ds_read_b128 v[232:235], v14 offset:1536
  ds_read_b128 v[236:239], v14 offset:1792
  ds_read_b128 v[240:243], v14 offset:2048
  s_waitcnt lgkmcnt(0)
  s_add_u32 m0, s33, 0
  s_add_u32 s46, s35, 32768
  buffer_load_dwordx4 v4, s[12:15], s35 offen offset:0 nt lds
  s_cmp_eq_u32 s32, 3
  s_cbranch_scc0 L_tagokB
  s_mov_b32 s51, 0
L_tagchkB:
  s_cmp_lg_u32 s90, 0
  s_cbranch_scc1 L_tagokB
  s_add_u32 s51, s51, 1
  s_cmp_ge_u32 s51, 0x100000
  s_cbranch_scc1 L_tagokB
  s_sleep 8
  v_mov_b32 v45, 0
  global_load_dwordx2 v[46:47], v45, s[94:95] sc1
  s_waitcnt vmcnt(0)
  v_readfirstlane_b32 s90, v46
  v_readfirstlane_b32 s91, v47
  s_branch L_tagchkB
L_tagokB:
  v_add_f32 v32, v232, v233
  v_add_f32 v34, v236, v237
  v_add_f32 v40, v240, v241
  v_add_f32 v234, v234, v235
  v_add_f32 v238, v238, v239
  v_add_f32 v242, v242, v243
  v_add_f32 v32, v32, v234
  v_add_f32 v34, v34, v238
  v_add_f32 v40, v40, v242
  v_rcp_f32 v32, v32
  v_rcp_f32 v34, v34
  v_rcp_f32 v40, v40
  s_mul_i32 s39, s32, 6144
  v_add_u32 v15, s39, v3
  s_waitcnt vmcnt(9)
  ds_read_b64_tr_b16 v[80:81], v8 offset:8192
  ds_read_b64_tr_b16 v[82:83], v8 offset:12288
  ds_read_b64_tr_b16 v[84:85], v9 offset:8192
  ds_read_b64_tr_b16 v[86:87], v9 offset:12288
  ds_read_b64_tr_b16 v[88:89], v10 offset:8192
  ds_read_b64_tr_b16 v[90:91], v10 offset:12288
  ds_read_b64_tr_b16 v[92:93], v11 offset:8192
  ds_read_b64_tr_b16 v[94:95], v11 offset:12288
  ds_read_b64_tr_b16 v[96:97], v8 offset:10240
  ds_read_b64_tr_b16 v[98:99], v8 offset:14336
  ds_read_b64_tr_b16 v[100:101], v9 offset:10240
  ds_read_b64_tr_b16 v[102:103], v9 offset:14336
  s_waitcnt lgkmcnt(10)
  v_mfma_f32_16x16x32_bf16 v[160:163], v[80:83], v[208:211], v[160:163]
  v_mfma_f32_16x16x32_bf16 v[164:167], v[80:83], v[212:215], v[164:167]
  v_mfma_f32_16x16x32_bf16 v[168:171], v[80:83], v[216:219], v[168:171]
  ds_read_b64_tr_b16 v[104:105], v10 offset:10240
  ds_read_b64_tr_b16 v[106:107], v10 offset:14336
  s_waitcnt lgkmcnt(10)
  v_mfma_f32_16x16x32_bf16 v[172:175], v[84:87], v[208:211], v[172:175]
  v_mfma_f32_16x16x32_bf16 v[176:179], v[84:87], v[212:215], v[176:179]
  v_mfma_f32_16x16x32_bf16 v[180:183], v[84:87], v[216:219], v[180:183]
  ds_read_b64_tr_b16 v[108:109], v11 offset:10240
  ds_read_b64_tr_b16 v[110:111], v11 offset:14336
  s_waitcnt lgkmcnt(10)
  v_mfma_f32_16x16x32_bf16 v[184:187], v[88:91], v[208:211], v[184:187]
  buffer_load_dwordx4 v5, s[12:15], s35 offen offset:1024 nt lds
  v_mfma_f32_16x16x32_bf16 v[188:191], v[88:91], v[212:215], v[188:191]
  v_mfma_f32_16x16x32_bf16 v[192:195], v[88:91], v[216:219], v[192:195]
  s_waitcnt lgkmcnt(8)
  v_mfma_f32_16x16x32_bf16 v[196:199], v[92:95], v[208:211], v[196:199]
  v_mfma_f32_16x16x32_bf16 v[200:203], v[92:95], v[212:215], v[200:203]
  v_mfma_f32_16x16x32_bf16 v[204:207], v[92:95], v[216:219], v[204:207]
  s_waitcnt lgkmcnt(6)
  v_mfma_f32_16x16x32_bf16 v[160:163], v[96:99], v[220:223], v[160:163]
  v_mfma_f32_16x16x32_bf16 v[164:167], v[96:99], v[224:227], v[164:167]
  buffer_load_dwordx4 v6, s[12:15], s35 offen offset:2048 nt lds
  v_mfma_f32_16x16x32_bf16 v[168:171], v[96:99], v[228:231], v[168:171]
  s_waitcnt lgkmcnt(4)
  v_mfma_f32_16x16x32_bf16 v[172:175], v[100:103], v[220:223], v[172:175]
  v_mfma_f32_16x16x32_bf16 v[176:179], v[100:103], v[224:227], v[176:179]
  v_mfma_f32_16x16x32_bf16 v[180:183], v[100:103], v[228:231], v[180:183]
  s_waitcnt lgkmcnt(2)
  v_mfma_f32_16x16x32_bf16 v[184:187], v[104:107], v[220:223], v[184:187]
  v_mfma_f32_16x16x32_bf16 v[188:191], v[104:107], v[224:227], v[188:191]
  v_mfma_f32_16x16x32_bf16 v[192:195], v[104:107], v[228:231], v[192:195]
  buffer_load_dwordx4 v7, s[12:15], s35 offen offset:3072 nt lds
  s_waitcnt lgkmcnt(0)
  v_mfma_f32_16x16x32_bf16 v[196:199], v[108:111], v[220:223], v[196:199]
  v_mfma_f32_16x16x32_bf16 v[200:203], v[108:111], v[224:227], v[200:203]
  v_mfma_f32_16x16x32_bf16 v[204:207], v[108:111], v[228:231], v[204:207]
  ds_read_b128 v[208:211], v3 offset:30720
  ds_read_b128 v[212:215], v3 offset:31744
  ds_read_b128 v[216:219], v3 offset:32768
  ds_read_b128 v[220:223], v3 offset:33792
  ds_read_b128 v[224:227], v3 offset:34816
  ds_read_b128 v[228:231], v3 offset:35840
  s_add_u32 m0, s33, 4096
  s_nop 0
  buffer_load_dwordx4 v4, s[12:15], s46 offen offset:0 nt lds
  buffer_load_dwordx4 v5, s[12:15], s46 offen offset:1024 nt lds
  buffer_load_dwordx4 v6, s[12:15], s46 offen offset:2048 nt lds
  buffer_load_dwordx4 v7, s[12:15], s46 offen offset:3072 nt lds
  s_add_u32 s35, s35, 16384
  s_waitcnt vmcnt(8)
  ds_read_b64_tr_b16 v[112:113], v8 offset:16384
  ds_read_b64_tr_b16 v[114:115], v8 offset:20480
  ds_read_b64_tr_b16 v[116:117], v9 offset:16384
  ds_read_b64_tr_b16 v[118:119], v9 offset:20480
  ds_read_b64_tr_b16 v[120:121], v10 offset:16384
  ds_read_b64_tr_b16 v[122:123], v10 offset:20480
  ds_read_b64_tr_b16 v[124:125], v11 offset:16384
  ds_read_b64_tr_b16 v[126:127], v11 offset:20480
  ds_read_b64_tr_b16 v[128:129], v8 offset:18432
  ds_read_b64_tr_b16 v[130:131], v8 offset:22528
  ds_read_b64_tr_b16 v[132:133], v9 offset:18432
  ds_read_b64_tr_b16 v[134:135], v9 offset:22528
  s_waitcnt lgkmcnt(10)
  v_mfma_f32_16x16x32_bf16 v[160:163], v[112:115], v[208:211], v[160:163]
  v_mfma_f32_16x16x32_bf16 v[164:167], v[112:115], v[212:215], v[164:167]
  v_mfma_f32_16x16x32_bf16 v[168:171], v[112:115], v[216:219], v[168:171]
  ds_read_b64_tr_b16 v[136:137], v10 offset:18432
  ds_read_b64_tr_b16 v[138:139], v10 offset:22528
  s_waitcnt lgkmcnt(10)
  v_mfma_f32_16x16x32_bf16 v[172:175], v[116:119], v[208:211], v[172:175]
  v_mfma_f32_16x16x32_bf16 v[176:179], v[116:119], v[212:215], v[176:179]
  v_mfma_f32_16x16x32_bf16 v[180:183], v[116:119], v[216:219], v[180:183]
  ds_read_b64_tr_b16 v[140:141], v11 offset:18432
  ds_read_b64_tr_b16 v[142:143], v11 offset:22528
  s_waitcnt lgkmcnt(10)
  v_mfma_f32_16x16x32_bf16 v[184:187], v[120:123], v[208:211], v[184:187]
  s_add_u32 m0, s33, 8192
  s_add_u32 s46, s35, 32768
  buffer_load_dwordx4 v4, s[12:15], s35 offen offset:0 nt lds
  v_mfma_f32_16x16x32_bf16 v[188:191], v[120:123], v[212:215], v[188:191]
  v_mfma_f32_16x16x32_bf16 v[192:195], v[120:123], v[216:219], v[192:195]
  s_waitcnt lgkmcnt(8)
  v_mfma_f32_16x16x32_bf16 v[196:199], v[124:127], v[208:211], v[196:199]
  v_mfma_f32_16x16x32_bf16 v[200:203], v[124:127], v[212:215], v[200:203]
  v_mfma_f32_16x16x32_bf16 v[204:207], v[124:127], v[216:219], v[204:207]
  s_waitcnt lgkmcnt(6)
  v_mfma_f32_16x16x32_bf16 v[160:163], v[128:131], v[220:223], v[160:163]
  v_mfma_f32_16x16x32_bf16 v[164:167], v[128:131], v[224:227], v[164:167]
  buffer_load_dwordx4 v5, s[12:15], s35 offen offset:1024 nt lds
  v_mfma_f32_16x16x32_bf16 v[168:171], v[128:131], v[228:231], v[168:171]
  s_waitcnt lgkmcnt(4)
  v_mfma_f32_16x16x32_bf16 v[172:175], v[132:135], v[220:223], v[172:175]
  v_mfma_f32_16x16x32_bf16 v[176:179], v[132:135], v[224:227], v[176:179]
  v_mfma_f32_16x16x32_bf16 v[180:183], v[132:135], v[228:231], v[180:183]
  s_waitcnt lgkmcnt(2)
  v_mfma_f32_16x16x32_bf16 v[184:187], v[136:139], v[220:223], v[184:187]
  v_mfma_f32_16x16x32_bf16 v[188:191], v[136:139], v[224:227], v[188:191]
  v_mfma_f32_16x16x32_bf16 v[192:195], v[136:139], v[228:231], v[192:195]
  buffer_load_dwordx4 v6, s[12:15], s35 offen offset:2048 nt lds
  s_waitcnt lgkmcnt(0)
  v_mfma_f32_16x16x32_bf16 v[196:199], v[140:143], v[220:223], v[196:199]
  v_mfma_f32_16x16x32_bf16 v[200:203], v[140:143], v[224:227], v[200:203]
  v_mfma_f32_16x16x32_bf16 v[204:207], v[140:143], v[228:231], v[204:207]
  ds_read_b128 v[208:211], v3 offset:36864
  ds_read_b128 v[212:215], v3 offset:37888
  ds_read_b128 v[216:219], v3 offset:38912
  ds_read_b128 v[220:223], v3 offset:39936
  ds_read_b128 v[224:227], v3 offset:40960
  ds_read_b128 v[228:231], v3 offset:41984
  buffer_load_dwordx4 v7, s[12:15], s35 offen offset:3072 nt lds
  s_add_u32 m0, s33, 12288
  s_nop 0
  buffer_load_dwordx4 v4, s[12:15], s46 offen offset:0 nt lds
  buffer_load_dwordx4 v5, s[12:15], s46 offen offset:1024 nt lds
  buffer_load_dwordx4 v6, s[12:15], s46 offen offset:2048 nt lds
  buffer_load_dwordx4 v7, s[12:15], s46 offen offset:3072 nt lds
  s_add_u32 s35, s35, 33341440
  s_waitcnt vmcnt(8)
  ds_read_b64_tr_b16 v[80:81], v8 offset:0
  ds_read_b64_tr_b16 v[82:83], v8 offset:4096
  ds_read_b64_tr_b16 v[84:85], v9 offset:0
  ds_read_b64_tr_b16 v[86:87], v9 offset:4096
  ds_read_b64_tr_b16 v[88:89], v10 offset:0
  ds_read_b64_tr_b16 v[90:91], v10 offset:4096
  ds_read_b64_tr_b16 v[92:93], v11 offset:0
  ds_read_b64_tr_b16 v[94:95], v11 offset:4096
  ds_read_b64_tr_b16 v[96:97], v8 offset:2048
  ds_read_b64_tr_b16 v[98:99], v8 offset:6144
  ds_read_b64_tr_b16 v[100:101], v9 offset:2048
  ds_read_b64_tr_b16 v[102:103], v9 offset:6144
  s_waitcnt lgkmcnt(10)
  v_mfma_f32_16x16x32_bf16 v[160:163], v[80:83], v[208:211], v[160:163]
  v_mfma_f32_16x16x32_bf16 v[164:167], v[80:83], v[212:215], v[164:167]
  v_mfma_f32_16x16x32_bf16 v[168:171], v[80:83], v[216:219], v[168:171]
  ds_read_b64_tr_b16 v[104:105], v10 offset:2048
  ds_read_b64_tr_b16 v[106:107], v10 offset:6144
  s_waitcnt lgkmcnt(10)
  v_mfma_f32_16x16x32_bf16 v[172:175], v[84:87], v[208:211], v[172:175]
  v_mfma_f32_16x16x32_bf16 v[176:179], v[84:87], v[212:215], v[176:179]
  v_mfma_f32_16x16x32_bf16 v[180:183], v[84:87], v[216:219], v[180:183]
  ds_read_b64_tr_b16 v[108:109], v11 offset:2048
  ds_read_b64_tr_b16 v[110:111], v11 offset:6144
  s_waitcnt lgkmcnt(10)
  v_mfma_f32_16x16x32_bf16 v[184:187], v[88:91], v[208:211], v[184:187]
  s_add_u32 m0, s33, 16384
  s_add_u32 s46, s34, 256
  buffer_load_dwordx4 v16, s[8:11], s34 offen offset:0 nt lds
  v_mfma_f32_16x16x32_bf16 v[188:191], v[88:91], v[212:215], v[188:191]
  v_mfma_f32_16x16x32_bf16 v[192:195], v[88:91], v[216:219], v[192:195]
  s_waitcnt lgkmcnt(8)
  v_mfma_f32_16x16x32_bf16 v[196:199], v[92:95], v[208:211], v[196:199]
  v_mfma_f32_16x16x32_bf16 v[200:203], v[92:95], v[212:215], v[200:203]
  v_mfma_f32_16x16x32_bf16 v[204:207], v[92:95], v[216:219], v[204:207]
  s_waitcnt lgkmcnt(6)
  v_mfma_f32_16x16x32_bf16 v[160:163], v[96:99], v[220:223], v[160:163]
  v_mfma_f32_16x16x32_bf16 v[164:167], v[96:99], v[224:227], v[164:167]
  buffer_load_dwordx4 v17, s[8:11], s34 offen offset:1024 nt lds
  v_mfma_f32_16x16x32_bf16 v[168:171], v[96:99], v[228:231], v[168:171]
  s_waitcnt lgkmcnt(4)
  v_mfma_f32_16x16x32_bf16 v[172:175], v[100:103], v[220:223], v[172:175]
  v_mfma_f32_16x16x32_bf16 v[176:179], v[100:103], v[224:227], v[176:179]
  v_mfma_f32_16x16x32_bf16 v[180:183], v[100:103], v[228:231], v[180:183]
  s_waitcnt lgkmcnt(2)
  v_mfma_f32_16x16x32_bf16 v[184:187], v[104:107], v[220:223], v[184:187]
  v_mfma_f32_16x16x32_bf16 v[188:191], v[104:107], v[224:227], v[188:191]
  v_mfma_f32_16x16x32_bf16 v[192:195], v[104:107], v[228:231], v[192:195]
  buffer_load_dwordx4 v18, s[8:11], s34 offen offset:2048 nt lds
  s_waitcnt lgkmcnt(0)
  v_mfma_f32_16x16x32_bf16 v[196:199], v[108:111], v[220:223], v[196:199]
  v_mfma_f32_16x16x32_bf16 v[200:203], v[108:111], v[224:227], v[200:203]
  v_mfma_f32_16x16x32_bf16 v[204:207], v[108:111], v[228:231], v[204:207]
  ds_read_b128 v[208:211], v3 offset:43008
  ds_read_b128 v[212:215], v3 offset:44032
  ds_read_b128 v[216:219], v3 offset:45056
  ds_read_b128 v[220:223], v3 offset:46080
  ds_read_b128 v[224:227], v3 offset:47104
  ds_read_b128 v[228:231], v3 offset:48128
  s_waitcnt lgkmcnt(0)
  buffer_load_dwordx4 v19, s[8:11], s34 offen offset:3072 nt lds
  s_barrier
  ds_write_b64 v42, a[224:225] offset:24576
  ds_write_b64 v42, a[226:227] offset:25600
  ds_write_b64 v42, a[228:229] offset:26624
  ds_write_b64 v42, a[230:231] offset:25088
  ds_write_b64 v42, a[232:233] offset:26112
  ds_write_b64 v42, a[234:235] offset:27136
  ds_write_b64 v42, a[236:237] offset:27648
  ds_write_b64 v42, a[238:239] offset:28672
  ds_write_b64 v42, a[240:241] offset:29696
  s_add_u32 m0, s33, 20480
  s_nop 0
  buffer_load_dwordx4 v16, s[8:11], s46 offen offset:0 nt lds
  ds_write_b64 v42, a[242:243] offset:28160
  ds_write_b64 v42, a[244:245] offset:29184
  ds_write_b64 v42, a[246:247] offset:30208
  s_waitcnt lgkmcnt(0)
  buffer_load_dwordx4 v17, s[8:11], s46 offen offset:1024 nt lds
  buffer_load_dwordx4 v18, s[8:11], s46 offen offset:2048 nt lds
  buffer_load_dwordx4 v19, s[8:11], s46 offen offset:3072 nt lds
  s_add_u32 s34, s34, 32768
  s_waitcnt vmcnt(8)
  ds_read_b64_tr_b16 v[112:113], v8 offset:8192
  ds_read_b64_tr_b16 v[114:115], v8 offset:12288
  ds_read_b64_tr_b16 v[116:117], v9 offset:8192
  ds_read_b64_tr_b16 v[118:119], v9 offset:12288
  ds_read_b64_tr_b16 v[120:121], v10 offset:8192
  ds_read_b64_tr_b16 v[122:123], v10 offset:12288
  ds_read_b64_tr_b16 v[124:125], v11 offset:8192
  ds_read_b64_tr_b16 v[126:127], v11 offset:12288
  ds_read_b64_tr_b16 v[128:129], v8 offset:10240
  ds_read_b64_tr_b16 v[130:131], v8 offset:14336
  ds_read_b64_tr_b16 v[132:133], v9 offset:10240
  ds_read_b64_tr_b16 v[134:135], v9 offset:14336
  s_waitcnt lgkmcnt(10)
  v_mfma_f32_16x16x32_bf16 v[160:163], v[112:115], v[208:211], v[160:163]
  v_mfma_f32_16x16x32_bf16 v[164:167], v[112:115], v[212:215], v[164:167]
  v_mfma_f32_16x16x32_bf16 v[168:171], v[112:115], v[216:219], v[168:171]
  ds_read_b64_tr_b16 v[136:137], v10 offset:10240
  ds_read_b64_tr_b16 v[138:139], v10 offset:14336
  s_waitcnt lgkmcnt(10)
  v_mfma_f32_16x16x32_bf16 v[172:175], v[116:119], v[208:211], v[172:175]
  v_mfma_f32_16x16x32_bf16 v[176:179], v[116:119], v[212:215], v[176:179]
  v_mfma_f32_16x16x32_bf16 v[180:183], v[116:119], v[216:219], v[180:183]
  ds_read_b64_tr_b16 v[140:141], v11 offset:10240
  ds_read_b64_tr_b16 v[142:143], v11 offset:14336
  s_waitcnt lgkmcnt(10)
  v_mfma_f32_16x16x32_bf16 v[184:187], v[120:123], v[208:211], v[184:187]
  s_add_u32 m0, s33, 0
  s_add_u32 s46, s34, 256
  buffer_load_dwordx4 v16, s[8:11], s34 offen offset:0 nt lds
  v_mfma_f32_16x16x32_bf16 v[188:191], v[120:123], v[212:215], v[188:191]
  v_mfma_f32_16x16x32_bf16 v[192:195], v[120:123], v[216:219], v[192:195]
  s_waitcnt lgkmcnt(8)
  v_mfma_f32_16x16x32_bf16 v[196:199], v[124:127], v[208:211], v[196:199]
  v_mfma_f32_16x16x32_bf16 v[200:203], v[124:127], v[212:215], v[200:203]
  v_mfma_f32_16x16x32_bf16 v[204:207], v[124:127], v[216:219], v[204:207]
  s_waitcnt lgkmcnt(6)
  v_mfma_f32_16x16x32_bf16 v[160:163], v[128:131], v[220:223], v[160:163]
  v_mfma_f32_16x16x32_bf16 v[164:167], v[128:131], v[224:227], v[164:167]
  buffer_load_dwordx4 v17, s[8:11], s34 offen offset:1024 nt lds
  v_mfma_f32_16x16x32_bf16 v[168:171], v[128:131], v[228:231], v[168:171]
  s_waitcnt lgkmcnt(4)
  v_mfma_f32_16x16x32_bf16 v[172:175], v[132:135], v[220:223], v[172:175]
  v_mfma_f32_16x16x32_bf16 v[176:179], v[132:135], v[224:227], v[176:179]
  v_mfma_f32_16x16x32_bf16 v[180:183], v[132:135], v[228:231], v[180:183]
  s_waitcnt lgkmcnt(2)
  v_mfma_f32_16x16x32_bf16 v[184:187], v[136:139], v[220:223], v[184:187]
  v_mfma_f32_16x16x32_bf16 v[188:191], v[136:139], v[224:227], v[188:191]
  v_mfma_f32_16x16x32_bf16 v[192:195], v[136:139], v[228:231], v[192:195]
  buffer_load_dwordx4 v18, s[8:11], s34 offen offset:2048 nt lds
  s_waitcnt lgkmcnt(0)
  v_mfma_f32_16x16x32_bf16 v[196:199], v[140:143], v[220:223], v[196:199]
  v_mfma_f32_16x16x32_bf16 v[200:203], v[140:143], v[224:227], v[200:203]
  v_mfma_f32_16x16x32_bf16 v[204:207], v[140:143], v[228:231], v[204:207]
  s_nop 2
  v_pk_mul_f32 v[160:161], v[160:161], v[32:33] op_sel_hi:[1,0]
  v_pk_mul_f32 v[162:163], v[162:163], v[32:33] op_sel_hi:[1,0]
  v_pk_mul_f32 v[172:173], v[172:173], v[32:33] op_sel_hi:[1,0]
  v_pk_mul_f32 v[174:175], v[174:175], v[32:33] op_sel_hi:[1,0]
  v_cvt_pk_bf16_f32 v160, v160, v161
  v_cvt_pk_bf16_f32 v161, v162, v163
  v_cvt_pk_bf16_f32 v162, v172, v173
  v_cvt_pk_bf16_f32 v163, v174, v175
  ds_write_b128 v15, v[160:163] offset:0
  v_pk_mul_f32 v[164:165], v[164:165], v[34:35] op_sel_hi:[1,0]
  v_pk_mul_f32 v[166:167], v[166:167], v[34:35] op_sel_hi:[1,0]
  v_pk_mul_f32 v[176:177], v[176:177], v[34:35] op_sel_hi:[1,0]
  v_pk_mul_f32 v[178:179], v[178:179], v[34:35] op_sel_hi:[1,0]
  v_cvt_pk_bf16_f32 v164, v164, v165
  v_cvt_pk_bf16_f32 v165, v166, v167
  v_cvt_pk_bf16_f32 v166, v176, v177
  v_cvt_pk_bf16_f32 v167, v178, v179
  ds_write_b128 v15, v[164:167] offset:1024
  v_pk_mul_f32 v[168:169], v[168:169], v[40:41] op_sel_hi:[1,0]
  v_pk_mul_f32 v[170:171], v[170:171], v[40:41] op_sel_hi:[1,0]
  v_pk_mul_f32 v[180:181], v[180:181], v[40:41] op_sel_hi:[1,0]
  v_pk_mul_f32 v[182:183], v[182:183], v[40:41] op_sel_hi:[1,0]
  v_cvt_pk_bf16_f32 v168, v168, v169
  v_cvt_pk_bf16_f32 v169, v170, v171
  v_cvt_pk_bf16_f32 v170, v180, v181
  v_cvt_pk_bf16_f32 v171, v182, v183
  ds_write_b128 v15, v[168:171] offset:2048
  v_pk_mul_f32 v[184:185], v[184:185], v[32:33] op_sel_hi:[1,0]
  buffer_load_dwordx4 v19, s[8:11], s34 offen offset:3072 nt lds
  v_pk_mul_f32 v[186:187], v[186:187], v[32:33] op_sel_hi:[1,0]
  v_pk_mul_f32 v[196:197], v[196:197], v[32:33] op_sel_hi:[1,0]
  v_pk_mul_f32 v[198:199], v[198:199], v[32:33] op_sel_hi:[1,0]
  v_cvt_pk_bf16_f32 v184, v184, v185
  v_cvt_pk_bf16_f32 v185, v186, v187
  v_cvt_pk_bf16_f32 v186, v196, v197
  v_cvt_pk_bf16_f32 v187, v198, v199
  ds_write_b128 v15, v[184:187] offset:3072
  v_pk_mul_f32 v[188:189], v[188:189], v[34:35] op_sel_hi:[1,0]
  v_pk_mul_f32 v[190:191], v[190:191], v[34:35] op_sel_hi:[1,0]
  v_pk_mul_f32 v[200:201], v[200:201], v[34:35] op_sel_hi:[1,0]
  v_pk_mul_f32 v[202:203], v[202:203], v[34:35] op_sel_hi:[1,0]
  v_cvt_pk_bf16_f32 v188, v188, v189
  v_cvt_pk_bf16_f32 v189, v190, v191
  v_cvt_pk_bf16_f32 v190, v200, v201
  v_cvt_pk_bf16_f32 v191, v202, v203
  ds_write_b128 v15, v[188:191] offset:4096
  v_pk_mul_f32 v[192:193], v[192:193], v[40:41] op_sel_hi:[1,0]
  v_pk_mul_f32 v[194:195], v[194:195], v[40:41] op_sel_hi:[1,0]
  v_pk_mul_f32 v[204:205], v[204:205], v[40:41] op_sel_hi:[1,0]
  v_pk_mul_f32 v[206:207], v[206:207], v[40:41] op_sel_hi:[1,0]
  v_cvt_pk_bf16_f32 v192, v192, v193
  s_add_u32 m0, s33, 4096
  s_nop 0
  buffer_load_dwordx4 v16, s[8:11], s46 offen offset:0 nt lds
  v_cvt_pk_bf16_f32 v193, v194, v195
  v_cvt_pk_bf16_f32 v194, v204, v205
  v_cvt_pk_bf16_f32 v195, v206, v207
  ds_write_b128 v15, v[192:195] offset:5120
  s_waitcnt lgkmcnt(0)
  s_barrier
  buffer_load_dwordx4 v17, s[8:11], s46 offen offset:1024 nt lds
  ds_read_b128 v[80:83], v3 offset:24576
  ds_read_b128 v[84:87], v3 offset:25600
  ds_read_b128 v[88:91], v3 offset:26624
  ds_read_b128 v[92:95], v3 offset:27648
  ds_read_b128 v[96:99], v3 offset:28672
  ds_read_b128 v[100:103], v3 offset:29696
  ds_read_b128 v[104:107], v3 offset:30720
  ds_read_b128 v[108:111], v3 offset:31744
  ds_read_b128 v[112:115], v3 offset:32768
  ds_read_b128 v[116:119], v3 offset:33792
  ds_read_b128 v[120:123], v3 offset:34816
  ds_read_b128 v[124:127], v3 offset:35840
  s_waitcnt lgkmcnt(0)
  buffer_load_dwordx4 v18, s[8:11], s46 offen offset:2048 nt lds
  ds_read_b128 v[128:131], v3 offset:36864
  ds_read_b128 v[132:135], v3 offset:37888
  ds_read_b128 v[136:139], v3 offset:38912
  ds_read_b128 v[140:143], v3 offset:39936
  ds_read_b128 v[144:147], v3 offset:40960
  ds_read_b128 v[148:151], v3 offset:41984
  ds_read_b128 v[152:155], v3 offset:43008
  ds_read_b128 v[156:159], v3 offset:44032
  ds_read_b128 v[24:27], v3 offset:45056
  ds_read_b128 v[28:31], v3 offset:46080
  ds_read_b128 a[248:251], v3 offset:47104
  ds_read_b128 a[252:255], v3 offset:48128
  s_waitcnt lgkmcnt(0)
  buffer_load_dwordx4 v19, s[8:11], s46 offen offset:3072 nt lds
  s_add_u32 s34, s34, 32768
  s_waitcnt vmcnt(8)
  ds_read_b128 v[48:51], v20 offset:16384
  ds_read_b128 v[52:55], v21 offset:16384
  ds_read_b128 v[56:59], v22 offset:16384
  ds_read_b128 v[60:63], v23 offset:16384
  ds_read_b128 v[64:67], v20 offset:20480
  ds_read_b128 v[68:71], v21 offset:20480
  ds_read_b128 v[72:75], v22 offset:20480
  ds_read_b128 v[76:79], v23 offset:20480
  s_waitcnt lgkmcnt(7)
  v_mfma_f32_16x16x32_bf16 v[160:163], v[48:51], v[80:83], 0
  v_mfma_f32_16x16x32_bf16 v[164:167], v[48:51], v[84:87], 0
  v_mfma_f32_16x16x32_bf16 v[168:171], v[48:51], v[88:91], 0
  s_waitcnt lgkmcnt(6)
  v_mfma_f32_16x16x32_bf16 v[160:163], v[52:55], v[92:95], v[160:163]
  v_mfma_f32_16x16x32_bf16 v[164:167], v[52:55], v[96:99], v[164:167]
  v_mfma_f32_16x16x32_bf16 v[168:171], v[52:55], v[100:103], v[168:171]
  s_waitcnt lgkmcnt(5)
  v_mfma_f32_16x16x32_bf16 v[160:163], v[56:59], v[104:107], v[160:163]
  s_add_u32 m0, s33, 8192
  s_add_u32 s46, s34, 256
  buffer_load_dwordx4 v16, s[8:11], s34 offen offset:0 nt lds
  v_mfma_f32_16x16x32_bf16 v[164:167], v[56:59], v[108:111], v[164:167]
  v_mfma_f32_16x16x32_bf16 v[168:171], v[56:59], v[112:115], v[168:171]
  s_waitcnt lgkmcnt(4)
  v_mfma_f32_16x16x32_bf16 v[160:163], v[60:63], v[116:119], v[160:163]
  v_mfma_f32_16x16x32_bf16 v[164:167], v[60:63], v[120:123], v[164:167]
  v_mfma_f32_16x16x32_bf16 v[168:171], v[60:63], v[124:127], v[168:171]
  s_waitcnt lgkmcnt(3)
  v_mfma_f32_16x16x32_bf16 v[160:163], v[64:67], v[128:131], v[160:163]
  v_mfma_f32_16x16x32_bf16 v[164:167], v[64:67], v[132:135], v[164:167]
  buffer_load_dwordx4 v17, s[8:11], s34 offen offset:1024 nt lds
  v_mfma_f32_16x16x32_bf16 v[168:171], v[64:67], v[136:139], v[168:171]
  s_waitcnt lgkmcnt(2)
  v_mfma_f32_16x16x32_bf16 v[160:163], v[68:71], v[140:143], v[160:163]
  v_mfma_f32_16x16x32_bf16 v[164:167], v[68:71], v[144:147], v[164:167]
  v_mfma_f32_16x16x32_bf16 v[168:171], v[68:71], v[148:151], v[168:171]
  s_waitcnt lgkmcnt(1)
  v_mfma_f32_16x16x32_bf16 v[160:163], v[72:75], v[152:155], v[160:163]
  v_mfma_f32_16x16x32_bf16 v[164:167], v[72:75], v[156:159], v[164:167]
  v_mfma_f32_16x16x32_bf16 v[168:171], v[72:75], v[24:27], v[168:171]
  buffer_load_dwordx4 v18, s[8:11], s34 offen offset:2048 nt lds
  s_waitcnt lgkmcnt(0)
  v_mfma_f32_16x16x32_bf16 v[160:163], v[76:79], v[28:31], v[160:163]
  v_mfma_f32_16x16x32_bf16 v[164:167], v[76:79], a[248:251], v[164:167]
  v_mfma_f32_16x16x32_bf16 v[168:171], v[76:79], a[252:255], v[168:171]
  buffer_load_dwordx4 v19, s[8:11], s34 offen offset:3072 nt lds
  s_add_u32 m0, s33, 12288
  s_nop 0
  buffer_load_dwordx4 v16, s[8:11], s46 offen offset:0 nt lds
  buffer_load_dwordx4 v17, s[8:11], s46 offen offset:1024 nt lds
  buffer_load_dwordx4 v18, s[8:11], s46 offen offset:2048 nt lds
  buffer_load_dwordx4 v19, s[8:11], s46 offen offset:3072 nt lds
  s_add_u32 s34, s34, 32768
  s_waitcnt vmcnt(8)
  ds_read_b128 v[48:51], v20 offset:0
  ds_read_b128 v[52:55], v21 offset:0
  ds_read_b128 v[56:59], v22 offset:0
  ds_read_b128 v[60:63], v23 offset:0
  ds_read_b128 v[64:67], v20 offset:4096
  ds_read_b128 v[68:71], v21 offset:4096
  ds_read_b128 v[72:75], v22 offset:4096
  ds_read_b128 v[76:79], v23 offset:4096
  s_waitcnt lgkmcnt(7)
  v_mfma_f32_16x16x32_bf16 v[172:175], v[48:51], v[80:83], 0
  v_mfma_f32_16x16x32_bf16 v[176:179], v[48:51], v[84:87], 0
  v_mfma_f32_16x16x32_bf16 v[180:183], v[48:51], v[88:91], 0
  s_waitcnt lgkmcnt(6)
  v_mfma_f32_16x16x32_bf16 v[172:175], v[52:55], v[92:95], v[172:175]
  v_mfma_f32_16x16x32_bf16 v[176:179], v[52:55], v[96:99], v[176:179]
  v_mfma_f32_16x16x32_bf16 v[180:183], v[52:55], v[100:103], v[180:183]
  s_waitcnt lgkmcnt(5)
  v_mfma_f32_16x16x32_bf16 v[172:175], v[56:59], v[104:107], v[172:175]
  s_add_u32 m0, s33, 16384
  s_add_u32 s46, s34, 256
  buffer_load_dwordx4 v16, s[8:11], s34 offen offset:0 nt lds
  v_mfma_f32_16x16x32_bf16 v[176:179], v[56:59], v[108:111], v[176:179]
  v_mfma_f32_16x16x32_bf16 v[180:183], v[56:59], v[112:115], v[180:183]
  s_waitcnt lgkmcnt(4)
  v_mfma_f32_16x16x32_bf16 v[172:175], v[60:63], v[116:119], v[172:175]
  v_mfma_f32_16x16x32_bf16 v[176:179], v[60:63], v[120:123], v[176:179]
  v_mfma_f32_16x16x32_bf16 v[180:183], v[60:63], v[124:127], v[180:183]
  s_waitcnt lgkmcnt(3)
  v_mfma_f32_16x16x32_bf16 v[172:175], v[64:67], v[128:131], v[172:175]
  v_mfma_f32_16x16x32_bf16 v[176:179], v[64:67], v[132:135], v[176:179]
  buffer_load_dwordx4 v17, s[8:11], s34 offen offset:1024 nt lds
  v_mfma_f32_16x16x32_bf16 v[180:183], v[64:67], v[136:139], v[180:183]
  s_waitcnt lgkmcnt(2)
  v_mfma_f32_16x16x32_bf16 v[172:175], v[68:71], v[140:143], v[172:175]
  v_mfma_f32_16x16x32_bf16 v[176:179], v[68:71], v[144:147], v[176:179]
  v_mfma_f32_16x16x32_bf16 v[180:183], v[68:71], v[148:151], v[180:183]
  s_waitcnt lgkmcnt(1)
  v_mfma_f32_16x16x32_bf16 v[172:175], v[72:75], v[152:155], v[172:175]
  v_mfma_f32_16x16x32_bf16 v[176:179], v[72:75], v[156:159], v[176:179]
  v_mfma_f32_16x16x32_bf16 v[180:183], v[72:75], v[24:27], v[180:183]
  buffer_load_dwordx4 v18, s[8:11], s34 offen offset:2048 nt lds
  s_waitcnt lgkmcnt(0)
  v_mfma_f32_16x16x32_bf16 v[172:175], v[76:79], v[28:31], v[172:175]
  v_mfma_f32_16x16x32_bf16 v[176:179], v[76:79], a[248:251], v[176:179]
  v_mfma_f32_16x16x32_bf16 v[180:183], v[76:79], a[252:255], v[180:183]
  buffer_load_dwordx4 v19, s[8:11], s34 offen offset:3072 nt lds
  s_add_u32 m0, s33, 20480
  s_nop 0
  buffer_load_dwordx4 v16, s[8:11], s46 offen offset:0 nt lds
  buffer_load_dwordx4 v17, s[8:11], s46 offen offset:1024 nt lds
  buffer_load_dwordx4 v18, s[8:11], s46 offen offset:2048 nt lds
  buffer_load_dwordx4 v19, s[8:11], s46 offen offset:3072 nt lds
  s_add_u32 s34, s34, 32768
  s_waitcnt vmcnt(8)
  ds_read_b128 v[48:51], v20 offset:8192
  ds_read_b128 v[52:55], v21 offset:8192
  ds_read_b128 v[56:59], v22 offset:8192
  ds_read_b128 v[60:63], v23 offset:8192
  ds_read_b128 v[64:67], v20 offset:12288
  ds_read_b128 v[68:71], v21 offset:12288
  ds_read_b128 v[72:75], v22 offset:12288
  ds_read_b128 v[76:79], v23 offset:12288
  s_waitcnt lgkmcnt(7)
  v_mfma_f32_16x16x32_bf16 v[184:187], v[48:51], v[80:83], 0
  v_mfma_f32_16x16x32_bf16 v[188:191], v[48:51], v[84:87], 0
  v_mfma_f32_16x16x32_bf16 v[192:195], v[48:51], v[88:91], 0
  s_waitcnt lgkmcnt(6)
  v_mfma_f32_16x16x32_bf16 v[184:187], v[52:55], v[92:95], v[184:187]
  v_mfma_f32_16x16x32_bf16 v[188:191], v[52:55], v[96:99], v[188:191]
  v_mfma_f32_16x16x32_bf16 v[192:195], v[52:55], v[100:103], v[192:195]
  s_waitcnt lgkmcnt(5)
  v_mfma_f32_16x16x32_bf16 v[184:187], v[56:59], v[104:107], v[184:187]
  s_add_u32 m0, s33, 0
  s_add_u32 s46, s34, 256
  buffer_load_dwordx4 v16, s[8:11], s34 offen offset:0 nt lds
  v_mfma_f32_16x16x32_bf16 v[188:191], v[56:59], v[108:111], v[188:191]
  v_mfma_f32_16x16x32_bf16 v[192:195], v[56:59], v[112:115], v[192:195]
  s_waitcnt lgkmcnt(4)
  v_mfma_f32_16x16x32_bf16 v[184:187], v[60:63], v[116:119], v[184:187]
  v_mfma_f32_16x16x32_bf16 v[188:191], v[60:63], v[120:123], v[188:191]
  v_mfma_f32_16x16x32_bf16 v[192:195], v[60:63], v[124:127], v[192:195]
  s_waitcnt lgkmcnt(3)
  v_mfma_f32_16x16x32_bf16 v[184:187], v[64:67], v[128:131], v[184:187]
  v_mfma_f32_16x16x32_bf16 v[188:191], v[64:67], v[132:135], v[188:191]
  buffer_load_dwordx4 v17, s[8:11], s34 offen offset:1024 nt lds
  v_mfma_f32_16x16x32_bf16 v[192:195], v[64:67], v[136:139], v[192:195]
  s_waitcnt lgkmcnt(2)
  v_mfma_f32_16x16x32_bf16 v[184:187], v[68:71], v[140:143], v[184:187]
  v_mfma_f32_16x16x32_bf16 v[188:191], v[68:71], v[144:147], v[188:191]
  v_mfma_f32_16x16x32_bf16 v[192:195], v[68:71], v[148:151], v[192:195]
  s_waitcnt lgkmcnt(1)
  v_mfma_f32_16x16x32_bf16 v[184:187], v[72:75], v[152:155], v[184:187]
  v_mfma_f32_16x16x32_bf16 v[188:191], v[72:75], v[156:159], v[188:191]
  v_mfma_f32_16x16x32_bf16 v[192:195], v[72:75], v[24:27], v[192:195]
  buffer_load_dwordx4 v18, s[8:11], s34 offen offset:2048 nt lds
  s_waitcnt lgkmcnt(0)
  v_mfma_f32_16x16x32_bf16 v[184:187], v[76:79], v[28:31], v[184:187]
  v_mfma_f32_16x16x32_bf16 v[188:191], v[76:79], a[248:251], v[188:191]
  v_mfma_f32_16x16x32_bf16 v[192:195], v[76:79], a[252:255], v[192:195]
  buffer_load_dwordx4 v19, s[8:11], s34 offen offset:3072 nt lds
  s_add_u32 m0, s33, 4096
  s_nop 0
  buffer_load_dwordx4 v16, s[8:11], s46 offen offset:0 nt lds
  buffer_load_dwordx4 v17, s[8:11], s46 offen offset:1024 nt lds
  buffer_load_dwordx4 v18, s[8:11], s46 offen offset:2048 nt lds
  buffer_load_dwordx4 v19, s[8:11], s46 offen offset:3072 nt lds
  s_add_u32 s34, s34, 32768
  s_waitcnt vmcnt(8)
  ds_read_b128 v[48:51], v20 offset:16384
  ds_read_b128 v[52:55], v21 offset:16384
  ds_read_b128 v[56:59], v22 offset:16384
  ds_read_b128 v[60:63], v23 offset:16384
  ds_read_b128 v[64:67], v20 offset:20480
  ds_read_b128 v[68:71], v21 offset:20480
  ds_read_b128 v[72:75], v22 offset:20480
  ds_read_b128 v[76:79], v23 offset:20480
  s_waitcnt lgkmcnt(7)
  v_mfma_f32_16x16x32_bf16 v[196:199], v[48:51], v[80:83], 0
  v_mfma_f32_16x16x32_bf16 v[200:203], v[48:51], v[84:87], 0
  v_mfma_f32_16x16x32_bf16 v[204:207], v[48:51], v[88:91], 0
  s_waitcnt lgkmcnt(6)
  v_mfma_f32_16x16x32_bf16 v[196:199], v[52:55], v[92:95], v[196:199]
  v_mfma_f32_16x16x32_bf16 v[200:203], v[52:55], v[96:99], v[200:203]
  v_mfma_f32_16x16x32_bf16 v[204:207], v[52:55], v[100:103], v[204:207]
  s_waitcnt lgkmcnt(5)
  v_mfma_f32_16x16x32_bf16 v[196:199], v[56:59], v[104:107], v[196:199]
  s_add_u32 m0, s33, 8192
  s_add_u32 s46, s34, 256
  buffer_load_dwordx4 v16, s[8:11], s34 offen offset:0 nt lds
  v_mfma_f32_16x16x32_bf16 v[200:203], v[56:59], v[108:111], v[200:203]
  v_mfma_f32_16x16x32_bf16 v[204:207], v[56:59], v[112:115], v[204:207]
  s_waitcnt lgkmcnt(4)
  v_mfma_f32_16x16x32_bf16 v[196:199], v[60:63], v[116:119], v[196:199]
  v_mfma_f32_16x16x32_bf16 v[200:203], v[60:63], v[120:123], v[200:203]
  v_mfma_f32_16x16x32_bf16 v[204:207], v[60:63], v[124:127], v[204:207]
  s_waitcnt lgkmcnt(3)
  v_mfma_f32_16x16x32_bf16 v[196:199], v[64:67], v[128:131], v[196:199]
  v_mfma_f32_16x16x32_bf16 v[200:203], v[64:67], v[132:135], v[200:203]
  buffer_load_dwordx4 v17, s[8:11], s34 offen offset:1024 nt lds
  v_mfma_f32_16x16x32_bf16 v[204:207], v[64:67], v[136:139], v[204:207]
  s_waitcnt lgkmcnt(2)
  v_mfma_f32_16x16x32_bf16 v[196:199], v[68:71], v[140:143], v[196:199]
  v_mfma_f32_16x16x32_bf16 v[200:203], v[68:71], v[144:147], v[200:203]
  v_mfma_f32_16x16x32_bf16 v[204:207], v[68:71], v[148:151], v[204:207]
  s_waitcnt lgkmcnt(1)
  v_mfma_f32_16x16x32_bf16 v[196:199], v[72:75], v[152:155], v[196:199]
  v_mfma_f32_16x16x32_bf16 v[200:203], v[72:75], v[156:159], v[200:203]
  v_mfma_f32_16x16x32_bf16 v[204:207], v[72:75], v[24:27], v[204:207]
  buffer_load_dwordx4 v18, s[8:11], s34 offen offset:2048 nt lds
  s_waitcnt lgkmcnt(0)
  v_mfma_f32_16x16x32_bf16 v[196:199], v[76:79], v[28:31], v[196:199]
  v_mfma_f32_16x16x32_bf16 v[200:203], v[76:79], a[248:251], v[200:203]
  v_mfma_f32_16x16x32_bf16 v[204:207], v[76:79], a[252:255], v[204:207]
  buffer_load_dwordx4 v19, s[8:11], s34 offen offset:3072 nt lds
  s_add_u32 m0, s33, 12288
  s_nop 0
  buffer_load_dwordx4 v16, s[8:11], s46 offen offset:0 nt lds
  buffer_load_dwordx4 v17, s[8:11], s46 offen offset:1024 nt lds
  buffer_load_dwordx4 v18, s[8:11], s46 offen offset:2048 nt lds
  buffer_load_dwordx4 v19, s[8:11], s46 offen offset:3072 nt lds
  s_add_u32 s34, s34, 32768
  s_waitcnt vmcnt(8)
  ds_read_b128 v[48:51], v20 offset:0
  ds_read_b128 v[52:55], v21 offset:0
  ds_read_b128 v[56:59], v22 offset:0
  ds_read_b128 v[60:63], v23 offset:0
  ds_read_b128 v[64:67], v20 offset:4096
  ds_read_b128 v[68:71], v21 offset:4096
  ds_read_b128 v[72:75], v22 offset:4096
  ds_read_b128 v[76:79], v23 offset:4096
  s_waitcnt lgkmcnt(7)
  v_mfma_f32_16x16x32_bf16 v[208:211], v[48:51], v[80:83], 0
  v_mfma_f32_16x16x32_bf16 v[212:215], v[48:51], v[84:87], 0
  v_mfma_f32_16x16x32_bf16 v[216:219], v[48:51], v[88:91], 0
  s_waitcnt lgkmcnt(6)
  v_mfma_f32_16x16x32_bf16 v[208:211], v[52:55], v[92:95], v[208:211]
  v_mfma_f32_16x16x32_bf16 v[212:215], v[52:55], v[96:99], v[212:215]
  v_mfma_f32_16x16x32_bf16 v[216:219], v[52:55], v[100:103], v[216:219]
  s_waitcnt lgkmcnt(5)
  v_mfma_f32_16x16x32_bf16 v[208:211], v[56:59], v[104:107], v[208:211]
  s_add_u32 m0, s33, 16384
  s_add_u32 s46, s34, 256
  buffer_load_dwordx4 v16, s[8:11], s34 offen offset:0 nt lds
  v_mfma_f32_16x16x32_bf16 v[212:215], v[56:59], v[108:111], v[212:215]
  v_mfma_f32_16x16x32_bf16 v[216:219], v[56:59], v[112:115], v[216:219]
  s_waitcnt lgkmcnt(4)
  v_mfma_f32_16x16x32_bf16 v[208:211], v[60:63], v[116:119], v[208:211]
  v_mfma_f32_16x16x32_bf16 v[212:215], v[60:63], v[120:123], v[212:215]
  v_mfma_f32_16x16x32_bf16 v[216:219], v[60:63], v[124:127], v[216:219]
  s_waitcnt lgkmcnt(3)
  v_mfma_f32_16x16x32_bf16 v[208:211], v[64:67], v[128:131], v[208:211]
  v_mfma_f32_16x16x32_bf16 v[212:215], v[64:67], v[132:135], v[212:215]
  buffer_load_dwordx4 v17, s[8:11], s34 offen offset:1024 nt lds
  v_mfma_f32_16x16x32_bf16 v[216:219], v[64:67], v[136:139], v[216:219]
  s_waitcnt lgkmcnt(2)
  v_mfma_f32_16x16x32_bf16 v[208:211], v[68:71], v[140:143], v[208:211]
  v_mfma_f32_16x16x32_bf16 v[212:215], v[68:71], v[144:147], v[212:215]
  v_mfma_f32_16x16x32_bf16 v[216:219], v[68:71], v[148:151], v[216:219]
  s_waitcnt lgkmcnt(1)
  v_mfma_f32_16x16x32_bf16 v[208:211], v[72:75], v[152:155], v[208:211]
  v_mfma_f32_16x16x32_bf16 v[212:215], v[72:75], v[156:159], v[212:215]
  v_mfma_f32_16x16x32_bf16 v[216:219], v[72:75], v[24:27], v[216:219]
  buffer_load_dwordx4 v18, s[8:11], s34 offen offset:2048 nt lds
  s_waitcnt lgkmcnt(0)
  v_mfma_f32_16x16x32_bf16 v[208:211], v[76:79], v[28:31], v[208:211]
  v_mfma_f32_16x16x32_bf16 v[212:215], v[76:79], a[248:251], v[212:215]
  v_mfma_f32_16x16x32_bf16 v[216:219], v[76:79], a[252:255], v[216:219]
  buffer_load_dwordx4 v19, s[8:11], s34 offen offset:3072 nt lds
  s_add_u32 m0, s33, 20480
  s_nop 0
  buffer_load_dwordx4 v16, s[8:11], s46 offen offset:0 nt lds
  buffer_load_dwordx4 v17, s[8:11], s46 offen offset:1024 nt lds
  buffer_load_dwordx4 v18, s[8:11], s46 offen offset:2048 nt lds
  buffer_load_dwordx4 v19, s[8:11], s46 offen offset:3072 nt lds
  s_add_u32 s34, s34, 32768
  s_waitcnt vmcnt(8)
  ds_read_b128 v[48:51], v20 offset:8192
  ds_read_b128 v[52:55], v21 offset:8192
  ds_read_b128 v[56:59], v22 offset:8192
  ds_read_b128 v[60:63], v23 offset:8192
  ds_read_b128 v[64:67], v20 offset:12288
  ds_read_b128 v[68:71], v21 offset:12288
  ds_read_b128 v[72:75], v22 offset:12288
  ds_read_b128 v[76:79], v23 offset:12288
  s_waitcnt lgkmcnt(7)
  v_mfma_f32_16x16x32_bf16 v[220:223], v[48:51], v[80:83], 0
  v_mfma_f32_16x16x32_bf16 v[224:227], v[48:51], v[84:87], 0
  v_mfma_f32_16x16x32_bf16 v[228:231], v[48:51], v[88:91], 0
  s_waitcnt lgkmcnt(6)
  v_mfma_f32_16x16x32_bf16 v[220:223], v[52:55], v[92:95], v[220:223]
  v_mfma_f32_16x16x32_bf16 v[224:227], v[52:55], v[96:99], v[224:227]
  v_mfma_f32_16x16x32_bf16 v[228:231], v[52:55], v[100:103], v[228:231]
  s_waitcnt lgkmcnt(5)
  v_mfma_f32_16x16x32_bf16 v[220:223], v[56:59], v[104:107], v[220:223]
  s_add_u32 m0, s33, 0
  s_add_u32 s46, s34, 256
  buffer_load_dwordx4 v16, s[8:11], s34 offen offset:0 nt lds
  v_mfma_f32_16x16x32_bf16 v[224:227], v[56:59], v[108:111], v[224:227]
  v_mfma_f32_16x16x32_bf16 v[228:231], v[56:59], v[112:115], v[228:231]
  s_waitcnt lgkmcnt(4)
  v_mfma_f32_16x16x32_bf16 v[220:223], v[60:63], v[116:119], v[220:223]
  v_mfma_f32_16x16x32_bf16 v[224:227], v[60:63], v[120:123], v[224:227]
  v_mfma_f32_16x16x32_bf16 v[228:231], v[60:63], v[124:127], v[228:231]
  s_waitcnt lgkmcnt(3)
  v_mfma_f32_16x16x32_bf16 v[220:223], v[64:67], v[128:131], v[220:223]
  v_mfma_f32_16x16x32_bf16 v[224:227], v[64:67], v[132:135], v[224:227]
  buffer_load_dwordx4 v17, s[8:11], s34 offen offset:1024 nt lds
  v_mfma_f32_16x16x32_bf16 v[228:231], v[64:67], v[136:139], v[228:231]
  s_waitcnt lgkmcnt(2)
  v_mfma_f32_16x16x32_bf16 v[220:223], v[68:71], v[140:143], v[220:223]
  v_mfma_f32_16x16x32_bf16 v[224:227], v[68:71], v[144:147], v[224:227]
  v_mfma_f32_16x16x32_bf16 v[228:231], v[68:71], v[148:151], v[228:231]
  s_waitcnt lgkmcnt(1)
  v_mfma_f32_16x16x32_bf16 v[220:223], v[72:75], v[152:155], v[220:223]
  v_mfma_f32_16x16x32_bf16 v[224:227], v[72:75], v[156:159], v[224:227]
  v_mfma_f32_16x16x32_bf16 v[228:231], v[72:75], v[24:27], v[228:231]
  buffer_load_dwordx4 v18, s[8:11], s34 offen offset:2048 nt lds
  s_waitcnt lgkmcnt(0)
  v_mfma_f32_16x16x32_bf16 v[220:223], v[76:79], v[28:31], v[220:223]
  v_mfma_f32_16x16x32_bf16 v[224:227], v[76:79], a[248:251], v[224:227]
  v_mfma_f32_16x16x32_bf16 v[228:231], v[76:79], a[252:255], v[228:231]
  buffer_load_dwordx4 v19, s[8:11], s34 offen offset:3072 nt lds
  s_add_u32 m0, s33, 4096
  s_nop 0
  buffer_load_dwordx4 v16, s[8:11], s46 offen offset:0 nt lds
  buffer_load_dwordx4 v17, s[8:11], s46 offen offset:1024 nt lds
  buffer_load_dwordx4 v18, s[8:11], s46 offen offset:2048 nt lds
  buffer_load_dwordx4 v19, s[8:11], s46 offen offset:3072 nt lds
  s_add_u32 s34, s34, 32768
  s_waitcnt vmcnt(8)
  ds_read_b128 v[48:51], v20 offset:16384
  ds_read_b128 v[52:55], v21 offset:16384
  ds_read_b128 v[56:59], v22 offset:16384
  ds_read_b128 v[60:63], v23 offset:16384
  ds_read_b128 v[64:67], v20 offset:20480
  ds_read_b128 v[68:71], v21 offset:20480
  ds_read_b128 v[72:75], v22 offset:20480
  ds_read_b128 v[76:79], v23 offset:20480
  s_waitcnt lgkmcnt(7)
  v_mfma_f32_16x16x32_bf16 v[232:235], v[48:51], v[80:83], 0
  v_mfma_f32_16x16x32_bf16 v[236:239], v[48:51], v[84:87], 0
  v_mfma_f32_16x16x32_bf16 v[240:243], v[48:51], v[88:91], 0
  s_waitcnt lgkmcnt(6)
  v_mfma_f32_16x16x32_bf16 v[232:235], v[52:55], v[92:95], v[232:235]
  v_mfma_f32_16x16x32_bf16 v[236:239], v[52:55], v[96:99], v[236:239]
  v_mfma_f32_16x16x32_bf16 v[240:243], v[52:55], v[100:103], v[240:243]
  s_waitcnt lgkmcnt(5)
  v_mfma_f32_16x16x32_bf16 v[232:235], v[56:59], v[104:107], v[232:235]
  s_add_u32 m0, s33, 8192
  s_add_u32 s46, s37, 14336
  buffer_load_dwordx4 v36, s[20:23], s37 offen offset:0 lds
  v_mfma_f32_16x16x32_bf16 v[236:239], v[56:59], v[108:111], v[236:239]
  v_mfma_f32_16x16x32_bf16 v[240:243], v[56:59], v[112:115], v[240:243]
  s_waitcnt lgkmcnt(4)
  v_mfma_f32_16x16x32_bf16 v[232:235], v[60:63], v[116:119], v[232:235]
  buffer_load_dwordx4 v37, s[20:23], s37 offen offset:1024 lds
  v_mfma_f32_16x16x32_bf16 v[236:239], v[60:63], v[120:123], v[236:239]
  v_mfma_f32_16x16x32_bf16 v[240:243], v[60:63], v[124:127], v[240:243]
  s_waitcnt lgkmcnt(3)
  v_mfma_f32_16x16x32_bf16 v[232:235], v[64:67], v[128:131], v[232:235]
  buffer_load_dwordx4 v38, s[20:23], s37 offen offset:2048 lds
  v_mfma_f32_16x16x32_bf16 v[236:239], v[64:67], v[132:135], v[236:239]
  v_mfma_f32_16x16x32_bf16 v[240:243], v[64:67], v[136:139], v[240:243]
  s_waitcnt lgkmcnt(2)
  v_mfma_f32_16x16x32_bf16 v[232:235], v[68:71], v[140:143], v[232:235]
  buffer_load_dwordx4 v39, s[20:23], s37 offen offset:3072 lds
  v_mfma_f32_16x16x32_bf16 v[236:239], v[68:71], v[144:147], v[236:239]
  v_mfma_f32_16x16x32_bf16 v[240:243], v[68:71], v[148:151], v[240:243]
  s_waitcnt lgkmcnt(1)
  v_mfma_f32_16x16x32_bf16 v[232:235], v[72:75], v[152:155], v[232:235]
  s_add_u32 m0, s33, 12288
  s_nop 0
  buffer_load_dwordx4 v36, s[20:23], s46 offen offset:0 lds
  v_mfma_f32_16x16x32_bf16 v[236:239], v[72:75], v[156:159], v[236:239]
  v_mfma_f32_16x16x32_bf16 v[240:243], v[72:75], v[24:27], v[240:243]
  s_waitcnt lgkmcnt(0)
  v_mfma_f32_16x16x32_bf16 v[232:235], v[76:79], v[28:31], v[232:235]
  buffer_load_dwordx4 v37, s[20:23], s46 offen offset:1024 lds
  v_mfma_f32_16x16x32_bf16 v[236:239], v[76:79], a[248:251], v[236:239]
  v_mfma_f32_16x16x32_bf16 v[240:243], v[76:79], a[252:255], v[240:243]
  buffer_load_dwordx4 v38, s[20:23], s46 offen offset:2048 lds
  buffer_load_dwordx4 v39, s[20:23], s46 offen offset:3072 lds
  s_add_u32 s37, s37, 28672
  s_cmp_eq_u32 s37, s38
  s_cselect_b32 s47, 229376, 0
  s_sub_u32 s37, s37, s47
  s_waitcnt vmcnt(8)
  ds_read_b128 v[48:51], v20 offset:0
  ds_read_b128 v[52:55], v21 offset:0
  ds_read_b128 v[56:59], v22 offset:0
  ds_read_b128 v[60:63], v23 offset:0
  ds_read_b128 v[64:67], v20 offset:4096
  ds_read_b128 v[68:71], v21 offset:4096
  ds_read_b128 v[72:75], v22 offset:4096
  ds_read_b128 v[76:79], v23 offset:4096
  s_waitcnt lgkmcnt(7)
  v_mfma_f32_16x16x32_bf16 v[244:247], v[48:51], v[80:83], 0
  v_mfma_f32_16x16x32_bf16 v[248:251], v[48:51], v[84:87], 0
  v_mfma_f32_16x16x32_bf16 v[252:255], v[48:51], v[88:91], 0
  s_waitcnt lgkmcnt(6)
  v_mfma_f32_16x16x32_bf16 v[244:247], v[52:55], v[92:95], v[244:247]
  v_mfma_f32_16x16x32_bf16 v[248:251], v[52:55], v[96:99], v[248:251]
  v_mfma_f32_16x16x32_bf16 v[252:255], v[52:55], v[100:103], v[252:255]
  s_waitcnt lgkmcnt(5)
  v_mfma_f32_16x16x32_bf16 v[244:247], v[56:59], v[104:107], v[244:247]
  s_add_u32 m0, s33, 16384
  s_add_u32 s46, s37, 14336
  buffer_load_dwordx4 v36, s[20:23], s37 offen offset:0 lds
  v_mfma_f32_16x16x32_bf16 v[248:251], v[56:59], v[108:111], v[248:251]
  v_mfma_f32_16x16x32_bf16 v[252:255], v[56:59], v[112:115], v[252:255]
  s_waitcnt lgkmcnt(4)
  v_mfma_f32_16x16x32_bf16 v[244:247], v[60:63], v[116:119], v[244:247]
  buffer_load_dwordx4 v37, s[20:23], s37 offen offset:1024 lds
  v_mfma_f32_16x16x32_bf16 v[248:251], v[60:63], v[120:123], v[248:251]
  v_mfma_f32_16x16x32_bf16 v[252:255], v[60:63], v[124:127], v[252:255]
  s_waitcnt lgkmcnt(3)
  v_mfma_f32_16x16x32_bf16 v[244:247], v[64:67], v[128:131], v[244:247]
  buffer_load_dwordx4 v38, s[20:23], s37 offen offset:2048 lds
  v_mfma_f32_16x16x32_bf16 v[248:251], v[64:67], v[132:135], v[248:251]
  v_mfma_f32_16x16x32_bf16 v[252:255], v[64:67], v[136:139], v[252:255]
  s_waitcnt lgkmcnt(2)
  v_mfma_f32_16x16x32_bf16 v[244:247], v[68:71], v[140:143], v[244:247]
  buffer_load_dwordx4 v39, s[20:23], s37 offen offset:3072 lds
  v_mfma_f32_16x16x32_bf16 v[248:251], v[68:71], v[144:147], v[248:251]
  v_mfma_f32_16x16x32_bf16 v[252:255], v[68:71], v[148:151], v[252:255]
  s_waitcnt lgkmcnt(1)
  v_mfma_f32_16x16x32_bf16 v[244:247], v[72:75], v[152:155], v[244:247]
  s_add_u32 m0, s33, 20480
  s_nop 0
  buffer_load_dwordx4 v36, s[20:23], s46 offen offset:0 lds
  v_mfma_f32_16x16x32_bf16 v[248:251], v[72:75], v[156:159], v[248:251]
  v_mfma_f32_16x16x32_bf16 v[252:255], v[72:75], v[24:27], v[252:255]
  s_waitcnt lgkmcnt(0)
  v_mfma_f32_16x16x32_bf16 v[244:247], v[76:79], v[28:31], v[244:247]
  buffer_load_dwordx4 v37, s[20:23], s46 offen offset:1024 lds
  v_mfma_f32_16x16x32_bf16 v[248:251], v[76:79], a[248:251], v[248:251]
  v_mfma_f32_16x16x32_bf16 v[252:255], v[76:79], a[252:255], v[252:255]
  v_add_u32 v24, s43, v3
  s_add_u32 s43, s43, 3072
  s_cmp_eq_u32 s43, 24576
  s_cselect_b32 s43, 0, s43
  v_add_u32 v25, s43, v3
  s_add_u32 s43, s43, 3072
  s_cmp_eq_u32 s43, 24576
  s_cselect_b32 s43, 0, s43
  buffer_load_dwordx4 v38, s[20:23], s46 offen offset:2048 lds
  v_add_u32 v26, s43, v3
  s_add_u32 s43, s43, 3072
  s_cmp_eq_u32 s43, 24576
  s_cselect_b32 s43, 0, s43
  v_add_u32 v27, s43, v3
  s_add_u32 s43, s43, 3072
  s_cmp_eq_u32 s43, 24576
  s_cselect_b32 s43, 0, s43
  v_add_u32 v28, s43, v3
  s_add_u32 s43, s43, 3072
  s_cmp_eq_u32 s43, 24576
  s_cselect_b32 s43, 0, s43
  v_add_u32 v29, s43, v3
  s_add_u32 s43, s43, 3072
  s_cmp_eq_u32 s43, 24576
  s_cselect_b32 s43, 0, s43
  v_add_u32 v30, s43, v3
  s_add_u32 s43, s43, 3072
  s_cmp_eq_u32 s43, 24576
  s_cselect_b32 s43, 0, s43
  buffer_load_dwordx4 v39, s[20:23], s46 offen offset:3072 lds
  s_add_u32 s37, s37, 28672
  s_cmp_eq_u32 s37, s38
  s_cselect_b32 s47, 229376, 0
  s_sub_u32 s37, s37, s47
  v_add_u32 v31, s43, v3
  s_add_u32 s43, s43, 3072
  s_cmp_eq_u32 s43, 24576
  s_cselect_b32 s43, 0, s43
  s_waitcnt vmcnt(8)
  ds_read_b128 v[48:51], v24 offset:0
  ds_read_b64_tr_b16 a[0:1], v12 offset:8192
  ds_read_b64_tr_b16 a[2:3], v12 offset:12288
  ds_read_b128 v[52:55], v24 offset:1024
  ds_read_b64_tr_b16 a[4:5], v12 offset:8224
  ds_read_b64_tr_b16 a[6:7], v12 offset:12320
  s_add_u32 m0, s33, 0
  s_add_u32 s46, s37, 14336
  buffer_load_dwordx4 v36, s[20:23], s37 offen offset:0 lds
  ds_read_b128 v[56:59], v24 offset:2048
  ds_read_b64_tr_b16 a[8:9], v12 offset:8256
  ds_read_b64_tr_b16 a[10:11], v12 offset:12352
  ds_read_b64_tr_b16 a[12:13], v12 offset:8288
  ds_read_b64_tr_b16 a[14:15], v12 offset:12384
  ds_read_b64_tr_b16 a[16:17], v12 offset:8320
  ds_read_b64_tr_b16 a[18:19], v12 offset:12416
  ds_read_b64_tr_b16 a[20:21], v12 offset:8352
  buffer_load_dwordx4 v37, s[20:23], s37 offen offset:1024 lds
  ds_read_b64_tr_b16 a[22:23], v12 offset:12448
  ds_read_b64_tr_b16 a[24:25], v12 offset:8384
  ds_read_b64_tr_b16 a[26:27], v12 offset:12480
  s_waitcnt lgkmcnt(0)
  buffer_load_dwordx4 v38, s[20:23], s37 offen offset:2048 lds
  v_mfma_f32_16x16x32_bf16 v[80:83], a[0:3], v[48:51], 0
  buffer_load_dwordx4 v39, s[20:23], s37 offen offset:3072 lds
  s_add_u32 m0, s33, 4096
  s_nop 0
  buffer_load_dwordx4 v36, s[20:23], s46 offen offset:0 lds
  buffer_load_dwordx4 v37, s[20:23], s46 offen offset:1024 lds
  buffer_load_dwordx4 v38, s[20:23], s46 offen offset:2048 lds
  buffer_load_dwordx4 v39, s[20:23], s46 offen offset:3072 lds
  s_add_u32 s37, s37, 28672
  s_cmp_eq_u32 s37, s38
  s_cselect_b32 s47, 229376, 0
  s_sub_u32 s37, s37, s47
  s_waitcnt vmcnt(8)
  v_mfma_f32_16x16x32_bf16 v[84:87], a[0:3], v[52:55], 0
  ds_read_b128 v[60:63], v25 offset:0
  v_mfma_f32_16x16x32_bf16 v[88:91], a[0:3], v[56:59], 0
  ds_read_b64_tr_b16 a[28:29], v12 offset:16384
  s_add_u32 m0, s33, 8192
  s_add_u32 s46, s37, 14336
  buffer_load_dwordx4 v36, s[20:23], s37 offen offset:0 lds
  v_mfma_f32_16x16x32_bf16 v[92:95], a[4:7], v[48:51], 0
  ds_read_b64_tr_b16 a[30:31], v12 offset:20480
  v_mfma_f32_16x16x32_bf16 v[96:99], a[4:7], v[52:55], 0
  ds_read_b128 v[64:67], v25 offset:1024
  buffer_load_dwordx4 v37, s[20:23], s37 offen offset:1024 lds
  v_mfma_f32_16x16x32_bf16 v[100:103], a[4:7], v[56:59], 0
  ds_read_b64_tr_b16 a[32:33], v12 offset:16416
  v_mfma_f32_16x16x32_bf16 v[104:107], a[8:11], v[48:51], 0
  ds_read_b64_tr_b16 a[34:35], v12 offset:20512
  buffer_load_dwordx4 v38, s[20:23], s37 offen offset:2048 lds
  v_mfma_f32_16x16x32_bf16 v[108:111], a[8:11], v[52:55], 0
  ds_read_b128 v[68:71], v25 offset:2048
  v_mfma_f32_16x16x32_bf16 v[112:115], a[8:11], v[56:59], 0
  ds_read_b64_tr_b16 a[36:37], v12 offset:16448
  buffer_load_dwordx4 v39, s[20:23], s37 offen offset:3072 lds
  v_mfma_f32_16x16x32_bf16 v[116:119], a[12:15], v[48:51], 0
  ds_read_b64_tr_b16 a[38:39], v12 offset:20544
  v_mfma_f32_16x16x32_bf16 v[120:123], a[12:15], v[52:55], 0
  ds_read_b64_tr_b16 a[40:41], v12 offset:16480
  s_add_u32 m0, s33, 12288
  s_nop 0
  buffer_load_dwordx4 v36, s[20:23], s46 offen offset:0 lds
  v_mfma_f32_16x16x32_bf16 v[124:127], a[12:15], v[56:59], 0
  ds_read_b64_tr_b16 a[42:43], v12 offset:20576
  v_mfma_f32_16x16x32_bf16 v[128:131], a[16:19], v[48:51], 0
  ds_read_b64_tr_b16 a[44:45], v12 offset:16512
  buffer_load_dwordx4 v37, s[20:23], s46 offen offset:1024 lds
  v_mfma_f32_16x16x32_bf16 v[132:135], a[16:19], v[52:55], 0
  ds_read_b64_tr_b16 a[46:47], v12 offset:20608
  v_mfma_f32_16x16x32_bf16 v[136:139], a[16:19], v[56:59], 0
  ds_read_b64_tr_b16 a[48:49], v12 offset:16544
  buffer_load_dwordx4 v38, s[20:23], s46 offen offset:2048 lds
  v_mfma_f32_16x16x32_bf16 v[140:143], a[20:23], v[48:51], 0
  ds_read_b64_tr_b16 a[50:51], v12 offset:20640
  v_mfma_f32_16x16x32_bf16 v[144:147], a[20:23], v[52:55], 0
  ds_read_b64_tr_b16 a[52:53], v12 offset:16576
  buffer_load_dwordx4 v39, s[20:23], s46 offen offset:3072 lds
  s_add_u32 s37, s37, 28672
  s_cmp_eq_u32 s37, s38
  s_cselect_b32 s47, 229376, 0
  s_sub_u32 s37, s37, s47
  v_mfma_f32_16x16x32_bf16 v[148:151], a[20:23], v[56:59], 0
  ds_read_b64_tr_b16 a[54:55], v12 offset:20672
  v_mfma_f32_16x16x32_bf16 v[152:155], a[24:27], v[48:51], 0
  v_mfma_f32_16x16x32_bf16 v[156:159], a[24:27], v[52:55], 0
  v_mfma_f32_16x16x32_bf16 a[248:251], a[24:27], v[56:59], 0
  s_waitcnt lgkmcnt(0)
  v_mfma_f32_16x16x32_bf16 v[80:83], a[28:31], v[60:63], v[80:83]
  s_add_u32 m0, s33, 16384
  s_add_u32 s46, s37, 14336
  buffer_load_dwordx4 v36, s[20:23], s37 offen offset:0 lds
  s_waitcnt vmcnt(9)
  v_mfma_f32_16x16x32_bf16 v[84:87], a[28:31], v[64:67], v[84:87]
  ds_read_b128 v[48:51], v26 offset:0
  v_mfma_f32_16x16x32_bf16 v[88:91], a[28:31], v[68:71], v[88:91]
  ds_read_b64_tr_b16 a[56:57], v12 offset:0
  buffer_load_dwordx4 v37, s[20:23], s37 offen offset:1024 lds
  v_mfma_f32_16x16x32_bf16 v[92:95], a[32:35], v[60:63], v[92:95]
  ds_read_b64_tr_b16 a[58:59], v12 offset:4096
  v_mfma_f32_16x16x32_bf16 v[96:99], a[32:35], v[64:67], v[96:99]
  ds_read_b128 v[52:55], v26 offset:1024
  buffer_load_dwordx4 v38, s[20:23], s37 offen offset:2048 lds
  v_mfma_f32_16x16x32_bf16 v[100:103], a[32:35], v[68:71], v[100:103]
  ds_read_b64_tr_b16 a[60:61], v12 offset:32
  v_mfma_f32_16x16x32_bf16 v[104:107], a[36:39], v[60:63], v[104:107]
  ds_read_b64_tr_b16 a[62:63], v12 offset:4128
  buffer_load_dwordx4 v39, s[20:23], s37 offen offset:3072 lds
  v_mfma_f32_16x16x32_bf16 v[108:111], a[36:39], v[64:67], v[108:111]
  ds_read_b128 v[56:59], v26 offset:2048
  v_mfma_f32_16x16x32_bf16 v[112:115], a[36:39], v[68:71], v[112:115]
  ds_read_b64_tr_b16 a[64:65], v12 offset:64
  s_add_u32 m0, s33, 20480
  s_nop 0
  buffer_load_dwordx4 v36, s[20:23], s46 offen offset:0 lds
  v_mfma_f32_16x16x32_bf16 v[116:119], a[40:43], v[60:63], v[116:119]
  ds_read_b64_tr_b16 a[66:67], v12 offset:4160
  v_mfma_f32_16x16x32_bf16 v[120:123], a[40:43], v[64:67], v[120:123]
  ds_read_b64_tr_b16 a[68:69], v12 offset:96
  buffer_load_dwordx4 v37, s[20:23], s46 offen offset:1024 lds
  v_mfma_f32_16x16x32_bf16 v[124:127], a[40:43], v[68:71], v[124:127]
  ds_read_b64_tr_b16 a[70:71], v12 offset:4192
  v_mfma_f32_16x16x32_bf16 v[128:131], a[44:47], v[60:63], v[128:131]
  ds_read_b64_tr_b16 a[72:73], v12 offset:128
  buffer_load_dwordx4 v38, s[20:23], s46 offen offset:2048 lds
  v_mfma_f32_16x16x32_bf16 v[132:135], a[44:47], v[64:67], v[132:135]
  ds_read_b64_tr_b16 a[74:75], v12 offset:4224
  v_mfma_f32_16x16x32_bf16 v[136:139], a[44:47], v[68:71], v[136:139]
  ds_read_b64_tr_b16 a[76:77], v12 offset:160
  buffer_load_dwordx4 v39, s[20:23], s46 offen offset:3072 lds
  s_add_u32 s37, s37, 28672
  s_cmp_eq_u32 s37, s38
  s_cselect_b32 s47, 229376, 0
  s_sub_u32 s37, s37, s47
  v_mfma_f32_16x16x32_bf16 v[140:143], a[48:51], v[60:63], v[140:143]
  ds_read_b64_tr_b16 a[78:79], v12 offset:4256
  v_mfma_f32_16x16x32_bf16 v[144:147], a[48:51], v[64:67], v[144:147]
  ds_read_b64_tr_b16 a[80:81], v12 offset:192
  v_mfma_f32_16x16x32_bf16 v[148:151], a[48:51], v[68:71], v[148:151]
  ds_read_b64_tr_b16 a[82:83], v12 offset:4288
  v_mfma_f32_16x16x32_bf16 v[152:155], a[52:55], v[60:63], v[152:155]
  v_mfma_f32_16x16x32_bf16 v[156:159], a[52:55], v[64:67], v[156:159]
  v_mfma_f32_16x16x32_bf16 a[248:251], a[52:55], v[68:71], a[248:251]
  s_waitcnt lgkmcnt(0)
  v_mfma_f32_16x16x32_bf16 v[80:83], a[56:59], v[48:51], v[80:83]
  s_add_u32 m0, s33, 0
  s_add_u32 s46, s37, 14336
  buffer_load_dwordx4 v36, s[20:23], s37 offen offset:0 lds
  s_waitcnt vmcnt(9)
  v_mfma_f32_16x16x32_bf16 v[84:87], a[56:59], v[52:55], v[84:87]
  ds_read_b128 v[60:63], v27 offset:0
  v_mfma_f32_16x16x32_bf16 v[88:91], a[56:59], v[56:59], v[88:91]
  ds_read_b64_tr_b16 a[84:85], v12 offset:8192
  buffer_load_dwordx4 v37, s[20:23], s37 offen offset:1024 lds
  v_mfma_f32_16x16x32_bf16 v[92:95], a[60:63], v[48:51], v[92:95]
  ds_read_b64_tr_b16 a[86:87], v12 offset:12288
  v_mfma_f32_16x16x32_bf16 v[96:99], a[60:63], v[52:55], v[96:99]
  ds_read_b128 v[64:67], v27 offset:1024
  buffer_load_dwordx4 v38, s[20:23], s37 offen offset:2048 lds
  v_mfma_f32_16x16x32_bf16 v[100:103], a[60:63], v[56:59], v[100:103]
  ds_read_b64_tr_b16 a[88:89], v12 offset:8224
  v_mfma_f32_16x16x32_bf16 v[104:107], a[64:67], v[48:51], v[104:107]
  ds_read_b64_tr_b16 a[90:91], v12 offset:12320
  buffer_load_dwordx4 v39, s[20:23], s37 offen offset:3072 lds
  v_mfma_f32_16x16x32_bf16 v[108:111], a[64:67], v[52:55], v[108:111]
  ds_read_b128 v[68:71], v27 offset:2048
  v_mfma_f32_16x16x32_bf16 v[112:115], a[64:67], v[56:59], v[112:115]
  ds_read_b64_tr_b16 a[92:93], v12 offset:8256
  s_add_u32 m0, s33, 4096
  s_nop 0
  buffer_load_dwordx4 v36, s[20:23], s46 offen offset:0 lds
  v_mfma_f32_16x16x32_bf16 v[116:119], a[68:71], v[48:51], v[116:119]
  ds_read_b64_tr_b16 a[94:95], v12 offset:12352
  v_mfma_f32_16x16x32_bf16 v[120:123], a[68:71], v[52:55], v[120:123]
  ds_read_b64_tr_b16 a[96:97], v12 offset:8288
  buffer_load_dwordx4 v37, s[20:23], s46 offen offset:1024 lds
  v_mfma_f32_16x16x32_bf16 v[124:127], a[68:71], v[56:59], v[124:127]
  ds_read_b64_tr_b16 a[98:99], v12 offset:12384
  v_mfma_f32_16x16x32_bf16 v[128:131], a[72:75], v[48:51], v[128:131]
  ds_read_b64_tr_b16 a[100:101], v12 offset:8320
  buffer_load_dwordx4 v38, s[20:23], s46 offen offset:2048 lds
  v_mfma_f32_16x16x32_bf16 v[132:135], a[72:75], v[52:55], v[132:135]
  ds_read_b64_tr_b16 a[102:103], v12 offset:12416
  v_mfma_f32_16x16x32_bf16 v[136:139], a[72:75], v[56:59], v[136:139]
  ds_read_b64_tr_b16 a[104:105], v12 offset:8352
  buffer_load_dwordx4 v39, s[20:23], s46 offen offset:3072 lds
  s_add_u32 s37, s37, 28672
  s_cmp_eq_u32 s37, s38
  s_cselect_b32 s47, 229376, 0
  s_sub_u32 s37, s37, s47
  v_mfma_f32_16x16x32_bf16 v[140:143], a[76:79], v[48:51], v[140:143]
  ds_read_b64_tr_b16 a[106:107], v12 offset:12448
  v_mfma_f32_16x16x32_bf16 v[144:147], a[76:79], v[52:55], v[144:147]
  ds_read_b64_tr_b16 a[108:109], v12 offset:8384
  v_mfma_f32_16x16x32_bf16 v[148:151], a[76:79], v[56:59], v[148:151]
  ds_read_b64_tr_b16 a[110:111], v12 offset:12480
  v_mfma_f32_16x16x32_bf16 v[152:155], a[80:83], v[48:51], v[152:155]
  v_mfma_f32_16x16x32_bf16 v[156:159], a[80:83], v[52:55], v[156:159]
  v_mfma_f32_16x16x32_bf16 a[248:251], a[80:83], v[56:59], a[248:251]
  s_waitcnt lgkmcnt(0)
  v_mfma_f32_16x16x32_bf16 v[80:83], a[84:87], v[60:63], v[80:83]
  s_add_u32 m0, s33, 8192
  s_add_u32 s46, s37, 14336
  buffer_load_dwordx4 v36, s[20:23], s37 offen offset:0 lds
  s_waitcnt vmcnt(9)
  v_mfma_f32_16x16x32_bf16 v[84:87], a[84:87], v[64:67], v[84:87]
  ds_read_b128 v[48:51], v28 offset:0
  v_mfma_f32_16x16x32_bf16 v[88:91], a[84:87], v[68:71], v[88:91]
  ds_read_b64_tr_b16 a[112:113], v12 offset:16384
  buffer_load_dwordx4 v37, s[20:23], s37 offen offset:1024 lds
  v_mfma_f32_16x16x32_bf16 v[92:95], a[88:91], v[60:63], v[92:95]
  ds_read_b64_tr_b16 a[114:115], v12 offset:20480
  v_mfma_f32_16x16x32_bf16 v[96:99], a[88:91], v[64:67], v[96:99]
  ds_read_b128 v[52:55], v28 offset:1024
  buffer_load_dwordx4 v38, s[20:23], s37 offen offset:2048 lds
  v_mfma_f32_16x16x32_bf16 v[100:103], a[88:91], v[68:71], v[100:103]
  ds_read_b64_tr_b16 a[116:117], v12 offset:16416
  v_mfma_f32_16x16x32_bf16 v[104:107], a[92:95], v[60:63], v[104:107]
  ds_read_b64_tr_b16 a[118:119], v12 offset:20512
  buffer_load_dwordx4 v39, s[20:23], s37 offen offset:3072 lds
  v_mfma_f32_16x16x32_bf16 v[108:111], a[92:95], v[64:67], v[108:111]
  ds_read_b128 v[56:59], v28 offset:2048
  v_mfma_f32_16x16x32_bf16 v[112:115], a[92:95], v[68:71], v[112:115]
  ds_read_b64_tr_b16 a[120:121], v12 offset:16448
  s_add_u32 m0, s33, 12288
  s_nop 0
  buffer_load_dwordx4 v36, s[20:23], s46 offen offset:0 lds
  v_mfma_f32_16x16x32_bf16 v[116:119], a[96:99], v[60:63], v[116:119]
  ds_read_b64_tr_b16 a[122:123], v12 offset:20544
  v_mfma_f32_16x16x32_bf16 v[120:123], a[96:99], v[64:67], v[120:123]
  ds_read_b64_tr_b16 a[124:125], v12 offset:16480
  buffer_load_dwordx4 v37, s[20:23], s46 offen offset:1024 lds
  v_mfma_f32_16x16x32_bf16 v[124:127], a[96:99], v[68:71], v[124:127]
  ds_read_b64_tr_b16 a[126:127], v12 offset:20576
  v_mfma_f32_16x16x32_bf16 v[128:131], a[100:103], v[60:63], v[128:131]
  ds_read_b64_tr_b16 a[128:129], v12 offset:16512
  buffer_load_dwordx4 v38, s[20:23], s46 offen offset:2048 lds
  v_mfma_f32_16x16x32_bf16 v[132:135], a[100:103], v[64:67], v[132:135]
  ds_read_b64_tr_b16 a[130:131], v12 offset:20608
  v_mfma_f32_16x16x32_bf16 v[136:139], a[100:103], v[68:71], v[136:139]
  ds_read_b64_tr_b16 a[132:133], v12 offset:16544
  buffer_load_dwordx4 v39, s[20:23], s46 offen offset:3072 lds
  s_add_u32 s37, s37, 28672
  s_cmp_eq_u32 s37, s38
  s_cselect_b32 s47, 229376, 0
  s_sub_u32 s37, s37, s47
  v_mfma_f32_16x16x32_bf16 v[140:143], a[104:107], v[60:63], v[140:143]
  ds_read_b64_tr_b16 a[134:135], v12 offset:20640
  v_mfma_f32_16x16x32_bf16 v[144:147], a[104:107], v[64:67], v[144:147]
  ds_read_b64_tr_b16 a[136:137], v12 offset:16576
  v_mfma_f32_16x16x32_bf16 v[148:151], a[104:107], v[68:71], v[148:151]
  ds_read_b64_tr_b16 a[138:139], v12 offset:20672
  v_mfma_f32_16x16x32_bf16 v[152:155], a[108:111], v[60:63], v[152:155]
  v_mfma_f32_16x16x32_bf16 v[156:159], a[108:111], v[64:67], v[156:159]
  v_mfma_f32_16x16x32_bf16 a[248:251], a[108:111], v[68:71], a[248:251]
  s_waitcnt lgkmcnt(0)
  v_mfma_f32_16x16x32_bf16 v[80:83], a[112:115], v[48:51], v[80:83]
  s_add_u32 m0, s33, 16384
  s_add_u32 s46, s37, 14336
  buffer_load_dwordx4 v36, s[20:23], s37 offen offset:0 lds
  s_waitcnt vmcnt(9)
  v_mfma_f32_16x16x32_bf16 v[84:87], a[112:115], v[52:55], v[84:87]
  ds_read_b128 v[60:63], v29 offset:0
  v_mfma_f32_16x16x32_bf16 v[88:91], a[112:115], v[56:59], v[88:91]
  ds_read_b64_tr_b16 a[140:141], v12 offset:0
  buffer_load_dwordx4 v37, s[20:23], s37 offen offset:1024 lds
  v_mfma_f32_16x16x32_bf16 v[92:95], a[116:119], v[48:51], v[92:95]
  ds_read_b64_tr_b16 a[142:143], v12 offset:4096
  v_mfma_f32_16x16x32_bf16 v[96:99], a[116:119], v[52:55], v[96:99]
  ds_read_b128 v[64:67], v29 offset:1024
  buffer_load_dwordx4 v38, s[20:23], s37 offen offset:2048 lds
  v_mfma_f32_16x16x32_bf16 v[100:103], a[116:119], v[56:59], v[100:103]
  ds_read_b64_tr_b16 a[144:145], v12 offset:32
  v_mfma_f32_16x16x32_bf16 v[104:107], a[120:123], v[48:51], v[104:107]
  ds_read_b64_tr_b16 a[146:147], v12 offset:4128
  buffer_load_dwordx4 v39, s[20:23], s37 offen offset:3072 lds
  v_mfma_f32_16x16x32_bf16 v[108:111], a[120:123], v[52:55], v[108:111]
  ds_read_b128 v[68:71], v29 offset:2048
  v_mfma_f32_16x16x32_bf16 v[112:115], a[120:123], v[56:59], v[112:115]
  ds_read_b64_tr_b16 a[148:149], v12 offset:64
  s_add_u32 m0, s33, 20480
  s_nop 0
  buffer_load_dwordx4 v36, s[20:23], s46 offen offset:0 lds
  v_mfma_f32_16x16x32_bf16 v[116:119], a[124:127], v[48:51], v[116:119]
  ds_read_b64_tr_b16 a[150:151], v12 offset:4160
  v_mfma_f32_16x16x32_bf16 v[120:123], a[124:127], v[52:55], v[120:123]
  ds_read_b64_tr_b16 a[152:153], v12 offset:96
  buffer_load_dwordx4 v37, s[20:23], s46 offen offset:1024 lds
  v_mfma_f32_16x16x32_bf16 v[124:127], a[124:127], v[56:59], v[124:127]
  ds_read_b64_tr_b16 a[154:155], v12 offset:4192
  v_mfma_f32_16x16x32_bf16 v[128:131], a[128:131], v[48:51], v[128:131]
  ds_read_b64_tr_b16 a[156:157], v12 offset:128
  buffer_load_dwordx4 v38, s[20:23], s46 offen offset:2048 lds
  v_mfma_f32_16x16x32_bf16 v[132:135], a[128:131], v[52:55], v[132:135]
  ds_read_b64_tr_b16 a[158:159], v12 offset:4224
  v_mfma_f32_16x16x32_bf16 v[136:139], a[128:131], v[56:59], v[136:139]
  ds_read_b64_tr_b16 a[160:161], v12 offset:160
  buffer_load_dwordx4 v39, s[20:23], s46 offen offset:3072 lds
  s_add_u32 s37, s37, 28672
  s_cmp_eq_u32 s37, s38
  s_cselect_b32 s47, 229376, 0
  s_sub_u32 s37, s37, s47
  s_add_u32 s37, s37, 229376
  s_add_u32 s38, s38, 229376
  v_mfma_f32_16x16x32_bf16 v[140:143], a[132:135], v[48:51], v[140:143]
  ds_read_b64_tr_b16 a[162:163], v12 offset:4256
  v_mfma_f32_16x16x32_bf16 v[144:147], a[132:135], v[52:55], v[144:147]
  ds_read_b64_tr_b16 a[164:165], v12 offset:192
  v_mfma_f32_16x16x32_bf16 v[148:151], a[132:135], v[56:59], v[148:151]
  ds_read_b64_tr_b16 a[166:167], v12 offset:4288
  v_mfma_f32_16x16x32_bf16 v[152:155], a[136:139], v[48:51], v[152:155]
  v_mfma_f32_16x16x32_bf16 v[156:159], a[136:139], v[52:55], v[156:159]
  v_mfma_f32_16x16x32_bf16 a[248:251], a[136:139], v[56:59], a[248:251]
  s_waitcnt lgkmcnt(0)
  v_mfma_f32_16x16x32_bf16 v[80:83], a[140:143], v[60:63], v[80:83]
  s_add_u32 m0, s33, 0
  s_add_u32 s46, s35, 32768
  buffer_load_dwordx4 v4, s[12:15], s35 offen offset:0 nt lds
  s_waitcnt vmcnt(9)
  v_mfma_f32_16x16x32_bf16 v[84:87], a[140:143], v[64:67], v[84:87]
  ds_read_b128 v[48:51], v30 offset:0
  v_mfma_f32_16x16x32_bf16 v[88:91], a[140:143], v[68:71], v[88:91]
  ds_read_b64_tr_b16 a[168:169], v12 offset:8192
  v_mfma_f32_16x16x32_bf16 v[92:95], a[144:147], v[60:63], v[92:95]
  ds_read_b64_tr_b16 a[170:171], v12 offset:12288
  v_mfma_f32_16x16x32_bf16 v[96:99], a[144:147], v[64:67], v[96:99]
  ds_read_b128 v[52:55], v30 offset:1024
  v_mfma_f32_16x16x32_bf16 v[100:103], a[144:147], v[68:71], v[100:103]
  ds_read_b64_tr_b16 a[172:173], v12 offset:8224
  buffer_load_dwordx4 v5, s[12:15], s35 offen offset:1024 nt lds
  v_mfma_f32_16x16x32_bf16 v[104:107], a[148:151], v[60:63], v[104:107]
  ds_read_b64_tr_b16 a[174:175], v12 offset:12320
  v_mfma_f32_16x16x32_bf16 v[108:111], a[148:151], v[64:67], v[108:111]
  ds_read_b128 v[56:59], v30 offset:2048
  v_mfma_f32_16x16x32_bf16 v[112:115], a[148:151], v[68:71], v[112:115]
  ds_read_b64_tr_b16 a[176:177], v12 offset:8256
  v_mfma_f32_16x16x32_bf16 v[116:119], a[152:155], v[60:63], v[116:119]
  ds_read_b64_tr_b16 a[178:179], v12 offset:12352
  v_mfma_f32_16x16x32_bf16 v[120:123], a[152:155], v[64:67], v[120:123]
  ds_read_b64_tr_b16 a[180:181], v12 offset:8288
  buffer_load_dwordx4 v6, s[12:15], s35 offen offset:2048 nt lds
  v_mfma_f32_16x16x32_bf16 v[124:127], a[152:155], v[68:71], v[124:127]
  ds_read_b64_tr_b16 a[182:183], v12 offset:12384
  v_mfma_f32_16x16x32_bf16 v[128:131], a[156:159], v[60:63], v[128:131]
  ds_read_b64_tr_b16 a[184:185], v12 offset:8320
  v_mfma_f32_16x16x32_bf16 v[132:135], a[156:159], v[64:67], v[132:135]
  ds_read_b64_tr_b16 a[186:187], v12 offset:12416
  v_mfma_f32_16x16x32_bf16 v[136:139], a[156:159], v[68:71], v[136:139]
  ds_read_b64_tr_b16 a[188:189], v12 offset:8352
  v_mfma_f32_16x16x32_bf16 v[140:143], a[160:163], v[60:63], v[140:143]
  ds_read_b64_tr_b16 a[190:191], v12 offset:12448
  buffer_load_dwordx4 v7, s[12:15], s35 offen offset:3072 nt lds
  v_mfma_f32_16x16x32_bf16 v[144:147], a[160:163], v[64:67], v[144:147]
  ds_read_b64_tr_b16 a[192:193], v12 offset:8384
  v_mfma_f32_16x16x32_bf16 v[148:151], a[160:163], v[68:71], v[148:151]
  ds_read_b64_tr_b16 a[194:195], v12 offset:12480
  v_mfma_f32_16x16x32_bf16 v[152:155], a[164:167], v[60:63], v[152:155]
  v_mfma_f32_16x16x32_bf16 v[156:159], a[164:167], v[64:67], v[156:159]
  v_mfma_f32_16x16x32_bf16 a[248:251], a[164:167], v[68:71], a[248:251]
  s_waitcnt lgkmcnt(0)
  s_add_u32 m0, s33, 4096
  s_nop 0
  buffer_load_dwordx4 v4, s[12:15], s46 offen offset:0 nt lds
  v_mfma_f32_16x16x32_bf16 v[80:83], a[168:171], v[48:51], v[80:83]
  s_waitcnt vmcnt(5)
  v_mfma_f32_16x16x32_bf16 v[84:87], a[168:171], v[52:55], v[84:87]
  ds_read_b128 v[60:63], v31 offset:0
  v_mfma_f32_16x16x32_bf16 v[88:91], a[168:171], v[56:59], v[88:91]
  ds_read_b64_tr_b16 a[196:197], v12 offset:16384
  v_mfma_f32_16x16x32_bf16 v[92:95], a[172:175], v[48:51], v[92:95]
  ds_read_b64_tr_b16 a[198:199], v12 offset:20480
  v_mfma_f32_16x16x32_bf16 v[96:99], a[172:175], v[52:55], v[96:99]
  ds_read_b128 v[64:67], v31 offset:1024
  v_mfma_f32_16x16x32_bf16 v[100:103], a[172:175], v[56:59], v[100:103]
  buffer_load_dwordx4 v5, s[12:15], s46 offen offset:1024 nt lds
  ds_read_b64_tr_b16 a[200:201], v12 offset:16416
  v_mfma_f32_16x16x32_bf16 v[104:107], a[176:179], v[48:51], v[104:107]
  ds_read_b64_tr_b16 a[202:203], v12 offset:20512
  v_mfma_f32_16x16x32_bf16 v[108:111], a[176:179], v[52:55], v[108:111]
  ds_read_b128 v[68:71], v31 offset:2048
  v_mfma_f32_16x16x32_bf16 v[112:115], a[176:179], v[56:59], v[112:115]
  ds_read_b64_tr_b16 a[204:205], v12 offset:16448
  v_mfma_f32_16x16x32_bf16 v[116:119], a[180:183], v[48:51], v[116:119]
  ds_read_b64_tr_b16 a[206:207], v12 offset:20544
  v_mfma_f32_16x16x32_bf16 v[120:123], a[180:183], v[52:55], v[120:123]
  buffer_load_dwordx4 v6, s[12:15], s46 offen offset:2048 nt lds
  ds_read_b64_tr_b16 a[208:209], v12 offset:16480
  v_mfma_f32_16x16x32_bf16 v[124:127], a[180:183], v[56:59], v[124:127]
  ds_read_b64_tr_b16 a[210:211], v12 offset:20576
  v_mfma_f32_16x16x32_bf16 v[128:131], a[184:187], v[48:51], v[128:131]
  ds_read_b64_tr_b16 a[212:213], v12 offset:16512
  v_mfma_f32_16x16x32_bf16 v[132:135], a[184:187], v[52:55], v[132:135]
  ds_read_b64_tr_b16 a[214:215], v12 offset:20608
  v_mfma_f32_16x16x32_bf16 v[136:139], a[184:187], v[56:59], v[136:139]
  ds_read_b64_tr_b16 a[216:217], v12 offset:16544
  v_mfma_f32_16x16x32_bf16 v[140:143], a[188:191], v[48:51], v[140:143]
  buffer_load_dwordx4 v7, s[12:15], s46 offen offset:3072 nt lds
  s_add_u32 s35, s35, 16384
  ds_read_b64_tr_b16 a[218:219], v12 offset:20640
  v_mfma_f32_16x16x32_bf16 v[144:147], a[188:191], v[52:55], v[144:147]
  ds_read_b64_tr_b16 a[220:221], v12 offset:16576
  v_mfma_f32_16x16x32_bf16 v[148:151], a[188:191], v[56:59], v[148:151]
  ds_read_b64_tr_b16 a[222:223], v12 offset:20672
  v_mfma_f32_16x16x32_bf16 v[152:155], a[192:195], v[48:51], v[152:155]
  v_mfma_f32_16x16x32_bf16 v[156:159], a[192:195], v[52:55], v[156:159]
  v_mfma_f32_16x16x32_bf16 a[248:251], a[192:195], v[56:59], a[248:251]
  s_waitcnt lgkmcnt(0)
  s_add_u32 m0, s33, 8192
  s_add_u32 s46, s35, 32768
  buffer_load_dwordx4 v4, s[12:15], s35 offen offset:0 nt lds
  v_mfma_f32_16x16x32_bf16 v[80:83], a[196:199], v[60:63], v[80:83]
  v_mfma_f32_16x16x32_bf16 v[84:87], a[196:199], v[64:67], v[84:87]
  v_mfma_f32_16x16x32_bf16 v[88:91], a[196:199], v[68:71], v[88:91]
  v_mfma_f32_16x16x32_bf16 v[92:95], a[200:203], v[60:63], v[92:95]
  v_mfma_f32_16x16x32_bf16 v[96:99], a[200:203], v[64:67], v[96:99]
  v_mfma_f32_16x16x32_bf16 v[100:103], a[200:203], v[68:71], v[100:103]
  v_mfma_f32_16x16x32_bf16 v[104:107], a[204:207], v[60:63], v[104:107]
  buffer_load_dwordx4 v5, s[12:15], s35 offen offset:1024 nt lds
  v_mfma_f32_16x16x32_bf16 v[108:111], a[204:207], v[64:67], v[108:111]
  v_mfma_f32_16x16x32_bf16 v[112:115], a[204:207], v[68:71], v[112:115]
  v_mfma_f32_16x16x32_bf16 v[116:119], a[208:211], v[60:63], v[116:119]
  v_mfma_f32_16x16x32_bf16 v[120:123], a[208:211], v[64:67], v[120:123]
  v_mfma_f32_16x16x32_bf16 v[124:127], a[208:211], v[68:71], v[124:127]
  v_mfma_f32_16x16x32_bf16 v[128:131], a[212:215], v[60:63], v[128:131]
  v_mfma_f32_16x16x32_bf16 v[132:135], a[212:215], v[64:67], v[132:135]
  buffer_load_dwordx4 v6, s[12:15], s35 offen offset:2048 nt lds
  v_mfma_f32_16x16x32_bf16 v[136:139], a[212:215], v[68:71], v[136:139]
  v_mfma_f32_16x16x32_bf16 v[140:143], a[216:219], v[60:63], v[140:143]
  v_mfma_f32_16x16x32_bf16 v[144:147], a[216:219], v[64:67], v[144:147]
  v_mfma_f32_16x16x32_bf16 v[148:151], a[216:219], v[68:71], v[148:151]
  v_mfma_f32_16x16x32_bf16 v[152:155], a[220:223], v[60:63], v[152:155]
  v_mfma_f32_16x16x32_bf16 v[156:159], a[220:223], v[64:67], v[156:159]
  v_mfma_f32_16x16x32_bf16 a[248:251], a[220:223], v[68:71], a[248:251]
  buffer_load_dwordx4 v7, s[12:15], s35 offen offset:3072 nt lds
  s_nop 7
  v_accvgpr_read_b32 v48, a248
  v_accvgpr_read_b32 v49, a249
  v_accvgpr_read_b32 v50, a250
  v_accvgpr_read_b32 v51, a251
  v_cvt_pk_bf16_f32 v52, v152, v153
  v_cvt_pk_bf16_f32 v53, v154, v155
  v_cvt_pk_bf16_f32 v154, v156, v157
  v_cvt_pk_bf16_f32 v155, v158, v159
  v_cvt_pk_bf16_f32 v156, v48, v49
  v_cvt_pk_bf16_f32 v157, v50, v51
  v_mov_b32 v152, v52
  v_mov_b32 v153, v53
  v_cvt_pk_bf16_f32 v151, v150, v151
  v_cvt_pk_bf16_f32 v150, v148, v149
  v_cvt_pk_bf16_f32 v148, v136, v137
  v_cvt_pk_bf16_f32 v149, v138, v139
  v_cvt_pk_bf16_f32 v147, v146, v147
  v_cvt_pk_bf16_f32 v146, v144, v145
  v_cvt_pk_bf16_f32 v144, v132, v133
  v_cvt_pk_bf16_f32 v145, v134, v135
  v_cvt_pk_bf16_f32 v143, v142, v143
  v_cvt_pk_bf16_f32 v142, v140, v141
  v_cvt_pk_bf16_f32 v140, v128, v129
  v_cvt_pk_bf16_f32 v141, v130, v131
  v_cvt_pk_bf16_f32 v139, v126, v127
  s_add_u32 m0, s33, 12288
  s_nop 0
  buffer_load_dwordx4 v4, s[12:15], s46 offen offset:0 nt lds
  v_cvt_pk_bf16_f32 v138, v124, v125
  v_cvt_pk_bf16_f32 v136, v112, v113
  v_cvt_pk_bf16_f32 v137, v114, v115
  v_cvt_pk_bf16_f32 v135, v122, v123
  v_cvt_pk_bf16_f32 v134, v120, v121
  v_cvt_pk_bf16_f32 v132, v108, v109
  v_cvt_pk_bf16_f32 v133, v110, v111
  v_cvt_pk_bf16_f32 v131, v118, v119
  v_cvt_pk_bf16_f32 v130, v116, v117
  v_cvt_pk_bf16_f32 v128, v104, v105
  v_cvt_pk_bf16_f32 v129, v106, v107
  v_cvt_pk_bf16_f32 v127, v102, v103
  v_cvt_pk_bf16_f32 v126, v100, v101
  v_cvt_pk_bf16_f32 v124, v88, v89
  v_cvt_pk_bf16_f32 v125, v90, v91
  v_cvt_pk_bf16_f32 v123, v98, v99
  v_cvt_pk_bf16_f32 v122, v96, v97
  v_cvt_pk_bf16_f32 v120, v84, v85
  v_cvt_pk_bf16_f32 v121, v86, v87
  v_cvt_pk_bf16_f32 v119, v94, v95
  v_cvt_pk_bf16_f32 v118, v92, v93
  v_cvt_pk_bf16_f32 v116, v80, v81
  v_cvt_pk_bf16_f32 v117, v82, v83
  s_nop 7
  v_max3_f32 v36, v160, v161, v162
  v_max3_f32 v38, v164, v165, v166
  buffer_load_dwordx4 v5, s[12:15], s46 offen offset:1024 nt lds
  v_max3_f32 v40, v168, v169, v170
  v_max3_f32 v36, v36, v163, v172
  v_max3_f32 v38, v38, v167, v176
  v_max3_f32 v40, v40, v171, v180
  v_max3_f32 v36, v36, v173, v174
  v_max3_f32 v38, v38, v177, v178
  v_max3_f32 v40, v40, v181, v182
  v_max3_f32 v36, v36, v175, v184
  v_max3_f32 v38, v38, v179, v188
  v_max3_f32 v40, v40, v183, v192
  v_max3_f32 v36, v36, v185, v186
  v_max3_f32 v38, v38, v189, v190
  v_max3_f32 v40, v40, v193, v194
  v_max3_f32 v36, v36, v187, v196
  v_max3_f32 v38, v38, v191, v200
  v_max3_f32 v40, v40, v195, v204
  v_max3_f32 v36, v36, v197, v198
  v_max3_f32 v38, v38, v201, v202
  v_max3_f32 v40, v40, v205, v206
  v_max3_f32 v36, v36, v199, v208
  v_max3_f32 v38, v38, v203, v212
  v_max3_f32 v40, v40, v207, v216
  v_max3_f32 v36, v36, v209, v210
  v_max3_f32 v38, v38, v213, v214
  v_max3_f32 v40, v40, v217, v218
  v_max3_f32 v36, v36, v211, v220
  v_max3_f32 v38, v38, v215, v224
  v_max3_f32 v40, v40, v219, v228
  buffer_load_dwordx4 v6, s[12:15], s46 offen offset:2048 nt lds
  v_max3_f32 v36, v36, v221, v222
  v_max3_f32 v38, v38, v225, v226
  v_max3_f32 v40, v40, v229, v230
  v_max3_f32 v36, v36, v223, v232
  v_max3_f32 v38, v38, v227, v236
  v_max3_f32 v40, v40, v231, v240
  v_max3_f32 v36, v36, v233, v234
  v_max3_f32 v38, v38, v237, v238
  v_max3_f32 v40, v40, v241, v242
  v_max3_f32 v36, v36, v235, v244
  v_max3_f32 v38, v38, v239, v248
  v_max3_f32 v40, v40, v243, v252
  v_max3_f32 v36, v36, v245, v246
  v_max3_f32 v38, v38, v249, v250
  v_max3_f32 v40, v40, v253, v254
  v_max_f32 v36, v36, v247
  v_max_f32 v38, v38, v251
  v_max_f32 v40, v40, v255
  v_mov_b32 v37, v36
  v_mov_b32 v39, v38
  v_mov_b32 v41, v40
  s_nop 1
  v_permlane32_swap_b32 v37, v36
  v_permlane32_swap_b32 v39, v38
  v_permlane32_swap_b32 v41, v40
  s_nop 1
  v_max_f32 v36, v36, v37
  buffer_load_dwordx4 v7, s[12:15], s46 offen offset:3072 nt lds
  s_add_u32 s35, s35, 49152
  v_max_f32 v38, v38, v39
  v_max_f32 v40, v40, v41
  v_mov_b32 v37, v36
  v_mov_b32 v39, v38
  v_mov_b32 v41, v40
  s_nop 1
  v_permlane16_swap_b32 v37, v36
  v_permlane16_swap_b32 v39, v38
  v_permlane16_swap_b32 v41, v40
  s_nop 1
  v_max_f32 v36, v36, v37
  v_max_f32 v38, v38, v39
  v_max_f32 v40, v40, v41
  ds_write_b32 v13, v36 offset:0
  ds_write_b32 v13, v38 offset:256
  ds_write_b32 v13, v40 offset:512
  s_waitcnt lgkmcnt(0)
  s_add_u32 m0, s33, 16384
  s_add_u32 s46, s35, 32768
  buffer_load_dwordx4 v4, s[12:15], s35 offen offset:0 nt lds
  s_barrier
  ds_read_b128 v[48:51], v14 offset:0
  ds_read_b128 v[52:55], v14 offset:256
  ds_read_b128 v[56:59], v14 offset:512
  s_waitcnt lgkmcnt(0)
  buffer_load_dwordx4 v5, s[12:15], s35 offen offset:1024 nt lds
  v_max3_f32 v36, v48, v49, v50
  v_max3_f32 v38, v52, v53, v54
  v_max3_f32 v40, v56, v57, v58
  v_max_f32 v36, v36, v51
  v_max_f32 v38, v38, v55
  v_max_f32 v40, v40, v59
  v_mul_f32 v36, s101, v36
  v_mul_f32 v38, s101, v38
  v_mul_f32 v40, s101, v40
  v_pk_fma_f32 v[160:161], v[160:161], s[100:101], v[36:37] op_sel_hi:[1,0,0]
  v_pk_fma_f32 v[164:165], v[164:165], s[100:101], v[38:39] op_sel_hi:[1,0,0]
  v_pk_fma_f32 v[168:169], v[168:169], s[100:101], v[40:41] op_sel_hi:[1,0,0]
  v_pk_fma_f32 v[162:163], v[162:163], s[100:101], v[36:37] op_sel_hi:[1,0,0]
  v_pk_fma_f32 v[166:167], v[166:167], s[100:101], v[38:39] op_sel_hi:[1,0,0]
  v_pk_fma_f32 v[170:171], v[170:171], s[100:101], v[40:41] op_sel_hi:[1,0,0]
  v_exp_f32 v160, v160
  v_exp_f32 v161, v161
  v_exp_f32 v164, v164
  v_exp_f32 v165, v165
  v_exp_f32 v168, v168
  v_exp_f32 v169, v169
  v_pk_fma_f32 v[172:173], v[172:173], s[100:101], v[36:37] op_sel_hi:[1,0,0]
  buffer_load_dwordx4 v6, s[12:15], s35 offen offset:2048 nt lds
  v_pk_fma_f32 v[176:177], v[176:177], s[100:101], v[38:39] op_sel_hi:[1,0,0]
  v_pk_fma_f32 v[180:181], v[180:181], s[100:101], v[40:41] op_sel_hi:[1,0,0]
  v_exp_f32 v162, v162
  v_exp_f32 v163, v163
  v_exp_f32 v166, v166
  v_exp_f32 v167, v167
  v_exp_f32 v170, v170
  v_exp_f32 v171, v171
  s_waitcnt vmcnt(11)
  ds_read_b64_tr_b16 v[80:81], v8 offset:0
  ds_read_b64_tr_b16 v[82:83], v8 offset:4096
  ds_read_b64_tr_b16 v[84:85], v9 offset:0
  ds_read_b64_tr_b16 v[86:87], v9 offset:4096
  ds_read_b64_tr_b16 v[88:89], v10 offset:0
  ds_read_b64_tr_b16 v[90:91], v10 offset:4096
  ds_read_b64_tr_b16 v[92:93], v11 offset:0
  ds_read_b64_tr_b16 v[94:95], v11 offset:4096
  ds_read_b64_tr_b16 v[96:97], v8 offset:2048
  buffer_load_dwordx4 v7, s[12:15], s35 offen offset:3072 nt lds
  ds_read_b64_tr_b16 v[98:99], v8 offset:6144
  ds_read_b64_tr_b16 v[100:101], v9 offset:2048
  ds_read_b64_tr_b16 v[102:103], v9 offset:6144
  ds_read_b64_tr_b16 v[104:105], v10 offset:2048
  ds_read_b64_tr_b16 v[106:107], v10 offset:6144
  ds_read_b64_tr_b16 v[108:109], v11 offset:2048
  ds_read_b64_tr_b16 v[110:111], v11 offset:6144
  v_pk_fma_f32 v[174:175], v[174:175], s[100:101], v[36:37] op_sel_hi:[1,0,0]
  v_pk_fma_f32 v[178:179], v[178:179], s[100:101], v[38:39] op_sel_hi:[1,0,0]
  v_pk_fma_f32 v[182:183], v[182:183], s[100:101], v[40:41] op_sel_hi:[1,0,0]
  v_exp_f32 v172, v172
  v_exp_f32 v173, v173
  v_exp_f32 v176, v176
  v_exp_f32 v177, v177
  v_exp_f32 v180, v180
  v_exp_f32 v181, v181
  v_pk_add_f32 v[42:43], v[160:161], v[162:163]
  v_pk_add_f32 v[44:45], v[164:165], v[166:167]
  s_add_u32 m0, s33, 20480
  s_nop 0
  buffer_load_dwordx4 v4, s[12:15], s46 offen offset:0 nt lds
  v_pk_add_f32 v[46:47], v[168:169], v[170:171]
  s_waitcnt lgkmcnt(0)
  v_pk_fma_f32 v[184:185], v[184:185], s[100:101], v[36:37] op_sel_hi:[1,0,0]
  v_pk_fma_f32 v[188:189], v[188:189], s[100:101], v[38:39] op_sel_hi:[1,0,0]
  v_pk_fma_f32 v[192:193], v[192:193], s[100:101], v[40:41] op_sel_hi:[1,0,0]
  v_exp_f32 v174, v174
  v_exp_f32 v175, v175
  v_exp_f32 v178, v178
  v_exp_f32 v179, v179
  v_exp_f32 v182, v182
  buffer_load_dwordx4 v5, s[12:15], s46 offen offset:1024 nt lds
  v_exp_f32 v183, v183
  v_pk_add_f32 v[42:43], v[42:43], v[172:173]
  v_pk_add_f32 v[44:45], v[44:45], v[176:177]
  v_pk_add_f32 v[46:47], v[46:47], v[180:181]
  v_pk_fma_f32 v[186:187], v[186:187], s[100:101], v[36:37] op_sel_hi:[1,0,0]
  v_pk_fma_f32 v[190:191], v[190:191], s[100:101], v[38:39] op_sel_hi:[1,0,0]
  v_pk_fma_f32 v[194:195], v[194:195], s[100:101], v[40:41] op_sel_hi:[1,0,0]
  v_exp_f32 v184, v184
  v_exp_f32 v185, v185
  v_exp_f32 v188, v188
  v_exp_f32 v189, v189
  v_exp_f32 v192, v192
  v_exp_f32 v193, v193
  v_pk_add_f32 v[42:43], v[42:43], v[174:175]
  v_pk_add_f32 v[44:45], v[44:45], v[178:179]
  v_pk_add_f32 v[46:47], v[46:47], v[182:183]
  v_pk_fma_f32 v[196:197], v[196:197], s[100:101], v[36:37] op_sel_hi:[1,0,0]
  v_pk_fma_f32 v[200:201], v[200:201], s[100:101], v[38:39] op_sel_hi:[1,0,0]
  v_pk_fma_f32 v[204:205], v[204:205], s[100:101], v[40:41] op_sel_hi:[1,0,0]
  v_exp_f32 v186, v186
  buffer_load_dwordx4 v6, s[12:15], s46 offen offset:2048 nt lds
  v_exp_f32 v187, v187
  v_exp_f32 v190, v190
  v_exp_f32 v191, v191
  v_exp_f32 v194, v194
  v_exp_f32 v195, v195
  v_pk_add_f32 v[42:43], v[42:43], v[184:185]
  v_pk_add_f32 v[44:45], v[44:45], v[188:189]
  v_pk_add_f32 v[46:47], v[46:47], v[192:193]
  v_pk_fma_f32 v[198:199], v[198:199], s[100:101], v[36:37] op_sel_hi:[1,0,0]
  v_pk_fma_f32 v[202:203], v[202:203], s[100:101], v[38:39] op_sel_hi:[1,0,0]
  v_pk_fma_f32 v[206:207], v[206:207], s[100:101], v[40:41] op_sel_hi:[1,0,0]
  v_exp_f32 v196, v196
  v_exp_f32 v197, v197
  v_exp_f32 v200, v200
  v_exp_f32 v201, v201
  v_exp_f32 v204, v204
  v_exp_f32 v205, v205
  buffer_load_dwordx4 v7, s[12:15], s46 offen offset:3072 nt lds
  s_add_u32 s35, s35, 16384
  v_pk_add_f32 v[42:43], v[42:43], v[186:187]
  v_pk_add_f32 v[44:45], v[44:45], v[190:191]
  v_pk_add_f32 v[46:47], v[46:47], v[194:195]
  v_pk_fma_f32 v[208:209], v[208:209], s[100:101], v[36:37] op_sel_hi:[1,0,0]
  v_pk_fma_f32 v[212:213], v[212:213], s[100:101], v[38:39] op_sel_hi:[1,0,0]
  v_pk_fma_f32 v[216:217], v[216:217], s[100:101], v[40:41] op_sel_hi:[1,0,0]
  v_exp_f32 v198, v198
  v_exp_f32 v199, v199
  v_exp_f32 v202, v202
  v_exp_f32 v203, v203
  v_exp_f32 v206, v206
  v_exp_f32 v207, v207
  v_pk_add_f32 v[42:43], v[42:43], v[196:197]
  v_pk_add_f32 v[44:45], v[44:45], v[200:201]
  v_pk_add_f32 v[46:47], v[46:47], v[204:205]
  v_pk_fma_f32 v[210:211], v[210:211], s[100:101], v[36:37] op_sel_hi:[1,0,0]
  v_pk_fma_f32 v[214:215], v[214:215], s[100:101], v[38:39] op_sel_hi:[1,0,0]
  v_pk_fma_f32 v[218:219], v[218:219], s[100:101], v[40:41] op_sel_hi:[1,0,0]
  v_exp_f32 v208, v208
  v_exp_f32 v209, v209
  s_add_u32 m0, s33, 0
  s_add_u32 s46, s35, 32768
  buffer_load_dwordx4 v4, s[12:15], s35 offen offset:0 nt lds
  v_exp_f32 v212, v212
  v_exp_f32 v213, v213
  v_exp_f32 v216, v216
  v_exp_f32 v217, v217
  v_pk_add_f32 v[42:43], v[42:43], v[198:199]
  v_pk_add_f32 v[44:45], v[44:45], v[202:203]
  v_pk_add_f32 v[46:47], v[46:47], v[206:207]
  v_pk_fma_f32 v[220:221], v[220:221], s[100:101], v[36:37] op_sel_hi:[1,0,0]
  v_pk_fma_f32 v[224:225], v[224:225], s[100:101], v[38:39] op_sel_hi:[1,0,0]
  v_pk_fma_f32 v[228:229], v[228:229], s[100:101], v[40:41] op_sel_hi:[1,0,0]
  v_exp_f32 v210, v210
  v_exp_f32 v211, v211
  v_exp_f32 v214, v214
  v_exp_f32 v215, v215
  v_exp_f32 v218, v218
  v_exp_f32 v219, v219
  v_pk_add_f32 v[42:43], v[42:43], v[208:209]
  v_pk_add_f32 v[44:45], v[44:45], v[212:213]
  buffer_load_dwordx4 v5, s[12:15], s35 offen offset:1024 nt lds
  v_pk_add_f32 v[46:47], v[46:47], v[216:217]
  s_waitcnt vmcnt(10)
  ds_read_b64_tr_b16 v[48:49], v8 offset:8192
  ds_read_b64_tr_b16 v[50:51], v8 offset:12288
  ds_read_b64_tr_b16 v[52:53], v9 offset:8192
  ds_read_b64_tr_b16 v[54:55], v9 offset:12288
  ds_read_b64_tr_b16 v[56:57], v10 offset:8192
  ds_read_b64_tr_b16 v[58:59], v10 offset:12288
  ds_read_b64_tr_b16 v[60:61], v11 offset:8192
  ds_read_b64_tr_b16 v[62:63], v11 offset:12288
  ds_read_b64_tr_b16 v[64:65], v8 offset:10240
  ds_read_b64_tr_b16 v[66:67], v8 offset:14336
  ds_read_b64_tr_b16 v[68:69], v9 offset:10240
  ds_read_b64_tr_b16 v[70:71], v9 offset:14336
  ds_read_b64_tr_b16 v[72:73], v10 offset:10240
  ds_read_b64_tr_b16 v[74:75], v10 offset:14336
  ds_read_b64_tr_b16 v[76:77], v11 offset:10240
  ds_read_b64_tr_b16 v[78:79], v11 offset:14336
  v_pk_fma_f32 v[222:223], v[222:223], s[100:101], v[36:37] op_sel_hi:[1,0,0]
  v_pk_fma_f32 v[226:227], v[226:227], s[100:101], v[38:39] op_sel_hi:[1,0,0]
  v_pk_fma_f32 v[230:231], v[230:231], s[100:101], v[40:41] op_sel_hi:[1,0,0]
  buffer_load_dwordx4 v6, s[12:15], s35 offen offset:2048 nt lds
  v_exp_f32 v220, v220
  v_exp_f32 v221, v221
  v_exp_f32 v224, v224
  v_exp_f32 v225, v225
  v_exp_f32 v228, v228
  v_exp_f32 v229, v229
  v_pk_add_f32 v[42:43], v[42:43], v[210:211]
  v_pk_add_f32 v[44:45], v[44:45], v[214:215]
  v_pk_add_f32 v[46:47], v[46:47], v[218:219]
  s_waitcnt lgkmcnt(0)
  buffer_load_dwordx4 v7, s[12:15], s35 offen offset:3072 nt lds
  v_pk_fma_f32 v[232:233], v[232:233], s[100:101], v[36:37] op_sel_hi:[1,0,0]
  v_pk_fma_f32 v[236:237], v[236:237], s[100:101], v[38:39] op_sel_hi:[1,0,0]
  v_pk_fma_f32 v[240:241], v[240:241], s[100:101], v[40:41] op_sel_hi:[1,0,0]
  v_exp_f32 v222, v222
  v_exp_f32 v223, v223
  v_exp_f32 v226, v226
  v_exp_f32 v227, v227
  v_exp_f32 v230, v230
  v_exp_f32 v231, v231
  v_pk_add_f32 v[42:43], v[42:43], v[220:221]
  v_pk_add_f32 v[44:45], v[44:45], v[224:225]
  v_pk_add_f32 v[46:47], v[46:47], v[228:229]
  v_pk_fma_f32 v[234:235], v[234:235], s[100:101], v[36:37] op_sel_hi:[1,0,0]
  v_pk_fma_f32 v[238:239], v[238:239], s[100:101], v[38:39] op_sel_hi:[1,0,0]
  v_pk_fma_f32 v[242:243], v[242:243], s[100:101], v[40:41] op_sel_hi:[1,0,0]
  v_exp_f32 v232, v232
  v_exp_f32 v233, v233
  v_exp_f32 v236, v236
  v_exp_f32 v237, v237
  s_add_u32 m0, s33, 4096
  s_nop 0
  buffer_load_dwordx4 v4, s[12:15], s46 offen offset:0 nt lds
  v_exp_f32 v240, v240
  v_exp_f32 v241, v241
  v_pk_add_f32 v[42:43], v[42:43], v[222:223]
  v_pk_add_f32 v[44:45], v[44:45], v[226:227]
  v_pk_add_f32 v[46:47], v[46:47], v[230:231]
  v_pk_fma_f32 v[244:245], v[244:245], s[100:101], v[36:37] op_sel_hi:[1,0,0]
  v_pk_fma_f32 v[248:249], v[248:249], s[100:101], v[38:39] op_sel_hi:[1,0,0]
  v_pk_fma_f32 v[252:253], v[252:253], s[100:101], v[40:41] op_sel_hi:[1,0,0]
  v_exp_f32 v234, v234
  v_exp_f32 v235, v235
  v_exp_f32 v238, v238
  v_exp_f32 v239, v239
  v_exp_f32 v242, v242
  v_exp_f32 v243, v243
  v_pk_add_f32 v[42:43], v[42:43], v[232:233]
  v_pk_add_f32 v[44:45], v[44:45], v[236:237]
  v_pk_add_f32 v[46:47], v[46:47], v[240:241]
  v_pk_fma_f32 v[246:247], v[246:247], s[100:101], v[36:37] op_sel_hi:[1,0,0]
  v_pk_fma_f32 v[250:251], v[250:251], s[100:101], v[38:39] op_sel_hi:[1,0,0]
  v_pk_fma_f32 v[254:255], v[254:255], s[100:101], v[40:41] op_sel_hi:[1,0,0]
  buffer_load_dwordx4 v5, s[12:15], s46 offen offset:1024 nt lds
  v_exp_f32 v244, v244
  v_exp_f32 v245, v245
  v_exp_f32 v248, v248
  v_exp_f32 v249, v249
  v_exp_f32 v252, v252
  v_exp_f32 v253, v253
  v_pk_add_f32 v[42:43], v[42:43], v[234:235]
  v_pk_add_f32 v[44:45], v[44:45], v[238:239]
  v_pk_add_f32 v[46:47], v[46:47], v[242:243]
  v_exp_f32 v246, v246
  v_exp_f32 v247, v247
  v_exp_f32 v250, v250
  v_exp_f32 v251, v251
  v_exp_f32 v254, v254
  v_exp_f32 v255, v255
  v_pk_add_f32 v[42:43], v[42:43], v[244:245]
  buffer_load_dwordx4 v6, s[12:15], s46 offen offset:2048 nt lds
  v_pk_add_f32 v[44:45], v[44:45], v[248:249]
  v_pk_add_f32 v[46:47], v[46:47], v[252:253]
  s_nop 0
  v_pk_add_f32 v[42:43], v[42:43], v[246:247]
  v_pk_add_f32 v[44:45], v[44:45], v[250:251]
  v_pk_add_f32 v[46:47], v[46:47], v[254:255]
  v_add_f32 v42, v42, v43
  v_add_f32 v44, v44, v45
  v_add_f32 v46, v46, v47
  v_mov_b32 v37, v42
  v_mov_b32 v39, v44
  v_mov_b32 v41, v46
  s_nop 1
  v_permlane32_swap_b32 v37, v42
  v_permlane32_swap_b32 v39, v44
  v_permlane32_swap_b32 v41, v46
  s_nop 1
  v_add_f32 v42, v42, v37
  v_add_f32 v44, v44, v39
  v_add_f32 v46, v46, v41
  v_mov_b32 v37, v42
  v_mov_b32 v39, v44
  v_mov_b32 v41, v46
  s_nop 1
  v_permlane16_swap_b32 v37, v42
  v_permlane16_swap_b32 v39, v44
  v_permlane16_swap_b32 v41, v46
  buffer_load_dwordx4 v7, s[12:15], s46 offen offset:3072 nt lds
  s_add_u32 s35, s35, 49152
  s_nop 1
  v_add_f32 v42, v42, v37
  v_add_f32 v44, v44, v39
  v_add_f32 v46, v46, v41
  ds_write_b32 v13, v42 offset:1536
  ds_write_b32 v13, v44 offset:1792
  ds_write_b32 v13, v46 offset:2048
  s_mul_i32 s39, s32, 3072
  v_add_u32 v15, s39, v3
  v_cvt_pk_bf16_f32 v175, v174, v175
  v_cvt_pk_bf16_f32 v174, v172, v173
  v_cvt_pk_bf16_f32 v172, v160, v161
  v_cvt_pk_bf16_f32 v173, v162, v163
  ds_write_b128 v15, v[172:175] offset:0
  v_cvt_pk_bf16_f32 v179, v178, v179
  v_cvt_pk_bf16_f32 v178, v176, v177
  v_cvt_pk_bf16_f32 v176, v164, v165
  v_cvt_pk_bf16_f32 v177, v166, v167
  ds_write_b128 v15, v[176:179] offset:1024
  v_cvt_pk_bf16_f32 v183, v182, v183
  v_cvt_pk_bf16_f32 v182, v180, v181
  s_add_u32 m0, s33, 8192
  s_add_u32 s46, s35, 32768
  buffer_load_dwordx4 v4, s[12:15], s35 offen offset:0 nt lds
  v_cvt_pk_bf16_f32 v180, v168, v169
  v_cvt_pk_bf16_f32 v181, v170, v171
  ds_write_b128 v15, v[180:183] offset:2048
  v_cvt_pk_bf16_f32 v199, v198, v199
  v_cvt_pk_bf16_f32 v198, v196, v197
  v_cvt_pk_bf16_f32 v196, v184, v185
  v_cvt_pk_bf16_f32 v197, v186, v187
  ds_write_b128 v15, v[196:199] offset:12288
  v_cvt_pk_bf16_f32 v203, v202, v203
  v_cvt_pk_bf16_f32 v202, v200, v201
  v_cvt_pk_bf16_f32 v200, v188, v189
  v_cvt_pk_bf16_f32 v201, v190, v191
  ds_write_b128 v15, v[200:203] offset:13312
  v_cvt_pk_bf16_f32 v207, v206, v207
  v_cvt_pk_bf16_f32 v206, v204, v205
  v_cvt_pk_bf16_f32 v204, v192, v193
  v_cvt_pk_bf16_f32 v205, v194, v195
  ds_write_b128 v15, v[204:207] offset:14336
  buffer_load_dwordx4 v5, s[12:15], s35 offen offset:1024 nt lds
  v_cvt_pk_bf16_f32 v223, v222, v223
  v_cvt_pk_bf16_f32 v222, v220, v221
  v_cvt_pk_bf16_f32 v220, v208, v209
  v_cvt_pk_bf16_f32 v221, v210, v211
  ds_write_b128 v15, v[220:223] offset:24576
  v_cvt_pk_bf16_f32 v227, v226, v227
  v_cvt_pk_bf16_f32 v226, v224, v225
  v_cvt_pk_bf16_f32 v224, v212, v213
  v_cvt_pk_bf16_f32 v225, v214, v215
  ds_write_b128 v15, v[224:227] offset:25600
  v_cvt_pk_bf16_f32 v231, v230, v231
  v_cvt_pk_bf16_f32 v230, v228, v229
  v_cvt_pk_bf16_f32 v228, v216, v217
  v_cvt_pk_bf16_f32 v229, v218, v219
  ds_write_b128 v15, v[228:231] offset:26624
  v_cvt_pk_bf16_f32 v247, v246, v247
  v_cvt_pk_bf16_f32 v246, v244, v245
  v_cvt_pk_bf16_f32 v244, v232, v233
  v_cvt_pk_bf16_f32 v245, v234, v235
  buffer_load_dwordx4 v6, s[12:15], s35 offen offset:2048 nt lds
  ds_write_b128 v15, v[244:247] offset:36864
  v_cvt_pk_bf16_f32 v251, v250, v251
  v_cvt_pk_bf16_f32 v250, v248, v249
  v_cvt_pk_bf16_f32 v248, v236, v237
  v_cvt_pk_bf16_f32 v249, v238, v239
  ds_write_b128 v15, v[248:251] offset:37888
  v_cvt_pk_bf16_f32 v255, v254, v255
  v_cvt_pk_bf16_f32 v254, v252, v253
  v_cvt_pk_bf16_f32 v252, v240, v241
  v_cvt_pk_bf16_f32 v253, v242, v243
  ds_write_b128 v15, v[252:255] offset:38912
  s_waitcnt lgkmcnt(0)
  buffer_load_dwordx4 v7, s[12:15], s35 offen offset:3072 nt lds
  s_barrier
  ds_read_b128 v[208:211], v3 offset:0
  ds_read_b128 v[212:215], v3 offset:1024
  ds_read_b128 v[216:219], v3 offset:2048
  ds_read_b128 v[220:223], v3 offset:3072
  ds_read_b128 v[224:227], v3 offset:4096
  ds_read_b128 v[228:231], v3 offset:5120
  s_waitcnt lgkmcnt(0)
  s_add_u32 m0, s33, 12288
  s_nop 0
  buffer_load_dwordx4 v4, s[12:15], s46 offen offset:0 nt lds
  v_mfma_f32_16x16x32_bf16 v[160:163], v[80:83], v[208:211], 0
  v_mfma_f32_16x16x32_bf16 v[164:167], v[80:83], v[212:215], 0
  v_mfma_f32_16x16x32_bf16 v[168:171], v[80:83], v[216:219], 0
  v_mfma_f32_16x16x32_bf16 v[172:175], v[84:87], v[208:211], 0
  v_mfma_f32_16x16x32_bf16 v[176:179], v[84:87], v[212:215], 0
  v_mfma_f32_16x16x32_bf16 v[180:183], v[84:87], v[216:219], 0
  v_mfma_f32_16x16x32_bf16 v[184:187], v[88:91], v[208:211], 0
  buffer_load_dwordx4 v5, s[12:15], s46 offen offset:1024 nt lds
  v_mfma_f32_16x16x32_bf16 v[188:191], v[88:91], v[212:215], 0
  v_mfma_f32_16x16x32_bf16 v[192:195], v[88:91], v[216:219], 0
  v_mfma_f32_16x16x32_bf16 v[196:199], v[92:95], v[208:211], 0
  v_mfma_f32_16x16x32_bf16 v[200:203], v[92:95], v[212:215], 0
  v_mfma_f32_16x16x32_bf16 v[204:207], v[92:95], v[216:219], 0
  v_mfma_f32_16x16x32_bf16 v[160:163], v[96:99], v[220:223], v[160:163]
  v_mfma_f32_16x16x32_bf16 v[164:167], v[96:99], v[224:227], v[164:167]
  buffer_load_dwordx4 v6, s[12:15], s46 offen offset:2048 nt lds
  v_mfma_f32_16x16x32_bf16 v[168:171], v[96:99], v[228:231], v[168:171]
  v_mfma_f32_16x16x32_bf16 v[172:175], v[100:103], v[220:223], v[172:175]
  v_mfma_f32_16x16x32_bf16 v[176:179], v[100:103], v[224:227], v[176:179]
  v_mfma_f32_16x16x32_bf16 v[180:183], v[100:103], v[228:231], v[180:183]
  v_mfma_f32_16x16x32_bf16 v[184:187], v[104:107], v[220:223], v[184:187]
  v_mfma_f32_16x16x32_bf16 v[188:191], v[104:107], v[224:227], v[188:191]
  v_mfma_f32_16x16x32_bf16 v[192:195], v[104:107], v[228:231], v[192:195]
  buffer_load_dwordx4 v7, s[12:15], s46 offen offset:3072 nt lds
  s_add_u32 s35, s35, 16384
  v_mfma_f32_16x16x32_bf16 v[196:199], v[108:111], v[220:223], v[196:199]
  v_mfma_f32_16x16x32_bf16 v[200:203], v[108:111], v[224:227], v[200:203]
  v_mfma_f32_16x16x32_bf16 v[204:207], v[108:111], v[228:231], v[204:207]
  ds_read_b128 v[208:211], v3 offset:6144
  ds_read_b128 v[212:215], v3 offset:7168
  ds_read_b128 v[216:219], v3 offset:8192
  ds_read_b128 v[220:223], v3 offset:9216
  ds_read_b128 v[224:227], v3 offset:10240
  ds_read_b128 v[228:231], v3 offset:11264
  s_waitcnt lgkmcnt(0)
  s_waitcnt vmcnt(16)
  v_mfma_f32_16x16x32_bf16 v[160:163], v[48:51], v[208:211], v[160:163]
  ds_read_b64_tr_b16 v[80:81], v8 offset:16384
  v_mfma_f32_16x16x32_bf16 v[164:167], v[48:51], v[212:215], v[164:167]
  ds_read_b64_tr_b16 v[82:83], v8 offset:20480
  v_mfma_f32_16x16x32_bf16 v[168:171], v[48:51], v[216:219], v[168:171]
  ds_read_b64_tr_b16 v[84:85], v9 offset:16384
  v_mfma_f32_16x16x32_bf16 v[172:175], v[52:55], v[208:211], v[172:175]
  ds_read_b64_tr_b16 v[86:87], v9 offset:20480
  v_mfma_f32_16x16x32_bf16 v[176:179], v[52:55], v[212:215], v[176:179]
  v_mfma_f32_16x16x32_bf16 v[180:183], v[52:55], v[216:219], v[180:183]
  ds_read_b64_tr_b16 v[88:89], v10 offset:16384
  v_mfma_f32_16x16x32_bf16 v[184:187], v[56:59], v[208:211], v[184:187]
  ds_read_b64_tr_b16 v[90:91], v10 offset:20480
  v_mfma_f32_16x16x32_bf16 v[188:191], v[56:59], v[212:215], v[188:191]
  ds_read_b64_tr_b16 v[92:93], v11 offset:16384
  v_mfma_f32_16x16x32_bf16 v[192:195], v[56:59], v[216:219], v[192:195]
  ds_read_b64_tr_b16 v[94:95], v11 offset:20480
  v_mfma_f32_16x16x32_bf16 v[196:199], v[60:63], v[208:211], v[196:199]
  v_mfma_f32_16x16x32_bf16 v[200:203], v[60:63], v[212:215], v[200:203]
  ds_read_b64_tr_b16 v[96:97], v8 offset:18432
  v_mfma_f32_16x16x32_bf16 v[204:207], v[60:63], v[216:219], v[204:207]
  ds_read_b64_tr_b16 v[98:99], v8 offset:22528
  v_mfma_f32_16x16x32_bf16 v[160:163], v[64:67], v[220:223], v[160:163]
  ds_read_b64_tr_b16 v[100:101], v9 offset:18432
  v_mfma_f32_16x16x32_bf16 v[164:167], v[64:67], v[224:227], v[164:167]
  ds_read_b64_tr_b16 v[102:103], v9 offset:22528
  v_mfma_f32_16x16x32_bf16 v[168:171], v[64:67], v[228:231], v[168:171]
  v_mfma_f32_16x16x32_bf16 v[172:175], v[68:71], v[220:223], v[172:175]
  ds_read_b64_tr_b16 v[104:105], v10 offset:18432
  v_mfma_f32_16x16x32_bf16 v[176:179], v[68:71], v[224:227], v[176:179]
  ds_read_b64_tr_b16 v[106:107], v10 offset:22528
  v_mfma_f32_16x16x32_bf16 v[180:183], v[68:71], v[228:231], v[180:183]
  ds_read_b64_tr_b16 v[108:109], v11 offset:18432
  v_mfma_f32_16x16x32_bf16 v[184:187], v[72:75], v[220:223], v[184:187]
  ds_read_b64_tr_b16 v[110:111], v11 offset:22528
  v_mfma_f32_16x16x32_bf16 v[188:191], v[72:75], v[224:227], v[188:191]
  v_mfma_f32_16x16x32_bf16 v[192:195], v[72:75], v[228:231], v[192:195]
  v_mfma_f32_16x16x32_bf16 v[196:199], v[76:79], v[220:223], v[196:199]
  v_mfma_f32_16x16x32_bf16 v[200:203], v[76:79], v[224:227], v[200:203]
  v_mfma_f32_16x16x32_bf16 v[204:207], v[76:79], v[228:231], v[204:207]
  s_waitcnt lgkmcnt(0)
  ds_read_b128 v[208:211], v3 offset:12288
  s_add_u32 m0, s33, 16384
  s_add_u32 s46, s35, 32768
  buffer_load_dwordx4 v4, s[12:15], s35 offen offset:0 nt lds
  ds_read_b128 v[212:215], v3 offset:13312
  ds_read_b128 v[216:219], v3 offset:14336
  ds_read_b128 v[220:223], v3 offset:15360
  ds_read_b128 v[224:227], v3 offset:16384
  ds_read_b128 v[228:231], v3 offset:17408
  s_waitcnt lgkmcnt(0)
  v_mfma_f32_16x16x32_bf16 v[160:163], v[80:83], v[208:211], v[160:163]
  v_mfma_f32_16x16x32_bf16 v[164:167], v[80:83], v[212:215], v[164:167]
  buffer_load_dwordx4 v5, s[12:15], s35 offen offset:1024 nt lds
  v_mfma_f32_16x16x32_bf16 v[168:171], v[80:83], v[216:219], v[168:171]
  v_mfma_f32_16x16x32_bf16 v[172:175], v[84:87], v[208:211], v[172:175]
  v_mfma_f32_16x16x32_bf16 v[176:179], v[84:87], v[212:215], v[176:179]
  v_mfma_f32_16x16x32_bf16 v[180:183], v[84:87], v[216:219], v[180:183]
  v_mfma_f32_16x16x32_bf16 v[184:187], v[88:91], v[208:211], v[184:187]
  v_mfma_f32_16x16x32_bf16 v[188:191], v[88:91], v[212:215], v[188:191]
  v_mfma_f32_16x16x32_bf16 v[192:195], v[88:91], v[216:219], v[192:195]
  buffer_load_dwordx4 v6, s[12:15], s35 offen offset:2048 nt lds
  v_mfma_f32_16x16x32_bf16 v[196:199], v[92:95], v[208:211], v[196:199]
  v_mfma_f32_16x16x32_bf16 v[200:203], v[92:95], v[212:215], v[200:203]
  v_mfma_f32_16x16x32_bf16 v[204:207], v[92:95], v[216:219], v[204:207]
  v_mfma_f32_16x16x32_bf16 v[160:163], v[96:99], v[220:223], v[160:163]
  v_mfma_f32_16x16x32_bf16 v[164:167], v[96:99], v[224:227], v[164:167]
  v_mfma_f32_16x16x32_bf16 v[168:171], v[96:99], v[228:231], v[168:171]
  v_mfma_f32_16x16x32_bf16 v[172:175], v[100:103], v[220:223], v[172:175]
  buffer_load_dwordx4 v7, s[12:15], s35 offen offset:3072 nt lds
  v_mfma_f32_16x16x32_bf16 v[176:179], v[100:103], v[224:227], v[176:179]
  v_mfma_f32_16x16x32_bf16 v[180:183], v[100:103], v[228:231], v[180:183]
  v_mfma_f32_16x16x32_bf16 v[184:187], v[104:107], v[220:223], v[184:187]
  v_mfma_f32_16x16x32_bf16 v[188:191], v[104:107], v[224:227], v[188:191]
  v_mfma_f32_16x16x32_bf16 v[192:195], v[104:107], v[228:231], v[192:195]
  v_mfma_f32_16x16x32_bf16 v[196:199], v[108:111], v[220:223], v[196:199]
  v_mfma_f32_16x16x32_bf16 v[200:203], v[108:111], v[224:227], v[200:203]
  s_add_u32 m0, s33, 20480
  s_nop 0
  buffer_load_dwordx4 v4, s[12:15], s46 offen offset:0 nt lds
  v_mfma_f32_16x16x32_bf16 v[204:207], v[108:111], v[228:231], v[204:207]
  ds_read_b128 v[208:211], v3 offset:18432
  ds_read_b128 v[212:215], v3 offset:19456
  ds_read_b128 v[216:219], v3 offset:20480
  ds_read_b128 v[220:223], v3 offset:21504
  ds_read_b128 v[224:227], v3 offset:22528
  ds_read_b128 v[228:231], v3 offset:23552
  s_mul_i32 s39, s32, 10752
  s_add_u32 s40, s39, 4096
  s_add_u32 s41, s39, 8192
  buffer_store_dwordx4 v[148:151], v33, s[28:31], s41 offen offset:0 sc1
  buffer_store_dwordx4 v[144:147], v33, s[28:31], s40 offen offset:3072 sc1
  buffer_store_dwordx4 v[140:143], v33, s[28:31], s40 offen offset:2048 sc1
  buffer_store_dwordx4 v[136:139], v33, s[28:31], s40 offen offset:1024 sc1
  buffer_store_dwordx4 v[132:135], v33, s[28:31], s40 offen offset:0 sc1
  buffer_store_dwordx4 v[128:131], v33, s[28:31], s39 offen offset:3072 sc1
  buffer_store_dwordx4 v[124:127], v33, s[28:31], s39 offen offset:2048 sc1
  buffer_store_dwordx4 v[120:123], v33, s[28:31], s39 offen offset:1024 sc1
  buffer_store_dwordx4 v[116:119], v33, s[28:31], s39 offen offset:0 sc1
  buffer_store_dwordx2 v[152:153], v35, s[28:31], s41 offen offset:1024 sc1
  buffer_store_dwordx2 v[154:155], v35, s[28:31], s41 offen offset:1536 sc1
  buffer_store_dwordx2 v[156:157], v35, s[28:31], s41 offen offset:2048 sc1
  s_waitcnt vmcnt(25)
  ds_read_b64_tr_b16 v[48:49], v8 offset:0
  ds_read_b64_tr_b16 v[50:51], v8 offset:4096
  ds_read_b64_tr_b16 v[52:53], v9 offset:0
  ds_read_b64_tr_b16 v[54:55], v9 offset:4096
  ds_read_b64_tr_b16 v[56:57], v10 offset:0
  ds_read_b64_tr_b16 v[58:59], v10 offset:4096
  ds_read_b64_tr_b16 v[60:61], v11 offset:0
  ds_read_b64_tr_b16 v[62:63], v11 offset:4096
  ds_read_b64_tr_b16 v[64:65], v8 offset:2048
  ds_read_b64_tr_b16 v[66:67], v8 offset:6144
  ds_read_b64_tr_b16 v[68:69], v9 offset:2048
  ds_read_b64_tr_b16 v[70:71], v9 offset:6144
  s_waitcnt lgkmcnt(10)
  v_mfma_f32_16x16x32_bf16 v[160:163], v[48:51], v[208:211], v[160:163]
  v_mfma_f32_16x16x32_bf16 v[164:167], v[48:51], v[212:215], v[164:167]
  v_mfma_f32_16x16x32_bf16 v[168:171], v[48:51], v[216:219], v[168:171]
  ds_read_b64_tr_b16 v[72:73], v10 offset:2048
  ds_read_b64_tr_b16 v[74:75], v10 offset:6144
  s_waitcnt lgkmcnt(10)
  v_mfma_f32_16x16x32_bf16 v[172:175], v[52:55], v[208:211], v[172:175]
  v_mfma_f32_16x16x32_bf16 v[176:179], v[52:55], v[212:215], v[176:179]
  v_mfma_f32_16x16x32_bf16 v[180:183], v[52:55], v[216:219], v[180:183]
  ds_read_b64_tr_b16 v[76:77], v11 offset:2048
  ds_read_b64_tr_b16 v[78:79], v11 offset:6144
  s_waitcnt lgkmcnt(10)
  v_mfma_f32_16x16x32_bf16 v[184:187], v[56:59], v[208:211], v[184:187]
  buffer_load_dwordx4 v5, s[12:15], s46 offen offset:1024 nt lds
  v_mfma_f32_16x16x32_bf16 v[188:191], v[56:59], v[212:215], v[188:191]
  v_mfma_f32_16x16x32_bf16 v[192:195], v[56:59], v[216:219], v[192:195]
  s_waitcnt lgkmcnt(8)
  v_mfma_f32_16x16x32_bf16 v[196:199], v[60:63], v[208:211], v[196:199]
  v_mfma_f32_16x16x32_bf16 v[200:203], v[60:63], v[212:215], v[200:203]
  v_mfma_f32_16x16x32_bf16 v[204:207], v[60:63], v[216:219], v[204:207]
  s_waitcnt lgkmcnt(6)
  v_mfma_f32_16x16x32_bf16 v[160:163], v[64:67], v[220:223], v[160:163]
  v_mfma_f32_16x16x32_bf16 v[164:167], v[64:67], v[224:227], v[164:167]
  buffer_load_dwordx4 v6, s[12:15], s46 offen offset:2048 nt lds
  v_mfma_f32_16x16x32_bf16 v[168:171], v[64:67], v[228:231], v[168:171]
  s_waitcnt lgkmcnt(4)
  v_mfma_f32_16x16x32_bf16 v[172:175], v[68:71], v[220:223], v[172:175]
  v_mfma_f32_16x16x32_bf16 v[176:179], v[68:71], v[224:227], v[176:179]
  v_mfma_f32_16x16x32_bf16 v[180:183], v[68:71], v[228:231], v[180:183]
  s_waitcnt lgkmcnt(2)
  v_mfma_f32_16x16x32_bf16 v[184:187], v[72:75], v[220:223], v[184:187]
  v_mfma_f32_16x16x32_bf16 v[188:191], v[72:75], v[224:227], v[188:191]
  v_mfma_f32_16x16x32_bf16 v[192:195], v[72:75], v[228:231], v[192:195]
  buffer_load_dwordx4 v7, s[12:15], s46 offen offset:3072 nt lds
  s_add_u32 s35, s35, 49152
  s_waitcnt lgkmcnt(0)
  v_mfma_f32_16x16x32_bf16 v[196:199], v[76:79], v[220:223], v[196:199]
  v_mfma_f32_16x16x32_bf16 v[200:203], v[76:79], v[224:227], v[200:203]
  v_mfma_f32_16x16x32_bf16 v[204:207], v[76:79], v[228:231], v[204:207]
  ds_read_b128 v[208:211], v3 offset:24576
  ds_read_b128 v[212:215], v3 offset:25600
  ds_read_b128 v[216:219], v3 offset:26624
  ds_read_b128 v[220:223], v3 offset:27648
  ds_read_b128 v[224:227], v3 offset:28672
  ds_read_b128 v[228:231], v3 offset:29696
  ds_read_b128 v[232:235], v14 offset:1536
  ds_read_b128 v[236:239], v14 offset:1792
  ds_read_b128 v[240:243], v14 offset:2048
  s_waitcnt lgkmcnt(0)
  s_add_u32 m0, s33, 0
  s_add_u32 s46, s35, 32768
  buffer_load_dwordx4 v4, s[12:15], s35 offen offset:0 nt lds
  v_add_f32 v32, v232, v233
  v_add_f32 v34, v236, v237
  v_add_f32 v40, v240, v241
  v_add_f32 v234, v234, v235
  v_add_f32 v238, v238, v239
  v_add_f32 v242, v242, v243
  v_add_f32 v32, v32, v234
  v_add_f32 v34, v34, v238
  v_add_f32 v40, v40, v242
  v_rcp_f32 v32, v32
  v_rcp_f32 v34, v34
  v_rcp_f32 v40, v40
  s_mul_i32 s39, s32, 6144
  v_add_u32 v15, s39, v3
  s_waitcnt vmcnt(21)
  ds_read_b64_tr_b16 v[80:81], v8 offset:8192
  ds_read_b64_tr_b16 v[82:83], v8 offset:12288
  ds_read_b64_tr_b16 v[84:85], v9 offset:8192
  ds_read_b64_tr_b16 v[86:87], v9 offset:12288
  ds_read_b64_tr_b16 v[88:89], v10 offset:8192
  ds_read_b64_tr_b16 v[90:91], v10 offset:12288
  ds_read_b64_tr_b16 v[92:93], v11 offset:8192
  ds_read_b64_tr_b16 v[94:95], v11 offset:12288
  ds_read_b64_tr_b16 v[96:97], v8 offset:10240
  ds_read_b64_tr_b16 v[98:99], v8 offset:14336
  ds_read_b64_tr_b16 v[100:101], v9 offset:10240
  ds_read_b64_tr_b16 v[102:103], v9 offset:14336
  s_waitcnt lgkmcnt(10)
  v_mfma_f32_16x16x32_bf16 v[160:163], v[80:83], v[208:211], v[160:163]
  v_mfma_f32_16x16x32_bf16 v[164:167], v[80:83], v[212:215], v[164:167]
  v_mfma_f32_16x16x32_bf16 v[168:171], v[80:83], v[216:219], v[168:171]
  ds_read_b64_tr_b16 v[104:105], v10 offset:10240
  ds_read_b64_tr_b16 v[106:107], v10 offset:14336
  s_waitcnt lgkmcnt(10)
  v_mfma_f32_16x16x32_bf16 v[172:175], v[84:87], v[208:211], v[172:175]
  v_mfma_f32_16x16x32_bf16 v[176:179], v[84:87], v[212:215], v[176:179]
  v_mfma_f32_16x16x32_bf16 v[180:183], v[84:87], v[216:219], v[180:183]
  ds_read_b64_tr_b16 v[108:109], v11 offset:10240
  ds_read_b64_tr_b16 v[110:111], v11 offset:14336
  s_waitcnt lgkmcnt(10)
  v_mfma_f32_16x16x32_bf16 v[184:187], v[88:91], v[208:211], v[184:187]
  buffer_load_dwordx4 v5, s[12:15], s35 offen offset:1024 nt lds
  v_mfma_f32_16x16x32_bf16 v[188:191], v[88:91], v[212:215], v[188:191]
  v_mfma_f32_16x16x32_bf16 v[192:195], v[88:91], v[216:219], v[192:195]
  s_waitcnt lgkmcnt(8)
  v_mfma_f32_16x16x32_bf16 v[196:199], v[92:95], v[208:211], v[196:199]
  v_mfma_f32_16x16x32_bf16 v[200:203], v[92:95], v[212:215], v[200:203]
  v_mfma_f32_16x16x32_bf16 v[204:207], v[92:95], v[216:219], v[204:207]
  s_waitcnt lgkmcnt(6)
  v_mfma_f32_16x16x32_bf16 v[160:163], v[96:99], v[220:223], v[160:163]
  v_mfma_f32_16x16x32_bf16 v[164:167], v[96:99], v[224:227], v[164:167]
  buffer_load_dwordx4 v6, s[12:15], s35 offen offset:2048 nt lds
  v_mfma_f32_16x16x32_bf16 v[168:171], v[96:99], v[228:231], v[168:171]
  s_waitcnt lgkmcnt(4)
  v_mfma_f32_16x16x32_bf16 v[172:175], v[100:103], v[220:223], v[172:175]
  v_mfma_f32_16x16x32_bf16 v[176:179], v[100:103], v[224:227], v[176:179]
  v_mfma_f32_16x16x32_bf16 v[180:183], v[100:103], v[228:231], v[180:183]
  s_waitcnt lgkmcnt(2)
  v_mfma_f32_16x16x32_bf16 v[184:187], v[104:107], v[220:223], v[184:187]
  v_mfma_f32_16x16x32_bf16 v[188:191], v[104:107], v[224:227], v[188:191]
  v_mfma_f32_16x16x32_bf16 v[192:195], v[104:107], v[228:231], v[192:195]
  buffer_load_dwordx4 v7, s[12:15], s35 offen offset:3072 nt lds
  s_waitcnt lgkmcnt(0)
  v_mfma_f32_16x16x32_bf16 v[196:199], v[108:111], v[220:223], v[196:199]
  v_mfma_f32_16x16x32_bf16 v[200:203], v[108:111], v[224:227], v[200:203]
  v_mfma_f32_16x16x32_bf16 v[204:207], v[108:111], v[228:231], v[204:207]
  ds_read_b128 v[208:211], v3 offset:30720
  ds_read_b128 v[212:215], v3 offset:31744
  ds_read_b128 v[216:219], v3 offset:32768
  ds_read_b128 v[220:223], v3 offset:33792
  ds_read_b128 v[224:227], v3 offset:34816
  ds_read_b128 v[228:231], v3 offset:35840
  s_add_u32 m0, s33, 4096
  s_nop 0
  buffer_load_dwordx4 v4, s[12:15], s46 offen offset:0 nt lds
  buffer_load_dwordx4 v5, s[12:15], s46 offen offset:1024 nt lds
  buffer_load_dwordx4 v6, s[12:15], s46 offen offset:2048 nt lds
  buffer_load_dwordx4 v7, s[12:15], s46 offen offset:3072 nt lds
  s_add_u32 s35, s35, 16384
  s_waitcnt vmcnt(8)
  ds_read_b64_tr_b16 v[48:49], v8 offset:16384
  ds_read_b64_tr_b16 v[50:51], v8 offset:20480
  ds_read_b64_tr_b16 v[52:53], v9 offset:16384
  ds_read_b64_tr_b16 v[54:55], v9 offset:20480
  ds_read_b64_tr_b16 v[56:57], v10 offset:16384
  ds_read_b64_tr_b16 v[58:59], v10 offset:20480
  ds_read_b64_tr_b16 v[60:61], v11 offset:16384
  ds_read_b64_tr_b16 v[62:63], v11 offset:20480
  ds_read_b64_tr_b16 v[64:65], v8 offset:18432
  ds_read_b64_tr_b16 v[66:67], v8 offset:22528
  ds_read_b64_tr_b16 v[68:69], v9 offset:18432
  ds_read_b64_tr_b16 v[70:71], v9 offset:22528
  s_waitcnt lgkmcnt(10)
  v_mfma_f32_16x16x32_bf16 v[160:163], v[48:51], v[208:211], v[160:163]
  v_mfma_f32_16x16x32_bf16 v[164:167], v[48:51], v[212:215], v[164:167]
  v_mfma_f32_16x16x32_bf16 v[168:171], v[48:51], v[216:219], v[168:171]
  ds_read_b64_tr_b16 v[72:73], v10 offset:18432
  ds_read_b64_tr_b16 v[74:75], v10 offset:22528
  s_waitcnt lgkmcnt(10)
  v_mfma_f32_16x16x32_bf16 v[172:175], v[52:55], v[208:211], v[172:175]
  v_mfma_f32_16x16x32_bf16 v[176:179], v[52:55], v[212:215], v[176:179]
  v_mfma_f32_16x16x32_bf16 v[180:183], v[52:55], v[216:219], v[180:183]
  ds_read_b64_tr_b16 v[76:77], v11 offset:18432
  ds_read_b64_tr_b16 v[78:79], v11 offset:22528
  s_waitcnt lgkmcnt(10)
  v_mfma_f32_16x16x32_bf16 v[184:187], v[56:59], v[208:211], v[184:187]
  s_add_u32 m0, s33, 8192
  s_add_u32 s46, s35, 32768
  buffer_load_dwordx4 v4, s[12:15], s35 offen offset:0 nt lds
  v_mfma_f32_16x16x32_bf16 v[188:191], v[56:59], v[212:215], v[188:191]
  v_mfma_f32_16x16x32_bf16 v[192:195], v[56:59], v[216:219], v[192:195]
  s_waitcnt lgkmcnt(8)
  v_mfma_f32_16x16x32_bf16 v[196:199], v[60:63], v[208:211], v[196:199]
  v_mfma_f32_16x16x32_bf16 v[200:203], v[60:63], v[212:215], v[200:203]
  v_mfma_f32_16x16x32_bf16 v[204:207], v[60:63], v[216:219], v[204:207]
  s_waitcnt lgkmcnt(6)
  v_mfma_f32_16x16x32_bf16 v[160:163], v[64:67], v[220:223], v[160:163]
  v_mfma_f32_16x16x32_bf16 v[164:167], v[64:67], v[224:227], v[164:167]
  buffer_load_dwordx4 v5, s[12:15], s35 offen offset:1024 nt lds
  v_mfma_f32_16x16x32_bf16 v[168:171], v[64:67], v[228:231], v[168:171]
  s_waitcnt lgkmcnt(4)
  v_mfma_f32_16x16x32_bf16 v[172:175], v[68:71], v[220:223], v[172:175]
  v_mfma_f32_16x16x32_bf16 v[176:179], v[68:71], v[224:227], v[176:179]
  v_mfma_f32_16x16x32_bf16 v[180:183], v[68:71], v[228:231], v[180:183]
  s_waitcnt lgkmcnt(2)
  v_mfma_f32_16x16x32_bf16 v[184:187], v[72:75], v[220:223], v[184:187]
  v_mfma_f32_16x16x32_bf16 v[188:191], v[72:75], v[224:227], v[188:191]
  v_mfma_f32_16x16x32_bf16 v[192:195], v[72:75], v[228:231], v[192:195]
  buffer_load_dwordx4 v6, s[12:15], s35 offen offset:2048 nt lds
  s_waitcnt lgkmcnt(0)
  v_mfma_f32_16x16x32_bf16 v[196:199], v[76:79], v[220:223], v[196:199]
  v_mfma_f32_16x16x32_bf16 v[200:203], v[76:79], v[224:227], v[200:203]
  v_mfma_f32_16x16x32_bf16 v[204:207], v[76:79], v[228:231], v[204:207]
  ds_read_b128 v[208:211], v3 offset:36864
  ds_read_b128 v[212:215], v3 offset:37888
  ds_read_b128 v[216:219], v3 offset:38912
  ds_read_b128 v[220:223], v3 offset:39936
  ds_read_b128 v[224:227], v3 offset:40960
  ds_read_b128 v[228:231], v3 offset:41984
  buffer_load_dwordx4 v7, s[12:15], s35 offen offset:3072 nt lds
  s_add_u32 m0, s33, 12288
  s_nop 0
  buffer_load_dwordx4 v4, s[12:15], s46 offen offset:0 nt lds
  buffer_load_dwordx4 v5, s[12:15], s46 offen offset:1024 nt lds
  buffer_load_dwordx4 v6, s[12:15], s46 offen offset:2048 nt lds
  buffer_load_dwordx4 v7, s[12:15], s46 offen offset:3072 nt lds
  s_add_u32 s35, s35, 49152
  s_waitcnt vmcnt(8)
  ds_read_b64_tr_b16 v[80:81], v8 offset:0
  ds_read_b64_tr_b16 v[82:83], v8 offset:4096
  ds_read_b64_tr_b16 v[84:85], v9 offset:0
  ds_read_b64_tr_b16 v[86:87], v9 offset:4096
  ds_read_b64_tr_b16 v[88:89], v10 offset:0
  ds_read_b64_tr_b16 v[90:91], v10 offset:4096
  ds_read_b64_tr_b16 v[92:93], v11 offset:0
  ds_read_b64_tr_b16 v[94:95], v11 offset:4096
  ds_read_b64_tr_b16 v[96:97], v8 offset:2048
  ds_read_b64_tr_b16 v[98:99], v8 offset:6144
  ds_read_b64_tr_b16 v[100:101], v9 offset:2048
  ds_read_b64_tr_b16 v[102:103], v9 offset:6144
  s_waitcnt lgkmcnt(10)
  v_mfma_f32_16x16x32_bf16 v[160:163], v[80:83], v[208:211], v[160:163]
  v_mfma_f32_16x16x32_bf16 v[164:167], v[80:83], v[212:215], v[164:167]
  v_mfma_f32_16x16x32_bf16 v[168:171], v[80:83], v[216:219], v[168:171]
  ds_read_b64_tr_b16 v[104:105], v10 offset:2048
  ds_read_b64_tr_b16 v[106:107], v10 offset:6144
  s_waitcnt lgkmcnt(10)
  v_mfma_f32_16x16x32_bf16 v[172:175], v[84:87], v[208:211], v[172:175]
  v_mfma_f32_16x16x32_bf16 v[176:179], v[84:87], v[212:215], v[176:179]
  v_mfma_f32_16x16x32_bf16 v[180:183], v[84:87], v[216:219], v[180:183]
  ds_read_b64_tr_b16 v[108:109], v11 offset:2048
  ds_read_b64_tr_b16 v[110:111], v11 offset:6144
  s_waitcnt lgkmcnt(10)
  v_mfma_f32_16x16x32_bf16 v[184:187], v[88:91], v[208:211], v[184:187]
  v_mfma_f32_16x16x32_bf16 v[188:191], v[88:91], v[212:215], v[188:191]
  v_mfma_f32_16x16x32_bf16 v[192:195], v[88:91], v[216:219], v[192:195]
  s_waitcnt lgkmcnt(8)
  v_mfma_f32_16x16x32_bf16 v[196:199], v[92:95], v[208:211], v[196:199]
  v_mfma_f32_16x16x32_bf16 v[200:203], v[92:95], v[212:215], v[200:203]
  v_mfma_f32_16x16x32_bf16 v[204:207], v[92:95], v[216:219], v[204:207]
  s_waitcnt lgkmcnt(6)
  v_mfma_f32_16x16x32_bf16 v[160:163], v[96:99], v[220:223], v[160:163]
  v_mfma_f32_16x16x32_bf16 v[164:167], v[96:99], v[224:227], v[164:167]
  v_mfma_f32_16x16x32_bf16 v[168:171], v[96:99], v[228:231], v[168:171]
  s_waitcnt lgkmcnt(4)
  v_mfma_f32_16x16x32_bf16 v[172:175], v[100:103], v[220:223], v[172:175]
  v_mfma_f32_16x16x32_bf16 v[176:179], v[100:103], v[224:227], v[176:179]
  v_mfma_f32_16x16x32_bf16 v[180:183], v[100:103], v[228:231], v[180:183]
  s_waitcnt lgkmcnt(2)
  v_mfma_f32_16x16x32_bf16 v[184:187], v[104:107], v[220:223], v[184:187]
  v_mfma_f32_16x16x32_bf16 v[188:191], v[104:107], v[224:227], v[188:191]
  v_mfma_f32_16x16x32_bf16 v[192:195], v[104:107], v[228:231], v[192:195]
  s_waitcnt lgkmcnt(0)
  v_mfma_f32_16x16x32_bf16 v[196:199], v[108:111], v[220:223], v[196:199]
  v_mfma_f32_16x16x32_bf16 v[200:203], v[108:111], v[224:227], v[200:203]
  v_mfma_f32_16x16x32_bf16 v[204:207], v[108:111], v[228:231], v[204:207]
  ds_read_b128 v[208:211], v3 offset:43008
  ds_read_b128 v[212:215], v3 offset:44032
  ds_read_b128 v[216:219], v3 offset:45056
  ds_read_b128 v[220:223], v3 offset:46080
  ds_read_b128 v[224:227], v3 offset:47104
  ds_read_b128 v[228:231], v3 offset:48128
  s_waitcnt lgkmcnt(0)
  s_waitcnt vmcnt(19)
  s_barrier
  v_mov_b32 v46, s90
  v_mov_b32 v47, s91
  s_lshl_b32 s56, s6, 3
  s_cmp_eq_u32 s32, 3
  s_cbranch_scc0 L_Bnof1
  s_mov_b64 exec, 1
  buffer_store_dwordx2 v[46:47], v35, s[24:27], s56 offen sc1
  s_mov_b64 exec, -1
L_Bnof1:
  s_lshl_b32 s39, s7, 5
  s_add_u32 s39, s39, 128
  s_mul_i32 s39, s39, 43136
  s_add_u32 s8, s58, s39
  s_addc_u32 s9, s59, 0
  s_mov_b32 s10, 1380352
  s_mov_b32 s11, 0x20000
  s_mov_b32 s12, s92
  s_mov_b32 s13, s93
  s_mov_b32 s14, 1376256
  s_mov_b32 s15, 0x20000
  s_mov_b32 s45, 0xffff0000
  s_mov_b32 s4, 0x00003f80
  s_mov_b32 s42, 0x3f800000
  s_mul_i32 s57, s7, 86016
  s_add_u32 s57, s57, 896
  s_mul_i32 s48, s6, 3
  s_add_u32 s48, s48, s32
  s_cmp_ge_u32 s6, 12
  s_cbranch_scc1 L_Bps
  s_mul_i32 s52, s48, 57
  s_lshr_b32 s52, s52, 9
  s_mul_i32 s53, s52, 9
  s_sub_u32 s53, s48, s53
  s_mul_i32 s49, s52, 10752
  s_lshl_b32 s54, s53, 10
  s_add_u32 s49, s49, s54
  s_mul_i32 s54, s53, 86
  s_lshr_b32 s54, s54, 8
  s_mul_i32 s55, s54, 3
  s_sub_u32 s55, s53, s55
  s_mul_i32 s50, s52, 224
  s_lshl_b32 s54, s54, 6
  s_add_u32 s50, s50, s54
  s_mul_i32 s55, s55, 28672
  s_add_u32 s50, s50, s55
  s_add_u32 s50, s50, s57
  s_branch L_Bpd
L_Bps:
  s_sub_u32 s48, s48, 36
  s_mul_i32 s52, s48, 86
  s_lshr_b32 s52, s52, 8
  s_mul_i32 s53, s52, 3
  s_sub_u32 s53, s48, s53
  s_mul_i32 s49, s52, 10752
  s_lshl_b32 s54, s53, 9
  s_add_u32 s49, s49, s54
  s_add_u32 s49, s49, 9216
  s_mul_i32 s50, s52, 224
  s_mul_i32 s53, s53, 28672
  s_add_u32 s50, s50, s53
  s_add_u32 s50, s50, 192
  s_add_u32 s50, s50, s57
L_Bpd:
  v_mul_u32_u24 v16, 1792, v1
  v_lshl_add_u32 v17, v2, 3, v16
  v_and_b32 v18, 1, v2
  v_lshl_add_u32 v16, v18, 5, v16
  v_lshrrev_b32 v18, 1, v2
  v_lshl_add_u32 v16, v18, 4, v16
  s_mul_i32 s39, s32, 10752
  s_add_u32 s39, s39, 690176
  s_add_u32 s40, s39, 4096
  s_add_u32 s41, s39, 8192
  s_waitcnt vmcnt(0)
  ds_read_b64_tr_b16 v[48:49], v8 offset:8192
  ds_read_b64_tr_b16 v[50:51], v8 offset:12288
  ds_read_b64_tr_b16 v[52:53], v9 offset:8192
  ds_read_b64_tr_b16 v[54:55], v9 offset:12288
  ds_read_b64_tr_b16 v[56:57], v10 offset:8192
  ds_read_b64_tr_b16 v[58:59], v10 offset:12288
  ds_read_b64_tr_b16 v[60:61], v11 offset:8192
  ds_read_b64_tr_b16 v[62:63], v11 offset:12288
  ds_read_b64_tr_b16 v[64:65], v8 offset:10240
  ds_read_b64_tr_b16 v[66:67], v8 offset:14336
  ds_read_b64_tr_b16 v[68:69], v9 offset:10240
  ds_read_b64_tr_b16 v[70:71], v9 offset:14336
  s_waitcnt lgkmcnt(10)
  v_mfma_f32_16x16x32_bf16 v[160:163], v[48:51], v[208:211], v[160:163]
  v_mfma_f32_16x16x32_bf16 v[164:167], v[48:51], v[212:215], v[164:167]
  v_mfma_f32_16x16x32_bf16 v[168:171], v[48:51], v[216:219], v[168:171]
  ds_read_b64_tr_b16 v[72:73], v10 offset:10240
  ds_read_b64_tr_b16 v[74:75], v10 offset:14336
  s_waitcnt lgkmcnt(10)
  v_mfma_f32_16x16x32_bf16 v[172:175], v[52:55], v[208:211], v[172:175]
  v_mfma_f32_16x16x32_bf16 v[176:179], v[52:55], v[212:215], v[176:179]
  v_mfma_f32_16x16x32_bf16 v[180:183], v[52:55], v[216:219], v[180:183]
  ds_read_b64_tr_b16 v[76:77], v11 offset:10240
  ds_read_b64_tr_b16 v[78:79], v11 offset:14336
  s_waitcnt lgkmcnt(10)
  v_mfma_f32_16x16x32_bf16 v[184:187], v[56:59], v[208:211], v[184:187]
  v_mfma_f32_16x16x32_bf16 v[188:191], v[56:59], v[212:215], v[188:191]
  v_mfma_f32_16x16x32_bf16 v[192:195], v[56:59], v[216:219], v[192:195]
  s_waitcnt lgkmcnt(8)
  v_mfma_f32_16x16x32_bf16 v[196:199], v[60:63], v[208:211], v[196:199]
  v_mfma_f32_16x16x32_bf16 v[200:203], v[60:63], v[212:215], v[200:203]
  v_mfma_f32_16x16x32_bf16 v[204:207], v[60:63], v[216:219], v[204:207]
  s_waitcnt lgkmcnt(6)
  v_mfma_f32_16x16x32_bf16 v[160:163], v[64:67], v[220:223], v[160:163]
  v_mfma_f32_16x16x32_bf16 v[164:167], v[64:67], v[224:227], v[164:167]
  v_mfma_f32_16x16x32_bf16 v[168:171], v[64:67], v[228:231], v[168:171]
  s_waitcnt lgkmcnt(4)
  v_mfma_f32_16x16x32_bf16 v[172:175], v[68:71], v[220:223], v[172:175]
  v_mfma_f32_16x16x32_bf16 v[176:179], v[68:71], v[224:227], v[176:179]
  v_mfma_f32_16x16x32_bf16 v[180:183], v[68:71], v[228:231], v[180:183]
  s_waitcnt lgkmcnt(2)
  v_mfma_f32_16x16x32_bf16 v[184:187], v[72:75], v[220:223], v[184:187]
  v_mfma_f32_16x16x32_bf16 v[188:191], v[72:75], v[224:227], v[188:191]
  v_mfma_f32_16x16x32_bf16 v[192:195], v[72:75], v[228:231], v[192:195]
  s_waitcnt lgkmcnt(0)
  v_mfma_f32_16x16x32_bf16 v[196:199], v[76:79], v[220:223], v[196:199]
  v_mfma_f32_16x16x32_bf16 v[200:203], v[76:79], v[224:227], v[200:203]
  v_mfma_f32_16x16x32_bf16 v[204:207], v[76:79], v[228:231], v[204:207]
  s_nop 2
  v_pk_mul_f32 v[160:161], v[160:161], v[32:33] op_sel_hi:[1,0]
  v_pk_mul_f32 v[162:163], v[162:163], v[32:33] op_sel_hi:[1,0]
  v_pk_mul_f32 v[172:173], v[172:173], v[32:33] op_sel_hi:[1,0]
  v_pk_mul_f32 v[174:175], v[174:175], v[32:33] op_sel_hi:[1,0]
  v_cvt_pk_bf16_f32 v160, v160, v161
  v_cvt_pk_bf16_f32 v161, v162, v163
  v_cvt_pk_bf16_f32 v162, v172, v173
  v_cvt_pk_bf16_f32 v163, v174, v175
  ds_write_b128 v15, v[160:163] offset:0
  v_pk_mul_f32 v[164:165], v[164:165], v[34:35] op_sel_hi:[1,0]
  v_pk_mul_f32 v[166:167], v[166:167], v[34:35] op_sel_hi:[1,0]
  v_pk_mul_f32 v[176:177], v[176:177], v[34:35] op_sel_hi:[1,0]
  v_pk_mul_f32 v[178:179], v[178:179], v[34:35] op_sel_hi:[1,0]
  v_cvt_pk_bf16_f32 v164, v164, v165
  v_cvt_pk_bf16_f32 v165, v166, v167
  v_cvt_pk_bf16_f32 v166, v176, v177
  v_cvt_pk_bf16_f32 v167, v178, v179
  ds_write_b128 v15, v[164:167] offset:1024
  v_pk_mul_f32 v[168:169], v[168:169], v[40:41] op_sel_hi:[1,0]
  v_pk_mul_f32 v[170:171], v[170:171], v[40:41] op_sel_hi:[1,0]
  v_pk_mul_f32 v[180:181], v[180:181], v[40:41] op_sel_hi:[1,0]
  v_pk_mul_f32 v[182:183], v[182:183], v[40:41] op_sel_hi:[1,0]
  v_cvt_pk_bf16_f32 v168, v168, v169
  v_cvt_pk_bf16_f32 v169, v170, v171
  v_cvt_pk_bf16_f32 v170, v180, v181
  v_cvt_pk_bf16_f32 v171, v182, v183
  ds_write_b128 v15, v[168:171] offset:2048
  v_pk_mul_f32 v[184:185], v[184:185], v[32:33] op_sel_hi:[1,0]
  v_pk_mul_f32 v[186:187], v[186:187], v[32:33] op_sel_hi:[1,0]
  v_pk_mul_f32 v[196:197], v[196:197], v[32:33] op_sel_hi:[1,0]
  v_pk_mul_f32 v[198:199], v[198:199], v[32:33] op_sel_hi:[1,0]
  v_cvt_pk_bf16_f32 v184, v184, v185
  v_cvt_pk_bf16_f32 v185, v186, v187
  v_cvt_pk_bf16_f32 v186, v196, v197
  v_cvt_pk_bf16_f32 v187, v198, v199
  ds_write_b128 v15, v[184:187] offset:3072
  v_pk_mul_f32 v[188:189], v[188:189], v[34:35] op_sel_hi:[1,0]
  v_pk_mul_f32 v[190:191], v[190:191], v[34:35] op_sel_hi:[1,0]
  v_pk_mul_f32 v[200:201], v[200:201], v[34:35] op_sel_hi:[1,0]
  v_pk_mul_f32 v[202:203], v[202:203], v[34:35] op_sel_hi:[1,0]
  v_cvt_pk_bf16_f32 v188, v188, v189
  v_cvt_pk_bf16_f32 v189, v190, v191
  v_cvt_pk_bf16_f32 v190, v200, v201
  v_cvt_pk_bf16_f32 v191, v202, v203
  ds_write_b128 v15, v[188:191] offset:4096
  v_pk_mul_f32 v[192:193], v[192:193], v[40:41] op_sel_hi:[1,0]
  v_pk_mul_f32 v[194:195], v[194:195], v[40:41] op_sel_hi:[1,0]
  v_pk_mul_f32 v[204:205], v[204:205], v[40:41] op_sel_hi:[1,0]
  v_pk_mul_f32 v[206:207], v[206:207], v[40:41] op_sel_hi:[1,0]
  v_cvt_pk_bf16_f32 v192, v192, v193
  v_cvt_pk_bf16_f32 v193, v194, v195
  v_cvt_pk_bf16_f32 v194, v204, v205
  v_cvt_pk_bf16_f32 v195, v206, v207
  ds_write_b128 v15, v[192:195] offset:5120
  s_waitcnt lgkmcnt(0)
  s_barrier
  ds_read_b128 v[160:163], v24 offset:0
  ds_read_b128 v[164:167], v24 offset:1024
  ds_read_b128 v[168:171], v24 offset:2048
  ds_read_b128 v[172:175], v25 offset:0
  ds_read_b128 v[176:179], v25 offset:1024
  ds_read_b128 v[180:183], v25 offset:2048
  ds_read_b128 v[184:187], v26 offset:0
  ds_read_b128 v[188:191], v26 offset:1024
  ds_read_b128 v[192:195], v26 offset:2048
  ds_read_b128 v[196:199], v27 offset:0
  ds_read_b128 v[200:203], v27 offset:1024
  ds_read_b128 v[204:207], v27 offset:2048
  s_waitcnt lgkmcnt(9)
  v_mfma_f32_16x16x32_bf16 v[80:83], a[0:3], v[160:163], 0
  ds_read_b128 v[208:211], v28 offset:0
  v_mfma_f32_16x16x32_bf16 v[84:87], a[0:3], v[164:167], 0
  v_mfma_f32_16x16x32_bf16 v[88:91], a[0:3], v[168:171], 0
  ds_read_b128 v[212:215], v28 offset:1024
  v_mfma_f32_16x16x32_bf16 v[92:95], a[4:7], v[160:163], 0
  v_mfma_f32_16x16x32_bf16 v[96:99], a[4:7], v[164:167], 0
  ds_read_b128 v[216:219], v28 offset:2048
  v_mfma_f32_16x16x32_bf16 v[100:103], a[4:7], v[168:171], 0
  s_waitcnt lgkmcnt(9)
  v_mfma_f32_16x16x32_bf16 v[80:83], a[28:31], v[172:175], v[80:83]
  ds_read_b128 v[220:223], v29 offset:0
  v_mfma_f32_16x16x32_bf16 v[84:87], a[28:31], v[176:179], v[84:87]
  v_mfma_f32_16x16x32_bf16 v[88:91], a[28:31], v[180:183], v[88:91]
  ds_read_b128 v[224:227], v29 offset:1024
  v_mfma_f32_16x16x32_bf16 v[92:95], a[32:35], v[172:175], v[92:95]
  v_mfma_f32_16x16x32_bf16 v[96:99], a[32:35], v[176:179], v[96:99]
  ds_read_b128 v[228:231], v29 offset:2048
  v_mfma_f32_16x16x32_bf16 v[100:103], a[32:35], v[180:183], v[100:103]
  s_waitcnt lgkmcnt(9)
  v_mfma_f32_16x16x32_bf16 v[80:83], a[56:59], v[184:187], v[80:83]
  ds_read_b128 v[232:235], v30 offset:0
  v_mfma_f32_16x16x32_bf16 v[84:87], a[56:59], v[188:191], v[84:87]
  v_mfma_f32_16x16x32_bf16 v[88:91], a[56:59], v[192:195], v[88:91]
  ds_read_b128 v[236:239], v30 offset:1024
  v_mfma_f32_16x16x32_bf16 v[92:95], a[60:63], v[184:187], v[92:95]
  v_mfma_f32_16x16x32_bf16 v[96:99], a[60:63], v[188:191], v[96:99]
  ds_read_b128 v[240:243], v30 offset:2048
  v_mfma_f32_16x16x32_bf16 v[100:103], a[60:63], v[192:195], v[100:103]
  s_waitcnt lgkmcnt(9)
  v_mfma_f32_16x16x32_bf16 v[80:83], a[84:87], v[196:199], v[80:83]
  ds_read_b128 v[244:247], v31 offset:0
  v_mfma_f32_16x16x32_bf16 v[84:87], a[84:87], v[200:203], v[84:87]
  v_mfma_f32_16x16x32_bf16 v[88:91], a[84:87], v[204:207], v[88:91]
  ds_read_b128 v[248:251], v31 offset:1024
  v_mfma_f32_16x16x32_bf16 v[92:95], a[88:91], v[196:199], v[92:95]
  v_mfma_f32_16x16x32_bf16 v[96:99], a[88:91], v[200:203], v[96:99]
  ds_read_b128 v[252:255], v31 offset:2048
  v_mfma_f32_16x16x32_bf16 v[100:103], a[88:91], v[204:207], v[100:103]
  s_waitcnt lgkmcnt(9)
  v_mfma_f32_16x16x32_bf16 v[80:83], a[112:115], v[208:211], v[80:83]
  v_mfma_f32_16x16x32_bf16 v[84:87], a[112:115], v[212:215], v[84:87]
  v_mfma_f32_16x16x32_bf16 v[88:91], a[112:115], v[216:219], v[88:91]
  v_mfma_f32_16x16x32_bf16 v[92:95], a[116:119], v[208:211], v[92:95]
  v_mfma_f32_16x16x32_bf16 v[96:99], a[116:119], v[212:215], v[96:99]
  v_mfma_f32_16x16x32_bf16 v[100:103], a[116:119], v[216:219], v[100:103]
  s_waitcnt lgkmcnt(6)
  v_mfma_f32_16x16x32_bf16 v[80:83], a[140:143], v[220:223], v[80:83]
  v_mfma_f32_16x16x32_bf16 v[84:87], a[140:143], v[224:227], v[84:87]
  v_mfma_f32_16x16x32_bf16 v[88:91], a[140:143], v[228:231], v[88:91]
  v_mfma_f32_16x16x32_bf16 v[92:95], a[144:147], v[220:223], v[92:95]
  v_mfma_f32_16x16x32_bf16 v[96:99], a[144:147], v[224:227], v[96:99]
  v_mfma_f32_16x16x32_bf16 v[100:103], a[144:147], v[228:231], v[100:103]
  s_waitcnt lgkmcnt(3)
  v_mfma_f32_16x16x32_bf16 v[80:83], a[168:171], v[232:235], v[80:83]
  v_mfma_f32_16x16x32_bf16 v[84:87], a[168:171], v[236:239], v[84:87]
  v_mfma_f32_16x16x32_bf16 v[88:91], a[168:171], v[240:243], v[88:91]
  v_mfma_f32_16x16x32_bf16 v[92:95], a[172:175], v[232:235], v[92:95]
  v_mfma_f32_16x16x32_bf16 v[96:99], a[172:175], v[236:239], v[96:99]
  v_mfma_f32_16x16x32_bf16 v[100:103], a[172:175], v[240:243], v[100:103]
  s_waitcnt lgkmcnt(0)
  v_mfma_f32_16x16x32_bf16 v[80:83], a[196:199], v[244:247], v[80:83]
  v_mfma_f32_16x16x32_bf16 v[84:87], a[196:199], v[248:251], v[84:87]
  v_mfma_f32_16x16x32_bf16 v[88:91], a[196:199], v[252:255], v[88:91]
  v_mfma_f32_16x16x32_bf16 v[92:95], a[200:203], v[244:247], v[92:95]
  v_mfma_f32_16x16x32_bf16 v[96:99], a[200:203], v[248:251], v[96:99]
  v_mfma_f32_16x16x32_bf16 v[100:103], a[200:203], v[252:255], v[100:103]
  v_mfma_f32_16x16x32_bf16 v[104:107], a[8:11], v[160:163], 0
  v_mfma_f32_16x16x32_bf16 v[108:111], a[8:11], v[164:167], 0
  v_mfma_f32_16x16x32_bf16 v[112:115], a[8:11], v[168:171], 0
  v_mfma_f32_16x16x32_bf16 v[116:119], a[12:15], v[160:163], 0
  v_mfma_f32_16x16x32_bf16 v[120:123], a[12:15], v[164:167], 0
  v_mfma_f32_16x16x32_bf16 v[124:127], a[12:15], v[168:171], 0
  v_mfma_f32_16x16x32_bf16 v[104:107], a[36:39], v[172:175], v[104:107]
  v_mfma_f32_16x16x32_bf16 v[108:111], a[36:39], v[176:179], v[108:111]
  v_mfma_f32_16x16x32_bf16 v[112:115], a[36:39], v[180:183], v[112:115]
  v_mfma_f32_16x16x32_bf16 v[116:119], a[40:43], v[172:175], v[116:119]
  v_cvt_pk_bf16_f32 v80, v80, v81
  v_cvt_pk_bf16_f32 v81, v82, v83
  v_mfma_f32_16x16x32_bf16 v[120:123], a[40:43], v[176:179], v[120:123]
  v_cvt_pk_bf16_f32 v82, v92, v93
  v_cvt_pk_bf16_f32 v83, v94, v95
  v_mfma_f32_16x16x32_bf16 v[124:127], a[40:43], v[180:183], v[124:127]
  buffer_store_dwordx4 v[80:83], v33, s[28:31], s39 offen offset:0 sc1
  v_mfma_f32_16x16x32_bf16 v[104:107], a[64:67], v[184:187], v[104:107]
  v_mfma_f32_16x16x32_bf16 v[108:111], a[64:67], v[188:191], v[108:111]
  v_cvt_pk_bf16_f32 v84, v84, v85
  v_cvt_pk_bf16_f32 v85, v86, v87
  v_mfma_f32_16x16x32_bf16 v[112:115], a[64:67], v[192:195], v[112:115]
  v_cvt_pk_bf16_f32 v86, v96, v97
  v_cvt_pk_bf16_f32 v87, v98, v99
  v_mfma_f32_16x16x32_bf16 v[116:119], a[68:71], v[184:187], v[116:119]
  buffer_store_dwordx4 v[84:87], v33, s[28:31], s39 offen offset:1024 sc1
  v_mfma_f32_16x16x32_bf16 v[120:123], a[68:71], v[188:191], v[120:123]
  v_mfma_f32_16x16x32_bf16 v[124:127], a[68:71], v[192:195], v[124:127]
  v_cvt_pk_bf16_f32 v88, v88, v89
  v_cvt_pk_bf16_f32 v89, v90, v91
  v_mfma_f32_16x16x32_bf16 v[104:107], a[92:95], v[196:199], v[104:107]
  v_cvt_pk_bf16_f32 v90, v100, v101
  v_cvt_pk_bf16_f32 v91, v102, v103
  v_mfma_f32_16x16x32_bf16 v[108:111], a[92:95], v[200:203], v[108:111]
  buffer_store_dwordx4 v[88:91], v33, s[28:31], s39 offen offset:2048 sc1
  v_mfma_f32_16x16x32_bf16 v[112:115], a[92:95], v[204:207], v[112:115]
  v_mfma_f32_16x16x32_bf16 v[116:119], a[96:99], v[196:199], v[116:119]
  v_mfma_f32_16x16x32_bf16 v[120:123], a[96:99], v[200:203], v[120:123]
  v_mfma_f32_16x16x32_bf16 v[124:127], a[96:99], v[204:207], v[124:127]
  v_mfma_f32_16x16x32_bf16 v[104:107], a[120:123], v[208:211], v[104:107]
  v_mfma_f32_16x16x32_bf16 v[108:111], a[120:123], v[212:215], v[108:111]
  v_mfma_f32_16x16x32_bf16 v[112:115], a[120:123], v[216:219], v[112:115]
  v_mfma_f32_16x16x32_bf16 v[116:119], a[124:127], v[208:211], v[116:119]
  v_mfma_f32_16x16x32_bf16 v[120:123], a[124:127], v[212:215], v[120:123]
  v_mfma_f32_16x16x32_bf16 v[124:127], a[124:127], v[216:219], v[124:127]
  v_mfma_f32_16x16x32_bf16 v[104:107], a[148:151], v[220:223], v[104:107]
  v_mfma_f32_16x16x32_bf16 v[108:111], a[148:151], v[224:227], v[108:111]
  v_mfma_f32_16x16x32_bf16 v[112:115], a[148:151], v[228:231], v[112:115]
  v_mfma_f32_16x16x32_bf16 v[116:119], a[152:155], v[220:223], v[116:119]
  v_mfma_f32_16x16x32_bf16 v[120:123], a[152:155], v[224:227], v[120:123]
  v_mfma_f32_16x16x32_bf16 v[124:127], a[152:155], v[228:231], v[124:127]
  v_mfma_f32_16x16x32_bf16 v[104:107], a[176:179], v[232:235], v[104:107]
  v_mfma_f32_16x16x32_bf16 v[108:111], a[176:179], v[236:239], v[108:111]
  v_mfma_f32_16x16x32_bf16 v[112:115], a[176:179], v[240:243], v[112:115]
  v_mfma_f32_16x16x32_bf16 v[116:119], a[180:183], v[232:235], v[116:119]
  v_mfma_f32_16x16x32_bf16 v[120:123], a[180:183], v[236:239], v[120:123]
  v_mfma_f32_16x16x32_bf16 v[124:127], a[180:183], v[240:243], v[124:127]
  v_mfma_f32_16x16x32_bf16 v[104:107], a[204:207], v[244:247], v[104:107]
  v_mfma_f32_16x16x32_bf16 v[108:111], a[204:207], v[248:251], v[108:111]
  v_mfma_f32_16x16x32_bf16 v[112:115], a[204:207], v[252:255], v[112:115]
  v_mfma_f32_16x16x32_bf16 v[116:119], a[208:211], v[244:247], v[116:119]
  v_mfma_f32_16x16x32_bf16 v[120:123], a[208:211], v[248:251], v[120:123]
  v_mfma_f32_16x16x32_bf16 v[124:127], a[208:211], v[252:255], v[124:127]
  v_mfma_f32_16x16x32_bf16 v[128:131], a[16:19], v[160:163], 0
  v_mfma_f32_16x16x32_bf16 v[132:135], a[16:19], v[164:167], 0
  v_mfma_f32_16x16x32_bf16 v[136:139], a[16:19], v[168:171], 0
  v_mfma_f32_16x16x32_bf16 v[140:143], a[20:23], v[160:163], 0
  v_mfma_f32_16x16x32_bf16 v[144:147], a[20:23], v[164:167], 0
  v_mfma_f32_16x16x32_bf16 v[148:151], a[20:23], v[168:171], 0
  v_mfma_f32_16x16x32_bf16 v[128:131], a[44:47], v[172:175], v[128:131]
  v_mfma_f32_16x16x32_bf16 v[132:135], a[44:47], v[176:179], v[132:135]
  v_mfma_f32_16x16x32_bf16 v[136:139], a[44:47], v[180:183], v[136:139]
  v_mfma_f32_16x16x32_bf16 v[140:143], a[48:51], v[172:175], v[140:143]
  v_cvt_pk_bf16_f32 v104, v104, v105
  v_cvt_pk_bf16_f32 v105, v106, v107
  v_mfma_f32_16x16x32_bf16 v[144:147], a[48:51], v[176:179], v[144:147]
  v_cvt_pk_bf16_f32 v106, v116, v117
  v_cvt_pk_bf16_f32 v107, v118, v119
  v_mfma_f32_16x16x32_bf16 v[148:151], a[48:51], v[180:183], v[148:151]
  buffer_store_dwordx4 v[104:107], v33, s[28:31], s39 offen offset:3072 sc1
  v_mfma_f32_16x16x32_bf16 v[128:131], a[72:75], v[184:187], v[128:131]
  v_mfma_f32_16x16x32_bf16 v[132:135], a[72:75], v[188:191], v[132:135]
  v_cvt_pk_bf16_f32 v108, v108, v109
  v_cvt_pk_bf16_f32 v109, v110, v111
  v_mfma_f32_16x16x32_bf16 v[136:139], a[72:75], v[192:195], v[136:139]
  v_cvt_pk_bf16_f32 v110, v120, v121
  v_cvt_pk_bf16_f32 v111, v122, v123
  v_mfma_f32_16x16x32_bf16 v[140:143], a[76:79], v[184:187], v[140:143]
  buffer_store_dwordx4 v[108:111], v33, s[28:31], s40 offen offset:0 sc1
  v_mfma_f32_16x16x32_bf16 v[144:147], a[76:79], v[188:191], v[144:147]
  v_mfma_f32_16x16x32_bf16 v[148:151], a[76:79], v[192:195], v[148:151]
  v_cvt_pk_bf16_f32 v112, v112, v113
  v_cvt_pk_bf16_f32 v113, v114, v115
  v_mfma_f32_16x16x32_bf16 v[128:131], a[100:103], v[196:199], v[128:131]
  v_cvt_pk_bf16_f32 v114, v124, v125
  v_cvt_pk_bf16_f32 v115, v126, v127
  v_mfma_f32_16x16x32_bf16 v[132:135], a[100:103], v[200:203], v[132:135]
  buffer_store_dwordx4 v[112:115], v33, s[28:31], s40 offen offset:1024 sc1
  v_mfma_f32_16x16x32_bf16 v[136:139], a[100:103], v[204:207], v[136:139]
  v_mfma_f32_16x16x32_bf16 v[140:143], a[104:107], v[196:199], v[140:143]
  v_mfma_f32_16x16x32_bf16 v[144:147], a[104:107], v[200:203], v[144:147]
  v_mfma_f32_16x16x32_bf16 v[148:151], a[104:107], v[204:207], v[148:151]
  v_mfma_f32_16x16x32_bf16 v[128:131], a[128:131], v[208:211], v[128:131]
  v_mfma_f32_16x16x32_bf16 v[132:135], a[128:131], v[212:215], v[132:135]
  v_mfma_f32_16x16x32_bf16 v[136:139], a[128:131], v[216:219], v[136:139]
  v_mfma_f32_16x16x32_bf16 v[140:143], a[132:135], v[208:211], v[140:143]
  v_mfma_f32_16x16x32_bf16 v[144:147], a[132:135], v[212:215], v[144:147]
  v_mfma_f32_16x16x32_bf16 v[148:151], a[132:135], v[216:219], v[148:151]
  v_mfma_f32_16x16x32_bf16 v[128:131], a[156:159], v[220:223], v[128:131]
  v_mfma_f32_16x16x32_bf16 v[132:135], a[156:159], v[224:227], v[132:135]
  v_mfma_f32_16x16x32_bf16 v[136:139], a[156:159], v[228:231], v[136:139]
  v_mfma_f32_16x16x32_bf16 v[140:143], a[160:163], v[220:223], v[140:143]
  v_mfma_f32_16x16x32_bf16 v[144:147], a[160:163], v[224:227], v[144:147]
  v_mfma_f32_16x16x32_bf16 v[148:151], a[160:163], v[228:231], v[148:151]
  v_mfma_f32_16x16x32_bf16 v[128:131], a[184:187], v[232:235], v[128:131]
  v_mfma_f32_16x16x32_bf16 v[132:135], a[184:187], v[236:239], v[132:135]
  v_mfma_f32_16x16x32_bf16 v[136:139], a[184:187], v[240:243], v[136:139]
  v_mfma_f32_16x16x32_bf16 v[140:143], a[188:191], v[232:235], v[140:143]
  v_mfma_f32_16x16x32_bf16 v[144:147], a[188:191], v[236:239], v[144:147]
  v_mfma_f32_16x16x32_bf16 v[148:151], a[188:191], v[240:243], v[148:151]
  v_mfma_f32_16x16x32_bf16 v[128:131], a[212:215], v[244:247], v[128:131]
  v_mfma_f32_16x16x32_bf16 v[132:135], a[212:215], v[248:251], v[132:135]
  v_mfma_f32_16x16x32_bf16 v[136:139], a[212:215], v[252:255], v[136:139]
  v_mfma_f32_16x16x32_bf16 v[140:143], a[216:219], v[244:247], v[140:143]
  v_mfma_f32_16x16x32_bf16 v[144:147], a[216:219], v[248:251], v[144:147]
  v_mfma_f32_16x16x32_bf16 v[148:151], a[216:219], v[252:255], v[148:151]
  s_cmp_eq_u32 s32, 3
  s_cbranch_scc0 L_Bnol1
  s_mov_b64 exec, 0xffff
  buffer_load_dwordx2 v[44:45], v35, s[24:27], 0 offen sc1
  s_mov_b64 exec, -1
L_Bnol1:
  v_mfma_f32_16x16x32_bf16 v[152:155], a[24:27], v[160:163], 0
  v_mfma_f32_16x16x32_bf16 v[156:159], a[24:27], v[164:167], 0
  v_mfma_f32_16x16x32_bf16 a[248:251], a[24:27], v[168:171], 0
  v_mfma_f32_16x16x32_bf16 v[152:155], a[52:55], v[172:175], v[152:155]
  v_mfma_f32_16x16x32_bf16 v[156:159], a[52:55], v[176:179], v[156:159]
  v_mfma_f32_16x16x32_bf16 a[248:251], a[52:55], v[180:183], a[248:251]
  v_mfma_f32_16x16x32_bf16 v[152:155], a[80:83], v[184:187], v[152:155]
  v_mfma_f32_16x16x32_bf16 v[156:159], a[80:83], v[188:191], v[156:159]
  v_mfma_f32_16x16x32_bf16 a[248:251], a[80:83], v[192:195], a[248:251]
  v_mfma_f32_16x16x32_bf16 v[152:155], a[108:111], v[196:199], v[152:155]
  v_cvt_pk_bf16_f32 v128, v128, v129
  v_cvt_pk_bf16_f32 v129, v130, v131
  v_mfma_f32_16x16x32_bf16 v[156:159], a[108:111], v[200:203], v[156:159]
  v_cvt_pk_bf16_f32 v130, v140, v141
  v_cvt_pk_bf16_f32 v131, v142, v143
  v_mfma_f32_16x16x32_bf16 a[248:251], a[108:111], v[204:207], a[248:251]
  buffer_store_dwordx4 v[128:131], v33, s[28:31], s40 offen offset:2048 sc1
  v_mfma_f32_16x16x32_bf16 v[152:155], a[136:139], v[208:211], v[152:155]
  v_mfma_f32_16x16x32_bf16 v[156:159], a[136:139], v[212:215], v[156:159]
  v_cvt_pk_bf16_f32 v132, v132, v133
  v_cvt_pk_bf16_f32 v133, v134, v135
  v_mfma_f32_16x16x32_bf16 a[248:251], a[136:139], v[216:219], a[248:251]
  v_cvt_pk_bf16_f32 v134, v144, v145
  v_cvt_pk_bf16_f32 v135, v146, v147
  v_mfma_f32_16x16x32_bf16 v[152:155], a[164:167], v[220:223], v[152:155]
  buffer_store_dwordx4 v[132:135], v33, s[28:31], s40 offen offset:3072 sc1
  v_mfma_f32_16x16x32_bf16 v[156:159], a[164:167], v[224:227], v[156:159]
  v_mfma_f32_16x16x32_bf16 a[248:251], a[164:167], v[228:231], a[248:251]
  v_cvt_pk_bf16_f32 v136, v136, v137
  v_cvt_pk_bf16_f32 v137, v138, v139
  v_mfma_f32_16x16x32_bf16 v[152:155], a[192:195], v[232:235], v[152:155]
  v_cvt_pk_bf16_f32 v138, v148, v149
  v_cvt_pk_bf16_f32 v139, v150, v151
  v_mfma_f32_16x16x32_bf16 v[156:159], a[192:195], v[236:239], v[156:159]
  buffer_store_dwordx4 v[136:139], v33, s[28:31], s41 offen offset:0 sc1
  v_mfma_f32_16x16x32_bf16 a[248:251], a[192:195], v[240:243], a[248:251]
  v_mfma_f32_16x16x32_bf16 v[152:155], a[220:223], v[244:247], v[152:155]
  v_mfma_f32_16x16x32_bf16 v[156:159], a[220:223], v[248:251], v[156:159]
  v_mfma_f32_16x16x32_bf16 a[248:251], a[220:223], v[252:255], a[248:251]
  s_nop 7
  v_accvgpr_read_b32 v48, a248
  v_accvgpr_read_b32 v49, a249
  v_accvgpr_read_b32 v50, a250
  v_accvgpr_read_b32 v51, a251
  v_cvt_pk_bf16_f32 v152, v152, v153
  v_cvt_pk_bf16_f32 v153, v154, v155
  buffer_store_dwordx2 v[152:153], v35, s[28:31], s41 offen offset:1024 sc1
  v_cvt_pk_bf16_f32 v156, v156, v157
  v_cvt_pk_bf16_f32 v157, v158, v159
  buffer_store_dwordx2 v[156:157], v35, s[28:31], s41 offen offset:1536 sc1
  v_cvt_pk_bf16_f32 v48, v48, v49
  v_cvt_pk_bf16_f32 v49, v50, v51
  buffer_store_dwordx2 v[48:49], v35, s[28:31], s41 offen offset:2048 sc1
  s_cmp_eq_u32 s32, 3
  s_cbranch_scc1 L_Bw3
  s_waitcnt vmcnt(0)
  s_barrier
  s_cmp_ge_u32 s6, 12
  s_cbranch_scc1 L_Bsingle
  s_mov_b32 s56, 0
L_Bred4:
  buffer_load_dwordx4 v[64:67], v33, s[8:11], s49 offen sc1
  s_add_u32 s49, s49, 43136
  buffer_load_dwordx4 v[68:71], v33, s[8:11], s49 offen sc1
  s_add_u32 s49, s49, 43136
  buffer_load_dwordx4 v[72:75], v33, s[8:11], s49 offen sc1
  s_add_u32 s49, s49, 43136
  buffer_load_dwordx4 v[76:79], v33, s[8:11], s49 offen sc1
  s_add_u32 s49, s49, 43136
  buffer_load_dwordx4 v[80:83], v33, s[8:11], s49 offen sc1
  s_add_u32 s49, s49, 43136
  buffer_load_dwordx4 v[84:87], v33, s[8:11], s49 offen sc1
  s_add_u32 s49, s49, 43136
  buffer_load_dwordx4 v[88:91], v33, s[8:11], s49 offen sc1
  s_add_u32 s49, s49, 43136
  buffer_load_dwordx4 v[92:95], v33, s[8:11], s49 offen sc1
  s_add_u32 s49, s49, 43136
  buffer_load_dwordx4 v[96:99], v33, s[8:11], s49 offen sc1
  s_add_u32 s49, s49, 43136
  buffer_load_dwordx4 v[100:103], v33, s[8:11], s49 offen sc1
  s_add_u32 s49, s49, 43136
  buffer_load_dwordx4 v[104:107], v33, s[8:11], s49 offen sc1
  s_add_u32 s49, s49, 43136
  buffer_load_dwordx4 v[108:111], v33, s[8:11], s49 offen sc1
  s_add_u32 s49, s49, 43136
  buffer_load_dwordx4 v[112:115], v33, s[8:11], s49 offen sc1
  s_add_u32 s49, s49, 43136
  buffer_load_dwordx4 v[116:119], v33, s[8:11], s49 offen sc1
  s_add_u32 s49, s49, 43136
  buffer_load_dwordx4 v[120:123], v33, s[8:11], s49 offen sc1
  s_add_u32 s49, s49, 43136
  buffer_load_dwordx4 v[124:127], v33, s[8:11], s49 offen sc1
  s_add_u32 s49, s49, 43136
  s_waitcnt vmcnt(15)
  v_lshlrev_b32 v232, 16, v64
  v_and_b32 v233, s45, v64
  v_lshlrev_b32 v234, 16, v65
  v_and_b32 v235, s45, v65
  v_lshlrev_b32 v236, 16, v66
  v_and_b32 v237, s45, v66
  v_lshlrev_b32 v238, 16, v67
  v_and_b32 v239, s45, v67
  s_waitcnt vmcnt(14)
  v_dot2c_f32_bf16 v232, s4, v68
  v_dot2c_f32_bf16 v233, s42, v68
  v_dot2c_f32_bf16 v234, s4, v69
  v_dot2c_f32_bf16 v235, s42, v69
  v_dot2c_f32_bf16 v236, s4, v70
  v_dot2c_f32_bf16 v237, s42, v70
  v_dot2c_f32_bf16 v238, s4, v71
  v_dot2c_f32_bf16 v239, s42, v71
  s_waitcnt vmcnt(13)
  v_dot2c_f32_bf16 v232, s4, v72
  v_dot2c_f32_bf16 v233, s42, v72
  v_dot2c_f32_bf16 v234, s4, v73
  v_dot2c_f32_bf16 v235, s42, v73
  v_dot2c_f32_bf16 v236, s4, v74
  v_dot2c_f32_bf16 v237, s42, v74
  v_dot2c_f32_bf16 v238, s4, v75
  v_dot2c_f32_bf16 v239, s42, v75
  s_waitcnt vmcnt(12)
  v_dot2c_f32_bf16 v232, s4, v76
  v_dot2c_f32_bf16 v233, s42, v76
  v_dot2c_f32_bf16 v234, s4, v77
  v_dot2c_f32_bf16 v235, s42, v77
  v_dot2c_f32_bf16 v236, s4, v78
  v_dot2c_f32_bf16 v237, s42, v78
  v_dot2c_f32_bf16 v238, s4, v79
  v_dot2c_f32_bf16 v239, s42, v79
  s_waitcnt vmcnt(11)
  v_dot2c_f32_bf16 v232, s4, v80
  v_dot2c_f32_bf16 v233, s42, v80
  v_dot2c_f32_bf16 v234, s4, v81
  v_dot2c_f32_bf16 v235, s42, v81
  v_dot2c_f32_bf16 v236, s4, v82
  v_dot2c_f32_bf16 v237, s42, v82
  v_dot2c_f32_bf16 v238, s4, v83
  v_dot2c_f32_bf16 v239, s42, v83
  s_waitcnt vmcnt(10)
  v_dot2c_f32_bf16 v232, s4, v84
  v_dot2c_f32_bf16 v233, s42, v84
  v_dot2c_f32_bf16 v234, s4, v85
  v_dot2c_f32_bf16 v235, s42, v85
  v_dot2c_f32_bf16 v236, s4, v86
  v_dot2c_f32_bf16 v237, s42, v86
  v_dot2c_f32_bf16 v238, s4, v87
  v_dot2c_f32_bf16 v239, s42, v87
  s_waitcnt vmcnt(9)
  v_dot2c_f32_bf16 v232, s4, v88
  v_dot2c_f32_bf16 v233, s42, v88
  v_dot2c_f32_bf16 v234, s4, v89
  v_dot2c_f32_bf16 v235, s42, v89
  v_dot2c_f32_bf16 v236, s4, v90
  v_dot2c_f32_bf16 v237, s42, v90
  v_dot2c_f32_bf16 v238, s4, v91
  v_dot2c_f32_bf16 v239, s42, v91
  s_waitcnt vmcnt(8)
  v_dot2c_f32_bf16 v232, s4, v92
  v_dot2c_f32_bf16 v233, s42, v92
  v_dot2c_f32_bf16 v234, s4, v93
  v_dot2c_f32_bf16 v235, s42, v93
  v_dot2c_f32_bf16 v236, s4, v94
  v_dot2c_f32_bf16 v237, s42, v94
  v_dot2c_f32_bf16 v238, s4, v95
  v_dot2c_f32_bf16 v239, s42, v95
  s_waitcnt vmcnt(7)
  v_dot2c_f32_bf16 v232, s4, v96
  v_dot2c_f32_bf16 v233, s42, v96
  v_dot2c_f32_bf16 v234, s4, v97
  v_dot2c_f32_bf16 v235, s42, v97
  v_dot2c_f32_bf16 v236, s4, v98
  v_dot2c_f32_bf16 v237, s42, v98
  v_dot2c_f32_bf16 v238, s4, v99
  v_dot2c_f32_bf16 v239, s42, v99
  s_waitcnt vmcnt(6)
  v_dot2c_f32_bf16 v232, s4, v100
  v_dot2c_f32_bf16 v233, s42, v100
  v_dot2c_f32_bf16 v234, s4, v101
  v_dot2c_f32_bf16 v235, s42, v101
  v_dot2c_f32_bf16 v236, s4, v102
  v_dot2c_f32_bf16 v237, s42, v102
  v_dot2c_f32_bf16 v238, s4, v103
  v_dot2c_f32_bf16 v239, s42, v103
  s_waitcnt vmcnt(5)
  v_dot2c_f32_bf16 v232, s4, v104
  v_dot2c_f32_bf16 v233, s42, v104
  v_dot2c_f32_bf16 v234, s4, v105
  v_dot2c_f32_bf16 v235, s42, v105
  v_dot2c_f32_bf16 v236, s4, v106
  v_dot2c_f32_bf16 v237, s42, v106
  v_dot2c_f32_bf16 v238, s4, v107
  v_dot2c_f32_bf16 v239, s42, v107
  s_waitcnt vmcnt(4)
  v_dot2c_f32_bf16 v232, s4, v108
  v_dot2c_f32_bf16 v233, s42, v108
  v_dot2c_f32_bf16 v234, s4, v109
  v_dot2c_f32_bf16 v235, s42, v109
  v_dot2c_f32_bf16 v236, s4, v110
  v_dot2c_f32_bf16 v237, s42, v110
  v_dot2c_f32_bf16 v238, s4, v111
  v_dot2c_f32_bf16 v239, s42, v111
  s_waitcnt vmcnt(3)
  v_dot2c_f32_bf16 v232, s4, v112
  v_dot2c_f32_bf16 v233, s42, v112
  v_dot2c_f32_bf16 v234, s4, v113
  v_dot2c_f32_bf16 v235, s42, v113
  v_dot2c_f32_bf16 v236, s4, v114
  v_dot2c_f32_bf16 v237, s42, v114
  v_dot2c_f32_bf16 v238, s4, v115
  v_dot2c_f32_bf16 v239, s42, v115
  s_waitcnt vmcnt(2)
  v_dot2c_f32_bf16 v232, s4, v116
  v_dot2c_f32_bf16 v233, s42, v116
  v_dot2c_f32_bf16 v234, s4, v117
  v_dot2c_f32_bf16 v235, s42, v117
  v_dot2c_f32_bf16 v236, s4, v118
  v_dot2c_f32_bf16 v237, s42, v118
  v_dot2c_f32_bf16 v238, s4, v119
  v_dot2c_f32_bf16 v239, s42, v119
  s_waitcnt vmcnt(1)
  v_dot2c_f32_bf16 v232, s4, v120
  v_dot2c_f32_bf16 v233, s42, v120
  v_dot2c_f32_bf16 v234, s4, v121
  v_dot2c_f32_bf16 v235, s42, v121
  v_dot2c_f32_bf16 v236, s4, v122
  v_dot2c_f32_bf16 v237, s42, v122
  v_dot2c_f32_bf16 v238, s4, v123
  v_dot2c_f32_bf16 v239, s42, v123
  s_waitcnt vmcnt(0)
  v_dot2c_f32_bf16 v232, s4, v124
  v_dot2c_f32_bf16 v233, s42, v124
  v_dot2c_f32_bf16 v234, s4, v125
  v_dot2c_f32_bf16 v235, s42, v125
  v_dot2c_f32_bf16 v236, s4, v126
  v_dot2c_f32_bf16 v237, s42, v126
  v_dot2c_f32_bf16 v238, s4, v127
  v_dot2c_f32_bf16 v239, s42, v127
  s_nop 2
  v_cvt_pk_bf16_f32 v240, v232, v233
  v_cvt_pk_bf16_f32 v241, v234, v235
  v_cvt_pk_bf16_f32 v242, v236, v237
  v_cvt_pk_bf16_f32 v243, v238, v239
  s_nop 1
  v_permlane16_swap_b32 v240, v242
  v_permlane16_swap_b32 v241, v243
  s_nop 1
  buffer_store_dwordx4 v[240:243], v16, s[12:15], s50 offen
  s_add_u32 s50, s50, 688128
  s_cmp_eq_u32 s56, 1
  s_cbranch_scc1 L_fin
  s_mov_b32 s56, 1
  s_barrier
  s_branch L_Bred4
L_Bsingle:
  s_mov_b32 s56, 0
L_Bred2:
  buffer_load_dwordx2 v[64:65], v35, s[8:11], s49 offen sc1
  s_add_u32 s49, s49, 43136
  buffer_load_dwordx2 v[68:69], v35, s[8:11], s49 offen sc1
  s_add_u32 s49, s49, 43136
  buffer_load_dwordx2 v[72:73], v35, s[8:11], s49 offen sc1
  s_add_u32 s49, s49, 43136
  buffer_load_dwordx2 v[76:77], v35, s[8:11], s49 offen sc1
  s_add_u32 s49, s49, 43136
  buffer_load_dwordx2 v[80:81], v35, s[8:11], s49 offen sc1
  s_add_u32 s49, s49, 43136
  buffer_load_dwordx2 v[84:85], v35, s[8:11], s49 offen sc1
  s_add_u32 s49, s49, 43136
  buffer_load_dwordx2 v[88:89], v35, s[8:11], s49 offen sc1
  s_add_u32 s49, s49, 43136
  buffer_load_dwordx2 v[92:93], v35, s[8:11], s49 offen sc1
  s_add_u32 s49, s49, 43136
  buffer_load_dwordx2 v[96:97], v35, s[8:11], s49 offen sc1
  s_add_u32 s49, s49, 43136
  buffer_load_dwordx2 v[100:101], v35, s[8:11], s49 offen sc1
  s_add_u32 s49, s49, 43136
  buffer_load_dwordx2 v[104:105], v35, s[8:11], s49 offen sc1
  s_add_u32 s49, s49, 43136
  buffer_load_dwordx2 v[108:109], v35, s[8:11], s49 offen sc1
  s_add_u32 s49, s49, 43136
  buffer_load_dwordx2 v[112:113], v35, s[8:11], s49 offen sc1
  s_add_u32 s49, s49, 43136
  buffer_load_dwordx2 v[116:117], v35, s[8:11], s49 offen sc1
  s_add_u32 s49, s49, 43136
  buffer_load_dwordx2 v[120:121], v35, s[8:11], s49 offen sc1
  s_add_u32 s49, s49, 43136
  buffer_load_dwordx2 v[124:125], v35, s[8:11], s49 offen sc1
  s_add_u32 s49, s49, 43136
  s_waitcnt vmcnt(15)
  v_lshlrev_b32 v232, 16, v64
  v_and_b32 v233, s45, v64
  v_lshlrev_b32 v234, 16, v65
  v_and_b32 v235, s45, v65
  s_waitcnt vmcnt(14)
  v_dot2c_f32_bf16 v232, s4, v68
  v_dot2c_f32_bf16 v233, s42, v68
  v_dot2c_f32_bf16 v234, s4, v69
  v_dot2c_f32_bf16 v235, s42, v69
  s_waitcnt vmcnt(13)
  v_dot2c_f32_bf16 v232, s4, v72
  v_dot2c_f32_bf16 v233, s42, v72
  v_dot2c_f32_bf16 v234, s4, v73
  v_dot2c_f32_bf16 v235, s42, v73
  s_waitcnt vmcnt(12)
  v_dot2c_f32_bf16 v232, s4, v76
  v_dot2c_f32_bf16 v233, s42, v76
  v_dot2c_f32_bf16 v234, s4, v77
  v_dot2c_f32_bf16 v235, s42, v77
  s_waitcnt vmcnt(11)
  v_dot2c_f32_bf16 v232, s4, v80
  v_dot2c_f32_bf16 v233, s42, v80
  v_dot2c_f32_bf16 v234, s4, v81
  v_dot2c_f32_bf16 v235, s42, v81
  s_waitcnt vmcnt(10)
  v_dot2c_f32_bf16 v232, s4, v84
  v_dot2c_f32_bf16 v233, s42, v84
  v_dot2c_f32_bf16 v234, s4, v85
  v_dot2c_f32_bf16 v235, s42, v85
  s_waitcnt vmcnt(9)
  v_dot2c_f32_bf16 v232, s4, v88
  v_dot2c_f32_bf16 v233, s42, v88
  v_dot2c_f32_bf16 v234, s4, v89
  v_dot2c_f32_bf16 v235, s42, v89
  s_waitcnt vmcnt(8)
  v_dot2c_f32_bf16 v232, s4, v92
  v_dot2c_f32_bf16 v233, s42, v92
  v_dot2c_f32_bf16 v234, s4, v93
  v_dot2c_f32_bf16 v235, s42, v93
  s_waitcnt vmcnt(7)
  v_dot2c_f32_bf16 v232, s4, v96
  v_dot2c_f32_bf16 v233, s42, v96
  v_dot2c_f32_bf16 v234, s4, v97
  v_dot2c_f32_bf16 v235, s42, v97
  s_waitcnt vmcnt(6)
  v_dot2c_f32_bf16 v232, s4, v100
  v_dot2c_f32_bf16 v233, s42, v100
  v_dot2c_f32_bf16 v234, s4, v101
  v_dot2c_f32_bf16 v235, s42, v101
  s_waitcnt vmcnt(5)
  v_dot2c_f32_bf16 v232, s4, v104
  v_dot2c_f32_bf16 v233, s42, v104
  v_dot2c_f32_bf16 v234, s4, v105
  v_dot2c_f32_bf16 v235, s42, v105
  s_waitcnt vmcnt(4)
  v_dot2c_f32_bf16 v232, s4, v108
  v_dot2c_f32_bf16 v233, s42, v108
  v_dot2c_f32_bf16 v234, s4, v109
  v_dot2c_f32_bf16 v235, s42, v109
  s_waitcnt vmcnt(3)
  v_dot2c_f32_bf16 v232, s4, v112
  v_dot2c_f32_bf16 v233, s42, v112
  v_dot2c_f32_bf16 v234, s4, v113
  v_dot2c_f32_bf16 v235, s42, v113
  s_waitcnt vmcnt(2)
  v_dot2c_f32_bf16 v232, s4, v116
  v_dot2c_f32_bf16 v233, s42, v116
  v_dot2c_f32_bf16 v234, s4, v117
  v_dot2c_f32_bf16 v235, s42, v117
  s_waitcnt vmcnt(1)
  v_dot2c_f32_bf16 v232, s4, v120
  v_dot2c_f32_bf16 v233, s42, v120
  v_dot2c_f32_bf16 v234, s4, v121
  v_dot2c_f32_bf16 v235, s42, v121
  s_waitcnt vmcnt(0)
  v_dot2c_f32_bf16 v232, s4, v124
  v_dot2c_f32_bf16 v233, s42, v124
  v_dot2c_f32_bf16 v234, s4, v125
  v_dot2c_f32_bf16 v235, s42, v125
  s_nop 2
  v_cvt_pk_bf16_f32 v240, v232, v233
  v_cvt_pk_bf16_f32 v241, v234, v235
  s_nop 1
  buffer_store_dwordx2 v[240:241], v17, s[12:15], s50 offen
  s_add_u32 s50, s50, 688128
  s_cmp_eq_u32 s56, 1
  s_cbranch_scc1 L_fin
  s_mov_b32 s56, 1
  s_barrier
  s_branch L_Bred2
L_Bw3:
  s_mov_b64 exec, 0xffff
  s_waitcnt vmcnt(0)
  s_mov_b32 s51, 0
  s_branch L_chkB1
L_pollB1:
  buffer_load_dwordx2 v[44:45], v35, s[24:27], 0 offen offset:0 sc1
  s_waitcnt vmcnt(0)
L_chkB1:
  v_cmp_eq_u64 vcc, v[44:45], v[46:47]
  s_add_u32 s51, s51, 1
  s_nop 0
  s_cmp_eq_u32 vcc_lo, 0xffff
  s_cbranch_scc1 L_polledB1
  s_cmp_ge_u32 s51, 0x100000
  s_cbranch_scc1 L_polledB1
  s_sleep 4
  s_branch L_pollB1
L_polledB1:
  s_barrier
  s_mov_b64 exec, 1
  buffer_store_dwordx2 v[46:47], v35, s[24:27], s56 offen offset:2048 sc1
  s_mov_b64 exec, 0xffff
  s_mov_b32 s51, 0
L_pollB2:
  buffer_load_dwordx2 v[44:45], v35, s[24:27], 0 offen offset:2048 sc1
  s_waitcnt vmcnt(0)
L_chkB2:
  v_cmp_eq_u64 vcc, v[44:45], v[46:47]
  s_add_u32 s51, s51, 1
  s_nop 0
  s_cmp_eq_u32 vcc_lo, 0xffff
  s_cbranch_scc1 L_polledB2
  s_cmp_ge_u32 s51, 0x100000
  s_cbranch_scc1 L_polledB2
  s_sleep 4
  s_branch L_pollB2
L_polledB2:
  s_mov_b64 exec, -1
  s_barrier
  s_branch L_fin
L_pathA:
  v_add_u32 v43, 0, v2
  v_xor_b32 v44, v43, v1
  v_lshlrev_b32 v44, 4, v44
  v_lshl_add_u32 v16, v43, 9, v44
  v_add_u32 v43, 4, v2
  v_xor_b32 v44, v43, v1
  v_lshlrev_b32 v44, 4, v44
  v_lshl_add_u32 v17, v43, 9, v44
  v_subrev_u32 v17, 1024, v17
  v_add_u32 v43, 8, v2
  v_xor_b32 v44, v43, v1
  v_lshlrev_b32 v44, 4, v44
  v_lshl_add_u32 v18, v43, 9, v44
  v_subrev_u32 v18, 2048, v18
  v_add_u32 v43, 12, v2
  v_xor_b32 v44, v43, v1
  v_lshlrev_b32 v44, 4, v44
  v_lshl_add_u32 v19, v43, 9, v44
  v_subrev_u32 v19, 3072, v19
  s_lshl_b32 s39, s5, 3
  s_add_u32 s44, s39, s3
  s_lshl_b32 s40, s44, 18
  s_waitcnt lgkmcnt(0)
  s_add_u32 s8, s50, s40
  s_addc_u32 s9, s51, 0
  s_mov_b32 s10, 262144
  s_mov_b32 s11, 0x20000
  s_add_u32 s12, s52, s40
  s_addc_u32 s13, s53, 0
  s_mov_b32 s14, 262144
  s_mov_b32 s15, 0x20000
  s_lshl_b32 s40, s3, 10
  s_sub_u32 s41, 3670016, s40
  s_add_u32 s16, s54, s40
  s_addc_u32 s17, s55, 0
  s_mov_b32 s18, s41
  s_mov_b32 s19, 0x20000
  s_mul_i32 s39, s5, 43008
  s_add_u32 s52, s86, s39
  s_addc_u32 s53, s87, 0
  s_mov_b32 s54, 43008
  s_mov_b32 s55, 0x20000
  v_lshlrev_b32 v15, 4, v0
  s_mov_b32 m0, 150528
  s_mul_i32 s40, s32, 11264
  buffer_load_dwordx4 v15, s[52:55], s40 offen offset:0 lds
  buffer_load_dwordx4 v15, s[52:55], s40 offen offset:1024 lds
  buffer_load_dwordx4 v15, s[52:55], s40 offen offset:2048 lds
  buffer_load_dwordx4 v15, s[52:55], s40 offen offset:3072 lds
  s_add_u32 s40, s40, 4096
  buffer_load_dwordx4 v15, s[52:55], s40 offen offset:0 lds
  buffer_load_dwordx4 v15, s[52:55], s40 offen offset:1024 lds
  buffer_load_dwordx4 v15, s[52:55], s40 offen offset:2048 lds
  buffer_load_dwordx4 v15, s[52:55], s40 offen offset:3072 lds
  s_add_u32 s40, s40, 4096
  buffer_load_dwordx4 v15, s[52:55], s40 offen offset:0 lds
  buffer_load_dwordx4 v15, s[52:55], s40 offen offset:1024 lds
  buffer_load_dwordx4 v15, s[52:55], s40 offen offset:2048 lds
  s_add_u32 m0, s33, 0
  s_add_u32 s46, s34, 256
  buffer_load_dwordx4 v16, s[8:11], s34 offen offset:0 nt lds
  buffer_load_dwordx4 v17, s[8:11], s34 offen offset:1024 nt lds
  buffer_load_dwordx4 v18, s[8:11], s34 offen offset:2048 nt lds
  buffer_load_dwordx4 v19, s[8:11], s34 offen offset:3072 nt lds
  s_add_u32 m0, s33, 4096
  s_nop 0
  buffer_load_dwordx4 v16, s[8:11], s46 offen offset:0 nt lds
  buffer_load_dwordx4 v17, s[8:11], s46 offen offset:1024 nt lds
  buffer_load_dwordx4 v18, s[8:11], s46 offen offset:2048 nt lds
  buffer_load_dwordx4 v19, s[8:11], s46 offen offset:3072 nt lds
  s_add_u32 s34, s34, 32768
  s_add_u32 m0, s33, 8192
  s_add_u32 s46, s34, 256
  buffer_load_dwordx4 v16, s[8:11], s34 offen offset:0 nt lds
  buffer_load_dwordx4 v17, s[8:11], s34 offen offset:1024 nt lds
  buffer_load_dwordx4 v18, s[8:11], s34 offen offset:2048 nt lds
  buffer_load_dwordx4 v19, s[8:11], s34 offen offset:3072 nt lds
  s_add_u32 m0, s33, 12288
  s_nop 0
  buffer_load_dwordx4 v16, s[8:11], s46 offen offset:0 nt lds
  buffer_load_dwordx4 v17, s[8:11], s46 offen offset:1024 nt lds
  buffer_load_dwordx4 v18, s[8:11], s46 offen offset:2048 nt lds
  buffer_load_dwordx4 v19, s[8:11], s46 offen offset:3072 nt lds
  s_add_u32 s34, s34, 32768
  s_mul_i32 s40, s5, 43008
  s_add_u32 s24, s48, s40
  s_addc_u32 s25, s49, 0
  s_mov_b32 s26, 43008
  s_mov_b32 s27, 0x20000
  s_mul_i32 s40, s3, 458752
  s_add_u32 s20, s56, s40
  s_addc_u32 s21, s57, 0
  s_mov_b32 s22, 458752
  s_mov_b32 s23, 0x20000
  s_mul_i32 s40, s44, 43136
  s_add_u32 s28, s58, s40
  s_addc_u32 s29, s59, 0
  s_mov_b32 s30, 43136
  s_mov_b32 s31, 0x20000
  s_cmp_ge_u32 s5, 14
  s_cselect_b32 s39, 14, 0
  s_sub_u32 s39, s5, s39
  s_lshl_b32 s36, s39, 18
  s_and_b32 s4, s39, 1
  s_lshl_b32 s4, s4, 6
  s_lshr_b32 s39, s39, 1
  s_mul_i32 s42, s39, 6144
  s_and_b32 s39, s5, 7
  s_mul_i32 s37, s39, 28672
  s_mul_i32 s43, s39, 3072
  s_lshr_b32 s39, s5, 1
  s_lshl_b32 s39, s39, 4
  s_lshl_b32 s40, s3, 1
  s_add_u32 s39, s39, s40
  s_lshl_b32 s39, s39, 18
  s_and_b32 s40, s32, 1
  s_lshl_b32 s40, s40, 25
  s_add_u32 s39, s39, s40
  s_cmp_ge_u32 s32, 2
  s_cselect_b32 s62, s78, s76
  s_cselect_b32 s63, s79, s77
  s_load_dword s64, s[62:63], s39
  s_lshl_b32 s39, s5, 3
  s_add_u32 s94, s94, s39
  s_addc_u32 s95, s95, 0
  s_cmp_eq_u32 s32, 0
  s_cbranch_scc0 L_notagA
  s_cmp_eq_u32 s3, 0
  s_cbranch_scc0 L_notagA
  s_or_b32 s90, s90, 1
  v_mov_b32 v46, s90
  v_mov_b32 v47, s91
  v_mov_b32 v45, 0
  s_mov_b64 exec, 1
  global_store_dwordx2 v45, v[46:47], s[94:95] sc1
  s_mov_b64 exec, -1
  s_nop 1
L_notagA:
  v_lshlrev_b32 v3, 4, v0
  v_add_u32 v3, 98304, v3
  v_lshrrev_b32 v46, 2, v1
  v_and_b32 v47, 3, v1
  v_and_b32 v44, 6, v1
  v_xor_b32 v44, v44, v2
  v_lshlrev_b32 v44, 4, v44
  v_lshl_add_u32 v44, v1, 7, v44
  v_add_u32 v41, 98304, v44
  v_lshl_add_u32 v43, v2, 2, v46
  v_mul_u32_u24 v44, 224, v43
  v_lshl_add_u32 v44, v47, 3, v44
  v_add_u32 v12, s33, v44
  v_and_b32 v43, 1, v2
  v_lshl_add_u32 v44, v43, 3, v46
  v_lshlrev_b32 v44, 8, v44
  v_lshl_add_u32 v45, v43, 2, v46
  v_lshl_add_u32 v44, v45, 5, v44
  v_lshl_add_u32 v44, v47, 3, v44
  v_lshrrev_b32 v45, 1, v2
  v_lshl_add_u32 v44, v45, 12, v44
  v_add_u32 v28, s33, v44
  v_xor_b32 v29, 32, v28
  v_xor_b32 v30, 64, v28
  v_xor_b32 v31, 96, v28
  v_xor_b32 v32, 128, v28
  v_xor_b32 v33, 160, v28
  v_xor_b32 v34, 192, v28
  s_add_u32 m0, s33, 16384
  s_add_u32 s46, s34, 256
  buffer_load_dwordx4 v16, s[8:11], s34 offen offset:0 nt lds
  v_xor_b32 v35, 224, v28
  s_mul_i32 s39, s32, 12288
  s_add_u32 s39, s39, 98304
  v_lshrrev_b32 v45, 1, v2
  v_lshlrev_b32 v44, 8, v45
  v_lshl_add_u32 v44, v1, 4, v44
  v_lshl_add_u32 v44, v43, 3, v44
  v_add_u32 v42, s39, v44
  v_xor_b32 v44, v2, v1
  v_lshlrev_b32 v44, 4, v44
  v_lshl_add_u32 v44, v1, 8, v44
  v_add_u32 v20, s33, v44
  v_xor_b32 v21, 64, v20
  v_xor_b32 v22, 128, v20
  v_xor_b32 v23, 192, v20
  s_lshl_b32 s39, s32, 7
  v_lshrrev_b32 v43, 3, v0
  v_and_b32 v44, 7, v0
  v_lshlrev_b32 v45, 1, v2
  v_xor_b32 v44, v44, v45
  v_lshlrev_b32 v44, 4, v44
  v_lshl_add_u32 v43, v43, 9, v44
  v_add_u32 v4, s39, v43
  v_add_u32 v5, 3072, v4
  v_add_u32 v6, 6144, v4
  v_add_u32 v7, 9216, v4
  v_lshlrev_b32 v44, 4, v1
  v_add_u32 v14, 147456, v44
  s_lshl_b32 s39, s32, 2
  v_add_u32 v13, s39, v14
  buffer_load_dwordx4 v17, s[8:11], s34 offen offset:1024 nt lds
  s_mov_b32 s100, 0x3db8aa3b
  s_mov_b32 s101, 0xbdb8aa3b
  v_lshrrev_b32 v43, 3, v0
  v_lshlrev_b32 v44, 1, v2
  v_and_b32 v45, 7, v0
  v_xor_b32 v44, v44, v45
  v_lshlrev_b32 v44, 4, v44
  v_mul_u32_u24 v43, 896, v43
  v_add_u32 v40, v43, v44
  s_lshl_b32 s39, s32, 8
  v_add_u32 v43, 0, v2
  v_lshlrev_b32 v44, 1, v2
  v_xor_b32 v44, v44, v1
  v_lshlrev_b32 v44, 4, v44
  v_lshl_add_u32 v43, v43, 13, v44
  v_add_u32 v24, s39, v43
  v_add_u32 v43, 4, v2
  v_lshlrev_b32 v44, 1, v2
  v_xor_b32 v44, v44, v1
  v_lshlrev_b32 v44, 4, v44
  v_lshl_add_u32 v43, v43, 13, v44
  v_add_u32 v25, s39, v43
  v_subrev_u32 v25, 1024, v25
  v_add_u32 v43, 8, v2
  v_lshlrev_b32 v44, 1, v2
  v_or_b32 v44, 8, v44
  v_xor_b32 v44, v44, v1
  v_lshlrev_b32 v44, 4, v44
  v_lshl_add_u32 v43, v43, 13, v44
  buffer_load_dwordx4 v18, s[8:11], s34 offen offset:2048 nt lds
  v_add_u32 v26, s39, v43
  v_subrev_u32 v26, 2048, v26
  v_add_u32 v43, 12, v2
  v_lshlrev_b32 v44, 1, v2
  v_or_b32 v44, 8, v44
  v_xor_b32 v44, v44, v1
  v_lshlrev_b32 v44, 4, v44
  v_lshl_add_u32 v43, v43, 13, v44
  v_add_u32 v27, s39, v43
  v_subrev_u32 v27, 3072, v27
  s_mul_i32 s39, s32, 224
  s_movk_i32 s40, 4682
  s_mov_b32 s41, 0x40000000
  v_add_u32 v43, 0, v0
  v_mul_u32_u24 v44, s40, v43
  v_lshrrev_b32 v44, 16, v44
  v_mul_u32_u24 v45, 14, v44
  v_sub_u32 v45, v43, v45
  v_lshlrev_b32 v45, 4, v45
  v_mul_u32_u24 v44, 896, v44
  v_add3_u32 v8, v44, v45, s39
  v_add_u32 v43, 64, v0
  v_mul_u32_u24 v44, s40, v43
  v_lshrrev_b32 v44, 16, v44
  v_mul_u32_u24 v45, 14, v44
  v_sub_u32 v45, v43, v45
  v_lshlrev_b32 v45, 4, v45
  v_mul_u32_u24 v44, 896, v44
  v_add3_u32 v9, v44, v45, s39
  buffer_load_dwordx4 v19, s[8:11], s34 offen offset:3072 nt lds
  v_subrev_u32 v9, 1024, v9
  v_add_u32 v43, 128, v0
  v_mul_u32_u24 v44, s40, v43
  v_lshrrev_b32 v44, 16, v44
  v_mul_u32_u24 v45, 14, v44
  v_sub_u32 v45, v43, v45
  v_lshlrev_b32 v45, 4, v45
  v_mul_u32_u24 v44, 896, v44
  v_add3_u32 v10, v44, v45, s39
  v_subrev_u32 v10, 2048, v10
  v_add_u32 v43, 192, v0
  v_mul_u32_u24 v44, s40, v43
  v_lshrrev_b32 v44, 16, v44
  v_mul_u32_u24 v45, 14, v44
  v_sub_u32 v45, v43, v45
  v_lshlrev_b32 v45, 4, v45
  v_mul_u32_u24 v44, 896, v44
  v_add3_u32 v11, v44, v45, s39
  v_subrev_u32 v11, 3072, v11
  v_mov_b32 v43, s41
  v_cmp_gt_u32 vcc, 32, v0
  s_nop 1
  v_cndmask_b32 v11, v43, v11, vcc
  s_waitcnt vmcnt(12)
  ds_read_b128 a[0:3], v20 offset:0
  ds_read_b128 a[4:7], v21 offset:0
  ds_read_b128 a[8:11], v22 offset:0
  s_add_u32 m0, s33, 20480
  s_nop 0
  buffer_load_dwordx4 v16, s[8:11], s46 offen offset:0 nt lds
  ds_read_b128 a[12:15], v23 offset:0
  ds_read_b128 a[16:19], v20 offset:4096
  ds_read_b128 a[20:23], v21 offset:4096
  ds_read_b128 a[24:27], v22 offset:4096
  ds_read_b128 a[28:31], v23 offset:4096
  s_waitcnt lgkmcnt(0)
  buffer_load_dwordx4 v17, s[8:11], s46 offen offset:1024 nt lds
  buffer_load_dwordx4 v18, s[8:11], s46 offen offset:2048 nt lds
  buffer_load_dwordx4 v19, s[8:11], s46 offen offset:3072 nt lds
  s_add_u32 s34, s34, 32768
  s_mov_b32 m0, 150528
  s_add_u32 s39, s36, 131072
  buffer_load_dwordx4 v24, s[16:19], s36 offen offset:0 lds
  buffer_load_dwordx4 v25, s[16:19], s36 offen offset:1024 lds
  buffer_load_dwordx4 v26, s[16:19], s36 offen offset:2048 lds
  buffer_load_dwordx4 v27, s[16:19], s36 offen offset:3072 lds
  buffer_load_dwordx4 v24, s[16:19], s39 offen offset:0 lds
  buffer_load_dwordx4 v25, s[16:19], s39 offen offset:1024 lds
  buffer_load_dwordx4 v26, s[16:19], s39 offen offset:2048 lds
  buffer_load_dwordx4 v27, s[16:19], s39 offen offset:3072 lds
  s_waitcnt vmcnt(16)
  ds_read_b128 a[32:35], v20 offset:8192
  ds_read_b128 a[36:39], v21 offset:8192
  ds_read_b128 a[40:43], v22 offset:8192
  ds_read_b128 a[44:47], v23 offset:8192
  ds_read_b128 a[48:51], v20 offset:12288
  ds_read_b128 a[52:55], v21 offset:12288
  ds_read_b128 a[56:59], v22 offset:12288
  ds_read_b128 a[60:63], v23 offset:12288
  s_waitcnt lgkmcnt(0)
  s_add_u32 m0, s33, 0
  s_add_u32 s46, s34, 256
  buffer_load_dwordx4 v16, s[8:11], s34 offen offset:0 nt lds
  buffer_load_dwordx4 v17, s[8:11], s34 offen offset:1024 nt lds
  buffer_load_dwordx4 v18, s[8:11], s34 offen offset:2048 nt lds
  buffer_load_dwordx4 v19, s[8:11], s34 offen offset:3072 nt lds
  s_add_u32 m0, s33, 4096
  s_nop 0
  buffer_load_dwordx4 v16, s[8:11], s46 offen offset:0 nt lds
  buffer_load_dwordx4 v17, s[8:11], s46 offen offset:1024 nt lds
  buffer_load_dwordx4 v18, s[8:11], s46 offen offset:2048 nt lds
  buffer_load_dwordx4 v19, s[8:11], s46 offen offset:3072 nt lds
  s_add_u32 s34, s34, 32768
  s_waitcnt vmcnt(16)
  ds_read_b128 a[64:67], v20 offset:16384
  ds_read_b128 a[68:71], v21 offset:16384
  ds_read_b128 a[72:75], v22 offset:16384
  ds_read_b128 a[76:79], v23 offset:16384
  ds_read_b128 a[80:83], v20 offset:20480
  ds_read_b128 a[84:87], v21 offset:20480
  ds_read_b128 a[88:91], v22 offset:20480
  ds_read_b128 a[92:95], v23 offset:20480
  s_waitcnt lgkmcnt(0)
  s_add_u32 m0, s33, 8192
  s_add_u32 s46, s34, 256
  buffer_load_dwordx4 v16, s[8:11], s34 offen offset:0 nt lds
  buffer_load_dwordx4 v17, s[8:11], s34 offen offset:1024 nt lds
  buffer_load_dwordx4 v18, s[8:11], s34 offen offset:2048 nt lds
  buffer_load_dwordx4 v19, s[8:11], s34 offen offset:3072 nt lds
  s_add_u32 m0, s33, 12288
  s_nop 0
  buffer_load_dwordx4 v16, s[8:11], s46 offen offset:0 nt lds
  buffer_load_dwordx4 v17, s[8:11], s46 offen offset:1024 nt lds
  buffer_load_dwordx4 v18, s[8:11], s46 offen offset:2048 nt lds
  buffer_load_dwordx4 v19, s[8:11], s46 offen offset:3072 nt lds
  s_add_u32 s34, s34, 32768
  s_waitcnt vmcnt(8)
  ds_read_b128 a[96:99], v20 offset:0
  ds_read_b128 a[100:103], v21 offset:0
  ds_read_b128 a[104:107], v22 offset:0
  ds_read_b128 a[108:111], v23 offset:0
  ds_read_b128 a[112:115], v20 offset:4096
  ds_read_b128 a[116:119], v21 offset:4096
  ds_read_b128 a[120:123], v22 offset:4096
  ds_read_b128 a[124:127], v23 offset:4096
  s_waitcnt lgkmcnt(0)
  s_lshl_b32 s39, s3, 4
  s_add_u32 s39, s39, s5
  s_mul_i32 s39, s39, 28672
  s_add_u32 s52, s56, s39
  s_addc_u32 s53, s57, 0
  s_mov_b32 s54, 28672
  s_mov_b32 s55, 0x20000
  v_lshlrev_b32 v15, 4, v0
  s_mov_b32 m0, 150528
  s_mul_i32 s40, s32, 7168
  buffer_load_dwordx4 v15, s[52:55], s40 offen offset:0 lds
  buffer_load_dwordx4 v15, s[52:55], s40 offen offset:1024 lds
  buffer_load_dwordx4 v15, s[52:55], s40 offen offset:2048 lds
  buffer_load_dwordx4 v15, s[52:55], s40 offen offset:3072 lds
  s_add_u32 s40, s40, 4096
  buffer_load_dwordx4 v15, s[52:55], s40 offen offset:0 lds
  buffer_load_dwordx4 v15, s[52:55], s40 offen offset:1024 lds
  buffer_load_dwordx4 v15, s[52:55], s40 offen offset:2048 lds
  s_add_u32 m0, s33, 16384
  s_add_u32 s46, s34, 256
  buffer_load_dwordx4 v16, s[8:11], s34 offen offset:0 nt lds
  buffer_load_dwordx4 v17, s[8:11], s34 offen offset:1024 nt lds
  buffer_load_dwordx4 v18, s[8:11], s34 offen offset:2048 nt lds
  buffer_load_dwordx4 v19, s[8:11], s34 offen offset:3072 nt lds
  s_add_u32 m0, s33, 20480
  s_nop 0
  buffer_load_dwordx4 v16, s[8:11], s46 offen offset:0 nt lds
  buffer_load_dwordx4 v17, s[8:11], s46 offen offset:1024 nt lds
  buffer_load_dwordx4 v18, s[8:11], s46 offen offset:2048 nt lds
  buffer_load_dwordx4 v19, s[8:11], s46 offen offset:3072 nt lds
  s_add_u32 s34, s34, 32768
  s_mov_b32 s39, s32
  s_mul_i32 s40, s32, 7168
  s_lshl_b32 s41, s32, 10
  s_add_u32 m0, s41, 98304
  s_add_u32 s39, s39, 4
  buffer_load_dwordx4 v40, s[24:27], s40 offen lds
  s_cmp_ge_u32 s39, 6
  s_cselect_b32 s41, 6, 0
  s_cselect_b32 s44, 42880, 0
  s_sub_u32 s39, s39, s41
  s_add_u32 s40, s40, 28672
  s_sub_u32 s40, s40, s44
  s_add_u32 m0, m0, 4096
  s_add_u32 s39, s39, 4
  buffer_load_dwordx4 v40, s[24:27], s40 offen lds
  s_cmp_ge_u32 s39, 6
  s_cselect_b32 s41, 6, 0
  s_cselect_b32 s44, 42880, 0
  s_sub_u32 s39, s39, s41
  s_add_u32 s40, s40, 28672
  s_sub_u32 s40, s40, s44
  s_add_u32 m0, m0, 4096
  s_add_u32 s39, s39, 4
  buffer_load_dwordx4 v40, s[24:27], s40 offen lds
  s_cmp_ge_u32 s39, 6
  s_cselect_b32 s41, 6, 0
  s_cselect_b32 s44, 42880, 0
  s_sub_u32 s39, s39, s41
  s_add_u32 s40, s40, 28672
  s_sub_u32 s40, s40, s44
  s_add_u32 m0, m0, 4096
  s_add_u32 s39, s39, 4
  buffer_load_dwordx4 v40, s[24:27], s40 offen lds
  s_cmp_ge_u32 s39, 6
  s_cselect_b32 s41, 6, 0
  s_cselect_b32 s44, 42880, 0
  s_sub_u32 s39, s39, s41
  s_add_u32 s40, s40, 28672
  s_sub_u32 s40, s40, s44
  s_add_u32 m0, m0, 4096
  s_add_u32 s39, s39, 4
  buffer_load_dwordx4 v40, s[24:27], s40 offen lds
  s_cmp_ge_u32 s39, 6
  s_cselect_b32 s41, 6, 0
  s_cselect_b32 s44, 42880, 0
  s_sub_u32 s39, s39, s41
  s_add_u32 s40, s40, 28672
  s_sub_u32 s40, s40, s44
  s_add_u32 m0, m0, 4096
  s_add_u32 s39, s39, 4
  buffer_load_dwordx4 v40, s[24:27], s40 offen lds
  s_cmp_ge_u32 s39, 6
  s_cselect_b32 s41, 6, 0
  s_cselect_b32 s44, 42880, 0
  s_sub_u32 s39, s39, s41
  s_add_u32 s40, s40, 28672
  s_sub_u32 s40, s40, s44
  s_add_u32 m0, m0, 4096
  s_add_u32 s39, s39, 4
  buffer_load_dwordx4 v40, s[24:27], s40 offen lds
  s_cmp_ge_u32 s39, 6
  s_cselect_b32 s41, 6, 0
  s_cselect_b32 s44, 42880, 0
  s_sub_u32 s39, s39, s41
  s_add_u32 s40, s40, 28672
  s_sub_u32 s40, s40, s44
  s_add_u32 m0, m0, 4096
  s_add_u32 s39, s39, 4
  buffer_load_dwordx4 v40, s[24:27], s40 offen lds
  s_cmp_ge_u32 s39, 6
  s_cselect_b32 s41, 6, 0
  s_cselect_b32 s44, 42880, 0
  s_sub_u32 s39, s39, s41
  s_add_u32 s40, s40, 28672
  s_sub_u32 s40, s40, s44
  s_add_u32 m0, m0, 4096
  s_add_u32 s39, s39, 4
  buffer_load_dwordx4 v40, s[24:27], s40 offen lds
  s_cmp_ge_u32 s39, 6
  s_cselect_b32 s41, 6, 0
  s_cselect_b32 s44, 42880, 0
  s_sub_u32 s39, s39, s41
  s_add_u32 s40, s40, 28672
  s_sub_u32 s40, s40, s44
  s_add_u32 m0, m0, 4096
  s_add_u32 s39, s39, 4
  buffer_load_dwordx4 v40, s[24:27], s40 offen lds
  s_cmp_ge_u32 s39, 6
  s_cselect_b32 s41, 6, 0
  s_cselect_b32 s44, 42880, 0
  s_sub_u32 s39, s39, s41
  s_add_u32 s40, s40, 28672
  s_sub_u32 s40, s40, s44
  s_add_u32 m0, m0, 4096
  s_add_u32 s39, s39, 4
  buffer_load_dwordx4 v40, s[24:27], s40 offen lds
  s_waitcnt vmcnt(26)
  ds_read_b128 a[128:131], v20 offset:8192
  ds_read_b128 a[132:135], v21 offset:8192
  ds_read_b128 a[136:139], v22 offset:8192
  ds_read_b128 a[140:143], v23 offset:8192
  ds_read_b128 a[144:147], v20 offset:12288
  ds_read_b128 a[148:151], v21 offset:12288
  ds_read_b128 a[152:155], v22 offset:12288
  ds_read_b128 a[156:159], v23 offset:12288
  s_add_u32 m0, s33, 0
  s_add_u32 s46, s36, 131072
  buffer_load_dwordx4 v24, s[16:19], s36 offen offset:0 lds
  s_waitcnt lgkmcnt(0)
  buffer_load_dwordx4 v25, s[16:19], s36 offen offset:1024 lds
  buffer_load_dwordx4 v26, s[16:19], s36 offen offset:2048 lds
  buffer_load_dwordx4 v27, s[16:19], s36 offen offset:3072 lds
  s_add_u32 m0, s33, 4096
  s_nop 0
  buffer_load_dwordx4 v24, s[16:19], s46 offen offset:0 lds
  buffer_load_dwordx4 v25, s[16:19], s46 offen offset:1024 lds
  buffer_load_dwordx4 v26, s[16:19], s46 offen offset:2048 lds
  buffer_load_dwordx4 v27, s[16:19], s46 offen offset:3072 lds
  s_add_u32 s36, s36, 262144
  s_cmp_eq_u32 s36, 3670016
  s_cselect_b32 s36, 0, s36
  s_waitcnt vmcnt(19)
  ds_read_b128 a[160:163], v20 offset:16384
  ds_read_b128 a[164:167], v21 offset:16384
  ds_read_b128 a[168:171], v22 offset:16384
  ds_read_b128 a[172:175], v23 offset:16384
  ds_read_b128 a[176:179], v20 offset:20480
  ds_read_b128 a[180:183], v21 offset:20480
  ds_read_b128 a[184:187], v22 offset:20480
  ds_read_b128 a[188:191], v23 offset:20480
  s_add_u32 m0, s33, 8192
  s_add_u32 s46, s36, 131072
  buffer_load_dwordx4 v24, s[16:19], s36 offen offset:0 lds
  s_waitcnt lgkmcnt(0)
  buffer_load_dwordx4 v25, s[16:19], s36 offen offset:1024 lds
  buffer_load_dwordx4 v26, s[16:19], s36 offen offset:2048 lds
  buffer_load_dwordx4 v27, s[16:19], s36 offen offset:3072 lds
  s_add_u32 m0, s33, 12288
  s_nop 0
  buffer_load_dwordx4 v24, s[16:19], s46 offen offset:0 lds
  buffer_load_dwordx4 v25, s[16:19], s46 offen offset:1024 lds
  buffer_load_dwordx4 v26, s[16:19], s46 offen offset:2048 lds
  buffer_load_dwordx4 v27, s[16:19], s46 offen offset:3072 lds
  s_add_u32 s36, s36, 262144
  s_cmp_eq_u32 s36, 3670016
  s_cselect_b32 s36, 0, s36
  s_waitcnt vmcnt(8)
  s_barrier
  s_add_u32 m0, s33, 16384
  s_add_u32 s46, s36, 131072
  buffer_load_dwordx4 v24, s[16:19], s36 offen offset:0 lds
  v_xor_b32 v15, s4, v41
  v_add_u32 v15, s42, v15
  s_mul_i32 s40, s4, 96
  s_add_u32 s42, s42, s40
  s_xor_b32 s4, s4, 64
  s_cmp_eq_u32 s42, 43008
  s_cselect_b32 s42, 0, s42
  ds_read_b128 v[112:115], v15 offset:0
  ds_read_b64_tr_b16 v[48:49], v28 offset:0
  ds_read_b64_tr_b16 v[50:51], v28 offset:1024
  ds_read_b128 v[116:119], v15 offset:2048
  ds_read_b64_tr_b16 v[52:53], v29 offset:0
  buffer_load_dwordx4 v25, s[16:19], s36 offen offset:1024 lds
  ds_read_b64_tr_b16 v[54:55], v29 offset:1024
  ds_read_b128 v[120:123], v15 offset:4096
  ds_read_b64_tr_b16 v[56:57], v30 offset:0
  ds_read_b64_tr_b16 v[58:59], v30 offset:1024
  ds_read_b64_tr_b16 v[60:61], v31 offset:0
  ds_read_b64_tr_b16 v[62:63], v31 offset:1024
  ds_read_b64_tr_b16 v[64:65], v32 offset:0
  ds_read_b64_tr_b16 v[66:67], v32 offset:1024
  buffer_load_dwordx4 v26, s[16:19], s36 offen offset:2048 lds
  ds_read_b64_tr_b16 v[68:69], v33 offset:0
  ds_read_b64_tr_b16 v[70:71], v33 offset:1024
  ds_read_b64_tr_b16 v[72:73], v34 offset:0
  ds_read_b64_tr_b16 v[74:75], v34 offset:1024
  ds_read_b64_tr_b16 v[76:77], v35 offset:0
  ds_read_b64_tr_b16 v[78:79], v35 offset:1024
  s_waitcnt lgkmcnt(0)
  buffer_load_dwordx4 v27, s[16:19], s36 offen offset:3072 lds
  v_mfma_f32_16x16x32_bf16 v[160:163], v[48:51], v[112:115], 0
  s_add_u32 m0, s33, 20480
  s_nop 0
  buffer_load_dwordx4 v24, s[16:19], s46 offen offset:0 lds
  buffer_load_dwordx4 v25, s[16:19], s46 offen offset:1024 lds
  buffer_load_dwordx4 v26, s[16:19], s46 offen offset:2048 lds
  buffer_load_dwordx4 v27, s[16:19], s46 offen offset:3072 lds
  s_add_u32 s36, s36, 262144
  s_cmp_eq_u32 s36, 3670016
  s_cselect_b32 s36, 0, s36
  s_waitcnt vmcnt(8)
  v_mfma_f32_16x16x32_bf16 v[164:167], v[48:51], v[116:119], 0
  v_xor_b32 v15, s4, v41
  v_add_u32 v15, s42, v15
  s_mul_i32 s40, s4, 96
  s_add_u32 s42, s42, s40
  s_xor_b32 s4, s4, 64
  s_cmp_eq_u32 s42, 43008
  s_cselect_b32 s42, 0, s42
  ds_read_b128 v[136:139], v15 offset:0
  v_mfma_f32_16x16x32_bf16 v[168:171], v[48:51], v[120:123], 0
  s_add_u32 m0, s33, 0
  s_add_u32 s46, s36, 131072
  buffer_load_dwordx4 v24, s[16:19], s36 offen offset:0 lds
  ds_read_b64_tr_b16 v[80:81], v28 offset:8192
  v_mfma_f32_16x16x32_bf16 v[172:175], v[52:55], v[112:115], 0
  ds_read_b64_tr_b16 v[82:83], v28 offset:9216
  v_mfma_f32_16x16x32_bf16 v[176:179], v[52:55], v[116:119], 0
  buffer_load_dwordx4 v25, s[16:19], s36 offen offset:1024 lds
  ds_read_b128 v[140:143], v15 offset:2048
  v_mfma_f32_16x16x32_bf16 v[180:183], v[52:55], v[120:123], 0
  ds_read_b64_tr_b16 v[84:85], v29 offset:8192
  v_mfma_f32_16x16x32_bf16 v[184:187], v[56:59], v[112:115], 0
  buffer_load_dwordx4 v26, s[16:19], s36 offen offset:2048 lds
  ds_read_b64_tr_b16 v[86:87], v29 offset:9216
  v_mfma_f32_16x16x32_bf16 v[188:191], v[56:59], v[116:119], 0
  ds_read_b128 v[144:147], v15 offset:4096
  v_mfma_f32_16x16x32_bf16 v[192:195], v[56:59], v[120:123], 0
  buffer_load_dwordx4 v27, s[16:19], s36 offen offset:3072 lds
  ds_read_b64_tr_b16 v[88:89], v30 offset:8192
  v_mfma_f32_16x16x32_bf16 v[196:199], v[60:63], v[112:115], 0
  ds_read_b64_tr_b16 v[90:91], v30 offset:9216
  v_mfma_f32_16x16x32_bf16 v[200:203], v[60:63], v[116:119], 0
  s_add_u32 m0, s33, 4096
  s_nop 0
  buffer_load_dwordx4 v24, s[16:19], s46 offen offset:0 lds
  ds_read_b64_tr_b16 v[92:93], v31 offset:8192
  v_mfma_f32_16x16x32_bf16 v[204:207], v[60:63], v[120:123], 0
  ds_read_b64_tr_b16 v[94:95], v31 offset:9216
  v_mfma_f32_16x16x32_bf16 v[208:211], v[64:67], v[112:115], 0
  buffer_load_dwordx4 v25, s[16:19], s46 offen offset:1024 lds
  ds_read_b64_tr_b16 v[96:97], v32 offset:8192
  v_mfma_f32_16x16x32_bf16 v[212:215], v[64:67], v[116:119], 0
  ds_read_b64_tr_b16 v[98:99], v32 offset:9216
  v_mfma_f32_16x16x32_bf16 v[216:219], v[64:67], v[120:123], 0
  buffer_load_dwordx4 v26, s[16:19], s46 offen offset:2048 lds
  ds_read_b64_tr_b16 v[100:101], v33 offset:8192
  v_mfma_f32_16x16x32_bf16 v[220:223], v[68:71], v[112:115], 0
  ds_read_b64_tr_b16 v[102:103], v33 offset:9216
  v_mfma_f32_16x16x32_bf16 v[224:227], v[68:71], v[116:119], 0
  buffer_load_dwordx4 v27, s[16:19], s46 offen offset:3072 lds
  s_add_u32 s36, s36, 262144
  s_cmp_eq_u32 s36, 3670016
  s_cselect_b32 s36, 0, s36
  ds_read_b64_tr_b16 v[104:105], v34 offset:8192
  v_mfma_f32_16x16x32_bf16 v[228:231], v[68:71], v[120:123], 0
  ds_read_b64_tr_b16 v[106:107], v34 offset:9216
  v_mfma_f32_16x16x32_bf16 v[232:235], v[72:75], v[112:115], 0
  ds_read_b64_tr_b16 v[108:109], v35 offset:8192
  v_mfma_f32_16x16x32_bf16 v[236:239], v[72:75], v[116:119], 0
  ds_read_b64_tr_b16 v[110:111], v35 offset:9216
  v_mfma_f32_16x16x32_bf16 v[240:243], v[72:75], v[120:123], 0
  v_mfma_f32_16x16x32_bf16 v[244:247], v[76:79], v[112:115], 0
  v_mfma_f32_16x16x32_bf16 v[248:251], v[76:79], v[116:119], 0
  v_mfma_f32_16x16x32_bf16 v[252:255], v[76:79], v[120:123], 0
  s_waitcnt lgkmcnt(0)
  v_mfma_f32_16x16x32_bf16 v[160:163], v[80:83], v[136:139], v[160:163]
  s_add_u32 m0, s33, 8192
  s_add_u32 s46, s36, 131072
  buffer_load_dwordx4 v24, s[16:19], s36 offen offset:0 lds
  s_waitcnt vmcnt(9)
  v_mfma_f32_16x16x32_bf16 v[164:167], v[80:83], v[140:143], v[164:167]
  v_xor_b32 v15, s4, v41
  v_add_u32 v15, s42, v15
  s_mul_i32 s40, s4, 96
  s_add_u32 s42, s42, s40
  s_xor_b32 s4, s4, 64
  s_cmp_eq_u32 s42, 43008
  s_cselect_b32 s42, 0, s42
  ds_read_b128 v[112:115], v15 offset:0
  v_mfma_f32_16x16x32_bf16 v[168:171], v[80:83], v[144:147], v[168:171]
  buffer_load_dwordx4 v25, s[16:19], s36 offen offset:1024 lds
  ds_read_b64_tr_b16 v[48:49], v28 offset:16384
  v_mfma_f32_16x16x32_bf16 v[172:175], v[84:87], v[136:139], v[172:175]
  ds_read_b64_tr_b16 v[50:51], v28 offset:17408
  v_mfma_f32_16x16x32_bf16 v[176:179], v[84:87], v[140:143], v[176:179]
  buffer_load_dwordx4 v26, s[16:19], s36 offen offset:2048 lds
  ds_read_b128 v[116:119], v15 offset:2048
  v_mfma_f32_16x16x32_bf16 v[180:183], v[84:87], v[144:147], v[180:183]
  ds_read_b64_tr_b16 v[52:53], v29 offset:16384
  v_mfma_f32_16x16x32_bf16 v[184:187], v[88:91], v[136:139], v[184:187]
  buffer_load_dwordx4 v27, s[16:19], s36 offen offset:3072 lds
  ds_read_b64_tr_b16 v[54:55], v29 offset:17408
  v_mfma_f32_16x16x32_bf16 v[188:191], v[88:91], v[140:143], v[188:191]
  ds_read_b128 v[120:123], v15 offset:4096
  v_mfma_f32_16x16x32_bf16 v[192:195], v[88:91], v[144:147], v[192:195]
  s_add_u32 m0, s33, 12288
  s_nop 0
  buffer_load_dwordx4 v24, s[16:19], s46 offen offset:0 lds
  ds_read_b64_tr_b16 v[56:57], v30 offset:16384
  v_mfma_f32_16x16x32_bf16 v[196:199], v[92:95], v[136:139], v[196:199]
  ds_read_b64_tr_b16 v[58:59], v30 offset:17408
  v_mfma_f32_16x16x32_bf16 v[200:203], v[92:95], v[140:143], v[200:203]
  buffer_load_dwordx4 v25, s[16:19], s46 offen offset:1024 lds
  ds_read_b64_tr_b16 v[60:61], v31 offset:16384
  v_mfma_f32_16x16x32_bf16 v[204:207], v[92:95], v[144:147], v[204:207]
  ds_read_b64_tr_b16 v[62:63], v31 offset:17408
  v_mfma_f32_16x16x32_bf16 v[208:211], v[96:99], v[136:139], v[208:211]
  buffer_load_dwordx4 v26, s[16:19], s46 offen offset:2048 lds
  ds_read_b64_tr_b16 v[64:65], v32 offset:16384
  v_mfma_f32_16x16x32_bf16 v[212:215], v[96:99], v[140:143], v[212:215]
  ds_read_b64_tr_b16 v[66:67], v32 offset:17408
  v_mfma_f32_16x16x32_bf16 v[216:219], v[96:99], v[144:147], v[216:219]
  buffer_load_dwordx4 v27, s[16:19], s46 offen offset:3072 lds
  s_add_u32 s36, s36, 262144
  s_cmp_eq_u32 s36, 3670016
  s_cselect_b32 s36, 0, s36
  ds_read_b64_tr_b16 v[68:69], v33 offset:16384
  v_mfma_f32_16x16x32_bf16 v[220:223], v[100:103], v[136:139], v[220:223]
  ds_read_b64_tr_b16 v[70:71], v33 offset:17408
  v_mfma_f32_16x16x32_bf16 v[224:227], v[100:103], v[140:143], v[224:227]
  ds_read_b64_tr_b16 v[72:73], v34 offset:16384
  v_mfma_f32_16x16x32_bf16 v[228:231], v[100:103], v[144:147], v[228:231]
  ds_read_b64_tr_b16 v[74:75], v34 offset:17408
  v_mfma_f32_16x16x32_bf16 v[232:235], v[104:107], v[136:139], v[232:235]
  ds_read_b64_tr_b16 v[76:77], v35 offset:16384
  v_mfma_f32_16x16x32_bf16 v[236:239], v[104:107], v[140:143], v[236:239]
  ds_read_b64_tr_b16 v[78:79], v35 offset:17408
  v_mfma_f32_16x16x32_bf16 v[240:243], v[104:107], v[144:147], v[240:243]
  v_mfma_f32_16x16x32_bf16 v[244:247], v[108:111], v[136:139], v[244:247]
  v_mfma_f32_16x16x32_bf16 v[248:251], v[108:111], v[140:143], v[248:251]
  v_mfma_f32_16x16x32_bf16 v[252:255], v[108:111], v[144:147], v[252:255]
  s_waitcnt lgkmcnt(0)
  v_mfma_f32_16x16x32_bf16 v[160:163], v[48:51], v[112:115], v[160:163]
  s_add_u32 m0, s33, 16384
  s_add_u32 s46, s36, 131072
  buffer_load_dwordx4 v24, s[16:19], s36 offen offset:0 lds
  s_waitcnt vmcnt(9)
  v_mfma_f32_16x16x32_bf16 v[164:167], v[48:51], v[116:119], v[164:167]
  v_xor_b32 v15, s4, v41
  v_add_u32 v15, s42, v15
  s_mul_i32 s40, s4, 96
  s_add_u32 s42, s42, s40
  s_xor_b32 s4, s4, 64
  s_cmp_eq_u32 s42, 43008
  s_cselect_b32 s42, 0, s42
  ds_read_b128 v[136:139], v15 offset:0
  v_mfma_f32_16x16x32_bf16 v[168:171], v[48:51], v[120:123], v[168:171]
  buffer_load_dwordx4 v25, s[16:19], s36 offen offset:1024 lds
  ds_read_b64_tr_b16 v[80:81], v28 offset:0
  v_mfma_f32_16x16x32_bf16 v[172:175], v[52:55], v[112:115], v[172:175]
  ds_read_b64_tr_b16 v[82:83], v28 offset:1024
  v_mfma_f32_16x16x32_bf16 v[176:179], v[52:55], v[116:119], v[176:179]
  buffer_load_dwordx4 v26, s[16:19], s36 offen offset:2048 lds
  ds_read_b128 v[140:143], v15 offset:2048
  v_mfma_f32_16x16x32_bf16 v[180:183], v[52:55], v[120:123], v[180:183]
  ds_read_b64_tr_b16 v[84:85], v29 offset:0
  v_mfma_f32_16x16x32_bf16 v[184:187], v[56:59], v[112:115], v[184:187]
  buffer_load_dwordx4 v27, s[16:19], s36 offen offset:3072 lds
  ds_read_b64_tr_b16 v[86:87], v29 offset:1024
  v_mfma_f32_16x16x32_bf16 v[188:191], v[56:59], v[116:119], v[188:191]
  ds_read_b128 v[144:147], v15 offset:4096
  v_mfma_f32_16x16x32_bf16 v[192:195], v[56:59], v[120:123], v[192:195]
  s_add_u32 m0, s33, 20480
  s_nop 0
  buffer_load_dwordx4 v24, s[16:19], s46 offen offset:0 lds
  ds_read_b64_tr_b16 v[88:89], v30 offset:0
  v_mfma_f32_16x16x32_bf16 v[196:199], v[60:63], v[112:115], v[196:199]
  ds_read_b64_tr_b16 v[90:91], v30 offset:1024
  v_mfma_f32_16x16x32_bf16 v[200:203], v[60:63], v[116:119], v[200:203]
  buffer_load_dwordx4 v25, s[16:19], s46 offen offset:1024 lds
  ds_read_b64_tr_b16 v[92:93], v31 offset:0
  v_mfma_f32_16x16x32_bf16 v[204:207], v[60:63], v[120:123], v[204:207]
  ds_read_b64_tr_b16 v[94:95], v31 offset:1024
  v_mfma_f32_16x16x32_bf16 v[208:211], v[64:67], v[112:115], v[208:211]
  buffer_load_dwordx4 v26, s[16:19], s46 offen offset:2048 lds
  ds_read_b64_tr_b16 v[96:97], v32 offset:0
  v_mfma_f32_16x16x32_bf16 v[212:215], v[64:67], v[116:119], v[212:215]
  ds_read_b64_tr_b16 v[98:99], v32 offset:1024
  v_mfma_f32_16x16x32_bf16 v[216:219], v[64:67], v[120:123], v[216:219]
  buffer_load_dwordx4 v27, s[16:19], s46 offen offset:3072 lds
  s_add_u32 s36, s36, 262144
  s_cmp_eq_u32 s36, 3670016
  s_cselect_b32 s36, 0, s36
  ds_read_b64_tr_b16 v[100:101], v33 offset:0
  v_mfma_f32_16x16x32_bf16 v[220:223], v[68:71], v[112:115], v[220:223]
  ds_read_b64_tr_b16 v[102:103], v33 offset:1024
  v_mfma_f32_16x16x32_bf16 v[224:227], v[68:71], v[116:119], v[224:227]
  ds_read_b64_tr_b16 v[104:105], v34 offset:0
  v_mfma_f32_16x16x32_bf16 v[228:231], v[68:71], v[120:123], v[228:231]
  ds_read_b64_tr_b16 v[106:107], v34 offset:1024
  v_mfma_f32_16x16x32_bf16 v[232:235], v[72:75], v[112:115], v[232:235]
  ds_read_b64_tr_b16 v[108:109], v35 offset:0
  v_mfma_f32_16x16x32_bf16 v[236:239], v[72:75], v[116:119], v[236:239]
  ds_read_b64_tr_b16 v[110:111], v35 offset:1024
  v_mfma_f32_16x16x32_bf16 v[240:243], v[72:75], v[120:123], v[240:243]
  v_mfma_f32_16x16x32_bf16 v[244:247], v[76:79], v[112:115], v[244:247]
  v_mfma_f32_16x16x32_bf16 v[248:251], v[76:79], v[116:119], v[248:251]
  v_mfma_f32_16x16x32_bf16 v[252:255], v[76:79], v[120:123], v[252:255]
  s_waitcnt lgkmcnt(0)
  v_mfma_f32_16x16x32_bf16 v[160:163], v[80:83], v[136:139], v[160:163]
  s_add_u32 m0, s33, 0
  s_add_u32 s46, s36, 131072
  buffer_load_dwordx4 v24, s[16:19], s36 offen offset:0 lds
  s_waitcnt vmcnt(9)
  v_mfma_f32_16x16x32_bf16 v[164:167], v[80:83], v[140:143], v[164:167]
  v_xor_b32 v15, s4, v41
  v_add_u32 v15, s42, v15
  s_mul_i32 s40, s4, 96
  s_add_u32 s42, s42, s40
  s_xor_b32 s4, s4, 64
  s_cmp_eq_u32 s42, 43008
  s_cselect_b32 s42, 0, s42
  ds_read_b128 v[112:115], v15 offset:0
  v_mfma_f32_16x16x32_bf16 v[168:171], v[80:83], v[144:147], v[168:171]
  buffer_load_dwordx4 v25, s[16:19], s36 offen offset:1024 lds
  ds_read_b64_tr_b16 v[48:49], v28 offset:8192
  v_mfma_f32_16x16x32_bf16 v[172:175], v[84:87], v[136:139], v[172:175]
  ds_read_b64_tr_b16 v[50:51], v28 offset:9216
  v_mfma_f32_16x16x32_bf16 v[176:179], v[84:87], v[140:143], v[176:179]
  buffer_load_dwordx4 v26, s[16:19], s36 offen offset:2048 lds
  ds_read_b128 v[116:119], v15 offset:2048
  v_mfma_f32_16x16x32_bf16 v[180:183], v[84:87], v[144:147], v[180:183]
  ds_read_b64_tr_b16 v[52:53], v29 offset:8192
  v_mfma_f32_16x16x32_bf16 v[184:187], v[88:91], v[136:139], v[184:187]
  buffer_load_dwordx4 v27, s[16:19], s36 offen offset:3072 lds
  ds_read_b64_tr_b16 v[54:55], v29 offset:9216
  v_mfma_f32_16x16x32_bf16 v[188:191], v[88:91], v[140:143], v[188:191]
  ds_read_b128 v[120:123], v15 offset:4096
  v_mfma_f32_16x16x32_bf16 v[192:195], v[88:91], v[144:147], v[192:195]
  s_add_u32 m0, s33, 4096
  s_nop 0
  buffer_load_dwordx4 v24, s[16:19], s46 offen offset:0 lds
  ds_read_b64_tr_b16 v[56:57], v30 offset:8192
  v_mfma_f32_16x16x32_bf16 v[196:199], v[92:95], v[136:139], v[196:199]
  ds_read_b64_tr_b16 v[58:59], v30 offset:9216
  v_mfma_f32_16x16x32_bf16 v[200:203], v[92:95], v[140:143], v[200:203]
  buffer_load_dwordx4 v25, s[16:19], s46 offen offset:1024 lds
  ds_read_b64_tr_b16 v[60:61], v31 offset:8192
  v_mfma_f32_16x16x32_bf16 v[204:207], v[92:95], v[144:147], v[204:207]
  ds_read_b64_tr_b16 v[62:63], v31 offset:9216
  v_mfma_f32_16x16x32_bf16 v[208:211], v[96:99], v[136:139], v[208:211]
  buffer_load_dwordx4 v26, s[16:19], s46 offen offset:2048 lds
  ds_read_b64_tr_b16 v[64:65], v32 offset:8192
  v_mfma_f32_16x16x32_bf16 v[212:215], v[96:99], v[140:143], v[212:215]
  ds_read_b64_tr_b16 v[66:67], v32 offset:9216
  v_mfma_f32_16x16x32_bf16 v[216:219], v[96:99], v[144:147], v[216:219]
  buffer_load_dwordx4 v27, s[16:19], s46 offen offset:3072 lds
  s_add_u32 s36, s36, 262144
  s_cmp_eq_u32 s36, 3670016
  s_cselect_b32 s36, 0, s36
  ds_read_b64_tr_b16 v[68:69], v33 offset:8192
  v_mfma_f32_16x16x32_bf16 v[220:223], v[100:103], v[136:139], v[220:223]
  ds_read_b64_tr_b16 v[70:71], v33 offset:9216
  v_mfma_f32_16x16x32_bf16 v[224:227], v[100:103], v[140:143], v[224:227]
  ds_read_b64_tr_b16 v[72:73], v34 offset:8192
  v_mfma_f32_16x16x32_bf16 v[228:231], v[100:103], v[144:147], v[228:231]
  ds_read_b64_tr_b16 v[74:75], v34 offset:9216
  v_mfma_f32_16x16x32_bf16 v[232:235], v[104:107], v[136:139], v[232:235]
  ds_read_b64_tr_b16 v[76:77], v35 offset:8192
  v_mfma_f32_16x16x32_bf16 v[236:239], v[104:107], v[140:143], v[236:239]
  ds_read_b64_tr_b16 v[78:79], v35 offset:9216
  v_mfma_f32_16x16x32_bf16 v[240:243], v[104:107], v[144:147], v[240:243]
  v_mfma_f32_16x16x32_bf16 v[244:247], v[108:111], v[136:139], v[244:247]
  v_mfma_f32_16x16x32_bf16 v[248:251], v[108:111], v[140:143], v[248:251]
  v_mfma_f32_16x16x32_bf16 v[252:255], v[108:111], v[144:147], v[252:255]
  s_waitcnt lgkmcnt(0)
  v_mfma_f32_16x16x32_bf16 v[160:163], v[48:51], v[112:115], v[160:163]
  s_add_u32 m0, s33, 8192
  s_add_u32 s46, s36, 131072
  buffer_load_dwordx4 v24, s[16:19], s36 offen offset:0 lds
  s_waitcnt vmcnt(9)
  v_mfma_f32_16x16x32_bf16 v[164:167], v[48:51], v[116:119], v[164:167]
  v_xor_b32 v15, s4, v41
  v_add_u32 v15, s42, v15
  s_mul_i32 s40, s4, 96
  s_add_u32 s42, s42, s40
  s_xor_b32 s4, s4, 64
  s_cmp_eq_u32 s42, 43008
  s_cselect_b32 s42, 0, s42
  ds_read_b128 v[136:139], v15 offset:0
  v_mfma_f32_16x16x32_bf16 v[168:171], v[48:51], v[120:123], v[168:171]
  buffer_load_dwordx4 v25, s[16:19], s36 offen offset:1024 lds
  ds_read_b64_tr_b16 v[80:81], v28 offset:16384
  v_mfma_f32_16x16x32_bf16 v[172:175], v[52:55], v[112:115], v[172:175]
  ds_read_b64_tr_b16 v[82:83], v28 offset:17408
  v_mfma_f32_16x16x32_bf16 v[176:179], v[52:55], v[116:119], v[176:179]
  buffer_load_dwordx4 v26, s[16:19], s36 offen offset:2048 lds
  ds_read_b128 v[140:143], v15 offset:2048
  v_mfma_f32_16x16x32_bf16 v[180:183], v[52:55], v[120:123], v[180:183]
  ds_read_b64_tr_b16 v[84:85], v29 offset:16384
  v_mfma_f32_16x16x32_bf16 v[184:187], v[56:59], v[112:115], v[184:187]
  buffer_load_dwordx4 v27, s[16:19], s36 offen offset:3072 lds
  ds_read_b64_tr_b16 v[86:87], v29 offset:17408
  v_mfma_f32_16x16x32_bf16 v[188:191], v[56:59], v[116:119], v[188:191]
  ds_read_b128 v[144:147], v15 offset:4096
  v_mfma_f32_16x16x32_bf16 v[192:195], v[56:59], v[120:123], v[192:195]
  s_add_u32 m0, s33, 12288
  s_nop 0
  buffer_load_dwordx4 v24, s[16:19], s46 offen offset:0 lds
  ds_read_b64_tr_b16 v[88:89], v30 offset:16384
  v_mfma_f32_16x16x32_bf16 v[196:199], v[60:63], v[112:115], v[196:199]
  ds_read_b64_tr_b16 v[90:91], v30 offset:17408
  v_mfma_f32_16x16x32_bf16 v[200:203], v[60:63], v[116:119], v[200:203]
  buffer_load_dwordx4 v25, s[16:19], s46 offen offset:1024 lds
  ds_read_b64_tr_b16 v[92:93], v31 offset:16384
  v_mfma_f32_16x16x32_bf16 v[204:207], v[60:63], v[120:123], v[204:207]
  ds_read_b64_tr_b16 v[94:95], v31 offset:17408
  v_mfma_f32_16x16x32_bf16 v[208:211], v[64:67], v[112:115], v[208:211]
  buffer_load_dwordx4 v26, s[16:19], s46 offen offset:2048 lds
  ds_read_b64_tr_b16 v[96:97], v32 offset:16384
  v_mfma_f32_16x16x32_bf16 v[212:215], v[64:67], v[116:119], v[212:215]
  ds_read_b64_tr_b16 v[98:99], v32 offset:17408
  v_mfma_f32_16x16x32_bf16 v[216:219], v[64:67], v[120:123], v[216:219]
  buffer_load_dwordx4 v27, s[16:19], s46 offen offset:3072 lds
  s_add_u32 s36, s36, 262144
  s_cmp_eq_u32 s36, 3670016
  s_cselect_b32 s36, 0, s36
  ds_read_b64_tr_b16 v[100:101], v33 offset:16384
  v_mfma_f32_16x16x32_bf16 v[220:223], v[68:71], v[112:115], v[220:223]
  ds_read_b64_tr_b16 v[102:103], v33 offset:17408
  v_mfma_f32_16x16x32_bf16 v[224:227], v[68:71], v[116:119], v[224:227]
  ds_read_b64_tr_b16 v[104:105], v34 offset:16384
  v_mfma_f32_16x16x32_bf16 v[228:231], v[68:71], v[120:123], v[228:231]
  ds_read_b64_tr_b16 v[106:107], v34 offset:17408
  v_mfma_f32_16x16x32_bf16 v[232:235], v[72:75], v[112:115], v[232:235]
  ds_read_b64_tr_b16 v[108:109], v35 offset:16384
  v_mfma_f32_16x16x32_bf16 v[236:239], v[72:75], v[116:119], v[236:239]
  ds_read_b64_tr_b16 v[110:111], v35 offset:17408
  v_mfma_f32_16x16x32_bf16 v[240:243], v[72:75], v[120:123], v[240:243]
  v_mfma_f32_16x16x32_bf16 v[244:247], v[76:79], v[112:115], v[244:247]
  v_mfma_f32_16x16x32_bf16 v[248:251], v[76:79], v[116:119], v[248:251]
  v_mfma_f32_16x16x32_bf16 v[252:255], v[76:79], v[120:123], v[252:255]
  s_waitcnt lgkmcnt(0)
  v_mfma_f32_16x16x32_bf16 v[160:163], v[80:83], v[136:139], v[160:163]
  s_add_u32 m0, s33, 16384
  s_add_u32 s46, s36, 131072
  buffer_load_dwordx4 v24, s[16:19], s36 offen offset:0 lds
  s_waitcnt vmcnt(9)
  v_mfma_f32_16x16x32_bf16 v[164:167], v[80:83], v[140:143], v[164:167]
  v_xor_b32 v15, s4, v41
  v_add_u32 v15, s42, v15
  s_mul_i32 s40, s4, 96
  s_add_u32 s42, s42, s40
  s_xor_b32 s4, s4, 64
  s_cmp_eq_u32 s42, 43008
  s_cselect_b32 s42, 0, s42
  ds_read_b128 v[112:115], v15 offset:0
  v_mfma_f32_16x16x32_bf16 v[168:171], v[80:83], v[144:147], v[168:171]
  buffer_load_dwordx4 v25, s[16:19], s36 offen offset:1024 lds
  ds_read_b64_tr_b16 v[48:49], v28 offset:0
  v_mfma_f32_16x16x32_bf16 v[172:175], v[84:87], v[136:139], v[172:175]
  ds_read_b64_tr_b16 v[50:51], v28 offset:1024
  v_mfma_f32_16x16x32_bf16 v[176:179], v[84:87], v[140:143], v[176:179]
  buffer_load_dwordx4 v26, s[16:19], s36 offen offset:2048 lds
  ds_read_b128 v[116:119], v15 offset:2048
  v_mfma_f32_16x16x32_bf16 v[180:183], v[84:87], v[144:147], v[180:183]
  ds_read_b64_tr_b16 v[52:53], v29 offset:0
  v_mfma_f32_16x16x32_bf16 v[184:187], v[88:91], v[136:139], v[184:187]
  buffer_load_dwordx4 v27, s[16:19], s36 offen offset:3072 lds
  ds_read_b64_tr_b16 v[54:55], v29 offset:1024
  v_mfma_f32_16x16x32_bf16 v[188:191], v[88:91], v[140:143], v[188:191]
  ds_read_b128 v[120:123], v15 offset:4096
  v_mfma_f32_16x16x32_bf16 v[192:195], v[88:91], v[144:147], v[192:195]
  s_add_u32 m0, s33, 20480
  s_nop 0
  buffer_load_dwordx4 v24, s[16:19], s46 offen offset:0 lds
  ds_read_b64_tr_b16 v[56:57], v30 offset:0
  v_mfma_f32_16x16x32_bf16 v[196:199], v[92:95], v[136:139], v[196:199]
  ds_read_b64_tr_b16 v[58:59], v30 offset:1024
  v_mfma_f32_16x16x32_bf16 v[200:203], v[92:95], v[140:143], v[200:203]
  buffer_load_dwordx4 v25, s[16:19], s46 offen offset:1024 lds
  ds_read_b64_tr_b16 v[60:61], v31 offset:0
  v_mfma_f32_16x16x32_bf16 v[204:207], v[92:95], v[144:147], v[204:207]
  ds_read_b64_tr_b16 v[62:63], v31 offset:1024
  v_mfma_f32_16x16x32_bf16 v[208:211], v[96:99], v[136:139], v[208:211]
  buffer_load_dwordx4 v26, s[16:19], s46 offen offset:2048 lds
  ds_read_b64_tr_b16 v[64:65], v32 offset:0
  v_mfma_f32_16x16x32_bf16 v[212:215], v[96:99], v[140:143], v[212:215]
  ds_read_b64_tr_b16 v[66:67], v32 offset:1024
  v_mfma_f32_16x16x32_bf16 v[216:219], v[96:99], v[144:147], v[216:219]
  buffer_load_dwordx4 v27, s[16:19], s46 offen offset:3072 lds
  s_add_u32 s36, s36, 262144
  s_cmp_eq_u32 s36, 3670016
  s_cselect_b32 s36, 0, s36
  ds_read_b64_tr_b16 v[68:69], v33 offset:0
  v_mfma_f32_16x16x32_bf16 v[220:223], v[100:103], v[136:139], v[220:223]
  ds_read_b64_tr_b16 v[70:71], v33 offset:1024
  v_mfma_f32_16x16x32_bf16 v[224:227], v[100:103], v[140:143], v[224:227]
  ds_read_b64_tr_b16 v[72:73], v34 offset:0
  v_mfma_f32_16x16x32_bf16 v[228:231], v[100:103], v[144:147], v[228:231]
  ds_read_b64_tr_b16 v[74:75], v34 offset:1024
  v_mfma_f32_16x16x32_bf16 v[232:235], v[104:107], v[136:139], v[232:235]
  ds_read_b64_tr_b16 v[76:77], v35 offset:0
  v_mfma_f32_16x16x32_bf16 v[236:239], v[104:107], v[140:143], v[236:239]
  ds_read_b64_tr_b16 v[78:79], v35 offset:1024
  v_mfma_f32_16x16x32_bf16 v[240:243], v[104:107], v[144:147], v[240:243]
  v_mfma_f32_16x16x32_bf16 v[244:247], v[108:111], v[136:139], v[244:247]
  v_mfma_f32_16x16x32_bf16 v[248:251], v[108:111], v[140:143], v[248:251]
  v_mfma_f32_16x16x32_bf16 v[252:255], v[108:111], v[144:147], v[252:255]
  s_waitcnt lgkmcnt(0)
  v_mfma_f32_16x16x32_bf16 v[160:163], v[48:51], v[112:115], v[160:163]
  s_add_u32 m0, s33, 0
  s_add_u32 s46, s36, 131072
  buffer_load_dwordx4 v24, s[16:19], s36 offen offset:0 lds
  s_waitcnt vmcnt(9)
  v_mfma_f32_16x16x32_bf16 v[164:167], v[48:51], v[116:119], v[164:167]
  v_xor_b32 v15, s4, v41
  v_add_u32 v15, s42, v15
  s_mul_i32 s40, s4, 96
  s_add_u32 s42, s42, s40
  s_xor_b32 s4, s4, 64
  s_cmp_eq_u32 s42, 43008
  s_cselect_b32 s42, 0, s42
  ds_read_b128 v[136:139], v15 offset:0
  v_mfma_f32_16x16x32_bf16 v[168:171], v[48:51], v[120:123], v[168:171]
  buffer_load_dwordx4 v25, s[16:19], s36 offen offset:1024 lds
  ds_read_b64_tr_b16 v[80:81], v28 offset:8192
  v_mfma_f32_16x16x32_bf16 v[172:175], v[52:55], v[112:115], v[172:175]
  ds_read_b64_tr_b16 v[82:83], v28 offset:9216
  v_mfma_f32_16x16x32_bf16 v[176:179], v[52:55], v[116:119], v[176:179]
  buffer_load_dwordx4 v26, s[16:19], s36 offen offset:2048 lds
  ds_read_b128 v[140:143], v15 offset:2048
  v_mfma_f32_16x16x32_bf16 v[180:183], v[52:55], v[120:123], v[180:183]
  ds_read_b64_tr_b16 v[84:85], v29 offset:8192
  v_mfma_f32_16x16x32_bf16 v[184:187], v[56:59], v[112:115], v[184:187]
  buffer_load_dwordx4 v27, s[16:19], s36 offen offset:3072 lds
  ds_read_b64_tr_b16 v[86:87], v29 offset:9216
  v_mfma_f32_16x16x32_bf16 v[188:191], v[56:59], v[116:119], v[188:191]
  ds_read_b128 v[144:147], v15 offset:4096
  v_mfma_f32_16x16x32_bf16 v[192:195], v[56:59], v[120:123], v[192:195]
  s_add_u32 m0, s33, 4096
  s_nop 0
  buffer_load_dwordx4 v24, s[16:19], s46 offen offset:0 lds
  ds_read_b64_tr_b16 v[88:89], v30 offset:8192
  v_mfma_f32_16x16x32_bf16 v[196:199], v[60:63], v[112:115], v[196:199]
  ds_read_b64_tr_b16 v[90:91], v30 offset:9216
  v_mfma_f32_16x16x32_bf16 v[200:203], v[60:63], v[116:119], v[200:203]
  buffer_load_dwordx4 v25, s[16:19], s46 offen offset:1024 lds
  ds_read_b64_tr_b16 v[92:93], v31 offset:8192
  v_mfma_f32_16x16x32_bf16 v[204:207], v[60:63], v[120:123], v[204:207]
  ds_read_b64_tr_b16 v[94:95], v31 offset:9216
  v_mfma_f32_16x16x32_bf16 v[208:211], v[64:67], v[112:115], v[208:211]
  buffer_load_dwordx4 v26, s[16:19], s46 offen offset:2048 lds
  ds_read_b64_tr_b16 v[96:97], v32 offset:8192
  v_mfma_f32_16x16x32_bf16 v[212:215], v[64:67], v[116:119], v[212:215]
  ds_read_b64_tr_b16 v[98:99], v32 offset:9216
  v_mfma_f32_16x16x32_bf16 v[216:219], v[64:67], v[120:123], v[216:219]
  buffer_load_dwordx4 v27, s[16:19], s46 offen offset:3072 lds
  s_add_u32 s36, s36, 262144
  s_cmp_eq_u32 s36, 3670016
  s_cselect_b32 s36, 0, s36
  ds_read_b64_tr_b16 v[100:101], v33 offset:8192
  v_mfma_f32_16x16x32_bf16 v[220:223], v[68:71], v[112:115], v[220:223]
  ds_read_b64_tr_b16 v[102:103], v33 offset:9216
  v_mfma_f32_16x16x32_bf16 v[224:227], v[68:71], v[116:119], v[224:227]
  ds_read_b64_tr_b16 v[104:105], v34 offset:8192
  v_mfma_f32_16x16x32_bf16 v[228:231], v[68:71], v[120:123], v[228:231]
  ds_read_b64_tr_b16 v[106:107], v34 offset:9216
  v_mfma_f32_16x16x32_bf16 v[232:235], v[72:75], v[112:115], v[232:235]
  ds_read_b64_tr_b16 v[108:109], v35 offset:8192
  v_mfma_f32_16x16x32_bf16 v[236:239], v[72:75], v[116:119], v[236:239]
  ds_read_b64_tr_b16 v[110:111], v35 offset:9216
  v_mfma_f32_16x16x32_bf16 v[240:243], v[72:75], v[120:123], v[240:243]
  v_mfma_f32_16x16x32_bf16 v[244:247], v[76:79], v[112:115], v[244:247]
  v_mfma_f32_16x16x32_bf16 v[248:251], v[76:79], v[116:119], v[248:251]
  v_mfma_f32_16x16x32_bf16 v[252:255], v[76:79], v[120:123], v[252:255]
  s_waitcnt lgkmcnt(0)
  v_mfma_f32_16x16x32_bf16 v[160:163], v[80:83], v[136:139], v[160:163]
  s_add_u32 m0, s33, 8192
  s_add_u32 s46, s36, 131072
  buffer_load_dwordx4 v24, s[16:19], s36 offen offset:0 lds
  s_waitcnt vmcnt(9)
  v_mfma_f32_16x16x32_bf16 v[164:167], v[80:83], v[140:143], v[164:167]
  v_xor_b32 v15, s4, v41
  v_add_u32 v15, s42, v15
  s_mul_i32 s40, s4, 96
  s_add_u32 s42, s42, s40
  s_xor_b32 s4, s4, 64
  s_cmp_eq_u32 s42, 43008
  s_cselect_b32 s42, 0, s42
  ds_read_b128 v[112:115], v15 offset:0
  v_mfma_f32_16x16x32_bf16 v[168:171], v[80:83], v[144:147], v[168:171]
  buffer_load_dwordx4 v25, s[16:19], s36 offen offset:1024 lds
  ds_read_b64_tr_b16 v[48:49], v28 offset:16384
  v_mfma_f32_16x16x32_bf16 v[172:175], v[84:87], v[136:139], v[172:175]
  ds_read_b64_tr_b16 v[50:51], v28 offset:17408
  v_mfma_f32_16x16x32_bf16 v[176:179], v[84:87], v[140:143], v[176:179]
  buffer_load_dwordx4 v26, s[16:19], s36 offen offset:2048 lds
  ds_read_b128 v[116:119], v15 offset:2048
  v_mfma_f32_16x16x32_bf16 v[180:183], v[84:87], v[144:147], v[180:183]
  ds_read_b64_tr_b16 v[52:53], v29 offset:16384
  v_mfma_f32_16x16x32_bf16 v[184:187], v[88:91], v[136:139], v[184:187]
  buffer_load_dwordx4 v27, s[16:19], s36 offen offset:3072 lds
  ds_read_b64_tr_b16 v[54:55], v29 offset:17408
  v_mfma_f32_16x16x32_bf16 v[188:191], v[88:91], v[140:143], v[188:191]
  ds_read_b128 v[120:123], v15 offset:4096
  v_mfma_f32_16x16x32_bf16 v[192:195], v[88:91], v[144:147], v[192:195]
  s_add_u32 m0, s33, 12288
  s_nop 0
  buffer_load_dwordx4 v24, s[16:19], s46 offen offset:0 lds
  ds_read_b64_tr_b16 v[56:57], v30 offset:16384
  v_mfma_f32_16x16x32_bf16 v[196:199], v[92:95], v[136:139], v[196:199]
  ds_read_b64_tr_b16 v[58:59], v30 offset:17408
  v_mfma_f32_16x16x32_bf16 v[200:203], v[92:95], v[140:143], v[200:203]
  buffer_load_dwordx4 v25, s[16:19], s46 offen offset:1024 lds
  ds_read_b64_tr_b16 v[60:61], v31 offset:16384
  v_mfma_f32_16x16x32_bf16 v[204:207], v[92:95], v[144:147], v[204:207]
  ds_read_b64_tr_b16 v[62:63], v31 offset:17408
  v_mfma_f32_16x16x32_bf16 v[208:211], v[96:99], v[136:139], v[208:211]
  buffer_load_dwordx4 v26, s[16:19], s46 offen offset:2048 lds
  ds_read_b64_tr_b16 v[64:65], v32 offset:16384
  v_mfma_f32_16x16x32_bf16 v[212:215], v[96:99], v[140:143], v[212:215]
  ds_read_b64_tr_b16 v[66:67], v32 offset:17408
  v_mfma_f32_16x16x32_bf16 v[216:219], v[96:99], v[144:147], v[216:219]
  buffer_load_dwordx4 v27, s[16:19], s46 offen offset:3072 lds
  s_add_u32 s36, s36, 262144
  s_cmp_eq_u32 s36, 3670016
  s_cselect_b32 s36, 0, s36
  ds_read_b64_tr_b16 v[68:69], v33 offset:16384
  v_mfma_f32_16x16x32_bf16 v[220:223], v[100:103], v[136:139], v[220:223]
  ds_read_b64_tr_b16 v[70:71], v33 offset:17408
  v_mfma_f32_16x16x32_bf16 v[224:227], v[100:103], v[140:143], v[224:227]
  ds_read_b64_tr_b16 v[72:73], v34 offset:16384
  v_mfma_f32_16x16x32_bf16 v[228:231], v[100:103], v[144:147], v[228:231]
  ds_read_b64_tr_b16 v[74:75], v34 offset:17408
  v_mfma_f32_16x16x32_bf16 v[232:235], v[104:107], v[136:139], v[232:235]
  ds_read_b64_tr_b16 v[76:77], v35 offset:16384
  v_mfma_f32_16x16x32_bf16 v[236:239], v[104:107], v[140:143], v[236:239]
  ds_read_b64_tr_b16 v[78:79], v35 offset:17408
  v_mfma_f32_16x16x32_bf16 v[240:243], v[104:107], v[144:147], v[240:243]
  v_mfma_f32_16x16x32_bf16 v[244:247], v[108:111], v[136:139], v[244:247]
  v_mfma_f32_16x16x32_bf16 v[248:251], v[108:111], v[140:143], v[248:251]
  v_mfma_f32_16x16x32_bf16 v[252:255], v[108:111], v[144:147], v[252:255]
  s_waitcnt lgkmcnt(0)
  v_mfma_f32_16x16x32_bf16 v[160:163], v[48:51], v[112:115], v[160:163]
  s_add_u32 m0, s33, 16384
  s_add_u32 s46, s36, 131072
  buffer_load_dwordx4 v24, s[16:19], s36 offen offset:0 lds
  s_waitcnt vmcnt(9)
  v_mfma_f32_16x16x32_bf16 v[164:167], v[48:51], v[116:119], v[164:167]
  v_xor_b32 v15, s4, v41
  v_add_u32 v15, s42, v15
  s_mul_i32 s40, s4, 96
  s_add_u32 s42, s42, s40
  s_xor_b32 s4, s4, 64
  s_cmp_eq_u32 s42, 43008
  s_cselect_b32 s42, 0, s42
  ds_read_b128 v[136:139], v15 offset:0
  v_mfma_f32_16x16x32_bf16 v[168:171], v[48:51], v[120:123], v[168:171]
  buffer_load_dwordx4 v25, s[16:19], s36 offen offset:1024 lds
  ds_read_b64_tr_b16 v[80:81], v28 offset:0
  v_mfma_f32_16x16x32_bf16 v[172:175], v[52:55], v[112:115], v[172:175]
  ds_read_b64_tr_b16 v[82:83], v28 offset:1024
  v_mfma_f32_16x16x32_bf16 v[176:179], v[52:55], v[116:119], v[176:179]
  buffer_load_dwordx4 v26, s[16:19], s36 offen offset:2048 lds
  ds_read_b128 v[140:143], v15 offset:2048
  v_mfma_f32_16x16x32_bf16 v[180:183], v[52:55], v[120:123], v[180:183]
  ds_read_b64_tr_b16 v[84:85], v29 offset:0
  v_mfma_f32_16x16x32_bf16 v[184:187], v[56:59], v[112:115], v[184:187]
  buffer_load_dwordx4 v27, s[16:19], s36 offen offset:3072 lds
  ds_read_b64_tr_b16 v[86:87], v29 offset:1024
  v_mfma_f32_16x16x32_bf16 v[188:191], v[56:59], v[116:119], v[188:191]
  ds_read_b128 v[144:147], v15 offset:4096
  v_mfma_f32_16x16x32_bf16 v[192:195], v[56:59], v[120:123], v[192:195]
  s_add_u32 m0, s33, 20480
  s_nop 0
  buffer_load_dwordx4 v24, s[16:19], s46 offen offset:0 lds
  ds_read_b64_tr_b16 v[88:89], v30 offset:0
  v_mfma_f32_16x16x32_bf16 v[196:199], v[60:63], v[112:115], v[196:199]
  ds_read_b64_tr_b16 v[90:91], v30 offset:1024
  v_mfma_f32_16x16x32_bf16 v[200:203], v[60:63], v[116:119], v[200:203]
  buffer_load_dwordx4 v25, s[16:19], s46 offen offset:1024 lds
  ds_read_b64_tr_b16 v[92:93], v31 offset:0
  v_mfma_f32_16x16x32_bf16 v[204:207], v[60:63], v[120:123], v[204:207]
  ds_read_b64_tr_b16 v[94:95], v31 offset:1024
  v_mfma_f32_16x16x32_bf16 v[208:211], v[64:67], v[112:115], v[208:211]
  buffer_load_dwordx4 v26, s[16:19], s46 offen offset:2048 lds
  ds_read_b64_tr_b16 v[96:97], v32 offset:0
  v_mfma_f32_16x16x32_bf16 v[212:215], v[64:67], v[116:119], v[212:215]
  ds_read_b64_tr_b16 v[98:99], v32 offset:1024
  v_mfma_f32_16x16x32_bf16 v[216:219], v[64:67], v[120:123], v[216:219]
  buffer_load_dwordx4 v27, s[16:19], s46 offen offset:3072 lds
  s_add_u32 s36, s36, 262144
  s_cmp_eq_u32 s36, 3670016
  s_cselect_b32 s36, 0, s36
  ds_read_b64_tr_b16 v[100:101], v33 offset:0
  v_mfma_f32_16x16x32_bf16 v[220:223], v[68:71], v[112:115], v[220:223]
  ds_read_b64_tr_b16 v[102:103], v33 offset:1024
  v_mfma_f32_16x16x32_bf16 v[224:227], v[68:71], v[116:119], v[224:227]
  ds_read_b64_tr_b16 v[104:105], v34 offset:0
  v_mfma_f32_16x16x32_bf16 v[228:231], v[68:71], v[120:123], v[228:231]
  ds_read_b64_tr_b16 v[106:107], v34 offset:1024
  v_mfma_f32_16x16x32_bf16 v[232:235], v[72:75], v[112:115], v[232:235]
  ds_read_b64_tr_b16 v[108:109], v35 offset:0
  v_mfma_f32_16x16x32_bf16 v[236:239], v[72:75], v[116:119], v[236:239]
  ds_read_b64_tr_b16 v[110:111], v35 offset:1024
  v_mfma_f32_16x16x32_bf16 v[240:243], v[72:75], v[120:123], v[240:243]
  v_mfma_f32_16x16x32_bf16 v[244:247], v[76:79], v[112:115], v[244:247]
  v_mfma_f32_16x16x32_bf16 v[248:251], v[76:79], v[116:119], v[248:251]
  v_mfma_f32_16x16x32_bf16 v[252:255], v[76:79], v[120:123], v[252:255]
  s_waitcnt lgkmcnt(0)
  v_mfma_f32_16x16x32_bf16 v[160:163], v[80:83], v[136:139], v[160:163]
  s_add_u32 m0, s33, 0
  s_add_u32 s46, s36, 131072
  buffer_load_dwordx4 v24, s[16:19], s36 offen offset:0 lds
  s_waitcnt vmcnt(9)
  v_mfma_f32_16x16x32_bf16 v[164:167], v[80:83], v[140:143], v[164:167]
  v_xor_b32 v15, s4, v41
  v_add_u32 v15, s42, v15
  s_mul_i32 s40, s4, 96
  s_add_u32 s42, s42, s40
  s_xor_b32 s4, s4, 64
  s_cmp_eq_u32 s42, 43008
  s_cselect_b32 s42, 0, s42
  ds_read_b128 v[112:115], v15 offset:0
  v_mfma_f32_16x16x32_bf16 v[168:171], v[80:83], v[144:147], v[168:171]
  buffer_load_dwordx4 v25, s[16:19], s36 offen offset:1024 lds
  ds_read_b64_tr_b16 v[48:49], v28 offset:8192
  v_mfma_f32_16x16x32_bf16 v[172:175], v[84:87], v[136:139], v[172:175]
  ds_read_b64_tr_b16 v[50:51], v28 offset:9216
  v_mfma_f32_16x16x32_bf16 v[176:179], v[84:87], v[140:143], v[176:179]
  buffer_load_dwordx4 v26, s[16:19], s36 offen offset:2048 lds
  ds_read_b128 v[116:119], v15 offset:2048
  v_mfma_f32_16x16x32_bf16 v[180:183], v[84:87], v[144:147], v[180:183]
  ds_read_b64_tr_b16 v[52:53], v29 offset:8192
  v_mfma_f32_16x16x32_bf16 v[184:187], v[88:91], v[136:139], v[184:187]
  buffer_load_dwordx4 v27, s[16:19], s36 offen offset:3072 lds
  ds_read_b64_tr_b16 v[54:55], v29 offset:9216
  v_mfma_f32_16x16x32_bf16 v[188:191], v[88:91], v[140:143], v[188:191]
  ds_read_b128 v[120:123], v15 offset:4096
  v_mfma_f32_16x16x32_bf16 v[192:195], v[88:91], v[144:147], v[192:195]
  s_add_u32 m0, s33, 4096
  s_nop 0
  buffer_load_dwordx4 v24, s[16:19], s46 offen offset:0 lds
  ds_read_b64_tr_b16 v[56:57], v30 offset:8192
  v_mfma_f32_16x16x32_bf16 v[196:199], v[92:95], v[136:139], v[196:199]
  ds_read_b64_tr_b16 v[58:59], v30 offset:9216
  v_mfma_f32_16x16x32_bf16 v[200:203], v[92:95], v[140:143], v[200:203]
  buffer_load_dwordx4 v25, s[16:19], s46 offen offset:1024 lds
  ds_read_b64_tr_b16 v[60:61], v31 offset:8192
  v_mfma_f32_16x16x32_bf16 v[204:207], v[92:95], v[144:147], v[204:207]
  ds_read_b64_tr_b16 v[62:63], v31 offset:9216
  v_mfma_f32_16x16x32_bf16 v[208:211], v[96:99], v[136:139], v[208:211]
  buffer_load_dwordx4 v26, s[16:19], s46 offen offset:2048 lds
  ds_read_b64_tr_b16 v[64:65], v32 offset:8192
  v_mfma_f32_16x16x32_bf16 v[212:215], v[96:99], v[140:143], v[212:215]
  ds_read_b64_tr_b16 v[66:67], v32 offset:9216
  v_mfma_f32_16x16x32_bf16 v[216:219], v[96:99], v[144:147], v[216:219]
  buffer_load_dwordx4 v27, s[16:19], s46 offen offset:3072 lds
  s_add_u32 s36, s36, 262144
  s_cmp_eq_u32 s36, 3670016
  s_cselect_b32 s36, 0, s36
  ds_read_b64_tr_b16 v[68:69], v33 offset:8192
  v_mfma_f32_16x16x32_bf16 v[220:223], v[100:103], v[136:139], v[220:223]
  ds_read_b64_tr_b16 v[70:71], v33 offset:9216
  v_mfma_f32_16x16x32_bf16 v[224:227], v[100:103], v[140:143], v[224:227]
  ds_read_b64_tr_b16 v[72:73], v34 offset:8192
  v_mfma_f32_16x16x32_bf16 v[228:231], v[100:103], v[144:147], v[228:231]
  ds_read_b64_tr_b16 v[74:75], v34 offset:9216
  v_mfma_f32_16x16x32_bf16 v[232:235], v[104:107], v[136:139], v[232:235]
  ds_read_b64_tr_b16 v[76:77], v35 offset:8192
  v_mfma_f32_16x16x32_bf16 v[236:239], v[104:107], v[140:143], v[236:239]
  ds_read_b64_tr_b16 v[78:79], v35 offset:9216
  v_mfma_f32_16x16x32_bf16 v[240:243], v[104:107], v[144:147], v[240:243]
  v_mfma_f32_16x16x32_bf16 v[244:247], v[108:111], v[136:139], v[244:247]
  v_mfma_f32_16x16x32_bf16 v[248:251], v[108:111], v[140:143], v[248:251]
  v_mfma_f32_16x16x32_bf16 v[252:255], v[108:111], v[144:147], v[252:255]
  s_waitcnt lgkmcnt(0)
  v_mfma_f32_16x16x32_bf16 v[160:163], v[48:51], v[112:115], v[160:163]
  s_add_u32 m0, s33, 8192
  s_add_u32 s46, s36, 131072
  buffer_load_dwordx4 v24, s[16:19], s36 offen offset:0 lds
  s_waitcnt vmcnt(9)
  v_mfma_f32_16x16x32_bf16 v[164:167], v[48:51], v[116:119], v[164:167]
  v_xor_b32 v15, s4, v41
  v_add_u32 v15, s42, v15
  s_mul_i32 s40, s4, 96
  s_add_u32 s42, s42, s40
  s_xor_b32 s4, s4, 64
  s_cmp_eq_u32 s42, 43008
  s_cselect_b32 s42, 0, s42
  ds_read_b128 v[136:139], v15 offset:0
  v_mfma_f32_16x16x32_bf16 v[168:171], v[48:51], v[120:123], v[168:171]
  buffer_load_dwordx4 v25, s[16:19], s36 offen offset:1024 lds
  ds_read_b64_tr_b16 v[80:81], v28 offset:16384
  v_mfma_f32_16x16x32_bf16 v[172:175], v[52:55], v[112:115], v[172:175]
  ds_read_b64_tr_b16 v[82:83], v28 offset:17408
  v_mfma_f32_16x16x32_bf16 v[176:179], v[52:55], v[116:119], v[176:179]
  buffer_load_dwordx4 v26, s[16:19], s36 offen offset:2048 lds
  ds_read_b128 v[140:143], v15 offset:2048
  v_mfma_f32_16x16x32_bf16 v[180:183], v[52:55], v[120:123], v[180:183]
  ds_read_b64_tr_b16 v[84:85], v29 offset:16384
  v_mfma_f32_16x16x32_bf16 v[184:187], v[56:59], v[112:115], v[184:187]
  buffer_load_dwordx4 v27, s[16:19], s36 offen offset:3072 lds
  ds_read_b64_tr_b16 v[86:87], v29 offset:17408
  v_mfma_f32_16x16x32_bf16 v[188:191], v[56:59], v[116:119], v[188:191]
  ds_read_b128 v[144:147], v15 offset:4096
  v_mfma_f32_16x16x32_bf16 v[192:195], v[56:59], v[120:123], v[192:195]
  s_add_u32 m0, s33, 12288
  s_nop 0
  buffer_load_dwordx4 v24, s[16:19], s46 offen offset:0 lds
  ds_read_b64_tr_b16 v[88:89], v30 offset:16384
  v_mfma_f32_16x16x32_bf16 v[196:199], v[60:63], v[112:115], v[196:199]
  ds_read_b64_tr_b16 v[90:91], v30 offset:17408
  v_mfma_f32_16x16x32_bf16 v[200:203], v[60:63], v[116:119], v[200:203]
  buffer_load_dwordx4 v25, s[16:19], s46 offen offset:1024 lds
  ds_read_b64_tr_b16 v[92:93], v31 offset:16384
  v_mfma_f32_16x16x32_bf16 v[204:207], v[60:63], v[120:123], v[204:207]
  ds_read_b64_tr_b16 v[94:95], v31 offset:17408
  v_mfma_f32_16x16x32_bf16 v[208:211], v[64:67], v[112:115], v[208:211]
  buffer_load_dwordx4 v26, s[16:19], s46 offen offset:2048 lds
  ds_read_b64_tr_b16 v[96:97], v32 offset:16384
  v_mfma_f32_16x16x32_bf16 v[212:215], v[64:67], v[116:119], v[212:215]
  ds_read_b64_tr_b16 v[98:99], v32 offset:17408
  v_mfma_f32_16x16x32_bf16 v[216:219], v[64:67], v[120:123], v[216:219]
  buffer_load_dwordx4 v27, s[16:19], s46 offen offset:3072 lds
  s_add_u32 s36, s36, 262144
  s_cmp_eq_u32 s36, 3670016
  s_cselect_b32 s36, 0, s36
  ds_read_b64_tr_b16 v[100:101], v33 offset:16384
  v_mfma_f32_16x16x32_bf16 v[220:223], v[68:71], v[112:115], v[220:223]
  ds_read_b64_tr_b16 v[102:103], v33 offset:17408
  v_mfma_f32_16x16x32_bf16 v[224:227], v[68:71], v[116:119], v[224:227]
  ds_read_b64_tr_b16 v[104:105], v34 offset:16384
  v_mfma_f32_16x16x32_bf16 v[228:231], v[68:71], v[120:123], v[228:231]
  ds_read_b64_tr_b16 v[106:107], v34 offset:17408
  v_mfma_f32_16x16x32_bf16 v[232:235], v[72:75], v[112:115], v[232:235]
  ds_read_b64_tr_b16 v[108:109], v35 offset:16384
  v_mfma_f32_16x16x32_bf16 v[236:239], v[72:75], v[116:119], v[236:239]
  ds_read_b64_tr_b16 v[110:111], v35 offset:17408
  v_mfma_f32_16x16x32_bf16 v[240:243], v[72:75], v[120:123], v[240:243]
  v_mfma_f32_16x16x32_bf16 v[244:247], v[76:79], v[112:115], v[244:247]
  v_mfma_f32_16x16x32_bf16 v[248:251], v[76:79], v[116:119], v[248:251]
  v_mfma_f32_16x16x32_bf16 v[252:255], v[76:79], v[120:123], v[252:255]
  s_waitcnt lgkmcnt(0)
  v_mfma_f32_16x16x32_bf16 v[160:163], v[80:83], v[136:139], v[160:163]
  s_add_u32 m0, s33, 16384
  s_add_u32 s46, s34, 256
  buffer_load_dwordx4 v16, s[8:11], s34 offen offset:0 nt lds
  s_waitcnt vmcnt(9)
  v_mfma_f32_16x16x32_bf16 v[164:167], v[80:83], v[140:143], v[164:167]
  v_xor_b32 v15, s4, v41
  v_add_u32 v15, s42, v15
  s_mul_i32 s40, s4, 96
  s_add_u32 s42, s42, s40
  s_xor_b32 s4, s4, 64
  s_cmp_eq_u32 s42, 43008
  s_cselect_b32 s42, 0, s42
  ds_read_b128 v[112:115], v15 offset:0
  v_mfma_f32_16x16x32_bf16 v[168:171], v[80:83], v[144:147], v[168:171]
  ds_read_b64_tr_b16 v[48:49], v28 offset:0
  v_mfma_f32_16x16x32_bf16 v[172:175], v[84:87], v[136:139], v[172:175]
  ds_read_b64_tr_b16 v[50:51], v28 offset:1024
  v_mfma_f32_16x16x32_bf16 v[176:179], v[84:87], v[140:143], v[176:179]
  ds_read_b128 v[116:119], v15 offset:2048
  v_mfma_f32_16x16x32_bf16 v[180:183], v[84:87], v[144:147], v[180:183]
  buffer_load_dwordx4 v17, s[8:11], s34 offen offset:1024 nt lds
  ds_read_b64_tr_b16 v[52:53], v29 offset:0
  v_mfma_f32_16x16x32_bf16 v[184:187], v[88:91], v[136:139], v[184:187]
  ds_read_b64_tr_b16 v[54:55], v29 offset:1024
  v_mfma_f32_16x16x32_bf16 v[188:191], v[88:91], v[140:143], v[188:191]
  ds_read_b128 v[120:123], v15 offset:4096
  v_mfma_f32_16x16x32_bf16 v[192:195], v[88:91], v[144:147], v[192:195]
  ds_read_b64_tr_b16 v[56:57], v30 offset:0
  v_mfma_f32_16x16x32_bf16 v[196:199], v[92:95], v[136:139], v[196:199]
  ds_read_b64_tr_b16 v[58:59], v30 offset:1024
  v_mfma_f32_16x16x32_bf16 v[200:203], v[92:95], v[140:143], v[200:203]
  buffer_load_dwordx4 v18, s[8:11], s34 offen offset:2048 nt lds
  ds_read_b64_tr_b16 v[60:61], v31 offset:0
  v_mfma_f32_16x16x32_bf16 v[204:207], v[92:95], v[144:147], v[204:207]
  ds_read_b64_tr_b16 v[62:63], v31 offset:1024
  v_mfma_f32_16x16x32_bf16 v[208:211], v[96:99], v[136:139], v[208:211]
  ds_read_b64_tr_b16 v[64:65], v32 offset:0
  v_mfma_f32_16x16x32_bf16 v[212:215], v[96:99], v[140:143], v[212:215]
  ds_read_b64_tr_b16 v[66:67], v32 offset:1024
  v_mfma_f32_16x16x32_bf16 v[216:219], v[96:99], v[144:147], v[216:219]
  ds_read_b64_tr_b16 v[68:69], v33 offset:0
  v_mfma_f32_16x16x32_bf16 v[220:223], v[100:103], v[136:139], v[220:223]
  buffer_load_dwordx4 v19, s[8:11], s34 offen offset:3072 nt lds
  ds_read_b64_tr_b16 v[70:71], v33 offset:1024
  v_mfma_f32_16x16x32_bf16 v[224:227], v[100:103], v[140:143], v[224:227]
  ds_read_b64_tr_b16 v[72:73], v34 offset:0
  v_mfma_f32_16x16x32_bf16 v[228:231], v[100:103], v[144:147], v[228:231]
  ds_read_b64_tr_b16 v[74:75], v34 offset:1024
  v_mfma_f32_16x16x32_bf16 v[232:235], v[104:107], v[136:139], v[232:235]
  ds_read_b64_tr_b16 v[76:77], v35 offset:0
  v_mfma_f32_16x16x32_bf16 v[236:239], v[104:107], v[140:143], v[236:239]
  ds_read_b64_tr_b16 v[78:79], v35 offset:1024
  v_mfma_f32_16x16x32_bf16 v[240:243], v[104:107], v[144:147], v[240:243]
  s_add_u32 m0, s33, 20480
  s_nop 0
  buffer_load_dwordx4 v16, s[8:11], s46 offen offset:0 nt lds
  v_mfma_f32_16x16x32_bf16 v[244:247], v[108:111], v[136:139], v[244:247]
  v_mfma_f32_16x16x32_bf16 v[248:251], v[108:111], v[140:143], v[248:251]
  v_mfma_f32_16x16x32_bf16 v[252:255], v[108:111], v[144:147], v[252:255]
  s_waitcnt lgkmcnt(0)
  v_mfma_f32_16x16x32_bf16 v[160:163], v[48:51], v[112:115], v[160:163]
  buffer_load_dwordx4 v17, s[8:11], s46 offen offset:1024 nt lds
  s_waitcnt vmcnt(6)
  v_mfma_f32_16x16x32_bf16 v[164:167], v[48:51], v[116:119], v[164:167]
  v_xor_b32 v15, s4, v41
  v_add_u32 v15, s42, v15
  s_mul_i32 s40, s4, 96
  s_add_u32 s42, s42, s40
  s_xor_b32 s4, s4, 64
  s_cmp_eq_u32 s42, 43008
  s_cselect_b32 s42, 0, s42
  ds_read_b128 v[136:139], v15 offset:0
  v_mfma_f32_16x16x32_bf16 v[168:171], v[48:51], v[120:123], v[168:171]
  ds_read_b64_tr_b16 v[80:81], v28 offset:8192
  v_mfma_f32_16x16x32_bf16 v[172:175], v[52:55], v[112:115], v[172:175]
  ds_read_b64_tr_b16 v[82:83], v28 offset:9216
  v_mfma_f32_16x16x32_bf16 v[176:179], v[52:55], v[116:119], v[176:179]
  ds_read_b128 v[140:143], v15 offset:2048
  v_mfma_f32_16x16x32_bf16 v[180:183], v[52:55], v[120:123], v[180:183]
  buffer_load_dwordx4 v18, s[8:11], s46 offen offset:2048 nt lds
  ds_read_b64_tr_b16 v[84:85], v29 offset:8192
  v_mfma_f32_16x16x32_bf16 v[184:187], v[56:59], v[112:115], v[184:187]
  ds_read_b64_tr_b16 v[86:87], v29 offset:9216
  v_mfma_f32_16x16x32_bf16 v[188:191], v[56:59], v[116:119], v[188:191]
  ds_read_b128 v[144:147], v15 offset:4096
  v_mfma_f32_16x16x32_bf16 v[192:195], v[56:59], v[120:123], v[192:195]
  ds_read_b64_tr_b16 v[88:89], v30 offset:8192
  v_mfma_f32_16x16x32_bf16 v[196:199], v[60:63], v[112:115], v[196:199]
  ds_read_b64_tr_b16 v[90:91], v30 offset:9216
  v_mfma_f32_16x16x32_bf16 v[200:203], v[60:63], v[116:119], v[200:203]
  buffer_load_dwordx4 v19, s[8:11], s46 offen offset:3072 nt lds
  s_add_u32 s34, s34, 32768
  ds_read_b64_tr_b16 v[92:93], v31 offset:8192
  v_mfma_f32_16x16x32_bf16 v[204:207], v[60:63], v[120:123], v[204:207]
  ds_read_b64_tr_b16 v[94:95], v31 offset:9216
  v_mfma_f32_16x16x32_bf16 v[208:211], v[64:67], v[112:115], v[208:211]
  ds_read_b64_tr_b16 v[96:97], v32 offset:8192
  v_mfma_f32_16x16x32_bf16 v[212:215], v[64:67], v[116:119], v[212:215]
  ds_read_b64_tr_b16 v[98:99], v32 offset:9216
  v_mfma_f32_16x16x32_bf16 v[216:219], v[64:67], v[120:123], v[216:219]
  ds_read_b64_tr_b16 v[100:101], v33 offset:8192
  v_mfma_f32_16x16x32_bf16 v[220:223], v[68:71], v[112:115], v[220:223]
  s_add_u32 m0, s33, 0
  s_add_u32 s46, s34, 256
  buffer_load_dwordx4 v16, s[8:11], s34 offen offset:0 nt lds
  ds_read_b64_tr_b16 v[102:103], v33 offset:9216
  v_mfma_f32_16x16x32_bf16 v[224:227], v[68:71], v[116:119], v[224:227]
  ds_read_b64_tr_b16 v[104:105], v34 offset:8192
  v_mfma_f32_16x16x32_bf16 v[228:231], v[68:71], v[120:123], v[228:231]
  ds_read_b64_tr_b16 v[106:107], v34 offset:9216
  v_mfma_f32_16x16x32_bf16 v[232:235], v[72:75], v[112:115], v[232:235]
  ds_read_b64_tr_b16 v[108:109], v35 offset:8192
  v_mfma_f32_16x16x32_bf16 v[236:239], v[72:75], v[116:119], v[236:239]
  ds_read_b64_tr_b16 v[110:111], v35 offset:9216
  v_mfma_f32_16x16x32_bf16 v[240:243], v[72:75], v[120:123], v[240:243]
  buffer_load_dwordx4 v17, s[8:11], s34 offen offset:1024 nt lds
  v_mfma_f32_16x16x32_bf16 v[244:247], v[76:79], v[112:115], v[244:247]
  v_mfma_f32_16x16x32_bf16 v[248:251], v[76:79], v[116:119], v[248:251]
  v_mfma_f32_16x16x32_bf16 v[252:255], v[76:79], v[120:123], v[252:255]
  s_waitcnt lgkmcnt(0)
  v_mfma_f32_16x16x32_bf16 v[160:163], v[80:83], v[136:139], v[160:163]
  buffer_load_dwordx4 v18, s[8:11], s34 offen offset:2048 nt lds
  v_mfma_f32_16x16x32_bf16 v[164:167], v[80:83], v[140:143], v[164:167]
  v_mfma_f32_16x16x32_bf16 v[168:171], v[80:83], v[144:147], v[168:171]
  v_mfma_f32_16x16x32_bf16 v[172:175], v[84:87], v[136:139], v[172:175]
  v_mfma_f32_16x16x32_bf16 v[176:179], v[84:87], v[140:143], v[176:179]
  v_mfma_f32_16x16x32_bf16 v[180:183], v[84:87], v[144:147], v[180:183]
  v_mfma_f32_16x16x32_bf16 v[184:187], v[88:91], v[136:139], v[184:187]
  v_mfma_f32_16x16x32_bf16 v[188:191], v[88:91], v[140:143], v[188:191]
  buffer_load_dwordx4 v19, s[8:11], s34 offen offset:3072 nt lds
  v_mfma_f32_16x16x32_bf16 v[192:195], v[88:91], v[144:147], v[192:195]
  v_mfma_f32_16x16x32_bf16 v[196:199], v[92:95], v[136:139], v[196:199]
  v_mfma_f32_16x16x32_bf16 v[200:203], v[92:95], v[140:143], v[200:203]
  v_mfma_f32_16x16x32_bf16 v[204:207], v[92:95], v[144:147], v[204:207]
  v_mfma_f32_16x16x32_bf16 v[208:211], v[96:99], v[136:139], v[208:211]
  v_mfma_f32_16x16x32_bf16 v[212:215], v[96:99], v[140:143], v[212:215]
  v_mfma_f32_16x16x32_bf16 v[216:219], v[96:99], v[144:147], v[216:219]
  s_add_u32 m0, s33, 4096
  s_nop 0
  buffer_load_dwordx4 v16, s[8:11], s46 offen offset:0 nt lds
  v_mfma_f32_16x16x32_bf16 v[220:223], v[100:103], v[136:139], v[220:223]
  v_mfma_f32_16x16x32_bf16 v[224:227], v[100:103], v[140:143], v[224:227]
  v_mfma_f32_16x16x32_bf16 v[228:231], v[100:103], v[144:147], v[228:231]
  v_mfma_f32_16x16x32_bf16 v[232:235], v[104:107], v[136:139], v[232:235]
  v_mfma_f32_16x16x32_bf16 v[236:239], v[104:107], v[140:143], v[236:239]
  v_mfma_f32_16x16x32_bf16 v[240:243], v[104:107], v[144:147], v[240:243]
  v_mfma_f32_16x16x32_bf16 v[244:247], v[108:111], v[136:139], v[244:247]
  buffer_load_dwordx4 v17, s[8:11], s46 offen offset:1024 nt lds
  v_mfma_f32_16x16x32_bf16 v[248:251], v[108:111], v[140:143], v[248:251]
  v_mfma_f32_16x16x32_bf16 v[252:255], v[108:111], v[144:147], v[252:255]
  s_barrier
  s_nop 5
  v_cvt_pk_bf16_f32 v160, v160, v161
  v_cvt_pk_bf16_f32 v161, v162, v163
  ds_write_b64 v42, v[160:161] offset:0
  buffer_load_dwordx4 v18, s[8:11], s46 offen offset:2048 nt lds
  v_cvt_pk_bf16_f32 v164, v164, v165
  v_cvt_pk_bf16_f32 v165, v166, v167
  ds_write_b64 v42, v[164:165] offset:1024
  v_cvt_pk_bf16_f32 v168, v168, v169
  v_cvt_pk_bf16_f32 v169, v170, v171
  ds_write_b64 v42, v[168:169] offset:2048
  v_cvt_pk_bf16_f32 v172, v172, v173
  v_cvt_pk_bf16_f32 v173, v174, v175
  ds_write_b64 v42, v[172:173] offset:512
  v_cvt_pk_bf16_f32 v176, v176, v177
  v_cvt_pk_bf16_f32 v177, v178, v179
  ds_write_b64 v42, v[176:177] offset:1536
  v_cvt_pk_bf16_f32 v180, v180, v181
  v_cvt_pk_bf16_f32 v181, v182, v183
  ds_write_b64 v42, v[180:181] offset:2560
  v_cvt_pk_bf16_f32 v184, v184, v185
  v_cvt_pk_bf16_f32 v185, v186, v187
  ds_write_b64 v42, v[184:185] offset:3072
  v_cvt_pk_bf16_f32 v188, v188, v189
  v_cvt_pk_bf16_f32 v189, v190, v191
  ds_write_b64 v42, v[188:189] offset:4096
  v_cvt_pk_bf16_f32 v192, v192, v193
  v_cvt_pk_bf16_f32 v193, v194, v195
  ds_write_b64 v42, v[192:193] offset:5120
  buffer_load_dwordx4 v19, s[8:11], s46 offen offset:3072 nt lds
  s_add_u32 s34, s34, 32768
  v_cvt_pk_bf16_f32 v196, v196, v197
  v_cvt_pk_bf16_f32 v197, v198, v199
  ds_write_b64 v42, v[196:197] offset:3584
  v_cvt_pk_bf16_f32 v200, v200, v201
  v_cvt_pk_bf16_f32 v201, v202, v203
  ds_write_b64 v42, v[200:201] offset:4608
  v_cvt_pk_bf16_f32 v204, v204, v205
  v_cvt_pk_bf16_f32 v205, v206, v207
  ds_write_b64 v42, v[204:205] offset:5632
  v_cvt_pk_bf16_f32 v208, v208, v209
  s_add_u32 m0, s33, 8192
  s_add_u32 s46, s37, 14336
  buffer_load_dwordx4 v8, s[20:23], s37 offen offset:0 lds
  v_cvt_pk_bf16_f32 v209, v210, v211
  ds_write_b64 v42, v[208:209] offset:6144
  v_cvt_pk_bf16_f32 v212, v212, v213
  v_cvt_pk_bf16_f32 v213, v214, v215
  ds_write_b64 v42, v[212:213] offset:7168
  v_cvt_pk_bf16_f32 v216, v216, v217
  v_cvt_pk_bf16_f32 v217, v218, v219
  ds_write_b64 v42, v[216:217] offset:8192
  v_cvt_pk_bf16_f32 v220, v220, v221
  v_cvt_pk_bf16_f32 v221, v222, v223
  buffer_load_dwordx4 v9, s[20:23], s37 offen offset:1024 lds
  ds_write_b64 v42, v[220:221] offset:6656
  v_cvt_pk_bf16_f32 v224, v224, v225
  v_cvt_pk_bf16_f32 v225, v226, v227
  ds_write_b64 v42, v[224:225] offset:7680
  v_cvt_pk_bf16_f32 v228, v228, v229
  v_cvt_pk_bf16_f32 v229, v230, v231
  ds_write_b64 v42, v[228:229] offset:8704
  v_cvt_pk_bf16_f32 v232, v232, v233
  v_cvt_pk_bf16_f32 v233, v234, v235
  ds_write_b64 v42, v[232:233] offset:9216
  buffer_load_dwordx4 v10, s[20:23], s37 offen offset:2048 lds
  v_cvt_pk_bf16_f32 v236, v236, v237
  v_cvt_pk_bf16_f32 v237, v238, v239
  ds_write_b64 v42, v[236:237] offset:10240
  v_cvt_pk_bf16_f32 v240, v240, v241
  v_cvt_pk_bf16_f32 v241, v242, v243
  ds_write_b64 v42, v[240:241] offset:11264
  v_cvt_pk_bf16_f32 v244, v244, v245
  v_cvt_pk_bf16_f32 v245, v246, v247
  ds_write_b64 v42, v[244:245] offset:9728
  v_cvt_pk_bf16_f32 v248, v248, v249
  buffer_load_dwordx4 v11, s[20:23], s37 offen offset:3072 lds
  v_cvt_pk_bf16_f32 v249, v250, v251
  ds_write_b64 v42, v[248:249] offset:10752
  v_cvt_pk_bf16_f32 v252, v252, v253
  v_cvt_pk_bf16_f32 v253, v254, v255
  ds_write_b64 v42, v[252:253] offset:11776
  s_waitcnt lgkmcnt(0)
  s_add_u32 m0, s33, 12288
  s_nop 0
  buffer_load_dwordx4 v8, s[20:23], s46 offen offset:0 lds
  s_barrier
  buffer_load_dwordx4 v9, s[20:23], s46 offen offset:1024 lds
  ds_read_b128 v[208:211], v3 offset:0
  ds_read_b128 v[212:215], v3 offset:1024
  ds_read_b128 v[216:219], v3 offset:2048
  ds_read_b128 v[220:223], v3 offset:24576
  ds_read_b128 v[224:227], v3 offset:25600
  ds_read_b128 v[228:231], v3 offset:26624
  s_waitcnt lgkmcnt(0)
  buffer_load_dwordx4 v10, s[20:23], s46 offen offset:2048 lds
  v_mfma_f32_16x16x32_bf16 v[64:67], a[0:3], v[208:211], 0
  ds_read_b128 v[232:235], v3 offset:3072
  v_mfma_f32_16x16x32_bf16 v[68:71], a[0:3], v[212:215], 0
  v_mfma_f32_16x16x32_bf16 v[72:75], a[0:3], v[216:219], 0
  buffer_load_dwordx4 v11, s[20:23], s46 offen offset:3072 lds
  s_add_u32 s37, s37, 28672
  s_cmp_eq_u32 s37, s38
  s_cselect_b32 s47, 229376, 0
  s_sub_u32 s37, s37, s47
  ds_read_b128 v[236:239], v3 offset:4096
  v_mfma_f32_16x16x32_bf16 v[76:79], a[0:3], v[220:223], 0
  v_mfma_f32_16x16x32_bf16 v[80:83], a[0:3], v[224:227], 0
  ds_read_b128 v[240:243], v3 offset:5120
  v_mfma_f32_16x16x32_bf16 v[84:87], a[0:3], v[228:231], 0
  v_mfma_f32_16x16x32_bf16 v[88:91], a[32:35], v[208:211], 0
  ds_read_b128 v[244:247], v3 offset:27648
  v_mfma_f32_16x16x32_bf16 v[92:95], a[32:35], v[212:215], 0
  v_mfma_f32_16x16x32_bf16 v[96:99], a[32:35], v[216:219], 0
  ds_read_b128 v[248:251], v3 offset:28672
  v_mfma_f32_16x16x32_bf16 v[100:103], a[32:35], v[220:223], 0
  v_mfma_f32_16x16x32_bf16 v[104:107], a[32:35], v[224:227], 0
  ds_read_b128 v[252:255], v3 offset:29696
  v_mfma_f32_16x16x32_bf16 v[108:111], a[32:35], v[228:231], 0
  v_mfma_f32_16x16x32_bf16 v[112:115], a[64:67], v[208:211], 0
  v_mfma_f32_16x16x32_bf16 v[116:119], a[64:67], v[212:215], 0
  v_mfma_f32_16x16x32_bf16 v[120:123], a[64:67], v[216:219], 0
  v_mfma_f32_16x16x32_bf16 v[124:127], a[64:67], v[220:223], 0
  v_mfma_f32_16x16x32_bf16 v[128:131], a[64:67], v[224:227], 0
  v_mfma_f32_16x16x32_bf16 v[132:135], a[64:67], v[228:231], 0
  v_mfma_f32_16x16x32_bf16 v[136:139], a[96:99], v[208:211], 0
  v_mfma_f32_16x16x32_bf16 v[140:143], a[96:99], v[212:215], 0
  v_mfma_f32_16x16x32_bf16 v[144:147], a[96:99], v[216:219], 0
  v_mfma_f32_16x16x32_bf16 v[148:151], a[96:99], v[220:223], 0
  v_mfma_f32_16x16x32_bf16 v[152:155], a[96:99], v[224:227], 0
  v_mfma_f32_16x16x32_bf16 v[156:159], a[96:99], v[228:231], 0
  v_mfma_f32_16x16x32_bf16 v[160:163], a[128:131], v[208:211], 0
  v_mfma_f32_16x16x32_bf16 v[164:167], a[128:131], v[212:215], 0
  v_mfma_f32_16x16x32_bf16 v[168:171], a[128:131], v[216:219], 0
  v_mfma_f32_16x16x32_bf16 v[172:175], a[128:131], v[220:223], 0
  v_mfma_f32_16x16x32_bf16 v[176:179], a[128:131], v[224:227], 0
  v_mfma_f32_16x16x32_bf16 v[180:183], a[128:131], v[228:231], 0
  v_mfma_f32_16x16x32_bf16 v[184:187], a[160:163], v[208:211], 0
  v_mfma_f32_16x16x32_bf16 v[188:191], a[160:163], v[212:215], 0
  v_mfma_f32_16x16x32_bf16 v[192:195], a[160:163], v[216:219], 0
  v_mfma_f32_16x16x32_bf16 v[196:199], a[160:163], v[220:223], 0
  v_mfma_f32_16x16x32_bf16 v[200:203], a[160:163], v[224:227], 0
  v_mfma_f32_16x16x32_bf16 v[204:207], a[160:163], v[228:231], 0
  s_waitcnt lgkmcnt(0)
  v_mfma_f32_16x16x32_bf16 v[64:67], a[4:7], v[232:235], v[64:67]
  ds_read_b128 v[208:211], v3 offset:6144
  v_mfma_f32_16x16x32_bf16 v[68:71], a[4:7], v[236:239], v[68:71]
  v_mfma_f32_16x16x32_bf16 v[72:75], a[4:7], v[240:243], v[72:75]
  ds_read_b128 v[212:215], v3 offset:7168
  v_mfma_f32_16x16x32_bf16 v[76:79], a[4:7], v[244:247], v[76:79]
  v_mfma_f32_16x16x32_bf16 v[80:83], a[4:7], v[248:251], v[80:83]
  ds_read_b128 v[216:219], v3 offset:8192
  v_mfma_f32_16x16x32_bf16 v[84:87], a[4:7], v[252:255], v[84:87]
  v_mfma_f32_16x16x32_bf16 v[88:91], a[36:39], v[232:235], v[88:91]
  ds_read_b128 v[220:223], v3 offset:30720
  v_mfma_f32_16x16x32_bf16 v[92:95], a[36:39], v[236:239], v[92:95]
  v_mfma_f32_16x16x32_bf16 v[96:99], a[36:39], v[240:243], v[96:99]
  ds_read_b128 v[224:227], v3 offset:31744
  v_mfma_f32_16x16x32_bf16 v[100:103], a[36:39], v[244:247], v[100:103]
  v_mfma_f32_16x16x32_bf16 v[104:107], a[36:39], v[248:251], v[104:107]
  ds_read_b128 v[228:231], v3 offset:32768
  v_mfma_f32_16x16x32_bf16 v[108:111], a[36:39], v[252:255], v[108:111]
  s_waitcnt vmcnt(16)
  v_mfma_f32_16x16x32_bf16 v[112:115], a[68:71], v[232:235], v[112:115]
  ds_read_b128 a[192:195], v20 offset:16384
  v_mfma_f32_16x16x32_bf16 v[116:119], a[68:71], v[236:239], v[116:119]
  v_mfma_f32_16x16x32_bf16 v[120:123], a[68:71], v[240:243], v[120:123]
  ds_read_b128 a[196:199], v21 offset:16384
  v_mfma_f32_16x16x32_bf16 v[124:127], a[68:71], v[244:247], v[124:127]
  v_mfma_f32_16x16x32_bf16 v[128:131], a[68:71], v[248:251], v[128:131]
  ds_read_b128 a[200:203], v22 offset:16384
  v_mfma_f32_16x16x32_bf16 v[132:135], a[68:71], v[252:255], v[132:135]
  v_mfma_f32_16x16x32_bf16 v[136:139], a[100:103], v[232:235], v[136:139]
  ds_read_b128 a[204:207], v23 offset:16384
  v_mfma_f32_16x16x32_bf16 v[140:143], a[100:103], v[236:239], v[140:143]
  v_mfma_f32_16x16x32_bf16 v[144:147], a[100:103], v[240:243], v[144:147]
  v_mfma_f32_16x16x32_bf16 v[148:151], a[100:103], v[244:247], v[148:151]
  ds_read_b128 a[208:211], v20 offset:20480
  v_mfma_f32_16x16x32_bf16 v[152:155], a[100:103], v[248:251], v[152:155]
  v_mfma_f32_16x16x32_bf16 v[156:159], a[100:103], v[252:255], v[156:159]
  ds_read_b128 a[212:215], v21 offset:20480
  v_mfma_f32_16x16x32_bf16 v[160:163], a[132:135], v[232:235], v[160:163]
  v_mfma_f32_16x16x32_bf16 v[164:167], a[132:135], v[236:239], v[164:167]
  ds_read_b128 a[216:219], v22 offset:20480
  v_mfma_f32_16x16x32_bf16 v[168:171], a[132:135], v[240:243], v[168:171]
  v_mfma_f32_16x16x32_bf16 v[172:175], a[132:135], v[244:247], v[172:175]
  ds_read_b128 a[220:223], v23 offset:20480
  v_mfma_f32_16x16x32_bf16 v[176:179], a[132:135], v[248:251], v[176:179]
  v_mfma_f32_16x16x32_bf16 v[180:183], a[132:135], v[252:255], v[180:183]
  v_mfma_f32_16x16x32_bf16 v[184:187], a[164:167], v[232:235], v[184:187]
  v_mfma_f32_16x16x32_bf16 v[188:191], a[164:167], v[236:239], v[188:191]
  v_mfma_f32_16x16x32_bf16 v[192:195], a[164:167], v[240:243], v[192:195]
  v_mfma_f32_16x16x32_bf16 v[196:199], a[164:167], v[244:247], v[196:199]
  v_mfma_f32_16x16x32_bf16 v[200:203], a[164:167], v[248:251], v[200:203]
  v_mfma_f32_16x16x32_bf16 v[204:207], a[164:167], v[252:255], v[204:207]
  s_waitcnt lgkmcnt(0)
  v_mfma_f32_16x16x32_bf16 v[64:67], a[8:11], v[208:211], v[64:67]
  s_add_u32 m0, s33, 16384
  s_add_u32 s46, s37, 14336
  buffer_load_dwordx4 v8, s[20:23], s37 offen offset:0 lds
  ds_read_b128 v[232:235], v3 offset:9216
  v_mfma_f32_16x16x32_bf16 v[68:71], a[8:11], v[212:215], v[68:71]
  v_mfma_f32_16x16x32_bf16 v[72:75], a[8:11], v[216:219], v[72:75]
  ds_read_b128 v[236:239], v3 offset:10240
  buffer_load_dwordx4 v9, s[20:23], s37 offen offset:1024 lds
  v_mfma_f32_16x16x32_bf16 v[76:79], a[8:11], v[220:223], v[76:79]
  v_mfma_f32_16x16x32_bf16 v[80:83], a[8:11], v[224:227], v[80:83]
  ds_read_b128 v[240:243], v3 offset:11264
  v_mfma_f32_16x16x32_bf16 v[84:87], a[8:11], v[228:231], v[84:87]
  buffer_load_dwordx4 v10, s[20:23], s37 offen offset:2048 lds
  v_mfma_f32_16x16x32_bf16 v[88:91], a[40:43], v[208:211], v[88:91]
  ds_read_b128 v[244:247], v3 offset:33792
  v_mfma_f32_16x16x32_bf16 v[92:95], a[40:43], v[212:215], v[92:95]
  v_mfma_f32_16x16x32_bf16 v[96:99], a[40:43], v[216:219], v[96:99]
  buffer_load_dwordx4 v11, s[20:23], s37 offen offset:3072 lds
  ds_read_b128 v[248:251], v3 offset:34816
  v_mfma_f32_16x16x32_bf16 v[100:103], a[40:43], v[220:223], v[100:103]
  v_mfma_f32_16x16x32_bf16 v[104:107], a[40:43], v[224:227], v[104:107]
  ds_read_b128 v[252:255], v3 offset:35840
  s_add_u32 m0, s33, 20480
  s_nop 0
  buffer_load_dwordx4 v8, s[20:23], s46 offen offset:0 lds
  v_mfma_f32_16x16x32_bf16 v[108:111], a[40:43], v[228:231], v[108:111]
  v_mfma_f32_16x16x32_bf16 v[112:115], a[72:75], v[208:211], v[112:115]
  v_mfma_f32_16x16x32_bf16 v[116:119], a[72:75], v[212:215], v[116:119]
  buffer_load_dwordx4 v9, s[20:23], s46 offen offset:1024 lds
  v_mfma_f32_16x16x32_bf16 v[120:123], a[72:75], v[216:219], v[120:123]
  v_mfma_f32_16x16x32_bf16 v[124:127], a[72:75], v[220:223], v[124:127]
  v_mfma_f32_16x16x32_bf16 v[128:131], a[72:75], v[224:227], v[128:131]
  buffer_load_dwordx4 v10, s[20:23], s46 offen offset:2048 lds
  v_mfma_f32_16x16x32_bf16 v[132:135], a[72:75], v[228:231], v[132:135]
  v_mfma_f32_16x16x32_bf16 v[136:139], a[104:107], v[208:211], v[136:139]
  v_mfma_f32_16x16x32_bf16 v[140:143], a[104:107], v[212:215], v[140:143]
  buffer_load_dwordx4 v11, s[20:23], s46 offen offset:3072 lds
  s_add_u32 s37, s37, 28672
  s_cmp_eq_u32 s37, s38
  s_cselect_b32 s47, 229376, 0
  s_sub_u32 s37, s37, s47
  v_mfma_f32_16x16x32_bf16 v[144:147], a[104:107], v[216:219], v[144:147]
  v_mfma_f32_16x16x32_bf16 v[148:151], a[104:107], v[220:223], v[148:151]
  v_mfma_f32_16x16x32_bf16 v[152:155], a[104:107], v[224:227], v[152:155]
  v_mfma_f32_16x16x32_bf16 v[156:159], a[104:107], v[228:231], v[156:159]
  v_mfma_f32_16x16x32_bf16 v[160:163], a[136:139], v[208:211], v[160:163]
  v_mfma_f32_16x16x32_bf16 v[164:167], a[136:139], v[212:215], v[164:167]
  v_mfma_f32_16x16x32_bf16 v[168:171], a[136:139], v[216:219], v[168:171]
  v_mfma_f32_16x16x32_bf16 v[172:175], a[136:139], v[220:223], v[172:175]
  v_mfma_f32_16x16x32_bf16 v[176:179], a[136:139], v[224:227], v[176:179]
  v_mfma_f32_16x16x32_bf16 v[180:183], a[136:139], v[228:231], v[180:183]
  v_mfma_f32_16x16x32_bf16 v[184:187], a[168:171], v[208:211], v[184:187]
  v_mfma_f32_16x16x32_bf16 v[188:191], a[168:171], v[212:215], v[188:191]
  v_mfma_f32_16x16x32_bf16 v[192:195], a[168:171], v[216:219], v[192:195]
  v_mfma_f32_16x16x32_bf16 v[196:199], a[168:171], v[220:223], v[196:199]
  v_mfma_f32_16x16x32_bf16 v[200:203], a[168:171], v[224:227], v[200:203]
  v_mfma_f32_16x16x32_bf16 v[204:207], a[168:171], v[228:231], v[204:207]
  s_waitcnt lgkmcnt(0)
  v_mfma_f32_16x16x32_bf16 v[64:67], a[12:15], v[232:235], v[64:67]
  ds_read_b128 v[208:211], v3 offset:12288
  v_mfma_f32_16x16x32_bf16 v[68:71], a[12:15], v[236:239], v[68:71]
  v_mfma_f32_16x16x32_bf16 v[72:75], a[12:15], v[240:243], v[72:75]
  ds_read_b128 v[212:215], v3 offset:13312
  v_mfma_f32_16x16x32_bf16 v[76:79], a[12:15], v[244:247], v[76:79]
  v_mfma_f32_16x16x32_bf16 v[80:83], a[12:15], v[248:251], v[80:83]
  ds_read_b128 v[216:219], v3 offset:14336
  v_mfma_f32_16x16x32_bf16 v[84:87], a[12:15], v[252:255], v[84:87]
  v_mfma_f32_16x16x32_bf16 v[88:91], a[44:47], v[232:235], v[88:91]
  ds_read_b128 v[220:223], v3 offset:36864
  v_mfma_f32_16x16x32_bf16 v[92:95], a[44:47], v[236:239], v[92:95]
  v_mfma_f32_16x16x32_bf16 v[96:99], a[44:47], v[240:243], v[96:99]
  ds_read_b128 v[224:227], v3 offset:37888
  v_mfma_f32_16x16x32_bf16 v[100:103], a[44:47], v[244:247], v[100:103]
  v_mfma_f32_16x16x32_bf16 v[104:107], a[44:47], v[248:251], v[104:107]
  ds_read_b128 v[228:231], v3 offset:38912
  v_mfma_f32_16x16x32_bf16 v[108:111], a[44:47], v[252:255], v[108:111]
  s_waitcnt vmcnt(16)
  v_mfma_f32_16x16x32_bf16 v[112:115], a[76:79], v[232:235], v[112:115]
  ds_read_b128 a[224:227], v20 offset:0
  v_mfma_f32_16x16x32_bf16 v[116:119], a[76:79], v[236:239], v[116:119]
  v_mfma_f32_16x16x32_bf16 v[120:123], a[76:79], v[240:243], v[120:123]
  ds_read_b128 a[228:231], v21 offset:0
  v_mfma_f32_16x16x32_bf16 v[124:127], a[76:79], v[244:247], v[124:127]
  v_mfma_f32_16x16x32_bf16 v[128:131], a[76:79], v[248:251], v[128:131]
  ds_read_b128 a[232:235], v22 offset:0
  v_mfma_f32_16x16x32_bf16 v[132:135], a[76:79], v[252:255], v[132:135]
  v_mfma_f32_16x16x32_bf16 v[136:139], a[108:111], v[232:235], v[136:139]
  ds_read_b128 a[236:239], v23 offset:0
  v_mfma_f32_16x16x32_bf16 v[140:143], a[108:111], v[236:239], v[140:143]
  v_mfma_f32_16x16x32_bf16 v[144:147], a[108:111], v[240:243], v[144:147]
  v_mfma_f32_16x16x32_bf16 v[148:151], a[108:111], v[244:247], v[148:151]
  ds_read_b128 a[240:243], v20 offset:4096
  v_mfma_f32_16x16x32_bf16 v[152:155], a[108:111], v[248:251], v[152:155]
  v_mfma_f32_16x16x32_bf16 v[156:159], a[108:111], v[252:255], v[156:159]
  ds_read_b128 a[244:247], v21 offset:4096
  v_mfma_f32_16x16x32_bf16 v[160:163], a[140:143], v[232:235], v[160:163]
  v_mfma_f32_16x16x32_bf16 v[164:167], a[140:143], v[236:239], v[164:167]
  ds_read_b128 a[248:251], v22 offset:4096
  v_mfma_f32_16x16x32_bf16 v[168:171], a[140:143], v[240:243], v[168:171]
  v_mfma_f32_16x16x32_bf16 v[172:175], a[140:143], v[244:247], v[172:175]
  ds_read_b128 a[252:255], v23 offset:4096
  v_mfma_f32_16x16x32_bf16 v[176:179], a[140:143], v[248:251], v[176:179]
  v_mfma_f32_16x16x32_bf16 v[180:183], a[140:143], v[252:255], v[180:183]
  v_mfma_f32_16x16x32_bf16 v[184:187], a[172:175], v[232:235], v[184:187]
  v_mfma_f32_16x16x32_bf16 v[188:191], a[172:175], v[236:239], v[188:191]
  v_mfma_f32_16x16x32_bf16 v[192:195], a[172:175], v[240:243], v[192:195]
  v_mfma_f32_16x16x32_bf16 v[196:199], a[172:175], v[244:247], v[196:199]
  v_mfma_f32_16x16x32_bf16 v[200:203], a[172:175], v[248:251], v[200:203]
  v_mfma_f32_16x16x32_bf16 v[204:207], a[172:175], v[252:255], v[204:207]
  s_waitcnt lgkmcnt(0)
  v_mfma_f32_16x16x32_bf16 v[64:67], a[16:19], v[208:211], v[64:67]
  s_add_u32 m0, s33, 0
  s_add_u32 s46, s37, 14336
  buffer_load_dwordx4 v8, s[20:23], s37 offen offset:0 lds
  ds_read_b128 v[232:235], v3 offset:15360
  v_mfma_f32_16x16x32_bf16 v[68:71], a[16:19], v[212:215], v[68:71]
  v_mfma_f32_16x16x32_bf16 v[72:75], a[16:19], v[216:219], v[72:75]
  ds_read_b128 v[236:239], v3 offset:16384
  buffer_load_dwordx4 v9, s[20:23], s37 offen offset:1024 lds
  v_mfma_f32_16x16x32_bf16 v[76:79], a[16:19], v[220:223], v[76:79]
  v_mfma_f32_16x16x32_bf16 v[80:83], a[16:19], v[224:227], v[80:83]
  ds_read_b128 v[240:243], v3 offset:17408
  v_mfma_f32_16x16x32_bf16 v[84:87], a[16:19], v[228:231], v[84:87]
  buffer_load_dwordx4 v10, s[20:23], s37 offen offset:2048 lds
  v_mfma_f32_16x16x32_bf16 v[88:91], a[48:51], v[208:211], v[88:91]
  ds_read_b128 v[244:247], v3 offset:39936
  v_mfma_f32_16x16x32_bf16 v[92:95], a[48:51], v[212:215], v[92:95]
  v_mfma_f32_16x16x32_bf16 v[96:99], a[48:51], v[216:219], v[96:99]
  buffer_load_dwordx4 v11, s[20:23], s37 offen offset:3072 lds
  ds_read_b128 v[248:251], v3 offset:40960
  v_mfma_f32_16x16x32_bf16 v[100:103], a[48:51], v[220:223], v[100:103]
  v_mfma_f32_16x16x32_bf16 v[104:107], a[48:51], v[224:227], v[104:107]
  ds_read_b128 v[252:255], v3 offset:41984
  s_add_u32 m0, s33, 4096
  s_nop 0
  buffer_load_dwordx4 v8, s[20:23], s46 offen offset:0 lds
  v_mfma_f32_16x16x32_bf16 v[108:111], a[48:51], v[228:231], v[108:111]
  v_mfma_f32_16x16x32_bf16 v[112:115], a[80:83], v[208:211], v[112:115]
  v_mfma_f32_16x16x32_bf16 v[116:119], a[80:83], v[212:215], v[116:119]
  buffer_load_dwordx4 v9, s[20:23], s46 offen offset:1024 lds
  v_mfma_f32_16x16x32_bf16 v[120:123], a[80:83], v[216:219], v[120:123]
  v_mfma_f32_16x16x32_bf16 v[124:127], a[80:83], v[220:223], v[124:127]
  v_mfma_f32_16x16x32_bf16 v[128:131], a[80:83], v[224:227], v[128:131]
  buffer_load_dwordx4 v10, s[20:23], s46 offen offset:2048 lds
  v_mfma_f32_16x16x32_bf16 v[132:135], a[80:83], v[228:231], v[132:135]
  v_mfma_f32_16x16x32_bf16 v[136:139], a[112:115], v[208:211], v[136:139]
  v_mfma_f32_16x16x32_bf16 v[140:143], a[112:115], v[212:215], v[140:143]
  buffer_load_dwordx4 v11, s[20:23], s46 offen offset:3072 lds
  s_add_u32 s37, s37, 28672
  s_cmp_eq_u32 s37, s38
  s_cselect_b32 s47, 229376, 0
  s_sub_u32 s37, s37, s47
  v_mfma_f32_16x16x32_bf16 v[144:147], a[112:115], v[216:219], v[144:147]
  v_mfma_f32_16x16x32_bf16 v[148:151], a[112:115], v[220:223], v[148:151]
  v_mfma_f32_16x16x32_bf16 v[152:155], a[112:115], v[224:227], v[152:155]
  v_mfma_f32_16x16x32_bf16 v[156:159], a[112:115], v[228:231], v[156:159]
  v_mfma_f32_16x16x32_bf16 v[160:163], a[144:147], v[208:211], v[160:163]
  v_mfma_f32_16x16x32_bf16 v[164:167], a[144:147], v[212:215], v[164:167]
  v_mfma_f32_16x16x32_bf16 v[168:171], a[144:147], v[216:219], v[168:171]
  v_mfma_f32_16x16x32_bf16 v[172:175], a[144:147], v[220:223], v[172:175]
  v_mfma_f32_16x16x32_bf16 v[176:179], a[144:147], v[224:227], v[176:179]
  v_mfma_f32_16x16x32_bf16 v[180:183], a[144:147], v[228:231], v[180:183]
  v_mfma_f32_16x16x32_bf16 v[184:187], a[176:179], v[208:211], v[184:187]
  v_mfma_f32_16x16x32_bf16 v[188:191], a[176:179], v[212:215], v[188:191]
  v_mfma_f32_16x16x32_bf16 v[192:195], a[176:179], v[216:219], v[192:195]
  v_mfma_f32_16x16x32_bf16 v[196:199], a[176:179], v[220:223], v[196:199]
  v_mfma_f32_16x16x32_bf16 v[200:203], a[176:179], v[224:227], v[200:203]
  v_mfma_f32_16x16x32_bf16 v[204:207], a[176:179], v[228:231], v[204:207]
  s_waitcnt lgkmcnt(0)
  v_mfma_f32_16x16x32_bf16 v[64:67], a[20:23], v[232:235], v[64:67]
  ds_read_b128 v[208:211], v3 offset:18432
  v_mfma_f32_16x16x32_bf16 v[68:71], a[20:23], v[236:239], v[68:71]
  v_mfma_f32_16x16x32_bf16 v[72:75], a[20:23], v[240:243], v[72:75]
  ds_read_b128 v[212:215], v3 offset:19456
  v_mfma_f32_16x16x32_bf16 v[76:79], a[20:23], v[244:247], v[76:79]
  v_mfma_f32_16x16x32_bf16 v[80:83], a[20:23], v[248:251], v[80:83]
  ds_read_b128 v[216:219], v3 offset:20480
  v_mfma_f32_16x16x32_bf16 v[84:87], a[20:23], v[252:255], v[84:87]
  v_mfma_f32_16x16x32_bf16 v[88:91], a[52:55], v[232:235], v[88:91]
  ds_read_b128 v[220:223], v3 offset:43008
  v_mfma_f32_16x16x32_bf16 v[92:95], a[52:55], v[236:239], v[92:95]
  v_mfma_f32_16x16x32_bf16 v[96:99], a[52:55], v[240:243], v[96:99]
  ds_read_b128 v[224:227], v3 offset:44032
  v_mfma_f32_16x16x32_bf16 v[100:103], a[52:55], v[244:247], v[100:103]
  v_mfma_f32_16x16x32_bf16 v[104:107], a[52:55], v[248:251], v[104:107]
  ds_read_b128 v[228:231], v3 offset:45056
  v_mfma_f32_16x16x32_bf16 v[108:111], a[52:55], v[252:255], v[108:111]
  v_mfma_f32_16x16x32_bf16 v[112:115], a[84:87], v[232:235], v[112:115]
  v_mfma_f32_16x16x32_bf16 v[116:119], a[84:87], v[236:239], v[116:119]
  v_mfma_f32_16x16x32_bf16 v[120:123], a[84:87], v[240:243], v[120:123]
  v_mfma_f32_16x16x32_bf16 v[124:127], a[84:87], v[244:247], v[124:127]
  v_mfma_f32_16x16x32_bf16 v[128:131], a[84:87], v[248:251], v[128:131]
  v_mfma_f32_16x16x32_bf16 v[132:135], a[84:87], v[252:255], v[132:135]
  v_mfma_f32_16x16x32_bf16 v[136:139], a[116:119], v[232:235], v[136:139]
  v_mfma_f32_16x16x32_bf16 v[140:143], a[116:119], v[236:239], v[140:143]
  v_mfma_f32_16x16x32_bf16 v[144:147], a[116:119], v[240:243], v[144:147]
  v_mfma_f32_16x16x32_bf16 v[148:151], a[116:119], v[244:247], v[148:151]
  v_mfma_f32_16x16x32_bf16 v[152:155], a[116:119], v[248:251], v[152:155]
  v_mfma_f32_16x16x32_bf16 v[156:159], a[116:119], v[252:255], v[156:159]
  v_mfma_f32_16x16x32_bf16 v[160:163], a[148:151], v[232:235], v[160:163]
  v_mfma_f32_16x16x32_bf16 v[164:167], a[148:151], v[236:239], v[164:167]
  v_mfma_f32_16x16x32_bf16 v[168:171], a[148:151], v[240:243], v[168:171]
  v_mfma_f32_16x16x32_bf16 v[172:175], a[148:151], v[244:247], v[172:175]
  v_mfma_f32_16x16x32_bf16 v[176:179], a[148:151], v[248:251], v[176:179]
  v_mfma_f32_16x16x32_bf16 v[180:183], a[148:151], v[252:255], v[180:183]
  v_mfma_f32_16x16x32_bf16 v[184:187], a[180:183], v[232:235], v[184:187]
  v_mfma_f32_16x16x32_bf16 v[188:191], a[180:183], v[236:239], v[188:191]
  v_mfma_f32_16x16x32_bf16 v[192:195], a[180:183], v[240:243], v[192:195]
  v_mfma_f32_16x16x32_bf16 v[196:199], a[180:183], v[244:247], v[196:199]
  v_mfma_f32_16x16x32_bf16 v[200:203], a[180:183], v[248:251], v[200:203]
  v_mfma_f32_16x16x32_bf16 v[204:207], a[180:183], v[252:255], v[204:207]
  s_waitcnt lgkmcnt(0)
  v_mfma_f32_16x16x32_bf16 v[64:67], a[24:27], v[208:211], v[64:67]
  ds_read_b128 v[232:235], v3 offset:21504
  v_mfma_f32_16x16x32_bf16 v[68:71], a[24:27], v[212:215], v[68:71]
  v_mfma_f32_16x16x32_bf16 v[72:75], a[24:27], v[216:219], v[72:75]
  ds_read_b128 v[236:239], v3 offset:22528
  v_mfma_f32_16x16x32_bf16 v[76:79], a[24:27], v[220:223], v[76:79]
  v_mfma_f32_16x16x32_bf16 v[80:83], a[24:27], v[224:227], v[80:83]
  ds_read_b128 v[240:243], v3 offset:23552
  v_mfma_f32_16x16x32_bf16 v[84:87], a[24:27], v[228:231], v[84:87]
  v_mfma_f32_16x16x32_bf16 v[88:91], a[56:59], v[208:211], v[88:91]
  ds_read_b128 v[244:247], v3 offset:46080
  v_mfma_f32_16x16x32_bf16 v[92:95], a[56:59], v[212:215], v[92:95]
  v_mfma_f32_16x16x32_bf16 v[96:99], a[56:59], v[216:219], v[96:99]
  ds_read_b128 v[248:251], v3 offset:47104
  v_mfma_f32_16x16x32_bf16 v[100:103], a[56:59], v[220:223], v[100:103]
  v_mfma_f32_16x16x32_bf16 v[104:107], a[56:59], v[224:227], v[104:107]
  ds_read_b128 v[252:255], v3 offset:48128
  v_mfma_f32_16x16x32_bf16 v[108:111], a[56:59], v[228:231], v[108:111]
  v_mfma_f32_16x16x32_bf16 v[112:115], a[88:91], v[208:211], v[112:115]
  v_mfma_f32_16x16x32_bf16 v[116:119], a[88:91], v[212:215], v[116:119]
  v_mfma_f32_16x16x32_bf16 v[120:123], a[88:91], v[216:219], v[120:123]
  v_mfma_f32_16x16x32_bf16 v[124:127], a[88:91], v[220:223], v[124:127]
  v_mfma_f32_16x16x32_bf16 v[128:131], a[88:91], v[224:227], v[128:131]
  v_mfma_f32_16x16x32_bf16 v[132:135], a[88:91], v[228:231], v[132:135]
  v_mfma_f32_16x16x32_bf16 v[136:139], a[120:123], v[208:211], v[136:139]
  v_mfma_f32_16x16x32_bf16 v[140:143], a[120:123], v[212:215], v[140:143]
  v_mfma_f32_16x16x32_bf16 v[144:147], a[120:123], v[216:219], v[144:147]
  v_mfma_f32_16x16x32_bf16 v[148:151], a[120:123], v[220:223], v[148:151]
  v_mfma_f32_16x16x32_bf16 v[152:155], a[120:123], v[224:227], v[152:155]
  v_mfma_f32_16x16x32_bf16 v[156:159], a[120:123], v[228:231], v[156:159]
  v_mfma_f32_16x16x32_bf16 v[160:163], a[152:155], v[208:211], v[160:163]
  v_mfma_f32_16x16x32_bf16 v[164:167], a[152:155], v[212:215], v[164:167]
  v_mfma_f32_16x16x32_bf16 v[168:171], a[152:155], v[216:219], v[168:171]
  v_mfma_f32_16x16x32_bf16 v[172:175], a[152:155], v[220:223], v[172:175]
  v_mfma_f32_16x16x32_bf16 v[176:179], a[152:155], v[224:227], v[176:179]
  v_mfma_f32_16x16x32_bf16 v[180:183], a[152:155], v[228:231], v[180:183]
  v_mfma_f32_16x16x32_bf16 v[184:187], a[184:187], v[208:211], v[184:187]
  v_mfma_f32_16x16x32_bf16 v[188:191], a[184:187], v[212:215], v[188:191]
  v_mfma_f32_16x16x32_bf16 v[192:195], a[184:187], v[216:219], v[192:195]
  v_mfma_f32_16x16x32_bf16 v[196:199], a[184:187], v[220:223], v[196:199]
  v_mfma_f32_16x16x32_bf16 v[200:203], a[184:187], v[224:227], v[200:203]
  v_mfma_f32_16x16x32_bf16 v[204:207], a[184:187], v[228:231], v[204:207]
  s_waitcnt lgkmcnt(0)
  v_mfma_f32_16x16x32_bf16 v[64:67], a[28:31], v[232:235], v[64:67]
  v_mfma_f32_16x16x32_bf16 v[68:71], a[28:31], v[236:239], v[68:71]
  v_mfma_f32_16x16x32_bf16 v[72:75], a[28:31], v[240:243], v[72:75]
  v_mfma_f32_16x16x32_bf16 v[76:79], a[28:31], v[244:247], v[76:79]
  v_mfma_f32_16x16x32_bf16 v[80:83], a[28:31], v[248:251], v[80:83]
  v_mfma_f32_16x16x32_bf16 v[84:87], a[28:31], v[252:255], v[84:87]
  v_mfma_f32_16x16x32_bf16 v[88:91], a[60:63], v[232:235], v[88:91]
  v_mfma_f32_16x16x32_bf16 v[92:95], a[60:63], v[236:239], v[92:95]
  v_mfma_f32_16x16x32_bf16 v[96:99], a[60:63], v[240:243], v[96:99]
  v_mfma_f32_16x16x32_bf16 v[100:103], a[60:63], v[244:247], v[100:103]
  v_mfma_f32_16x16x32_bf16 v[104:107], a[60:63], v[248:251], v[104:107]
  v_mfma_f32_16x16x32_bf16 v[108:111], a[60:63], v[252:255], v[108:111]
  v_mfma_f32_16x16x32_bf16 v[112:115], a[92:95], v[232:235], v[112:115]
  v_mfma_f32_16x16x32_bf16 v[116:119], a[92:95], v[236:239], v[116:119]
  v_mfma_f32_16x16x32_bf16 v[120:123], a[92:95], v[240:243], v[120:123]
  v_mfma_f32_16x16x32_bf16 v[124:127], a[92:95], v[244:247], v[124:127]
  v_mfma_f32_16x16x32_bf16 v[128:131], a[92:95], v[248:251], v[128:131]
  v_mfma_f32_16x16x32_bf16 v[132:135], a[92:95], v[252:255], v[132:135]
  v_mfma_f32_16x16x32_bf16 v[136:139], a[124:127], v[232:235], v[136:139]
  v_mfma_f32_16x16x32_bf16 v[140:143], a[124:127], v[236:239], v[140:143]
  v_mfma_f32_16x16x32_bf16 v[144:147], a[124:127], v[240:243], v[144:147]
  v_mfma_f32_16x16x32_bf16 v[148:151], a[124:127], v[244:247], v[148:151]
  v_mfma_f32_16x16x32_bf16 v[152:155], a[124:127], v[248:251], v[152:155]
  v_mfma_f32_16x16x32_bf16 v[156:159], a[124:127], v[252:255], v[156:159]
  v_mfma_f32_16x16x32_bf16 v[160:163], a[156:159], v[232:235], v[160:163]
  v_mfma_f32_16x16x32_bf16 v[164:167], a[156:159], v[236:239], v[164:167]
  v_mfma_f32_16x16x32_bf16 v[168:171], a[156:159], v[240:243], v[168:171]
  v_mfma_f32_16x16x32_bf16 v[172:175], a[156:159], v[244:247], v[172:175]
  v_mfma_f32_16x16x32_bf16 v[176:179], a[156:159], v[248:251], v[176:179]
  v_mfma_f32_16x16x32_bf16 v[180:183], a[156:159], v[252:255], v[180:183]
  v_mfma_f32_16x16x32_bf16 v[184:187], a[188:191], v[232:235], v[184:187]
  v_mfma_f32_16x16x32_bf16 v[188:191], a[188:191], v[236:239], v[188:191]
  v_mfma_f32_16x16x32_bf16 v[192:195], a[188:191], v[240:243], v[192:195]
  v_mfma_f32_16x16x32_bf16 v[196:199], a[188:191], v[244:247], v[196:199]
  v_mfma_f32_16x16x32_bf16 v[200:203], a[188:191], v[248:251], v[200:203]
  v_mfma_f32_16x16x32_bf16 v[204:207], a[188:191], v[252:255], v[204:207]
  s_waitcnt lgkmcnt(0)
  ds_read_b128 v[16:19], v3 offset:0
  ds_read_b128 v[20:23], v3 offset:1024
  ds_read_b128 v[24:27], v3 offset:2048
  ds_read_b128 v[28:31], v3 offset:24576
  ds_read_b128 v[32:35], v3 offset:25600
  ds_read_b128 v[36:39], v3 offset:26624
  s_waitcnt lgkmcnt(0)
  v_mfma_f32_16x16x32_bf16 v[208:211], a[192:195], v[16:19], 0
  ds_read_b128 v[40:43], v3 offset:3072
  ds_read_b128 v[44:47], v3 offset:4096
  v_mfma_f32_16x16x32_bf16 v[212:215], a[192:195], v[20:23], 0
  ds_read_b128 v[48:51], v3 offset:5120
  v_mfma_f32_16x16x32_bf16 v[216:219], a[192:195], v[24:27], 0
  ds_read_b128 v[52:55], v3 offset:27648
  ds_read_b128 v[56:59], v3 offset:28672
  v_mfma_f32_16x16x32_bf16 v[220:223], a[192:195], v[28:31], 0
  ds_read_b128 v[60:63], v3 offset:29696
  v_mfma_f32_16x16x32_bf16 v[224:227], a[192:195], v[32:35], 0
  v_mfma_f32_16x16x32_bf16 v[228:231], a[192:195], v[36:39], 0
  v_mfma_f32_16x16x32_bf16 v[232:235], a[224:227], v[16:19], 0
  v_mfma_f32_16x16x32_bf16 v[236:239], a[224:227], v[20:23], 0
  v_mfma_f32_16x16x32_bf16 v[240:243], a[224:227], v[24:27], 0
  v_mfma_f32_16x16x32_bf16 v[244:247], a[224:227], v[28:31], 0
  v_mfma_f32_16x16x32_bf16 v[248:251], a[224:227], v[32:35], 0
  v_mfma_f32_16x16x32_bf16 v[252:255], a[224:227], v[36:39], 0
  s_waitcnt lgkmcnt(0)
  v_mfma_f32_16x16x32_bf16 v[208:211], a[196:199], v[40:43], v[208:211]
  ds_read_b128 v[16:19], v3 offset:6144
  ds_read_b128 v[20:23], v3 offset:7168
  v_mfma_f32_16x16x32_bf16 v[212:215], a[196:199], v[44:47], v[212:215]
  ds_read_b128 v[24:27], v3 offset:8192
  v_mfma_f32_16x16x32_bf16 v[216:219], a[196:199], v[48:51], v[216:219]
  ds_read_b128 v[28:31], v3 offset:30720
  ds_read_b128 v[32:35], v3 offset:31744
  v_mfma_f32_16x16x32_bf16 v[220:223], a[196:199], v[52:55], v[220:223]
  ds_read_b128 v[36:39], v3 offset:32768
  s_waitcnt vmcnt(16)
  v_mfma_f32_16x16x32_bf16 v[224:227], a[196:199], v[56:59], v[224:227]
  ds_read_b64_tr_b16 a[0:1], v12 offset:8192
  ds_read_b64_tr_b16 a[2:3], v12 offset:12288
  v_mfma_f32_16x16x32_bf16 v[228:231], a[196:199], v[60:63], v[228:231]
  ds_read_b64_tr_b16 a[32:33], v12 offset:8224
  ds_read_b64_tr_b16 a[34:35], v12 offset:12320
  v_mfma_f32_16x16x32_bf16 v[232:235], a[228:231], v[40:43], v[232:235]
  ds_read_b64_tr_b16 a[64:65], v12 offset:8256
  ds_read_b64_tr_b16 a[66:67], v12 offset:12352
  v_mfma_f32_16x16x32_bf16 v[236:239], a[228:231], v[44:47], v[236:239]
  ds_read_b64_tr_b16 a[96:97], v12 offset:8288
  v_mfma_f32_16x16x32_bf16 v[240:243], a[228:231], v[48:51], v[240:243]
  ds_read_b64_tr_b16 a[98:99], v12 offset:12384
  ds_read_b64_tr_b16 a[128:129], v12 offset:8320
  v_mfma_f32_16x16x32_bf16 v[244:247], a[228:231], v[52:55], v[244:247]
  ds_read_b64_tr_b16 a[130:131], v12 offset:12416
  ds_read_b64_tr_b16 a[160:161], v12 offset:8352
  v_mfma_f32_16x16x32_bf16 v[248:251], a[228:231], v[56:59], v[248:251]
  ds_read_b64_tr_b16 a[162:163], v12 offset:12448
  ds_read_b64_tr_b16 a[192:193], v12 offset:8384
  v_mfma_f32_16x16x32_bf16 v[252:255], a[228:231], v[60:63], v[252:255]
  ds_read_b64_tr_b16 a[194:195], v12 offset:12480
  s_waitcnt lgkmcnt(0)
  v_mfma_f32_16x16x32_bf16 v[208:211], a[200:203], v[16:19], v[208:211]
  s_add_u32 m0, s33, 8192
  s_add_u32 s46, s37, 14336
  buffer_load_dwordx4 v8, s[20:23], s37 offen offset:0 lds
  ds_read_b128 v[40:43], v3 offset:9216
  ds_read_b128 v[44:47], v3 offset:10240
  v_mfma_f32_16x16x32_bf16 v[212:215], a[200:203], v[20:23], v[212:215]
  ds_read_b128 v[48:51], v3 offset:11264
  v_mfma_f32_16x16x32_bf16 v[216:219], a[200:203], v[24:27], v[216:219]
  buffer_load_dwordx4 v9, s[20:23], s37 offen offset:1024 lds
  ds_read_b128 v[52:55], v3 offset:33792
  ds_read_b128 v[56:59], v3 offset:34816
  v_mfma_f32_16x16x32_bf16 v[220:223], a[200:203], v[28:31], v[220:223]
  ds_read_b128 v[60:63], v3 offset:35840
  s_waitcnt vmcnt(10)
  v_mfma_f32_16x16x32_bf16 v[224:227], a[200:203], v[32:35], v[224:227]
  buffer_load_dwordx4 v10, s[20:23], s37 offen offset:2048 lds
  ds_read_b64_tr_b16 a[4:5], v12 offset:16384
  ds_read_b64_tr_b16 a[6:7], v12 offset:20480
  v_mfma_f32_16x16x32_bf16 v[228:231], a[200:203], v[36:39], v[228:231]
  ds_read_b64_tr_b16 a[36:37], v12 offset:16416
  ds_read_b64_tr_b16 a[38:39], v12 offset:20512
  v_mfma_f32_16x16x32_bf16 v[232:235], a[232:235], v[16:19], v[232:235]
  buffer_load_dwordx4 v11, s[20:23], s37 offen offset:3072 lds
  ds_read_b64_tr_b16 a[68:69], v12 offset:16448
  ds_read_b64_tr_b16 a[70:71], v12 offset:20544
  v_mfma_f32_16x16x32_bf16 v[236:239], a[232:235], v[20:23], v[236:239]
  ds_read_b64_tr_b16 a[100:101], v12 offset:16480
  v_mfma_f32_16x16x32_bf16 v[240:243], a[232:235], v[24:27], v[240:243]
  s_add_u32 m0, s33, 12288
  s_nop 0
  buffer_load_dwordx4 v8, s[20:23], s46 offen offset:0 lds
  ds_read_b64_tr_b16 a[102:103], v12 offset:20576
  ds_read_b64_tr_b16 a[132:133], v12 offset:16512
  v_mfma_f32_16x16x32_bf16 v[244:247], a[232:235], v[28:31], v[244:247]
  ds_read_b64_tr_b16 a[134:135], v12 offset:20608
  ds_read_b64_tr_b16 a[164:165], v12 offset:16544
  v_mfma_f32_16x16x32_bf16 v[248:251], a[232:235], v[32:35], v[248:251]
  buffer_load_dwordx4 v9, s[20:23], s46 offen offset:1024 lds
  ds_read_b64_tr_b16 a[166:167], v12 offset:20640
  ds_read_b64_tr_b16 a[196:197], v12 offset:16576
  v_mfma_f32_16x16x32_bf16 v[252:255], a[232:235], v[36:39], v[252:255]
  ds_read_b64_tr_b16 a[198:199], v12 offset:20672
  s_waitcnt lgkmcnt(0)
  v_mfma_f32_16x16x32_bf16 v[208:211], a[204:207], v[40:43], v[208:211]
  buffer_load_dwordx4 v10, s[20:23], s46 offen offset:2048 lds
  ds_read_b128 v[16:19], v3 offset:12288
  ds_read_b128 v[20:23], v3 offset:13312
  v_mfma_f32_16x16x32_bf16 v[212:215], a[204:207], v[44:47], v[212:215]
  ds_read_b128 v[24:27], v3 offset:14336
  v_mfma_f32_16x16x32_bf16 v[216:219], a[204:207], v[48:51], v[216:219]
  buffer_load_dwordx4 v11, s[20:23], s46 offen offset:3072 lds
  s_add_u32 s37, s37, 28672
  s_cmp_eq_u32 s37, s38
  s_cselect_b32 s47, 229376, 0
  s_sub_u32 s37, s37, s47
  ds_read_b128 v[28:31], v3 offset:36864
  ds_read_b128 v[32:35], v3 offset:37888
  v_mfma_f32_16x16x32_bf16 v[220:223], a[204:207], v[52:55], v[220:223]
  ds_read_b128 v[36:39], v3 offset:38912
  s_waitcnt vmcnt(8)
  v_mfma_f32_16x16x32_bf16 v[224:227], a[204:207], v[56:59], v[224:227]
  s_add_u32 m0, s33, 16384
  s_add_u32 s46, s37, 14336
  buffer_load_dwordx4 v8, s[20:23], s37 offen offset:0 lds
  ds_read_b64_tr_b16 a[8:9], v12 offset:0
  ds_read_b64_tr_b16 a[10:11], v12 offset:4096
  v_mfma_f32_16x16x32_bf16 v[228:231], a[204:207], v[60:63], v[228:231]
  ds_read_b64_tr_b16 a[40:41], v12 offset:32
  ds_read_b64_tr_b16 a[42:43], v12 offset:4128
  v_mfma_f32_16x16x32_bf16 v[232:235], a[236:239], v[40:43], v[232:235]
  buffer_load_dwordx4 v9, s[20:23], s37 offen offset:1024 lds
  ds_read_b64_tr_b16 a[72:73], v12 offset:64
  ds_read_b64_tr_b16 a[74:75], v12 offset:4160
  v_mfma_f32_16x16x32_bf16 v[236:239], a[236:239], v[44:47], v[236:239]
  ds_read_b64_tr_b16 a[104:105], v12 offset:96
  v_mfma_f32_16x16x32_bf16 v[240:243], a[236:239], v[48:51], v[240:243]
  buffer_load_dwordx4 v10, s[20:23], s37 offen offset:2048 lds
  ds_read_b64_tr_b16 a[106:107], v12 offset:4192
  ds_read_b64_tr_b16 a[136:137], v12 offset:128
  v_mfma_f32_16x16x32_bf16 v[244:247], a[236:239], v[52:55], v[244:247]
  ds_read_b64_tr_b16 a[138:139], v12 offset:4224
  ds_read_b64_tr_b16 a[168:169], v12 offset:160
  v_mfma_f32_16x16x32_bf16 v[248:251], a[236:239], v[56:59], v[248:251]
  buffer_load_dwordx4 v11, s[20:23], s37 offen offset:3072 lds
  ds_read_b64_tr_b16 a[170:171], v12 offset:4256
  ds_read_b64_tr_b16 a[200:201], v12 offset:192
  v_mfma_f32_16x16x32_bf16 v[252:255], a[236:239], v[60:63], v[252:255]
  ds_read_b64_tr_b16 a[202:203], v12 offset:4288
  s_waitcnt lgkmcnt(0)
  v_mfma_f32_16x16x32_bf16 v[208:211], a[208:211], v[16:19], v[208:211]
  s_add_u32 m0, s33, 20480
  s_nop 0
  buffer_load_dwordx4 v8, s[20:23], s46 offen offset:0 lds
  ds_read_b128 v[40:43], v3 offset:15360
  ds_read_b128 v[44:47], v3 offset:16384
  v_mfma_f32_16x16x32_bf16 v[212:215], a[208:211], v[20:23], v[212:215]
  ds_read_b128 v[48:51], v3 offset:17408
  v_mfma_f32_16x16x32_bf16 v[216:219], a[208:211], v[24:27], v[216:219]
  buffer_load_dwordx4 v9, s[20:23], s46 offen offset:1024 lds
  ds_read_b128 v[52:55], v3 offset:39936
  ds_read_b128 v[56:59], v3 offset:40960
  v_mfma_f32_16x16x32_bf16 v[220:223], a[208:211], v[28:31], v[220:223]
  ds_read_b128 v[60:63], v3 offset:41984
  buffer_load_dwordx4 v10, s[20:23], s46 offen offset:2048 lds
  buffer_load_dwordx4 v11, s[20:23], s46 offen offset:3072 lds
  s_add_u32 s37, s37, 28672
  s_cmp_eq_u32 s37, s38
  s_cselect_b32 s47, 229376, 0
  s_sub_u32 s37, s37, s47
  s_waitcnt vmcnt(8)
  v_mfma_f32_16x16x32_bf16 v[224:227], a[208:211], v[32:35], v[224:227]
  ds_read_b64_tr_b16 a[12:13], v12 offset:8192
  ds_read_b64_tr_b16 a[14:15], v12 offset:12288
  v_mfma_f32_16x16x32_bf16 v[228:231], a[208:211], v[36:39], v[228:231]
  s_add_u32 m0, s33, 0
  s_add_u32 s46, s37, 14336
  buffer_load_dwordx4 v8, s[20:23], s37 offen offset:0 lds
  ds_read_b64_tr_b16 a[44:45], v12 offset:8224
  ds_read_b64_tr_b16 a[46:47], v12 offset:12320
  v_mfma_f32_16x16x32_bf16 v[232:235], a[240:243], v[16:19], v[232:235]
  ds_read_b64_tr_b16 a[76:77], v12 offset:8256
  ds_read_b64_tr_b16 a[78:79], v12 offset:12352
  v_mfma_f32_16x16x32_bf16 v[236:239], a[240:243], v[20:23], v[236:239]
  buffer_load_dwordx4 v9, s[20:23], s37 offen offset:1024 lds
  ds_read_b64_tr_b16 a[108:109], v12 offset:8288
  v_mfma_f32_16x16x32_bf16 v[240:243], a[240:243], v[24:27], v[240:243]
  ds_read_b64_tr_b16 a[110:111], v12 offset:12384
  ds_read_b64_tr_b16 a[140:141], v12 offset:8320
  v_mfma_f32_16x16x32_bf16 v[244:247], a[240:243], v[28:31], v[244:247]
  buffer_load_dwordx4 v10, s[20:23], s37 offen offset:2048 lds
  ds_read_b64_tr_b16 a[142:143], v12 offset:12416
  ds_read_b64_tr_b16 a[172:173], v12 offset:8352
  v_mfma_f32_16x16x32_bf16 v[248:251], a[240:243], v[32:35], v[248:251]
  ds_read_b64_tr_b16 a[174:175], v12 offset:12448
  ds_read_b64_tr_b16 a[204:205], v12 offset:8384
  v_mfma_f32_16x16x32_bf16 v[252:255], a[240:243], v[36:39], v[252:255]
  buffer_load_dwordx4 v11, s[20:23], s37 offen offset:3072 lds
  ds_read_b64_tr_b16 a[206:207], v12 offset:12480
  s_waitcnt lgkmcnt(0)
  v_mfma_f32_16x16x32_bf16 v[208:211], a[212:215], v[40:43], v[208:211]
  ds_read_b128 v[16:19], v3 offset:18432
  ds_read_b128 v[20:23], v3 offset:19456
  v_mfma_f32_16x16x32_bf16 v[212:215], a[212:215], v[44:47], v[212:215]
  s_add_u32 m0, s33, 4096
  s_nop 0
  buffer_load_dwordx4 v8, s[20:23], s46 offen offset:0 lds
  ds_read_b128 v[24:27], v3 offset:20480
  v_mfma_f32_16x16x32_bf16 v[216:219], a[212:215], v[48:51], v[216:219]
  ds_read_b128 v[28:31], v3 offset:43008
  ds_read_b128 v[32:35], v3 offset:44032
  v_mfma_f32_16x16x32_bf16 v[220:223], a[212:215], v[52:55], v[220:223]
  buffer_load_dwordx4 v9, s[20:23], s46 offen offset:1024 lds
  ds_read_b128 v[36:39], v3 offset:45056
  buffer_load_dwordx4 v10, s[20:23], s46 offen offset:2048 lds
  buffer_load_dwordx4 v11, s[20:23], s46 offen offset:3072 lds
  s_add_u32 s37, s37, 28672
  s_cmp_eq_u32 s37, s38
  s_cselect_b32 s47, 229376, 0
  s_sub_u32 s37, s37, s47
  s_waitcnt vmcnt(8)
  v_mfma_f32_16x16x32_bf16 v[224:227], a[212:215], v[56:59], v[224:227]
  ds_read_b64_tr_b16 a[16:17], v12 offset:16384
  ds_read_b64_tr_b16 a[18:19], v12 offset:20480
  v_mfma_f32_16x16x32_bf16 v[228:231], a[212:215], v[60:63], v[228:231]
  s_add_u32 m0, s33, 8192
  s_add_u32 s46, s37, 14336
  buffer_load_dwordx4 v8, s[20:23], s37 offen offset:0 lds
  ds_read_b64_tr_b16 a[48:49], v12 offset:16416
  ds_read_b64_tr_b16 a[50:51], v12 offset:20512
  v_mfma_f32_16x16x32_bf16 v[232:235], a[244:247], v[40:43], v[232:235]
  ds_read_b64_tr_b16 a[80:81], v12 offset:16448
  ds_read_b64_tr_b16 a[82:83], v12 offset:20544
  v_mfma_f32_16x16x32_bf16 v[236:239], a[244:247], v[44:47], v[236:239]
  buffer_load_dwordx4 v9, s[20:23], s37 offen offset:1024 lds
  ds_read_b64_tr_b16 a[112:113], v12 offset:16480
  v_mfma_f32_16x16x32_bf16 v[240:243], a[244:247], v[48:51], v[240:243]
  ds_read_b64_tr_b16 a[114:115], v12 offset:20576
  ds_read_b64_tr_b16 a[144:145], v12 offset:16512
  v_mfma_f32_16x16x32_bf16 v[244:247], a[244:247], v[52:55], v[244:247]
  buffer_load_dwordx4 v10, s[20:23], s37 offen offset:2048 lds
  ds_read_b64_tr_b16 a[146:147], v12 offset:20608
  ds_read_b64_tr_b16 a[176:177], v12 offset:16544
  v_mfma_f32_16x16x32_bf16 v[248:251], a[244:247], v[56:59], v[248:251]
  ds_read_b64_tr_b16 a[178:179], v12 offset:20640
  ds_read_b64_tr_b16 a[208:209], v12 offset:16576
  v_mfma_f32_16x16x32_bf16 v[252:255], a[244:247], v[60:63], v[252:255]
  buffer_load_dwordx4 v11, s[20:23], s37 offen offset:3072 lds
  ds_read_b64_tr_b16 a[210:211], v12 offset:20672
  s_waitcnt lgkmcnt(0)
  v_mfma_f32_16x16x32_bf16 v[208:211], a[216:219], v[16:19], v[208:211]
  ds_read_b128 v[40:43], v3 offset:21504
  ds_read_b128 v[44:47], v3 offset:22528
  v_mfma_f32_16x16x32_bf16 v[212:215], a[216:219], v[20:23], v[212:215]
  s_add_u32 m0, s33, 12288
  s_nop 0
  buffer_load_dwordx4 v8, s[20:23], s46 offen offset:0 lds
  ds_read_b128 v[48:51], v3 offset:23552
  v_mfma_f32_16x16x32_bf16 v[216:219], a[216:219], v[24:27], v[216:219]
  ds_read_b128 v[52:55], v3 offset:46080
  ds_read_b128 v[56:59], v3 offset:47104
  v_mfma_f32_16x16x32_bf16 v[220:223], a[216:219], v[28:31], v[220:223]
  buffer_load_dwordx4 v9, s[20:23], s46 offen offset:1024 lds
  ds_read_b128 v[60:63], v3 offset:48128
  buffer_load_dwordx4 v10, s[20:23], s46 offen offset:2048 lds
  buffer_load_dwordx4 v11, s[20:23], s46 offen offset:3072 lds
  s_add_u32 s37, s37, 28672
  s_cmp_eq_u32 s37, s38
  s_cselect_b32 s47, 229376, 0
  s_sub_u32 s37, s37, s47
  s_waitcnt vmcnt(8)
  v_mfma_f32_16x16x32_bf16 v[224:227], a[216:219], v[32:35], v[224:227]
  ds_read_b64_tr_b16 a[20:21], v12 offset:0
  ds_read_b64_tr_b16 a[22:23], v12 offset:4096
  v_mfma_f32_16x16x32_bf16 v[228:231], a[216:219], v[36:39], v[228:231]
  s_add_u32 m0, s33, 16384
  s_add_u32 s46, s37, 14336
  buffer_load_dwordx4 v8, s[20:23], s37 offen offset:0 lds
  ds_read_b64_tr_b16 a[52:53], v12 offset:32
  ds_read_b64_tr_b16 a[54:55], v12 offset:4128
  v_mfma_f32_16x16x32_bf16 v[232:235], a[248:251], v[16:19], v[232:235]
  ds_read_b64_tr_b16 a[84:85], v12 offset:64
  ds_read_b64_tr_b16 a[86:87], v12 offset:4160
  v_mfma_f32_16x16x32_bf16 v[236:239], a[248:251], v[20:23], v[236:239]
  buffer_load_dwordx4 v9, s[20:23], s37 offen offset:1024 lds
  ds_read_b64_tr_b16 a[116:117], v12 offset:96
  v_mfma_f32_16x16x32_bf16 v[240:243], a[248:251], v[24:27], v[240:243]
  ds_read_b64_tr_b16 a[118:119], v12 offset:4192
  ds_read_b64_tr_b16 a[148:149], v12 offset:128
  v_mfma_f32_16x16x32_bf16 v[244:247], a[248:251], v[28:31], v[244:247]
  buffer_load_dwordx4 v10, s[20:23], s37 offen offset:2048 lds
  ds_read_b64_tr_b16 a[150:151], v12 offset:4224
  ds_read_b64_tr_b16 a[180:181], v12 offset:160
  v_mfma_f32_16x16x32_bf16 v[248:251], a[248:251], v[32:35], v[248:251]
  ds_read_b64_tr_b16 a[182:183], v12 offset:4256
  ds_read_b64_tr_b16 a[212:213], v12 offset:192
  v_mfma_f32_16x16x32_bf16 v[252:255], a[248:251], v[36:39], v[252:255]
  buffer_load_dwordx4 v11, s[20:23], s37 offen offset:3072 lds
  ds_read_b64_tr_b16 a[214:215], v12 offset:4288
  s_waitcnt lgkmcnt(0)
  v_mfma_f32_16x16x32_bf16 v[208:211], a[220:223], v[40:43], v[208:211]
  v_mfma_f32_16x16x32_bf16 v[212:215], a[220:223], v[44:47], v[212:215]
  v_mfma_f32_16x16x32_bf16 v[216:219], a[220:223], v[48:51], v[216:219]
  s_add_u32 m0, s33, 20480
  s_nop 0
  buffer_load_dwordx4 v8, s[20:23], s46 offen offset:0 lds
  v_mfma_f32_16x16x32_bf16 v[220:223], a[220:223], v[52:55], v[220:223]
  buffer_load_dwordx4 v9, s[20:23], s46 offen offset:1024 lds
  buffer_load_dwordx4 v10, s[20:23], s46 offen offset:2048 lds
  buffer_load_dwordx4 v11, s[20:23], s46 offen offset:3072 lds
  s_add_u32 s37, s37, 28672
  s_cmp_eq_u32 s37, s38
  s_cselect_b32 s47, 229376, 0
  s_sub_u32 s37, s37, s47
  s_add_u32 s37, s37, 229376
  s_add_u32 s38, s38, 229376
  s_waitcnt vmcnt(8)
  v_mfma_f32_16x16x32_bf16 v[224:227], a[220:223], v[56:59], v[224:227]
  ds_read_b64_tr_b16 a[24:25], v12 offset:8192
  ds_read_b64_tr_b16 a[26:27], v12 offset:12288
  v_mfma_f32_16x16x32_bf16 v[228:231], a[220:223], v[60:63], v[228:231]
  ds_read_b64_tr_b16 a[56:57], v12 offset:8224
  ds_read_b64_tr_b16 a[58:59], v12 offset:12320
  v_mfma_f32_16x16x32_bf16 v[232:235], a[252:255], v[40:43], v[232:235]
  ds_read_b64_tr_b16 a[88:89], v12 offset:8256
  ds_read_b64_tr_b16 a[90:91], v12 offset:12352
  v_mfma_f32_16x16x32_bf16 v[236:239], a[252:255], v[44:47], v[236:239]
  ds_read_b64_tr_b16 a[120:121], v12 offset:8288
  v_mfma_f32_16x16x32_bf16 v[240:243], a[252:255], v[48:51], v[240:243]
  ds_read_b64_tr_b16 a[122:123], v12 offset:12384
  ds_read_b64_tr_b16 a[152:153], v12 offset:8320
  v_mfma_f32_16x16x32_bf16 v[244:247], a[252:255], v[52:55], v[244:247]
  ds_read_b64_tr_b16 a[154:155], v12 offset:12416
  ds_read_b64_tr_b16 a[184:185], v12 offset:8352
  v_mfma_f32_16x16x32_bf16 v[248:251], a[252:255], v[56:59], v[248:251]
  s_add_u32 m0, s33, 0
  s_add_u32 s46, s35, 32768
  buffer_load_dwordx4 v4, s[12:15], s35 offen offset:0 nt lds
  ds_read_b64_tr_b16 a[186:187], v12 offset:12448
  ds_read_b64_tr_b16 a[216:217], v12 offset:8384
  v_mfma_f32_16x16x32_bf16 v[252:255], a[252:255], v[60:63], v[252:255]
  ds_read_b64_tr_b16 a[218:219], v12 offset:12480
  s_waitcnt lgkmcnt(0)
  s_nop 7
  v_max3_f32 v16, v64, v65, v66
  v_max3_f32 v18, v68, v69, v70
  v_max3_f32 v20, v72, v73, v74
  v_max3_f32 v22, v76, v77, v78
  v_max3_f32 v24, v80, v81, v82
  v_max3_f32 v26, v84, v85, v86
  v_max3_f32 v16, v16, v67, v88
  v_max3_f32 v18, v18, v71, v92
  v_max3_f32 v20, v20, v75, v96
  v_max3_f32 v22, v22, v79, v100
  v_max3_f32 v24, v24, v83, v104
  v_max3_f32 v26, v26, v87, v108
  v_max3_f32 v16, v16, v89, v90
  v_max3_f32 v18, v18, v93, v94
  v_max3_f32 v20, v20, v97, v98
  v_max3_f32 v22, v22, v101, v102
  v_max3_f32 v24, v24, v105, v106
  v_max3_f32 v26, v26, v109, v110
  v_max3_f32 v16, v16, v91, v112
  v_max3_f32 v18, v18, v95, v116
  v_max3_f32 v20, v20, v99, v120
  v_max3_f32 v22, v22, v103, v124
  v_max3_f32 v24, v24, v107, v128
  v_max3_f32 v26, v26, v111, v132
  v_max3_f32 v16, v16, v113, v114
  v_max3_f32 v18, v18, v117, v118
  v_max3_f32 v20, v20, v121, v122
  v_max3_f32 v22, v22, v125, v126
  v_max3_f32 v24, v24, v129, v130
  v_max3_f32 v26, v26, v133, v134
  v_max3_f32 v16, v16, v115, v136
  v_max3_f32 v18, v18, v119, v140
  buffer_load_dwordx4 v5, s[12:15], s35 offen offset:1024 nt lds
  v_max3_f32 v20, v20, v123, v144
  v_max3_f32 v22, v22, v127, v148
  v_max3_f32 v24, v24, v131, v152
  v_max3_f32 v26, v26, v135, v156
  v_max3_f32 v16, v16, v137, v138
  v_max3_f32 v18, v18, v141, v142
  v_max3_f32 v20, v20, v145, v146
  v_max3_f32 v22, v22, v149, v150
  v_max3_f32 v24, v24, v153, v154
  v_max3_f32 v26, v26, v157, v158
  v_max3_f32 v16, v16, v139, v160
  v_max3_f32 v18, v18, v143, v164
  v_max3_f32 v20, v20, v147, v168
  v_max3_f32 v22, v22, v151, v172
  v_max3_f32 v24, v24, v155, v176
  v_max3_f32 v26, v26, v159, v180
  v_max3_f32 v16, v16, v161, v162
  v_max3_f32 v18, v18, v165, v166
  v_max3_f32 v20, v20, v169, v170
  v_max3_f32 v22, v22, v173, v174
  v_max3_f32 v24, v24, v177, v178
  v_max3_f32 v26, v26, v181, v182
  v_max3_f32 v16, v16, v163, v184
  v_max3_f32 v18, v18, v167, v188
  v_max3_f32 v20, v20, v171, v192
  v_max3_f32 v22, v22, v175, v196
  v_max3_f32 v24, v24, v179, v200
  v_max3_f32 v26, v26, v183, v204
  v_max3_f32 v16, v16, v185, v186
  v_max3_f32 v18, v18, v189, v190
  v_max3_f32 v20, v20, v193, v194
  v_max3_f32 v22, v22, v197, v198
  v_max3_f32 v24, v24, v201, v202
  v_max3_f32 v26, v26, v205, v206
  v_max3_f32 v16, v16, v187, v208
  v_max3_f32 v18, v18, v191, v212
  v_max3_f32 v20, v20, v195, v216
  v_max3_f32 v22, v22, v199, v220
  v_max3_f32 v24, v24, v203, v224
  v_max3_f32 v26, v26, v207, v228
  v_max3_f32 v16, v16, v209, v210
  v_max3_f32 v18, v18, v213, v214
  v_max3_f32 v20, v20, v217, v218
  buffer_load_dwordx4 v6, s[12:15], s35 offen offset:2048 nt lds
  v_max3_f32 v22, v22, v221, v222
  v_max3_f32 v24, v24, v225, v226
  v_max3_f32 v26, v26, v229, v230
  v_max3_f32 v16, v16, v211, v232
  v_max3_f32 v18, v18, v215, v236
  v_max3_f32 v20, v20, v219, v240
  v_max3_f32 v22, v22, v223, v244
  v_max3_f32 v24, v24, v227, v248
  v_max3_f32 v26, v26, v231, v252
  v_max3_f32 v16, v16, v233, v234
  v_max3_f32 v18, v18, v237, v238
  v_max3_f32 v20, v20, v241, v242
  v_max3_f32 v22, v22, v245, v246
  v_max3_f32 v24, v24, v249, v250
  v_max3_f32 v26, v26, v253, v254
  v_max_f32 v16, v16, v235
  v_max_f32 v18, v18, v239
  v_max_f32 v20, v20, v243
  v_max_f32 v22, v22, v247
  v_max_f32 v24, v24, v251
  v_max_f32 v26, v26, v255
  v_mov_b32 v17, v16
  v_mov_b32 v19, v18
  v_mov_b32 v21, v20
  v_mov_b32 v23, v22
  v_mov_b32 v25, v24
  v_mov_b32 v27, v26
  s_nop 1
  v_permlane32_swap_b32 v17, v16
  v_permlane32_swap_b32 v19, v18
  v_permlane32_swap_b32 v21, v20
  v_permlane32_swap_b32 v23, v22
  v_permlane32_swap_b32 v25, v24
  v_permlane32_swap_b32 v27, v26
  s_nop 1
  v_max_f32 v16, v16, v17
  v_max_f32 v18, v18, v19
  v_max_f32 v20, v20, v21
  v_max_f32 v22, v22, v23
  v_max_f32 v24, v24, v25
  v_max_f32 v26, v26, v27
  v_mov_b32 v17, v16
  buffer_load_dwordx4 v7, s[12:15], s35 offen offset:3072 nt lds
  v_mov_b32 v19, v18
  v_mov_b32 v21, v20
  v_mov_b32 v23, v22
  v_mov_b32 v25, v24
  v_mov_b32 v27, v26
  s_nop 1
  v_permlane16_swap_b32 v17, v16
  v_permlane16_swap_b32 v19, v18
  v_permlane16_swap_b32 v21, v20
  v_permlane16_swap_b32 v23, v22
  v_permlane16_swap_b32 v25, v24
  v_permlane16_swap_b32 v27, v26
  s_nop 1
  v_max_f32 v16, v16, v17
  v_max_f32 v18, v18, v19
  v_max_f32 v20, v20, v21
  v_max_f32 v22, v22, v23
  v_max_f32 v24, v24, v25
  v_max_f32 v26, v26, v27
  ds_write_b32 v13, v16 offset:0
  ds_write_b32 v13, v18 offset:256
  ds_write_b32 v13, v20 offset:512
  ds_write_b32 v13, v22 offset:768
  ds_write_b32 v13, v24 offset:1024
  ds_write_b32 v13, v26 offset:1280
  s_waitcnt lgkmcnt(0)
  s_add_u32 m0, s33, 4096
  s_nop 0
  buffer_load_dwordx4 v4, s[12:15], s46 offen offset:0 nt lds
  s_barrier
  ds_read_b128 v[40:43], v14 offset:0
  ds_read_b128 v[44:47], v14 offset:256
  ds_read_b128 v[48:51], v14 offset:512
  ds_read_b128 v[52:55], v14 offset:768
  ds_read_b128 v[56:59], v14 offset:1024
  ds_read_b128 v[60:63], v14 offset:1280
  s_waitcnt vmcnt(5)
  ds_read_b64_tr_b16 a[28:29], v12 offset:16384
  ds_read_b64_tr_b16 a[30:31], v12 offset:20480
  ds_read_b64_tr_b16 a[60:61], v12 offset:16416
  ds_read_b64_tr_b16 a[62:63], v12 offset:20512
  ds_read_b64_tr_b16 a[92:93], v12 offset:16448
  ds_read_b64_tr_b16 a[94:95], v12 offset:20544
  ds_read_b64_tr_b16 a[124:125], v12 offset:16480
  ds_read_b64_tr_b16 a[126:127], v12 offset:20576
  ds_read_b64_tr_b16 a[156:157], v12 offset:16512
  ds_read_b64_tr_b16 a[158:159], v12 offset:20608
  ds_read_b64_tr_b16 a[188:189], v12 offset:16544
  ds_read_b64_tr_b16 a[190:191], v12 offset:20640
  ds_read_b64_tr_b16 a[220:221], v12 offset:16576
  buffer_load_dwordx4 v5, s[12:15], s46 offen offset:1024 nt lds
  ds_read_b64_tr_b16 a[222:223], v12 offset:20672
  s_waitcnt lgkmcnt(0)
  buffer_load_dwordx4 v6, s[12:15], s46 offen offset:2048 nt lds
  buffer_load_dwordx4 v7, s[12:15], s46 offen offset:3072 nt lds
  s_add_u32 s35, s35, 16384
  s_lshl_b32 s39, s3, 4
  s_add_u32 s39, s39, s5
  s_mul_i32 s39, s39, 28672
  s_add_u32 s52, s88, s39
  s_addc_u32 s53, s89, 0
  s_mov_b32 s54, 28672
  s_mov_b32 s55, 0x20000
  v_lshlrev_b32 v15, 4, v0
  s_mov_b32 m0, 150528
  s_mul_i32 s40, s32, 7168
  buffer_load_dwordx4 v15, s[52:55], s40 offen offset:0 lds
  buffer_load_dwordx4 v15, s[52:55], s40 offen offset:1024 lds
  buffer_load_dwordx4 v15, s[52:55], s40 offen offset:2048 lds
  buffer_load_dwordx4 v15, s[52:55], s40 offen offset:3072 lds
  s_add_u32 s40, s40, 4096
  buffer_load_dwordx4 v15, s[52:55], s40 offen offset:0 lds
  buffer_load_dwordx4 v15, s[52:55], s40 offen offset:1024 lds
  buffer_load_dwordx4 v15, s[52:55], s40 offen offset:2048 lds
  s_waitcnt lgkmcnt(0)
  v_max3_f32 v16, v40, v41, v42
  v_max3_f32 v18, v44, v45, v46
  v_max3_f32 v20, v48, v49, v50
  v_max3_f32 v22, v52, v53, v54
  v_max3_f32 v24, v56, v57, v58
  v_max3_f32 v26, v60, v61, v62
  v_max_f32 v16, v16, v43
  v_max_f32 v18, v18, v47
  v_max_f32 v20, v20, v51
  v_max_f32 v22, v22, v55
  v_max_f32 v24, v24, v59
  v_max_f32 v26, v26, v63
  v_mul_f32 v16, s101, v16
  v_mul_f32 v18, s101, v18
  v_mul_f32 v20, s101, v20
  v_mul_f32 v22, s101, v22
  v_mul_f32 v24, s101, v24
  v_mul_f32 v26, s101, v26
  v_pk_fma_f32 v[64:65], v[64:65], s[100:101], v[16:17] op_sel_hi:[1,0,0]
  v_pk_fma_f32 v[68:69], v[68:69], s[100:101], v[18:19] op_sel_hi:[1,0,0]
  v_pk_fma_f32 v[72:73], v[72:73], s[100:101], v[20:21] op_sel_hi:[1,0,0]
  v_pk_fma_f32 v[76:77], v[76:77], s[100:101], v[22:23] op_sel_hi:[1,0,0]
  v_pk_fma_f32 v[80:81], v[80:81], s[100:101], v[24:25] op_sel_hi:[1,0,0]
  v_pk_fma_f32 v[84:85], v[84:85], s[100:101], v[26:27] op_sel_hi:[1,0,0]
  v_pk_fma_f32 v[66:67], v[66:67], s[100:101], v[16:17] op_sel_hi:[1,0,0]
  v_pk_fma_f32 v[70:71], v[70:71], s[100:101], v[18:19] op_sel_hi:[1,0,0]
  v_pk_fma_f32 v[74:75], v[74:75], s[100:101], v[20:21] op_sel_hi:[1,0,0]
  v_pk_fma_f32 v[78:79], v[78:79], s[100:101], v[22:23] op_sel_hi:[1,0,0]
  s_add_u32 m0, s33, 8192
  s_add_u32 s46, s35, 32768
  buffer_load_dwordx4 v4, s[12:15], s35 offen offset:0 nt lds
  v_pk_fma_f32 v[82:83], v[82:83], s[100:101], v[24:25] op_sel_hi:[1,0,0]
  v_pk_fma_f32 v[86:87], v[86:87], s[100:101], v[26:27] op_sel_hi:[1,0,0]
  v_exp_f32 v64, v64
  v_exp_f32 v65, v65
  v_exp_f32 v68, v68
  v_exp_f32 v69, v69
  v_exp_f32 v72, v72
  v_exp_f32 v73, v73
  v_exp_f32 v76, v76
  v_exp_f32 v77, v77
  v_exp_f32 v80, v80
  v_exp_f32 v81, v81
  v_exp_f32 v84, v84
  v_exp_f32 v85, v85
  v_pk_fma_f32 v[88:89], v[88:89], s[100:101], v[16:17] op_sel_hi:[1,0,0]
  v_pk_fma_f32 v[92:93], v[92:93], s[100:101], v[18:19] op_sel_hi:[1,0,0]
  v_pk_fma_f32 v[96:97], v[96:97], s[100:101], v[20:21] op_sel_hi:[1,0,0]
  v_pk_fma_f32 v[100:101], v[100:101], s[100:101], v[22:23] op_sel_hi:[1,0,0]
  v_pk_fma_f32 v[104:105], v[104:105], s[100:101], v[24:25] op_sel_hi:[1,0,0]
  v_pk_fma_f32 v[108:109], v[108:109], s[100:101], v[26:27] op_sel_hi:[1,0,0]
  v_exp_f32 v66, v66
  v_exp_f32 v67, v67
  v_exp_f32 v70, v70
  v_exp_f32 v71, v71
  v_exp_f32 v74, v74
  v_exp_f32 v75, v75
  buffer_load_dwordx4 v5, s[12:15], s35 offen offset:1024 nt lds
  v_exp_f32 v78, v78
  v_exp_f32 v79, v79
  v_exp_f32 v82, v82
  v_exp_f32 v83, v83
  v_exp_f32 v86, v86
  v_exp_f32 v87, v87
  v_pk_fma_f32 v[90:91], v[90:91], s[100:101], v[16:17] op_sel_hi:[1,0,0]
  v_pk_fma_f32 v[94:95], v[94:95], s[100:101], v[18:19] op_sel_hi:[1,0,0]
  v_pk_fma_f32 v[98:99], v[98:99], s[100:101], v[20:21] op_sel_hi:[1,0,0]
  v_pk_fma_f32 v[102:103], v[102:103], s[100:101], v[22:23] op_sel_hi:[1,0,0]
  v_pk_fma_f32 v[106:107], v[106:107], s[100:101], v[24:25] op_sel_hi:[1,0,0]
  v_pk_fma_f32 v[110:111], v[110:111], s[100:101], v[26:27] op_sel_hi:[1,0,0]
  v_exp_f32 v88, v88
  v_exp_f32 v89, v89
  v_exp_f32 v92, v92
  v_exp_f32 v93, v93
  v_exp_f32 v96, v96
  v_exp_f32 v97, v97
  v_exp_f32 v100, v100
  v_exp_f32 v101, v101
  v_exp_f32 v104, v104
  v_exp_f32 v105, v105
  v_exp_f32 v108, v108
  v_exp_f32 v109, v109
  v_pk_add_f32 v[28:29], v[64:65], v[66:67]
  buffer_load_dwordx4 v6, s[12:15], s35 offen offset:2048 nt lds
  v_pk_add_f32 v[30:31], v[68:69], v[70:71]
  v_pk_add_f32 v[32:33], v[72:73], v[74:75]
  v_pk_add_f32 v[34:35], v[76:77], v[78:79]
  v_pk_add_f32 v[36:37], v[80:81], v[82:83]
  v_pk_add_f32 v[38:39], v[84:85], v[86:87]
  v_pk_fma_f32 v[112:113], v[112:113], s[100:101], v[16:17] op_sel_hi:[1,0,0]
  v_pk_fma_f32 v[116:117], v[116:117], s[100:101], v[18:19] op_sel_hi:[1,0,0]
  v_pk_fma_f32 v[120:121], v[120:121], s[100:101], v[20:21] op_sel_hi:[1,0,0]
  v_pk_fma_f32 v[124:125], v[124:125], s[100:101], v[22:23] op_sel_hi:[1,0,0]
  v_pk_fma_f32 v[128:129], v[128:129], s[100:101], v[24:25] op_sel_hi:[1,0,0]
  v_pk_fma_f32 v[132:133], v[132:133], s[100:101], v[26:27] op_sel_hi:[1,0,0]
  v_exp_f32 v90, v90
  v_exp_f32 v91, v91
  v_exp_f32 v94, v94
  v_exp_f32 v95, v95
  v_exp_f32 v98, v98
  v_exp_f32 v99, v99
  v_exp_f32 v102, v102
  v_exp_f32 v103, v103
  v_exp_f32 v106, v106
  v_exp_f32 v107, v107
  v_exp_f32 v110, v110
  v_exp_f32 v111, v111
  v_pk_add_f32 v[28:29], v[28:29], v[88:89]
  v_pk_add_f32 v[30:31], v[30:31], v[92:93]
  v_pk_add_f32 v[32:33], v[32:33], v[96:97]
  v_pk_add_f32 v[34:35], v[34:35], v[100:101]
  v_pk_add_f32 v[36:37], v[36:37], v[104:105]
  v_pk_add_f32 v[38:39], v[38:39], v[108:109]
  v_pk_fma_f32 v[114:115], v[114:115], s[100:101], v[16:17] op_sel_hi:[1,0,0]
  v_pk_fma_f32 v[118:119], v[118:119], s[100:101], v[18:19] op_sel_hi:[1,0,0]
  buffer_load_dwordx4 v7, s[12:15], s35 offen offset:3072 nt lds
  v_pk_fma_f32 v[122:123], v[122:123], s[100:101], v[20:21] op_sel_hi:[1,0,0]
  v_pk_fma_f32 v[126:127], v[126:127], s[100:101], v[22:23] op_sel_hi:[1,0,0]
  v_pk_fma_f32 v[130:131], v[130:131], s[100:101], v[24:25] op_sel_hi:[1,0,0]
  v_pk_fma_f32 v[134:135], v[134:135], s[100:101], v[26:27] op_sel_hi:[1,0,0]
  v_exp_f32 v112, v112
  v_exp_f32 v113, v113
  v_exp_f32 v116, v116
  v_exp_f32 v117, v117
  v_exp_f32 v120, v120
  v_exp_f32 v121, v121
  v_exp_f32 v124, v124
  v_exp_f32 v125, v125
  v_exp_f32 v128, v128
  v_exp_f32 v129, v129
  v_exp_f32 v132, v132
  v_exp_f32 v133, v133
  v_pk_add_f32 v[28:29], v[28:29], v[90:91]
  v_pk_add_f32 v[30:31], v[30:31], v[94:95]
  v_pk_add_f32 v[32:33], v[32:33], v[98:99]
  v_pk_add_f32 v[34:35], v[34:35], v[102:103]
  v_pk_add_f32 v[36:37], v[36:37], v[106:107]
  v_pk_add_f32 v[38:39], v[38:39], v[110:111]
  v_pk_fma_f32 v[136:137], v[136:137], s[100:101], v[16:17] op_sel_hi:[1,0,0]
  v_pk_fma_f32 v[140:141], v[140:141], s[100:101], v[18:19] op_sel_hi:[1,0,0]
  v_pk_fma_f32 v[144:145], v[144:145], s[100:101], v[20:21] op_sel_hi:[1,0,0]
  v_pk_fma_f32 v[148:149], v[148:149], s[100:101], v[22:23] op_sel_hi:[1,0,0]
  v_pk_fma_f32 v[152:153], v[152:153], s[100:101], v[24:25] op_sel_hi:[1,0,0]
  v_pk_fma_f32 v[156:157], v[156:157], s[100:101], v[26:27] op_sel_hi:[1,0,0]
  v_exp_f32 v114, v114
  v_exp_f32 v115, v115
  s_add_u32 m0, s33, 12288
  s_nop 0
  buffer_load_dwordx4 v4, s[12:15], s46 offen offset:0 nt lds
  v_exp_f32 v118, v118
  v_exp_f32 v119, v119
  v_exp_f32 v122, v122
  v_exp_f32 v123, v123
  v_exp_f32 v126, v126
  v_exp_f32 v127, v127
  v_exp_f32 v130, v130
  v_exp_f32 v131, v131
  v_exp_f32 v134, v134
  v_exp_f32 v135, v135
  v_pk_add_f32 v[28:29], v[28:29], v[112:113]
  v_pk_add_f32 v[30:31], v[30:31], v[116:117]
  v_pk_add_f32 v[32:33], v[32:33], v[120:121]
  v_pk_add_f32 v[34:35], v[34:35], v[124:125]
  v_pk_add_f32 v[36:37], v[36:37], v[128:129]
  v_pk_add_f32 v[38:39], v[38:39], v[132:133]
  v_pk_fma_f32 v[138:139], v[138:139], s[100:101], v[16:17] op_sel_hi:[1,0,0]
  v_pk_fma_f32 v[142:143], v[142:143], s[100:101], v[18:19] op_sel_hi:[1,0,0]
  v_pk_fma_f32 v[146:147], v[146:147], s[100:101], v[20:21] op_sel_hi:[1,0,0]
  v_pk_fma_f32 v[150:151], v[150:151], s[100:101], v[22:23] op_sel_hi:[1,0,0]
  v_pk_fma_f32 v[154:155], v[154:155], s[100:101], v[24:25] op_sel_hi:[1,0,0]
  v_pk_fma_f32 v[158:159], v[158:159], s[100:101], v[26:27] op_sel_hi:[1,0,0]
  v_exp_f32 v136, v136
  v_exp_f32 v137, v137
  v_exp_f32 v140, v140
  v_exp_f32 v141, v141
  v_exp_f32 v144, v144
  v_exp_f32 v145, v145
  buffer_load_dwordx4 v5, s[12:15], s46 offen offset:1024 nt lds
  v_exp_f32 v148, v148
  v_exp_f32 v149, v149
  v_exp_f32 v152, v152
  v_exp_f32 v153, v153
  v_exp_f32 v156, v156
  v_exp_f32 v157, v157
  v_pk_add_f32 v[28:29], v[28:29], v[114:115]
  v_pk_add_f32 v[30:31], v[30:31], v[118:119]
  v_pk_add_f32 v[32:33], v[32:33], v[122:123]
  v_pk_add_f32 v[34:35], v[34:35], v[126:127]
  v_pk_add_f32 v[36:37], v[36:37], v[130:131]
  v_pk_add_f32 v[38:39], v[38:39], v[134:135]
  v_pk_fma_f32 v[160:161], v[160:161], s[100:101], v[16:17] op_sel_hi:[1,0,0]
  v_pk_fma_f32 v[164:165], v[164:165], s[100:101], v[18:19] op_sel_hi:[1,0,0]
  v_pk_fma_f32 v[168:169], v[168:169], s[100:101], v[20:21] op_sel_hi:[1,0,0]
  v_pk_fma_f32 v[172:173], v[172:173], s[100:101], v[22:23] op_sel_hi:[1,0,0]
  v_pk_fma_f32 v[176:177], v[176:177], s[100:101], v[24:25] op_sel_hi:[1,0,0]
  v_pk_fma_f32 v[180:181], v[180:181], s[100:101], v[26:27] op_sel_hi:[1,0,0]
  v_exp_f32 v138, v138
  v_exp_f32 v139, v139
  v_exp_f32 v142, v142
  v_exp_f32 v143, v143
  v_exp_f32 v146, v146
  v_exp_f32 v147, v147
  v_exp_f32 v150, v150
  v_exp_f32 v151, v151
  v_exp_f32 v154, v154
  v_exp_f32 v155, v155
  buffer_load_dwordx4 v6, s[12:15], s46 offen offset:2048 nt lds
  v_exp_f32 v158, v158
  v_exp_f32 v159, v159
  v_pk_add_f32 v[28:29], v[28:29], v[136:137]
  v_pk_add_f32 v[30:31], v[30:31], v[140:141]
  v_pk_add_f32 v[32:33], v[32:33], v[144:145]
  v_pk_add_f32 v[34:35], v[34:35], v[148:149]
  v_pk_add_f32 v[36:37], v[36:37], v[152:153]
  v_pk_add_f32 v[38:39], v[38:39], v[156:157]
  v_pk_fma_f32 v[162:163], v[162:163], s[100:101], v[16:17] op_sel_hi:[1,0,0]
  v_pk_fma_f32 v[166:167], v[166:167], s[100:101], v[18:19] op_sel_hi:[1,0,0]
  v_pk_fma_f32 v[170:171], v[170:171], s[100:101], v[20:21] op_sel_hi:[1,0,0]
  v_pk_fma_f32 v[174:175], v[174:175], s[100:101], v[22:23] op_sel_hi:[1,0,0]
  v_pk_fma_f32 v[178:179], v[178:179], s[100:101], v[24:25] op_sel_hi:[1,0,0]
  v_pk_fma_f32 v[182:183], v[182:183], s[100:101], v[26:27] op_sel_hi:[1,0,0]
  v_exp_f32 v160, v160
  v_exp_f32 v161, v161
  v_exp_f32 v164, v164
  v_exp_f32 v165, v165
  v_exp_f32 v168, v168
  v_exp_f32 v169, v169
  v_exp_f32 v172, v172
  v_exp_f32 v173, v173
  v_exp_f32 v176, v176
  v_exp_f32 v177, v177
  v_exp_f32 v180, v180
  v_exp_f32 v181, v181
  v_pk_add_f32 v[28:29], v[28:29], v[138:139]
  v_pk_add_f32 v[30:31], v[30:31], v[142:143]
  v_pk_add_f32 v[32:33], v[32:33], v[146:147]
  buffer_load_dwordx4 v7, s[12:15], s46 offen offset:3072 nt lds
  s_add_u32 s35, s35, 49152
  v_pk_add_f32 v[34:35], v[34:35], v[150:151]
  v_pk_add_f32 v[36:37], v[36:37], v[154:155]
  v_pk_add_f32 v[38:39], v[38:39], v[158:159]
  v_pk_fma_f32 v[184:185], v[184:185], s[100:101], v[16:17] op_sel_hi:[1,0,0]
  v_pk_fma_f32 v[188:189], v[188:189], s[100:101], v[18:19] op_sel_hi:[1,0,0]
  v_pk_fma_f32 v[192:193], v[192:193], s[100:101], v[20:21] op_sel_hi:[1,0,0]
  v_pk_fma_f32 v[196:197], v[196:197], s[100:101], v[22:23] op_sel_hi:[1,0,0]
  v_pk_fma_f32 v[200:201], v[200:201], s[100:101], v[24:25] op_sel_hi:[1,0,0]
  v_pk_fma_f32 v[204:205], v[204:205], s[100:101], v[26:27] op_sel_hi:[1,0,0]
  v_exp_f32 v162, v162
  v_exp_f32 v163, v163
  v_exp_f32 v166, v166
  v_exp_f32 v167, v167
  v_exp_f32 v170, v170
  v_exp_f32 v171, v171
  v_exp_f32 v174, v174
  v_exp_f32 v175, v175
  v_exp_f32 v178, v178
  v_exp_f32 v179, v179
  v_exp_f32 v182, v182
  v_exp_f32 v183, v183
  v_pk_add_f32 v[28:29], v[28:29], v[160:161]
  v_pk_add_f32 v[30:31], v[30:31], v[164:165]
  v_pk_add_f32 v[32:33], v[32:33], v[168:169]
  v_pk_add_f32 v[34:35], v[34:35], v[172:173]
  v_pk_add_f32 v[36:37], v[36:37], v[176:177]
  v_pk_add_f32 v[38:39], v[38:39], v[180:181]
  v_pk_fma_f32 v[186:187], v[186:187], s[100:101], v[16:17] op_sel_hi:[1,0,0]
  v_pk_fma_f32 v[190:191], v[190:191], s[100:101], v[18:19] op_sel_hi:[1,0,0]
  v_pk_fma_f32 v[194:195], v[194:195], s[100:101], v[20:21] op_sel_hi:[1,0,0]
  v_pk_fma_f32 v[198:199], v[198:199], s[100:101], v[22:23] op_sel_hi:[1,0,0]
  s_add_u32 m0, s33, 16384
  s_add_u32 s46, s35, 32768
  buffer_load_dwordx4 v4, s[12:15], s35 offen offset:0 nt lds
  v_pk_fma_f32 v[202:203], v[202:203], s[100:101], v[24:25] op_sel_hi:[1,0,0]
  v_pk_fma_f32 v[206:207], v[206:207], s[100:101], v[26:27] op_sel_hi:[1,0,0]
  v_exp_f32 v184, v184
  v_exp_f32 v185, v185
  v_exp_f32 v188, v188
  v_exp_f32 v189, v189
  v_exp_f32 v192, v192
  v_exp_f32 v193, v193
  v_exp_f32 v196, v196
  v_exp_f32 v197, v197
  v_exp_f32 v200, v200
  v_exp_f32 v201, v201
  v_exp_f32 v204, v204
  v_exp_f32 v205, v205
  v_pk_add_f32 v[28:29], v[28:29], v[162:163]
  v_pk_add_f32 v[30:31], v[30:31], v[166:167]
  v_pk_add_f32 v[32:33], v[32:33], v[170:171]
  v_pk_add_f32 v[34:35], v[34:35], v[174:175]
  v_pk_add_f32 v[36:37], v[36:37], v[178:179]
  v_pk_add_f32 v[38:39], v[38:39], v[182:183]
  v_pk_fma_f32 v[208:209], v[208:209], s[100:101], v[16:17] op_sel_hi:[1,0,0]
  v_pk_fma_f32 v[212:213], v[212:213], s[100:101], v[18:19] op_sel_hi:[1,0,0]
  v_pk_fma_f32 v[216:217], v[216:217], s[100:101], v[20:21] op_sel_hi:[1,0,0]
  v_pk_fma_f32 v[220:221], v[220:221], s[100:101], v[22:23] op_sel_hi:[1,0,0]
  v_pk_fma_f32 v[224:225], v[224:225], s[100:101], v[24:25] op_sel_hi:[1,0,0]
  v_pk_fma_f32 v[228:229], v[228:229], s[100:101], v[26:27] op_sel_hi:[1,0,0]
  v_exp_f32 v186, v186
  v_exp_f32 v187, v187
  v_exp_f32 v190, v190
  buffer_load_dwordx4 v5, s[12:15], s35 offen offset:1024 nt lds
  v_exp_f32 v191, v191
  v_exp_f32 v194, v194
  v_exp_f32 v195, v195
  v_exp_f32 v198, v198
  v_exp_f32 v199, v199
  v_exp_f32 v202, v202
  v_exp_f32 v203, v203
  v_exp_f32 v206, v206
  v_exp_f32 v207, v207
  v_pk_add_f32 v[28:29], v[28:29], v[184:185]
  v_pk_add_f32 v[30:31], v[30:31], v[188:189]
  v_pk_add_f32 v[32:33], v[32:33], v[192:193]
  v_pk_add_f32 v[34:35], v[34:35], v[196:197]
  v_pk_add_f32 v[36:37], v[36:37], v[200:201]
  v_pk_add_f32 v[38:39], v[38:39], v[204:205]
  v_pk_fma_f32 v[210:211], v[210:211], s[100:101], v[16:17] op_sel_hi:[1,0,0]
  v_pk_fma_f32 v[214:215], v[214:215], s[100:101], v[18:19] op_sel_hi:[1,0,0]
  v_pk_fma_f32 v[218:219], v[218:219], s[100:101], v[20:21] op_sel_hi:[1,0,0]
  v_pk_fma_f32 v[222:223], v[222:223], s[100:101], v[22:23] op_sel_hi:[1,0,0]
  v_pk_fma_f32 v[226:227], v[226:227], s[100:101], v[24:25] op_sel_hi:[1,0,0]
  v_pk_fma_f32 v[230:231], v[230:231], s[100:101], v[26:27] op_sel_hi:[1,0,0]
  v_exp_f32 v208, v208
  v_exp_f32 v209, v209
  v_exp_f32 v212, v212
  v_exp_f32 v213, v213
  v_exp_f32 v216, v216
  v_exp_f32 v217, v217
  v_exp_f32 v220, v220
  buffer_load_dwordx4 v6, s[12:15], s35 offen offset:2048 nt lds
  v_exp_f32 v221, v221
  v_exp_f32 v224, v224
  v_exp_f32 v225, v225
  v_exp_f32 v228, v228
  v_exp_f32 v229, v229
  v_pk_add_f32 v[28:29], v[28:29], v[186:187]
  v_pk_add_f32 v[30:31], v[30:31], v[190:191]
  v_pk_add_f32 v[32:33], v[32:33], v[194:195]
  v_pk_add_f32 v[34:35], v[34:35], v[198:199]
  v_pk_add_f32 v[36:37], v[36:37], v[202:203]
  v_pk_add_f32 v[38:39], v[38:39], v[206:207]
  v_pk_fma_f32 v[232:233], v[232:233], s[100:101], v[16:17] op_sel_hi:[1,0,0]
  v_pk_fma_f32 v[236:237], v[236:237], s[100:101], v[18:19] op_sel_hi:[1,0,0]
  v_pk_fma_f32 v[240:241], v[240:241], s[100:101], v[20:21] op_sel_hi:[1,0,0]
  v_pk_fma_f32 v[244:245], v[244:245], s[100:101], v[22:23] op_sel_hi:[1,0,0]
  v_pk_fma_f32 v[248:249], v[248:249], s[100:101], v[24:25] op_sel_hi:[1,0,0]
  v_pk_fma_f32 v[252:253], v[252:253], s[100:101], v[26:27] op_sel_hi:[1,0,0]
  v_exp_f32 v210, v210
  v_exp_f32 v211, v211
  v_exp_f32 v214, v214
  v_exp_f32 v215, v215
  v_exp_f32 v218, v218
  v_exp_f32 v219, v219
  v_exp_f32 v222, v222
  v_exp_f32 v223, v223
  v_exp_f32 v226, v226
  v_exp_f32 v227, v227
  v_exp_f32 v230, v230
  buffer_load_dwordx4 v7, s[12:15], s35 offen offset:3072 nt lds
  v_exp_f32 v231, v231
  v_pk_add_f32 v[28:29], v[28:29], v[208:209]
  v_pk_add_f32 v[30:31], v[30:31], v[212:213]
  v_pk_add_f32 v[32:33], v[32:33], v[216:217]
  v_pk_add_f32 v[34:35], v[34:35], v[220:221]
  v_pk_add_f32 v[36:37], v[36:37], v[224:225]
  v_pk_add_f32 v[38:39], v[38:39], v[228:229]
  v_pk_fma_f32 v[234:235], v[234:235], s[100:101], v[16:17] op_sel_hi:[1,0,0]
  v_pk_fma_f32 v[238:239], v[238:239], s[100:101], v[18:19] op_sel_hi:[1,0,0]
  v_pk_fma_f32 v[242:243], v[242:243], s[100:101], v[20:21] op_sel_hi:[1,0,0]
  v_pk_fma_f32 v[246:247], v[246:247], s[100:101], v[22:23] op_sel_hi:[1,0,0]
  v_pk_fma_f32 v[250:251], v[250:251], s[100:101], v[24:25] op_sel_hi:[1,0,0]
  v_pk_fma_f32 v[254:255], v[254:255], s[100:101], v[26:27] op_sel_hi:[1,0,0]
  v_exp_f32 v232, v232
  v_exp_f32 v233, v233
  v_exp_f32 v236, v236
  v_exp_f32 v237, v237
  v_exp_f32 v240, v240
  v_exp_f32 v241, v241
  v_exp_f32 v244, v244
  v_exp_f32 v245, v245
  v_exp_f32 v248, v248
  v_exp_f32 v249, v249
  v_exp_f32 v252, v252
  v_exp_f32 v253, v253
  v_pk_add_f32 v[28:29], v[28:29], v[210:211]
  v_pk_add_f32 v[30:31], v[30:31], v[214:215]
  v_pk_add_f32 v[32:33], v[32:33], v[218:219]
  v_pk_add_f32 v[34:35], v[34:35], v[222:223]
  v_pk_add_f32 v[36:37], v[36:37], v[226:227]
  s_add_u32 m0, s33, 20480
  s_nop 0
  buffer_load_dwordx4 v4, s[12:15], s46 offen offset:0 nt lds
  v_pk_add_f32 v[38:39], v[38:39], v[230:231]
  v_exp_f32 v234, v234
  v_exp_f32 v235, v235
  v_exp_f32 v238, v238
  v_exp_f32 v239, v239
  v_exp_f32 v242, v242
  v_exp_f32 v243, v243
  v_exp_f32 v246, v246
  v_exp_f32 v247, v247
  v_exp_f32 v250, v250
  v_exp_f32 v251, v251
  v_exp_f32 v254, v254
  v_exp_f32 v255, v255
  v_pk_add_f32 v[28:29], v[28:29], v[232:233]
  v_pk_add_f32 v[30:31], v[30:31], v[236:237]
  v_pk_add_f32 v[32:33], v[32:33], v[240:241]
  v_pk_add_f32 v[34:35], v[34:35], v[244:245]
  v_pk_add_f32 v[36:37], v[36:37], v[248:249]
  v_pk_add_f32 v[38:39], v[38:39], v[252:253]
  s_nop 0
  v_pk_add_f32 v[28:29], v[28:29], v[234:235]
  v_pk_add_f32 v[30:31], v[30:31], v[238:239]
  v_pk_add_f32 v[32:33], v[32:33], v[242:243]
  v_pk_add_f32 v[34:35], v[34:35], v[246:247]
  v_pk_add_f32 v[36:37], v[36:37], v[250:251]
  v_pk_add_f32 v[38:39], v[38:39], v[254:255]
  v_add_f32 v28, v28, v29
  v_add_f32 v30, v30, v31
  v_add_f32 v32, v32, v33
  v_add_f32 v34, v34, v35
  v_add_f32 v36, v36, v37
  buffer_load_dwordx4 v5, s[12:15], s46 offen offset:1024 nt lds
  v_add_f32 v38, v38, v39
  v_mov_b32 v17, v28
  v_mov_b32 v19, v30
  v_mov_b32 v21, v32
  v_mov_b32 v23, v34
  v_mov_b32 v25, v36
  v_mov_b32 v27, v38
  s_nop 1
  v_permlane32_swap_b32 v17, v28
  v_permlane32_swap_b32 v19, v30
  v_permlane32_swap_b32 v21, v32
  v_permlane32_swap_b32 v23, v34
  v_permlane32_swap_b32 v25, v36
  v_permlane32_swap_b32 v27, v38
  s_nop 1
  v_add_f32 v28, v28, v17
  v_add_f32 v30, v30, v19
  v_add_f32 v32, v32, v21
  v_add_f32 v34, v34, v23
  v_add_f32 v36, v36, v25
  v_add_f32 v38, v38, v27
  v_mov_b32 v17, v28
  v_mov_b32 v19, v30
  v_mov_b32 v21, v32
  v_mov_b32 v23, v34
  v_mov_b32 v25, v36
  v_mov_b32 v27, v38
  s_nop 1
  v_permlane16_swap_b32 v17, v28
  v_permlane16_swap_b32 v19, v30
  v_permlane16_swap_b32 v21, v32
  v_permlane16_swap_b32 v23, v34
  v_permlane16_swap_b32 v25, v36
  v_permlane16_swap_b32 v27, v38
  s_nop 1
  v_add_f32 v28, v28, v17
  v_add_f32 v30, v30, v19
  v_add_f32 v32, v32, v21
  v_add_f32 v34, v34, v23
  v_add_f32 v36, v36, v25
  v_add_f32 v38, v38, v27
  ds_write_b32 v13, v28 offset:1536
  buffer_load_dwordx4 v6, s[12:15], s46 offen offset:2048 nt lds
  ds_write_b32 v13, v30 offset:1792
  ds_write_b32 v13, v32 offset:2048
  ds_write_b32 v13, v34 offset:2304
  ds_write_b32 v13, v36 offset:2560
  ds_write_b32 v13, v38 offset:2816
  s_mul_i32 s39, s32, 6144
  v_add_u32 v15, s39, v3
  v_cvt_pk_bf16_f32 v91, v90, v91
  v_cvt_pk_bf16_f32 v90, v88, v89
  v_cvt_pk_bf16_f32 v88, v64, v65
  v_cvt_pk_bf16_f32 v89, v66, v67
  ds_write_b128 v15, v[88:91] offset:0
  v_cvt_pk_bf16_f32 v95, v94, v95
  v_cvt_pk_bf16_f32 v94, v92, v93
  v_cvt_pk_bf16_f32 v92, v68, v69
  v_cvt_pk_bf16_f32 v93, v70, v71
  ds_write_b128 v15, v[92:95] offset:1024
  v_cvt_pk_bf16_f32 v99, v98, v99
  v_cvt_pk_bf16_f32 v98, v96, v97
  v_cvt_pk_bf16_f32 v96, v72, v73
  v_cvt_pk_bf16_f32 v97, v74, v75
  ds_write_b128 v15, v[96:99] offset:2048
  v_cvt_pk_bf16_f32 v103, v102, v103
  v_cvt_pk_bf16_f32 v102, v100, v101
  v_cvt_pk_bf16_f32 v100, v76, v77
  v_cvt_pk_bf16_f32 v101, v78, v79
  ds_write_b128 v15, v[100:103] offset:3072
  v_cvt_pk_bf16_f32 v107, v106, v107
  v_cvt_pk_bf16_f32 v106, v104, v105
  buffer_load_dwordx4 v7, s[12:15], s46 offen offset:3072 nt lds
  s_add_u32 s35, s35, 16384
  v_cvt_pk_bf16_f32 v104, v80, v81
  v_cvt_pk_bf16_f32 v105, v82, v83
  ds_write_b128 v15, v[104:107] offset:4096
  v_cvt_pk_bf16_f32 v111, v110, v111
  v_cvt_pk_bf16_f32 v110, v108, v109
  v_cvt_pk_bf16_f32 v108, v84, v85
  v_cvt_pk_bf16_f32 v109, v86, v87
  ds_write_b128 v15, v[108:111] offset:5120
  v_cvt_pk_bf16_f32 v139, v138, v139
  v_cvt_pk_bf16_f32 v138, v136, v137
  v_cvt_pk_bf16_f32 v136, v112, v113
  v_cvt_pk_bf16_f32 v137, v114, v115
  ds_write_b128 v15, v[136:139] offset:24576
  v_cvt_pk_bf16_f32 v143, v142, v143
  v_cvt_pk_bf16_f32 v142, v140, v141
  v_cvt_pk_bf16_f32 v140, v116, v117
  v_cvt_pk_bf16_f32 v141, v118, v119
  ds_write_b128 v15, v[140:143] offset:25600
  v_cvt_pk_bf16_f32 v147, v146, v147
  v_cvt_pk_bf16_f32 v146, v144, v145
  v_cvt_pk_bf16_f32 v144, v120, v121
  v_cvt_pk_bf16_f32 v145, v122, v123
  ds_write_b128 v15, v[144:147] offset:26624
  v_cvt_pk_bf16_f32 v151, v150, v151
  v_cvt_pk_bf16_f32 v150, v148, v149
  v_cvt_pk_bf16_f32 v148, v124, v125
  v_cvt_pk_bf16_f32 v149, v126, v127
  ds_write_b128 v15, v[148:151] offset:27648
  v_cvt_pk_bf16_f32 v155, v154, v155
  v_cvt_pk_bf16_f32 v154, v152, v153
  v_cvt_pk_bf16_f32 v152, v128, v129
  v_cvt_pk_bf16_f32 v153, v130, v131
  ds_write_b128 v15, v[152:155] offset:28672
  v_cvt_pk_bf16_f32 v159, v158, v159
  v_cvt_pk_bf16_f32 v158, v156, v157
  v_cvt_pk_bf16_f32 v156, v132, v133
  v_cvt_pk_bf16_f32 v157, v134, v135
  ds_write_b128 v15, v[156:159] offset:29696
  v_cvt_pk_bf16_f32 v235, v234, v235
  v_cvt_pk_bf16_f32 v234, v232, v233
  v_cvt_pk_bf16_f32 v232, v208, v209
  v_cvt_pk_bf16_f32 v233, v210, v211
  v_cvt_pk_bf16_f32 v239, v238, v239
  v_cvt_pk_bf16_f32 v238, v236, v237
  v_cvt_pk_bf16_f32 v236, v212, v213
  v_cvt_pk_bf16_f32 v237, v214, v215
  v_cvt_pk_bf16_f32 v243, v242, v243
  v_cvt_pk_bf16_f32 v242, v240, v241
  v_cvt_pk_bf16_f32 v240, v216, v217
  v_cvt_pk_bf16_f32 v241, v218, v219
  v_cvt_pk_bf16_f32 v247, v246, v247
  v_cvt_pk_bf16_f32 v246, v244, v245
  v_cvt_pk_bf16_f32 v244, v220, v221
  v_cvt_pk_bf16_f32 v245, v222, v223
  v_cvt_pk_bf16_f32 v251, v250, v251
  v_cvt_pk_bf16_f32 v250, v248, v249
  v_cvt_pk_bf16_f32 v248, v224, v225
  v_cvt_pk_bf16_f32 v249, v226, v227
  v_cvt_pk_bf16_f32 v255, v254, v255
  v_cvt_pk_bf16_f32 v254, v252, v253
  v_cvt_pk_bf16_f32 v252, v228, v229
  v_cvt_pk_bf16_f32 v253, v230, v231
  v_cvt_pk_bf16_f32 v211, v186, v187
  v_cvt_pk_bf16_f32 v210, v184, v185
  v_cvt_pk_bf16_f32 v208, v160, v161
  v_cvt_pk_bf16_f32 v209, v162, v163
  v_cvt_pk_bf16_f32 v215, v190, v191
  v_cvt_pk_bf16_f32 v214, v188, v189
  v_cvt_pk_bf16_f32 v212, v164, v165
  v_cvt_pk_bf16_f32 v213, v166, v167
  v_cvt_pk_bf16_f32 v219, v194, v195
  v_cvt_pk_bf16_f32 v218, v192, v193
  v_cvt_pk_bf16_f32 v216, v168, v169
  v_cvt_pk_bf16_f32 v217, v170, v171
  v_cvt_pk_bf16_f32 v223, v198, v199
  v_cvt_pk_bf16_f32 v222, v196, v197
  v_cvt_pk_bf16_f32 v220, v172, v173
  v_cvt_pk_bf16_f32 v221, v174, v175
  v_cvt_pk_bf16_f32 v227, v202, v203
  v_cvt_pk_bf16_f32 v226, v200, v201
  v_cvt_pk_bf16_f32 v224, v176, v177
  v_cvt_pk_bf16_f32 v225, v178, v179
  v_cvt_pk_bf16_f32 v231, v206, v207
  v_cvt_pk_bf16_f32 v230, v204, v205
  v_cvt_pk_bf16_f32 v228, v180, v181
  v_cvt_pk_bf16_f32 v229, v182, v183
  s_waitcnt lgkmcnt(0)
  v_lshlrev_b32 v33, 4, v0
  v_lshlrev_b32 v35, 3, v0
  v_lshrrev_b32 v46, 2, v1
  v_and_b32 v47, 3, v1
  v_lshl_add_u32 v43, v2, 2, v46
  v_lshrrev_b32 v44, 1, v43
  v_and_b32 v44, 3, v44
  v_lshlrev_b32 v44, 5, v44
  v_lshl_add_u32 v44, v43, 7, v44
  v_lshl_add_u32 v44, v47, 3, v44
  v_add_u32 v28, s33, v44
  v_xor_b32 v29, 32, v28
  v_xor_b32 v30, 64, v28
  v_xor_b32 v31, 96, v28
  s_barrier
  ds_read_b128 v[80:83], v3 offset:0
  ds_read_b128 v[84:87], v3 offset:1024
  ds_read_b128 v[88:91], v3 offset:2048
  ds_read_b128 v[92:95], v3 offset:3072
  ds_read_b128 v[96:99], v3 offset:4096
  ds_read_b128 v[100:103], v3 offset:5120
  ds_read_b128 v[104:107], v3 offset:6144
  ds_read_b128 v[108:111], v3 offset:7168
  ds_read_b128 v[112:115], v3 offset:8192
  ds_read_b128 v[116:119], v3 offset:9216
  ds_read_b128 v[120:123], v3 offset:10240
  ds_read_b128 v[124:127], v3 offset:11264
  s_waitcnt lgkmcnt(0)
  s_waitcnt vmcnt(23)
  ds_read_b64_tr_b16 v[48:49], v28 offset:0
  ds_read_b64_tr_b16 v[50:51], v28 offset:4096
  ds_read_b64_tr_b16 v[52:53], v29 offset:0
  ds_read_b64_tr_b16 v[54:55], v29 offset:4096
  ds_read_b64_tr_b16 v[56:57], v30 offset:0
  ds_read_b64_tr_b16 v[58:59], v30 offset:4096
  ds_read_b64_tr_b16 v[60:61], v31 offset:0
  ds_read_b64_tr_b16 v[62:63], v31 offset:4096
  ds_read_b64_tr_b16 v[64:65], v28 offset:2048
  ds_read_b64_tr_b16 v[66:67], v28 offset:6144
  ds_read_b64_tr_b16 v[68:69], v29 offset:2048
  ds_read_b64_tr_b16 v[70:71], v29 offset:6144
  s_waitcnt lgkmcnt(10)
  v_mfma_f32_16x16x32_bf16 v[128:131], v[48:51], v[80:83], 0
  v_mfma_f32_16x16x32_bf16 v[132:135], v[48:51], v[84:87], 0
  v_mfma_f32_16x16x32_bf16 v[136:139], v[48:51], v[88:91], 0
  v_mfma_f32_16x16x32_bf16 v[140:143], v[48:51], v[92:95], 0
  v_mfma_f32_16x16x32_bf16 v[144:147], v[48:51], v[96:99], 0
  v_mfma_f32_16x16x32_bf16 v[148:151], v[48:51], v[100:103], 0
  ds_read_b64_tr_b16 v[72:73], v30 offset:2048
  ds_read_b64_tr_b16 v[74:75], v30 offset:6144
  s_waitcnt lgkmcnt(10)
  v_mfma_f32_16x16x32_bf16 v[152:155], v[52:55], v[80:83], 0
  v_mfma_f32_16x16x32_bf16 v[156:159], v[52:55], v[84:87], 0
  v_mfma_f32_16x16x32_bf16 v[160:163], v[52:55], v[88:91], 0
  v_mfma_f32_16x16x32_bf16 v[164:167], v[52:55], v[92:95], 0
  v_mfma_f32_16x16x32_bf16 v[168:171], v[52:55], v[96:99], 0
  v_mfma_f32_16x16x32_bf16 v[172:175], v[52:55], v[100:103], 0
  ds_read_b64_tr_b16 v[76:77], v31 offset:2048
  ds_read_b64_tr_b16 v[78:79], v31 offset:6144
  s_waitcnt lgkmcnt(10)
  v_mfma_f32_16x16x32_bf16 v[176:179], v[56:59], v[80:83], 0
  v_mfma_f32_16x16x32_bf16 v[180:183], v[56:59], v[84:87], 0
  v_mfma_f32_16x16x32_bf16 v[184:187], v[56:59], v[88:91], 0
  v_mfma_f32_16x16x32_bf16 v[188:191], v[56:59], v[92:95], 0
  v_mfma_f32_16x16x32_bf16 v[192:195], v[56:59], v[96:99], 0
  v_mfma_f32_16x16x32_bf16 v[196:199], v[56:59], v[100:103], 0
  s_waitcnt lgkmcnt(8)
  v_mfma_f32_16x16x32_bf16 v[200:203], v[60:63], v[80:83], 0
  v_mfma_f32_16x16x32_bf16 v[204:207], v[60:63], v[84:87], 0
  v_mfma_f32_16x16x32_bf16 a[224:227], v[60:63], v[88:91], 0
  v_mfma_f32_16x16x32_bf16 a[228:231], v[60:63], v[92:95], 0
  v_mfma_f32_16x16x32_bf16 a[232:235], v[60:63], v[96:99], 0
  v_mfma_f32_16x16x32_bf16 a[236:239], v[60:63], v[100:103], 0
  s_waitcnt lgkmcnt(6)
  v_mfma_f32_16x16x32_bf16 v[128:131], v[64:67], v[104:107], v[128:131]
  v_mfma_f32_16x16x32_bf16 v[132:135], v[64:67], v[108:111], v[132:135]
  v_mfma_f32_16x16x32_bf16 v[136:139], v[64:67], v[112:115], v[136:139]
  v_mfma_f32_16x16x32_bf16 v[140:143], v[64:67], v[116:119], v[140:143]
  v_mfma_f32_16x16x32_bf16 v[144:147], v[64:67], v[120:123], v[144:147]
  v_mfma_f32_16x16x32_bf16 v[148:151], v[64:67], v[124:127], v[148:151]
  s_waitcnt lgkmcnt(4)
  v_mfma_f32_16x16x32_bf16 v[152:155], v[68:71], v[104:107], v[152:155]
  v_mfma_f32_16x16x32_bf16 v[156:159], v[68:71], v[108:111], v[156:159]
  v_mfma_f32_16x16x32_bf16 v[160:163], v[68:71], v[112:115], v[160:163]
  v_mfma_f32_16x16x32_bf16 v[164:167], v[68:71], v[116:119], v[164:167]
  v_mfma_f32_16x16x32_bf16 v[168:171], v[68:71], v[120:123], v[168:171]
  v_mfma_f32_16x16x32_bf16 v[172:175], v[68:71], v[124:127], v[172:175]
  s_waitcnt lgkmcnt(2)
  v_mfma_f32_16x16x32_bf16 v[176:179], v[72:75], v[104:107], v[176:179]
  v_mfma_f32_16x16x32_bf16 v[180:183], v[72:75], v[108:111], v[180:183]
  v_mfma_f32_16x16x32_bf16 v[184:187], v[72:75], v[112:115], v[184:187]
  v_mfma_f32_16x16x32_bf16 v[188:191], v[72:75], v[116:119], v[188:191]
  v_mfma_f32_16x16x32_bf16 v[192:195], v[72:75], v[120:123], v[192:195]
  v_mfma_f32_16x16x32_bf16 v[196:199], v[72:75], v[124:127], v[196:199]
  s_waitcnt lgkmcnt(0)
  v_mfma_f32_16x16x32_bf16 v[200:203], v[76:79], v[104:107], v[200:203]
  s_add_u32 m0, s33, 0
  s_add_u32 s46, s35, 32768
  buffer_load_dwordx4 v4, s[12:15], s35 offen offset:0 nt lds
  v_mfma_f32_16x16x32_bf16 v[204:207], v[76:79], v[108:111], v[204:207]
  v_mfma_f32_16x16x32_bf16 a[224:227], v[76:79], v[112:115], a[224:227]
  v_mfma_f32_16x16x32_bf16 a[228:231], v[76:79], v[116:119], a[228:231]
  v_mfma_f32_16x16x32_bf16 a[232:235], v[76:79], v[120:123], a[232:235]
  v_mfma_f32_16x16x32_bf16 a[236:239], v[76:79], v[124:127], a[236:239]
  ds_read_b128 v[80:83], v3 offset:12288
  ds_read_b128 v[84:87], v3 offset:13312
  ds_read_b128 v[88:91], v3 offset:14336
  ds_read_b128 v[92:95], v3 offset:15360
  ds_read_b128 v[96:99], v3 offset:16384
  ds_read_b128 v[100:103], v3 offset:17408
  ds_read_b128 v[104:107], v3 offset:18432
  ds_read_b128 v[108:111], v3 offset:19456
  ds_read_b128 v[112:115], v3 offset:20480
  ds_read_b128 v[116:119], v3 offset:21504
  ds_read_b128 v[120:123], v3 offset:22528
  ds_read_b128 v[124:127], v3 offset:23552
  s_waitcnt lgkmcnt(0)
  buffer_load_dwordx4 v5, s[12:15], s35 offen offset:1024 nt lds
  s_waitcnt vmcnt(10)
  ds_read_b64_tr_b16 v[48:49], v28 offset:8192
  ds_read_b64_tr_b16 v[50:51], v28 offset:12288
  ds_read_b64_tr_b16 v[52:53], v29 offset:8192
  ds_read_b64_tr_b16 v[54:55], v29 offset:12288
  ds_read_b64_tr_b16 v[56:57], v30 offset:8192
  ds_read_b64_tr_b16 v[58:59], v30 offset:12288
  ds_read_b64_tr_b16 v[60:61], v31 offset:8192
  ds_read_b64_tr_b16 v[62:63], v31 offset:12288
  ds_read_b64_tr_b16 v[64:65], v28 offset:10240
  ds_read_b64_tr_b16 v[66:67], v28 offset:14336
  ds_read_b64_tr_b16 v[68:69], v29 offset:10240
  ds_read_b64_tr_b16 v[70:71], v29 offset:14336
  s_waitcnt lgkmcnt(10)
  v_mfma_f32_16x16x32_bf16 v[128:131], v[48:51], v[80:83], v[128:131]
  v_mfma_f32_16x16x32_bf16 v[132:135], v[48:51], v[84:87], v[132:135]
  v_mfma_f32_16x16x32_bf16 v[136:139], v[48:51], v[88:91], v[136:139]
  v_mfma_f32_16x16x32_bf16 v[140:143], v[48:51], v[92:95], v[140:143]
  v_mfma_f32_16x16x32_bf16 v[144:147], v[48:51], v[96:99], v[144:147]
  v_mfma_f32_16x16x32_bf16 v[148:151], v[48:51], v[100:103], v[148:151]
  ds_read_b64_tr_b16 v[72:73], v30 offset:10240
  ds_read_b64_tr_b16 v[74:75], v30 offset:14336
  s_waitcnt lgkmcnt(10)
  v_mfma_f32_16x16x32_bf16 v[152:155], v[52:55], v[80:83], v[152:155]
  v_mfma_f32_16x16x32_bf16 v[156:159], v[52:55], v[84:87], v[156:159]
  v_mfma_f32_16x16x32_bf16 v[160:163], v[52:55], v[88:91], v[160:163]
  v_mfma_f32_16x16x32_bf16 v[164:167], v[52:55], v[92:95], v[164:167]
  v_mfma_f32_16x16x32_bf16 v[168:171], v[52:55], v[96:99], v[168:171]
  v_mfma_f32_16x16x32_bf16 v[172:175], v[52:55], v[100:103], v[172:175]
  ds_read_b64_tr_b16 v[76:77], v31 offset:10240
  ds_read_b64_tr_b16 v[78:79], v31 offset:14336
  s_waitcnt lgkmcnt(10)
  v_mfma_f32_16x16x32_bf16 v[176:179], v[56:59], v[80:83], v[176:179]
  buffer_load_dwordx4 v6, s[12:15], s35 offen offset:2048 nt lds
  v_mfma_f32_16x16x32_bf16 v[180:183], v[56:59], v[84:87], v[180:183]
  v_mfma_f32_16x16x32_bf16 v[184:187], v[56:59], v[88:91], v[184:187]
  v_mfma_f32_16x16x32_bf16 v[188:191], v[56:59], v[92:95], v[188:191]
  v_mfma_f32_16x16x32_bf16 v[192:195], v[56:59], v[96:99], v[192:195]
  v_mfma_f32_16x16x32_bf16 v[196:199], v[56:59], v[100:103], v[196:199]
  s_waitcnt lgkmcnt(8)
  v_mfma_f32_16x16x32_bf16 v[200:203], v[60:63], v[80:83], v[200:203]
  v_mfma_f32_16x16x32_bf16 v[204:207], v[60:63], v[84:87], v[204:207]
  v_mfma_f32_16x16x32_bf16 a[224:227], v[60:63], v[88:91], a[224:227]
  v_mfma_f32_16x16x32_bf16 a[228:231], v[60:63], v[92:95], a[228:231]
  v_mfma_f32_16x16x32_bf16 a[232:235], v[60:63], v[96:99], a[232:235]
  v_mfma_f32_16x16x32_bf16 a[236:239], v[60:63], v[100:103], a[236:239]
  buffer_load_dwordx4 v7, s[12:15], s35 offen offset:3072 nt lds
  s_waitcnt lgkmcnt(6)
  v_mfma_f32_16x16x32_bf16 v[128:131], v[64:67], v[104:107], v[128:131]
  v_mfma_f32_16x16x32_bf16 v[132:135], v[64:67], v[108:111], v[132:135]
  v_mfma_f32_16x16x32_bf16 v[136:139], v[64:67], v[112:115], v[136:139]
  v_mfma_f32_16x16x32_bf16 v[140:143], v[64:67], v[116:119], v[140:143]
  v_mfma_f32_16x16x32_bf16 v[144:147], v[64:67], v[120:123], v[144:147]
  v_mfma_f32_16x16x32_bf16 v[148:151], v[64:67], v[124:127], v[148:151]
  s_waitcnt lgkmcnt(4)
  v_mfma_f32_16x16x32_bf16 v[152:155], v[68:71], v[104:107], v[152:155]
  v_mfma_f32_16x16x32_bf16 v[156:159], v[68:71], v[108:111], v[156:159]
  v_mfma_f32_16x16x32_bf16 v[160:163], v[68:71], v[112:115], v[160:163]
  v_mfma_f32_16x16x32_bf16 v[164:167], v[68:71], v[116:119], v[164:167]
  v_mfma_f32_16x16x32_bf16 v[168:171], v[68:71], v[120:123], v[168:171]
  s_add_u32 m0, s33, 4096
  s_nop 0
  buffer_load_dwordx4 v4, s[12:15], s46 offen offset:0 nt lds
  v_mfma_f32_16x16x32_bf16 v[172:175], v[68:71], v[124:127], v[172:175]
  s_waitcnt lgkmcnt(2)
  v_mfma_f32_16x16x32_bf16 v[176:179], v[72:75], v[104:107], v[176:179]
  v_mfma_f32_16x16x32_bf16 v[180:183], v[72:75], v[108:111], v[180:183]
  v_mfma_f32_16x16x32_bf16 v[184:187], v[72:75], v[112:115], v[184:187]
  v_mfma_f32_16x16x32_bf16 v[188:191], v[72:75], v[116:119], v[188:191]
  v_mfma_f32_16x16x32_bf16 v[192:195], v[72:75], v[120:123], v[192:195]
  v_mfma_f32_16x16x32_bf16 v[196:199], v[72:75], v[124:127], v[196:199]
  s_waitcnt lgkmcnt(0)
  v_mfma_f32_16x16x32_bf16 v[200:203], v[76:79], v[104:107], v[200:203]
  v_mfma_f32_16x16x32_bf16 v[204:207], v[76:79], v[108:111], v[204:207]
  v_mfma_f32_16x16x32_bf16 a[224:227], v[76:79], v[112:115], a[224:227]
  v_mfma_f32_16x16x32_bf16 a[228:231], v[76:79], v[116:119], a[228:231]
  buffer_load_dwordx4 v5, s[12:15], s46 offen offset:1024 nt lds
  v_mfma_f32_16x16x32_bf16 a[232:235], v[76:79], v[120:123], a[232:235]
  v_mfma_f32_16x16x32_bf16 a[236:239], v[76:79], v[124:127], a[236:239]
  ds_read_b128 v[80:83], v3 offset:24576
  ds_read_b128 v[84:87], v3 offset:25600
  ds_read_b128 v[88:91], v3 offset:26624
  ds_read_b128 v[92:95], v3 offset:27648
  ds_read_b128 v[96:99], v3 offset:28672
  ds_read_b128 v[100:103], v3 offset:29696
  ds_read_b128 v[104:107], v3 offset:30720
  ds_read_b128 v[108:111], v3 offset:31744
  ds_read_b128 v[112:115], v3 offset:32768
  ds_read_b128 v[116:119], v3 offset:33792
  ds_read_b128 v[120:123], v3 offset:34816
  ds_read_b128 v[124:127], v3 offset:35840
  s_waitcnt lgkmcnt(0)
  buffer_load_dwordx4 v6, s[12:15], s46 offen offset:2048 nt lds
  buffer_load_dwordx4 v7, s[12:15], s46 offen offset:3072 nt lds
  s_add_u32 s35, s35, 49152
  s_waitcnt vmcnt(8)
  ds_read_b64_tr_b16 v[48:49], v28 offset:16384
  ds_read_b64_tr_b16 v[50:51], v28 offset:20480
  ds_read_b64_tr_b16 v[52:53], v29 offset:16384
  ds_read_b64_tr_b16 v[54:55], v29 offset:20480
  ds_read_b64_tr_b16 v[56:57], v30 offset:16384
  ds_read_b64_tr_b16 v[58:59], v30 offset:20480
  ds_read_b64_tr_b16 v[60:61], v31 offset:16384
  ds_read_b64_tr_b16 v[62:63], v31 offset:20480
  ds_read_b64_tr_b16 v[64:65], v28 offset:18432
  ds_read_b64_tr_b16 v[66:67], v28 offset:22528
  ds_read_b64_tr_b16 v[68:69], v29 offset:18432
  ds_read_b64_tr_b16 v[70:71], v29 offset:22528
  s_waitcnt lgkmcnt(10)
  v_mfma_f32_16x16x32_bf16 v[128:131], v[48:51], v[80:83], v[128:131]
  v_mfma_f32_16x16x32_bf16 v[132:135], v[48:51], v[84:87], v[132:135]
  v_mfma_f32_16x16x32_bf16 v[136:139], v[48:51], v[88:91], v[136:139]
  v_mfma_f32_16x16x32_bf16 v[140:143], v[48:51], v[92:95], v[140:143]
  v_mfma_f32_16x16x32_bf16 v[144:147], v[48:51], v[96:99], v[144:147]
  v_mfma_f32_16x16x32_bf16 v[148:151], v[48:51], v[100:103], v[148:151]
  ds_read_b64_tr_b16 v[72:73], v30 offset:18432
  ds_read_b64_tr_b16 v[74:75], v30 offset:22528
  s_waitcnt lgkmcnt(10)
  v_mfma_f32_16x16x32_bf16 v[152:155], v[52:55], v[80:83], v[152:155]
  v_mfma_f32_16x16x32_bf16 v[156:159], v[52:55], v[84:87], v[156:159]
  v_mfma_f32_16x16x32_bf16 v[160:163], v[52:55], v[88:91], v[160:163]
  v_mfma_f32_16x16x32_bf16 v[164:167], v[52:55], v[92:95], v[164:167]
  v_mfma_f32_16x16x32_bf16 v[168:171], v[52:55], v[96:99], v[168:171]
  v_mfma_f32_16x16x32_bf16 v[172:175], v[52:55], v[100:103], v[172:175]
  ds_read_b64_tr_b16 v[76:77], v31 offset:18432
  ds_read_b64_tr_b16 v[78:79], v31 offset:22528
  s_waitcnt lgkmcnt(10)
  v_mfma_f32_16x16x32_bf16 v[176:179], v[56:59], v[80:83], v[176:179]
  s_add_u32 m0, s33, 8192
  s_add_u32 s46, s35, 32768
  buffer_load_dwordx4 v4, s[12:15], s35 offen offset:0 nt lds
  v_mfma_f32_16x16x32_bf16 v[180:183], v[56:59], v[84:87], v[180:183]
  v_mfma_f32_16x16x32_bf16 v[184:187], v[56:59], v[88:91], v[184:187]
  v_mfma_f32_16x16x32_bf16 v[188:191], v[56:59], v[92:95], v[188:191]
  v_mfma_f32_16x16x32_bf16 v[192:195], v[56:59], v[96:99], v[192:195]
  v_mfma_f32_16x16x32_bf16 v[196:199], v[56:59], v[100:103], v[196:199]
  s_waitcnt lgkmcnt(8)
  v_mfma_f32_16x16x32_bf16 v[200:203], v[60:63], v[80:83], v[200:203]
  v_mfma_f32_16x16x32_bf16 v[204:207], v[60:63], v[84:87], v[204:207]
  v_mfma_f32_16x16x32_bf16 a[224:227], v[60:63], v[88:91], a[224:227]
  v_mfma_f32_16x16x32_bf16 a[228:231], v[60:63], v[92:95], a[228:231]
  v_mfma_f32_16x16x32_bf16 a[232:235], v[60:63], v[96:99], a[232:235]
  v_mfma_f32_16x16x32_bf16 a[236:239], v[60:63], v[100:103], a[236:239]
  buffer_load_dwordx4 v5, s[12:15], s35 offen offset:1024 nt lds
  s_waitcnt lgkmcnt(6)
  v_mfma_f32_16x16x32_bf16 v[128:131], v[64:67], v[104:107], v[128:131]
  v_mfma_f32_16x16x32_bf16 v[132:135], v[64:67], v[108:111], v[132:135]
  v_mfma_f32_16x16x32_bf16 v[136:139], v[64:67], v[112:115], v[136:139]
  v_mfma_f32_16x16x32_bf16 v[140:143], v[64:67], v[116:119], v[140:143]
  v_mfma_f32_16x16x32_bf16 v[144:147], v[64:67], v[120:123], v[144:147]
  v_mfma_f32_16x16x32_bf16 v[148:151], v[64:67], v[124:127], v[148:151]
  s_waitcnt lgkmcnt(4)
  v_mfma_f32_16x16x32_bf16 v[152:155], v[68:71], v[104:107], v[152:155]
  v_mfma_f32_16x16x32_bf16 v[156:159], v[68:71], v[108:111], v[156:159]
  v_mfma_f32_16x16x32_bf16 v[160:163], v[68:71], v[112:115], v[160:163]
  v_mfma_f32_16x16x32_bf16 v[164:167], v[68:71], v[116:119], v[164:167]
  v_mfma_f32_16x16x32_bf16 v[168:171], v[68:71], v[120:123], v[168:171]
  buffer_load_dwordx4 v6, s[12:15], s35 offen offset:2048 nt lds
  v_mfma_f32_16x16x32_bf16 v[172:175], v[68:71], v[124:127], v[172:175]
  s_waitcnt lgkmcnt(2)
  v_mfma_f32_16x16x32_bf16 v[176:179], v[72:75], v[104:107], v[176:179]
  v_mfma_f32_16x16x32_bf16 v[180:183], v[72:75], v[108:111], v[180:183]
  v_mfma_f32_16x16x32_bf16 v[184:187], v[72:75], v[112:115], v[184:187]
  v_mfma_f32_16x16x32_bf16 v[188:191], v[72:75], v[116:119], v[188:191]
  v_mfma_f32_16x16x32_bf16 v[192:195], v[72:75], v[120:123], v[192:195]
  v_mfma_f32_16x16x32_bf16 v[196:199], v[72:75], v[124:127], v[196:199]
  s_waitcnt lgkmcnt(0)
  v_mfma_f32_16x16x32_bf16 v[200:203], v[76:79], v[104:107], v[200:203]
  v_mfma_f32_16x16x32_bf16 v[204:207], v[76:79], v[108:111], v[204:207]
  v_mfma_f32_16x16x32_bf16 a[224:227], v[76:79], v[112:115], a[224:227]
  v_mfma_f32_16x16x32_bf16 a[228:231], v[76:79], v[116:119], a[228:231]
  buffer_load_dwordx4 v7, s[12:15], s35 offen offset:3072 nt lds
  v_mfma_f32_16x16x32_bf16 a[232:235], v[76:79], v[120:123], a[232:235]
  v_mfma_f32_16x16x32_bf16 a[236:239], v[76:79], v[124:127], a[236:239]
  ds_read_b128 v[80:83], v3 offset:36864
  ds_read_b128 v[84:87], v3 offset:37888
  ds_read_b128 v[88:91], v3 offset:38912
  ds_read_b128 v[92:95], v3 offset:39936
  ds_read_b128 v[96:99], v3 offset:40960
  ds_read_b128 v[100:103], v3 offset:41984
  ds_read_b128 v[104:107], v3 offset:43008
  ds_read_b128 v[108:111], v3 offset:44032
  ds_read_b128 v[112:115], v3 offset:45056
  ds_read_b128 v[116:119], v3 offset:46080
  ds_read_b128 v[120:123], v3 offset:47104
  ds_read_b128 v[124:127], v3 offset:48128
  s_waitcnt lgkmcnt(0)
  s_add_u32 m0, s33, 12288
  s_nop 0
  buffer_load_dwordx4 v4, s[12:15], s46 offen offset:0 nt lds
  buffer_load_dwordx4 v5, s[12:15], s46 offen offset:1024 nt lds
  buffer_load_dwordx4 v6, s[12:15], s46 offen offset:2048 nt lds
  buffer_load_dwordx4 v7, s[12:15], s46 offen offset:3072 nt lds
  s_add_u32 s35, s35, 16384
  s_waitcnt vmcnt(8)
  ds_read_b64_tr_b16 v[48:49], v28 offset:0
  ds_read_b64_tr_b16 v[50:51], v28 offset:4096
  ds_read_b64_tr_b16 v[52:53], v29 offset:0
  ds_read_b64_tr_b16 v[54:55], v29 offset:4096
  ds_read_b64_tr_b16 v[56:57], v30 offset:0
  ds_read_b64_tr_b16 v[58:59], v30 offset:4096
  ds_read_b64_tr_b16 v[60:61], v31 offset:0
  ds_read_b64_tr_b16 v[62:63], v31 offset:4096
  ds_read_b64_tr_b16 v[64:65], v28 offset:2048
  ds_read_b64_tr_b16 v[66:67], v28 offset:6144
  ds_read_b64_tr_b16 v[68:69], v29 offset:2048
  ds_read_b64_tr_b16 v[70:71], v29 offset:6144
  s_waitcnt lgkmcnt(10)
  v_mfma_f32_16x16x32_bf16 v[128:131], v[48:51], v[80:83], v[128:131]
  v_mfma_f32_16x16x32_bf16 v[132:135], v[48:51], v[84:87], v[132:135]
  v_mfma_f32_16x16x32_bf16 v[136:139], v[48:51], v[88:91], v[136:139]
  v_mfma_f32_16x16x32_bf16 v[140:143], v[48:51], v[92:95], v[140:143]
  v_mfma_f32_16x16x32_bf16 v[144:147], v[48:51], v[96:99], v[144:147]
  v_mfma_f32_16x16x32_bf16 v[148:151], v[48:51], v[100:103], v[148:151]
  ds_read_b64_tr_b16 v[72:73], v30 offset:2048
  ds_read_b64_tr_b16 v[74:75], v30 offset:6144
  s_waitcnt lgkmcnt(10)
  v_mfma_f32_16x16x32_bf16 v[152:155], v[52:55], v[80:83], v[152:155]
  v_mfma_f32_16x16x32_bf16 v[156:159], v[52:55], v[84:87], v[156:159]
  v_mfma_f32_16x16x32_bf16 v[160:163], v[52:55], v[88:91], v[160:163]
  v_mfma_f32_16x16x32_bf16 v[164:167], v[52:55], v[92:95], v[164:167]
  v_mfma_f32_16x16x32_bf16 v[168:171], v[52:55], v[96:99], v[168:171]
  v_mfma_f32_16x16x32_bf16 v[172:175], v[52:55], v[100:103], v[172:175]
  ds_read_b64_tr_b16 v[76:77], v31 offset:2048
  ds_read_b64_tr_b16 v[78:79], v31 offset:6144
  s_waitcnt lgkmcnt(10)
  v_mfma_f32_16x16x32_bf16 v[176:179], v[56:59], v[80:83], v[176:179]
  s_add_u32 m0, s33, 16384
  s_add_u32 s46, s35, 32768
  buffer_load_dwordx4 v4, s[12:15], s35 offen offset:0 nt lds
  v_mfma_f32_16x16x32_bf16 v[180:183], v[56:59], v[84:87], v[180:183]
  v_mfma_f32_16x16x32_bf16 v[184:187], v[56:59], v[88:91], v[184:187]
  v_mfma_f32_16x16x32_bf16 v[188:191], v[56:59], v[92:95], v[188:191]
  v_mfma_f32_16x16x32_bf16 v[192:195], v[56:59], v[96:99], v[192:195]
  v_mfma_f32_16x16x32_bf16 v[196:199], v[56:59], v[100:103], v[196:199]
  s_waitcnt lgkmcnt(8)
  v_mfma_f32_16x16x32_bf16 v[200:203], v[60:63], v[80:83], v[200:203]
  v_mfma_f32_16x16x32_bf16 v[204:207], v[60:63], v[84:87], v[204:207]
  v_mfma_f32_16x16x32_bf16 a[224:227], v[60:63], v[88:91], a[224:227]
  v_mfma_f32_16x16x32_bf16 a[228:231], v[60:63], v[92:95], a[228:231]
  v_mfma_f32_16x16x32_bf16 a[232:235], v[60:63], v[96:99], a[232:235]
  v_mfma_f32_16x16x32_bf16 a[236:239], v[60:63], v[100:103], a[236:239]
  buffer_load_dwordx4 v5, s[12:15], s35 offen offset:1024 nt lds
  s_waitcnt lgkmcnt(6)
  v_mfma_f32_16x16x32_bf16 v[128:131], v[64:67], v[104:107], v[128:131]
  v_mfma_f32_16x16x32_bf16 v[132:135], v[64:67], v[108:111], v[132:135]
  v_mfma_f32_16x16x32_bf16 v[136:139], v[64:67], v[112:115], v[136:139]
  v_mfma_f32_16x16x32_bf16 v[140:143], v[64:67], v[116:119], v[140:143]
  v_mfma_f32_16x16x32_bf16 v[144:147], v[64:67], v[120:123], v[144:147]
  v_mfma_f32_16x16x32_bf16 v[148:151], v[64:67], v[124:127], v[148:151]
  s_waitcnt lgkmcnt(4)
  v_mfma_f32_16x16x32_bf16 v[152:155], v[68:71], v[104:107], v[152:155]
  v_mfma_f32_16x16x32_bf16 v[156:159], v[68:71], v[108:111], v[156:159]
  v_mfma_f32_16x16x32_bf16 v[160:163], v[68:71], v[112:115], v[160:163]
  v_mfma_f32_16x16x32_bf16 v[164:167], v[68:71], v[116:119], v[164:167]
  v_mfma_f32_16x16x32_bf16 v[168:171], v[68:71], v[120:123], v[168:171]
  buffer_load_dwordx4 v6, s[12:15], s35 offen offset:2048 nt lds
  v_mfma_f32_16x16x32_bf16 v[172:175], v[68:71], v[124:127], v[172:175]
  s_waitcnt lgkmcnt(2)
  v_mfma_f32_16x16x32_bf16 v[176:179], v[72:75], v[104:107], v[176:179]
  v_mfma_f32_16x16x32_bf16 v[180:183], v[72:75], v[108:111], v[180:183]
  v_mfma_f32_16x16x32_bf16 v[184:187], v[72:75], v[112:115], v[184:187]
  v_mfma_f32_16x16x32_bf16 v[188:191], v[72:75], v[116:119], v[188:191]
  v_mfma_f32_16x16x32_bf16 v[192:195], v[72:75], v[120:123], v[192:195]
  v_mfma_f32_16x16x32_bf16 v[196:199], v[72:75], v[124:127], v[196:199]
  s_waitcnt lgkmcnt(0)
  v_mfma_f32_16x16x32_bf16 v[200:203], v[76:79], v[104:107], v[200:203]
  v_mfma_f32_16x16x32_bf16 v[204:207], v[76:79], v[108:111], v[204:207]
  v_mfma_f32_16x16x32_bf16 a[224:227], v[76:79], v[112:115], a[224:227]
  v_mfma_f32_16x16x32_bf16 a[228:231], v[76:79], v[116:119], a[228:231]
  buffer_load_dwordx4 v7, s[12:15], s35 offen offset:3072 nt lds
  v_mfma_f32_16x16x32_bf16 a[232:235], v[76:79], v[120:123], a[232:235]
  v_mfma_f32_16x16x32_bf16 a[236:239], v[76:79], v[124:127], a[236:239]
  s_barrier
  ds_write_b128 v15, v[208:211] offset:0
  ds_write_b128 v15, v[212:215] offset:1024
  ds_write_b128 v15, v[216:219] offset:2048
  ds_write_b128 v15, v[220:223] offset:3072
  ds_write_b128 v15, v[224:227] offset:4096
  s_add_u32 m0, s33, 20480
  s_nop 0
  buffer_load_dwordx4 v4, s[12:15], s46 offen offset:0 nt lds
  ds_write_b128 v15, v[228:231] offset:5120
  ds_write_b128 v15, v[232:235] offset:24576
  ds_write_b128 v15, v[236:239] offset:25600
  ds_write_b128 v15, v[240:243] offset:26624
  ds_write_b128 v15, v[244:247] offset:27648
  ds_write_b128 v15, v[248:251] offset:28672
  ds_write_b128 v15, v[252:255] offset:29696
  s_waitcnt lgkmcnt(0)
  buffer_load_dwordx4 v5, s[12:15], s46 offen offset:1024 nt lds
  s_barrier
  ds_read_b128 v[80:83], v3 offset:0
  ds_read_b128 v[84:87], v3 offset:1024
  ds_read_b128 v[88:91], v3 offset:2048
  ds_read_b128 v[92:95], v3 offset:3072
  ds_read_b128 v[96:99], v3 offset:4096
  ds_read_b128 v[100:103], v3 offset:5120
  ds_read_b128 v[104:107], v3 offset:6144
  ds_read_b128 v[108:111], v3 offset:7168
  ds_read_b128 v[112:115], v3 offset:8192
  ds_read_b128 v[116:119], v3 offset:9216
  ds_read_b128 v[120:123], v3 offset:10240
  ds_read_b128 v[124:127], v3 offset:11264
  s_waitcnt lgkmcnt(0)
  buffer_load_dwordx4 v6, s[12:15], s46 offen offset:2048 nt lds
  buffer_load_dwordx4 v7, s[12:15], s46 offen offset:3072 nt lds
  s_add_u32 s35, s35, 49152
  s_waitcnt vmcnt(8)
  ds_read_b64_tr_b16 v[48:49], v28 offset:8192
  ds_read_b64_tr_b16 v[50:51], v28 offset:12288
  ds_read_b64_tr_b16 v[52:53], v29 offset:8192
  ds_read_b64_tr_b16 v[54:55], v29 offset:12288
  ds_read_b64_tr_b16 v[56:57], v30 offset:8192
  ds_read_b64_tr_b16 v[58:59], v30 offset:12288
  ds_read_b64_tr_b16 v[60:61], v31 offset:8192
  ds_read_b64_tr_b16 v[62:63], v31 offset:12288
  ds_read_b64_tr_b16 v[64:65], v28 offset:10240
  ds_read_b64_tr_b16 v[66:67], v28 offset:14336
  ds_read_b64_tr_b16 v[68:69], v29 offset:10240
  ds_read_b64_tr_b16 v[70:71], v29 offset:14336
  s_waitcnt lgkmcnt(10)
  v_mfma_f32_16x16x32_bf16 v[128:131], v[48:51], v[80:83], v[128:131]
  v_mfma_f32_16x16x32_bf16 v[132:135], v[48:51], v[84:87], v[132:135]
  v_mfma_f32_16x16x32_bf16 v[136:139], v[48:51], v[88:91], v[136:139]
  v_mfma_f32_16x16x32_bf16 v[140:143], v[48:51], v[92:95], v[140:143]
  v_mfma_f32_16x16x32_bf16 v[144:147], v[48:51], v[96:99], v[144:147]
  v_mfma_f32_16x16x32_bf16 v[148:151], v[48:51], v[100:103], v[148:151]
  ds_read_b64_tr_b16 v[72:73], v30 offset:10240
  ds_read_b64_tr_b16 v[74:75], v30 offset:14336
  s_waitcnt lgkmcnt(10)
  v_mfma_f32_16x16x32_bf16 v[152:155], v[52:55], v[80:83], v[152:155]
  v_mfma_f32_16x16x32_bf16 v[156:159], v[52:55], v[84:87], v[156:159]
  v_mfma_f32_16x16x32_bf16 v[160:163], v[52:55], v[88:91], v[160:163]
  v_mfma_f32_16x16x32_bf16 v[164:167], v[52:55], v[92:95], v[164:167]
  v_mfma_f32_16x16x32_bf16 v[168:171], v[52:55], v[96:99], v[168:171]
  v_mfma_f32_16x16x32_bf16 v[172:175], v[52:55], v[100:103], v[172:175]
  ds_read_b64_tr_b16 v[76:77], v31 offset:10240
  ds_read_b64_tr_b16 v[78:79], v31 offset:14336
  s_waitcnt lgkmcnt(10)
  v_mfma_f32_16x16x32_bf16 v[176:179], v[56:59], v[80:83], v[176:179]
  s_add_u32 m0, s33, 0
  s_add_u32 s46, s35, 32768
  buffer_load_dwordx4 v4, s[12:15], s35 offen offset:0 nt lds
  v_mfma_f32_16x16x32_bf16 v[180:183], v[56:59], v[84:87], v[180:183]
  v_mfma_f32_16x16x32_bf16 v[184:187], v[56:59], v[88:91], v[184:187]
  v_mfma_f32_16x16x32_bf16 v[188:191], v[56:59], v[92:95], v[188:191]
  v_mfma_f32_16x16x32_bf16 v[192:195], v[56:59], v[96:99], v[192:195]
  v_mfma_f32_16x16x32_bf16 v[196:199], v[56:59], v[100:103], v[196:199]
  s_waitcnt lgkmcnt(8)
  v_mfma_f32_16x16x32_bf16 v[200:203], v[60:63], v[80:83], v[200:203]
  v_mfma_f32_16x16x32_bf16 v[204:207], v[60:63], v[84:87], v[204:207]
  v_mfma_f32_16x16x32_bf16 a[224:227], v[60:63], v[88:91], a[224:227]
  v_mfma_f32_16x16x32_bf16 a[228:231], v[60:63], v[92:95], a[228:231]
  v_mfma_f32_16x16x32_bf16 a[232:235], v[60:63], v[96:99], a[232:235]
  v_mfma_f32_16x16x32_bf16 a[236:239], v[60:63], v[100:103], a[236:239]
  buffer_load_dwordx4 v5, s[12:15], s35 offen offset:1024 nt lds
  s_waitcnt lgkmcnt(6)
  v_mfma_f32_16x16x32_bf16 v[128:131], v[64:67], v[104:107], v[128:131]
  v_mfma_f32_16x16x32_bf16 v[132:135], v[64:67], v[108:111], v[132:135]
  v_mfma_f32_16x16x32_bf16 v[136:139], v[64:67], v[112:115], v[136:139]
  v_mfma_f32_16x16x32_bf16 v[140:143], v[64:67], v[116:119], v[140:143]
  v_mfma_f32_16x16x32_bf16 v[144:147], v[64:67], v[120:123], v[144:147]
  v_mfma_f32_16x16x32_bf16 v[148:151], v[64:67], v[124:127], v[148:151]
  s_waitcnt lgkmcnt(4)
  v_mfma_f32_16x16x32_bf16 v[152:155], v[68:71], v[104:107], v[152:155]
  v_mfma_f32_16x16x32_bf16 v[156:159], v[68:71], v[108:111], v[156:159]
  v_mfma_f32_16x16x32_bf16 v[160:163], v[68:71], v[112:115], v[160:163]
  v_mfma_f32_16x16x32_bf16 v[164:167], v[68:71], v[116:119], v[164:167]
  v_mfma_f32_16x16x32_bf16 v[168:171], v[68:71], v[120:123], v[168:171]
  buffer_load_dwordx4 v6, s[12:15], s35 offen offset:2048 nt lds
  v_mfma_f32_16x16x32_bf16 v[172:175], v[68:71], v[124:127], v[172:175]
  s_waitcnt lgkmcnt(2)
  v_mfma_f32_16x16x32_bf16 v[176:179], v[72:75], v[104:107], v[176:179]
  v_mfma_f32_16x16x32_bf16 v[180:183], v[72:75], v[108:111], v[180:183]
  v_mfma_f32_16x16x32_bf16 v[184:187], v[72:75], v[112:115], v[184:187]
  v_mfma_f32_16x16x32_bf16 v[188:191], v[72:75], v[116:119], v[188:191]
  v_mfma_f32_16x16x32_bf16 v[192:195], v[72:75], v[120:123], v[192:195]
  v_mfma_f32_16x16x32_bf16 v[196:199], v[72:75], v[124:127], v[196:199]
  s_waitcnt lgkmcnt(0)
  v_mfma_f32_16x16x32_bf16 v[200:203], v[76:79], v[104:107], v[200:203]
  v_mfma_f32_16x16x32_bf16 v[204:207], v[76:79], v[108:111], v[204:207]
  v_mfma_f32_16x16x32_bf16 a[224:227], v[76:79], v[112:115], a[224:227]
  v_mfma_f32_16x16x32_bf16 a[228:231], v[76:79], v[116:119], a[228:231]
  buffer_load_dwordx4 v7, s[12:15], s35 offen offset:3072 nt lds
  v_mfma_f32_16x16x32_bf16 a[232:235], v[76:79], v[120:123], a[232:235]
  v_mfma_f32_16x16x32_bf16 a[236:239], v[76:79], v[124:127], a[236:239]
  ds_read_b128 v[80:83], v3 offset:12288
  ds_read_b128 v[84:87], v3 offset:13312
  ds_read_b128 v[88:91], v3 offset:14336
  ds_read_b128 v[92:95], v3 offset:15360
  ds_read_b128 v[96:99], v3 offset:16384
  ds_read_b128 v[100:103], v3 offset:17408
  ds_read_b128 v[104:107], v3 offset:18432
  ds_read_b128 v[108:111], v3 offset:19456
  ds_read_b128 v[112:115], v3 offset:20480
  ds_read_b128 v[116:119], v3 offset:21504
  ds_read_b128 v[120:123], v3 offset:22528
  ds_read_b128 v[124:127], v3 offset:23552
  s_cmp_eq_u32 s32, 0
  s_cbranch_scc0 L_tagldA
  s_load_dwordx2 s[90:91], s[94:95], 0
L_tagldA:
  ds_read_b128 v[208:211], v14 offset:1536
  ds_read_b128 v[212:215], v14 offset:1792
  ds_read_b128 v[216:219], v14 offset:2048
  ds_read_b128 v[220:223], v14 offset:2304
  ds_read_b128 v[224:227], v14 offset:2560
  ds_read_b128 v[228:231], v14 offset:2816
  s_waitcnt lgkmcnt(0)
  s_add_u32 m0, s33, 4096
  s_nop 0
  buffer_load_dwordx4 v4, s[12:15], s46 offen offset:0 nt lds
  s_cmp_eq_u32 s32, 0
  s_cbranch_scc0 L_tagokA
  s_mov_b32 s51, 0
L_tagchkA:
  s_cmp_lg_u32 s90, 0
  s_cbranch_scc1 L_tagokA
  s_add_u32 s51, s51, 1
  s_cmp_ge_u32 s51, 0x100000
  s_cbranch_scc1 L_tagokA
  s_sleep 8
  v_mov_b32 v45, 0
  global_load_dwordx2 v[46:47], v45, s[94:95] sc1
  s_waitcnt vmcnt(0)
  v_readfirstlane_b32 s90, v46
  v_readfirstlane_b32 s91, v47
  s_branch L_tagchkA
L_tagokA:
  v_add_f32 v16, v208, v209
  v_add_f32 v18, v212, v213
  v_add_f32 v20, v216, v217
  v_add_f32 v22, v220, v221
  v_add_f32 v24, v224, v225
  v_add_f32 v26, v228, v229
  v_add_f32 v210, v210, v211
  v_add_f32 v214, v214, v215
  v_add_f32 v218, v218, v219
  v_add_f32 v222, v222, v223
  v_add_f32 v226, v226, v227
  v_add_f32 v230, v230, v231
  v_add_f32 v16, v16, v210
  v_add_f32 v18, v18, v214
  v_add_f32 v20, v20, v218
  v_add_f32 v22, v22, v222
  v_add_f32 v24, v24, v226
  v_add_f32 v26, v26, v230
  v_rcp_f32 v16, v16
  v_rcp_f32 v18, v18
  v_rcp_f32 v20, v20
  v_rcp_f32 v22, v22
  v_rcp_f32 v24, v24
  v_rcp_f32 v26, v26
  s_mul_i32 s39, s32, 6144
  v_add_u32 v15, s39, v3
  v_add_u32 v36, s43, v3
  s_add_u32 s43, s43, 3072
  s_cmp_eq_u32 s43, 24576
  s_cselect_b32 s43, 0, s43
  v_add_u32 v37, s43, v3
  s_add_u32 s43, s43, 3072
  s_cmp_eq_u32 s43, 24576
  s_cselect_b32 s43, 0, s43
  v_add_u32 v38, s43, v3
  s_add_u32 s43, s43, 3072
  s_cmp_eq_u32 s43, 24576
  s_cselect_b32 s43, 0, s43
  v_add_u32 v39, s43, v3
  s_add_u32 s43, s43, 3072
  s_cmp_eq_u32 s43, 24576
  s_cselect_b32 s43, 0, s43
  v_add_u32 v40, s43, v3
  s_add_u32 s43, s43, 3072
  s_cmp_eq_u32 s43, 24576
  s_cselect_b32 s43, 0, s43
  buffer_load_dwordx4 v5, s[12:15], s46 offen offset:1024 nt lds
  v_add_u32 v41, s43, v3
  s_add_u32 s43, s43, 3072
  s_cmp_eq_u32 s43, 24576
  s_cselect_b32 s43, 0, s43
  v_add_u32 v42, s43, v3
  s_add_u32 s43, s43, 3072
  s_cmp_eq_u32 s43, 24576
  s_cselect_b32 s43, 0, s43
  v_add_u32 v43, s43, v3
  s_add_u32 s43, s43, 3072
  s_cmp_eq_u32 s43, 24576
  s_cselect_b32 s43, 0, s43
  s_waitcnt lgkmcnt(0)
  buffer_load_dwordx4 v6, s[12:15], s46 offen offset:2048 nt lds
  buffer_load_dwordx4 v7, s[12:15], s46 offen offset:3072 nt lds
  s_add_u32 s35, s35, 16384
  s_waitcnt vmcnt(8)
  ds_read_b64_tr_b16 v[48:49], v28 offset:16384
  ds_read_b64_tr_b16 v[50:51], v28 offset:20480
  ds_read_b64_tr_b16 v[52:53], v29 offset:16384
  ds_read_b64_tr_b16 v[54:55], v29 offset:20480
  ds_read_b64_tr_b16 v[56:57], v30 offset:16384
  ds_read_b64_tr_b16 v[58:59], v30 offset:20480
  ds_read_b64_tr_b16 v[60:61], v31 offset:16384
  ds_read_b64_tr_b16 v[62:63], v31 offset:20480
  ds_read_b64_tr_b16 v[64:65], v28 offset:18432
  ds_read_b64_tr_b16 v[66:67], v28 offset:22528
  ds_read_b64_tr_b16 v[68:69], v29 offset:18432
  ds_read_b64_tr_b16 v[70:71], v29 offset:22528
  s_waitcnt lgkmcnt(10)
  v_mfma_f32_16x16x32_bf16 v[128:131], v[48:51], v[80:83], v[128:131]
  v_mfma_f32_16x16x32_bf16 v[132:135], v[48:51], v[84:87], v[132:135]
  v_mfma_f32_16x16x32_bf16 v[136:139], v[48:51], v[88:91], v[136:139]
  v_mfma_f32_16x16x32_bf16 v[140:143], v[48:51], v[92:95], v[140:143]
  v_mfma_f32_16x16x32_bf16 v[144:147], v[48:51], v[96:99], v[144:147]
  v_mfma_f32_16x16x32_bf16 v[148:151], v[48:51], v[100:103], v[148:151]
  ds_read_b64_tr_b16 v[72:73], v30 offset:18432
  ds_read_b64_tr_b16 v[74:75], v30 offset:22528
  s_waitcnt lgkmcnt(10)
  v_mfma_f32_16x16x32_bf16 v[152:155], v[52:55], v[80:83], v[152:155]
  v_mfma_f32_16x16x32_bf16 v[156:159], v[52:55], v[84:87], v[156:159]
  v_mfma_f32_16x16x32_bf16 v[160:163], v[52:55], v[88:91], v[160:163]
  v_mfma_f32_16x16x32_bf16 v[164:167], v[52:55], v[92:95], v[164:167]
  v_mfma_f32_16x16x32_bf16 v[168:171], v[52:55], v[96:99], v[168:171]
  v_mfma_f32_16x16x32_bf16 v[172:175], v[52:55], v[100:103], v[172:175]
  ds_read_b64_tr_b16 v[76:77], v31 offset:18432
  ds_read_b64_tr_b16 v[78:79], v31 offset:22528
  s_waitcnt lgkmcnt(10)
  v_mfma_f32_16x16x32_bf16 v[176:179], v[56:59], v[80:83], v[176:179]
  s_add_u32 m0, s33, 8192
  s_add_u32 s46, s35, 32768
  buffer_load_dwordx4 v4, s[12:15], s35 offen offset:0 nt lds
  v_mfma_f32_16x16x32_bf16 v[180:183], v[56:59], v[84:87], v[180:183]
  v_mfma_f32_16x16x32_bf16 v[184:187], v[56:59], v[88:91], v[184:187]
  v_mfma_f32_16x16x32_bf16 v[188:191], v[56:59], v[92:95], v[188:191]
  v_mfma_f32_16x16x32_bf16 v[192:195], v[56:59], v[96:99], v[192:195]
  v_mfma_f32_16x16x32_bf16 v[196:199], v[56:59], v[100:103], v[196:199]
  s_waitcnt lgkmcnt(8)
  v_mfma_f32_16x16x32_bf16 v[200:203], v[60:63], v[80:83], v[200:203]
  v_mfma_f32_16x16x32_bf16 v[204:207], v[60:63], v[84:87], v[204:207]
  v_mfma_f32_16x16x32_bf16 a[224:227], v[60:63], v[88:91], a[224:227]
  v_mfma_f32_16x16x32_bf16 a[228:231], v[60:63], v[92:95], a[228:231]
  v_mfma_f32_16x16x32_bf16 a[232:235], v[60:63], v[96:99], a[232:235]
  v_mfma_f32_16x16x32_bf16 a[236:239], v[60:63], v[100:103], a[236:239]
  buffer_load_dwordx4 v5, s[12:15], s35 offen offset:1024 nt lds
  s_waitcnt lgkmcnt(6)
  v_mfma_f32_16x16x32_bf16 v[128:131], v[64:67], v[104:107], v[128:131]
  v_mfma_f32_16x16x32_bf16 v[132:135], v[64:67], v[108:111], v[132:135]
  v_mfma_f32_16x16x32_bf16 v[136:139], v[64:67], v[112:115], v[136:139]
  v_mfma_f32_16x16x32_bf16 v[140:143], v[64:67], v[116:119], v[140:143]
  v_mfma_f32_16x16x32_bf16 v[144:147], v[64:67], v[120:123], v[144:147]
  v_mfma_f32_16x16x32_bf16 v[148:151], v[64:67], v[124:127], v[148:151]
  s_waitcnt lgkmcnt(4)
  v_mfma_f32_16x16x32_bf16 v[152:155], v[68:71], v[104:107], v[152:155]
  v_mfma_f32_16x16x32_bf16 v[156:159], v[68:71], v[108:111], v[156:159]
  v_mfma_f32_16x16x32_bf16 v[160:163], v[68:71], v[112:115], v[160:163]
  v_mfma_f32_16x16x32_bf16 v[164:167], v[68:71], v[116:119], v[164:167]
  v_mfma_f32_16x16x32_bf16 v[168:171], v[68:71], v[120:123], v[168:171]
  buffer_load_dwordx4 v6, s[12:15], s35 offen offset:2048 nt lds
  v_mfma_f32_16x16x32_bf16 v[172:175], v[68:71], v[124:127], v[172:175]
  s_waitcnt lgkmcnt(2)
  v_mfma_f32_16x16x32_bf16 v[176:179], v[72:75], v[104:107], v[176:179]
  v_mfma_f32_16x16x32_bf16 v[180:183], v[72:75], v[108:111], v[180:183]
  v_mfma_f32_16x16x32_bf16 v[184:187], v[72:75], v[112:115], v[184:187]
  v_mfma_f32_16x16x32_bf16 v[188:191], v[72:75], v[116:119], v[188:191]
  v_mfma_f32_16x16x32_bf16 v[192:195], v[72:75], v[120:123], v[192:195]
  v_mfma_f32_16x16x32_bf16 v[196:199], v[72:75], v[124:127], v[196:199]
  s_waitcnt lgkmcnt(0)
  v_mfma_f32_16x16x32_bf16 v[200:203], v[76:79], v[104:107], v[200:203]
  v_mfma_f32_16x16x32_bf16 v[204:207], v[76:79], v[108:111], v[204:207]
  v_mfma_f32_16x16x32_bf16 a[224:227], v[76:79], v[112:115], a[224:227]
  v_mfma_f32_16x16x32_bf16 a[228:231], v[76:79], v[116:119], a[228:231]
  buffer_load_dwordx4 v7, s[12:15], s35 offen offset:3072 nt lds
  v_mfma_f32_16x16x32_bf16 a[232:235], v[76:79], v[120:123], a[232:235]
  v_mfma_f32_16x16x32_bf16 a[236:239], v[76:79], v[124:127], a[236:239]
  ds_read_b128 v[80:83], v3 offset:24576
  ds_read_b128 v[84:87], v3 offset:25600
  ds_read_b128 v[88:91], v3 offset:26624
  ds_read_b128 v[92:95], v3 offset:27648
  ds_read_b128 v[96:99], v3 offset:28672
  ds_read_b128 v[100:103], v3 offset:29696
  ds_read_b128 v[104:107], v3 offset:30720
  ds_read_b128 v[108:111], v3 offset:31744
  ds_read_b128 v[112:115], v3 offset:32768
  ds_read_b128 v[116:119], v3 offset:33792
  ds_read_b128 v[120:123], v3 offset:34816
  ds_read_b128 v[124:127], v3 offset:35840
  s_waitcnt lgkmcnt(0)
  s_add_u32 m0, s33, 12288
  s_nop 0
  buffer_load_dwordx4 v4, s[12:15], s46 offen offset:0 nt lds
  buffer_load_dwordx4 v5, s[12:15], s46 offen offset:1024 nt lds
  buffer_load_dwordx4 v6, s[12:15], s46 offen offset:2048 nt lds
  buffer_load_dwordx4 v7, s[12:15], s46 offen offset:3072 nt lds
  s_add_u32 s35, s35, 49152
  s_waitcnt vmcnt(8)
  ds_read_b64_tr_b16 v[48:49], v28 offset:0
  ds_read_b64_tr_b16 v[50:51], v28 offset:4096
  ds_read_b64_tr_b16 v[52:53], v29 offset:0
  ds_read_b64_tr_b16 v[54:55], v29 offset:4096
  ds_read_b64_tr_b16 v[56:57], v30 offset:0
  ds_read_b64_tr_b16 v[58:59], v30 offset:4096
  ds_read_b64_tr_b16 v[60:61], v31 offset:0
  ds_read_b64_tr_b16 v[62:63], v31 offset:4096
  ds_read_b64_tr_b16 v[64:65], v28 offset:2048
  ds_read_b64_tr_b16 v[66:67], v28 offset:6144
  ds_read_b64_tr_b16 v[68:69], v29 offset:2048
  ds_read_b64_tr_b16 v[70:71], v29 offset:6144
  s_waitcnt lgkmcnt(10)
  v_mfma_f32_16x16x32_bf16 v[128:131], v[48:51], v[80:83], v[128:131]
  v_mfma_f32_16x16x32_bf16 v[132:135], v[48:51], v[84:87], v[132:135]
  v_mfma_f32_16x16x32_bf16 v[136:139], v[48:51], v[88:91], v[136:139]
  v_mfma_f32_16x16x32_bf16 v[140:143], v[48:51], v[92:95], v[140:143]
  v_mfma_f32_16x16x32_bf16 v[144:147], v[48:51], v[96:99], v[144:147]
  v_mfma_f32_16x16x32_bf16 v[148:151], v[48:51], v[100:103], v[148:151]
  ds_read_b64_tr_b16 v[72:73], v30 offset:2048
  ds_read_b64_tr_b16 v[74:75], v30 offset:6144
  s_waitcnt lgkmcnt(10)
  v_mfma_f32_16x16x32_bf16 v[152:155], v[52:55], v[80:83], v[152:155]
  v_mfma_f32_16x16x32_bf16 v[156:159], v[52:55], v[84:87], v[156:159]
  v_mfma_f32_16x16x32_bf16 v[160:163], v[52:55], v[88:91], v[160:163]
  v_mfma_f32_16x16x32_bf16 v[164:167], v[52:55], v[92:95], v[164:167]
  v_mfma_f32_16x16x32_bf16 v[168:171], v[52:55], v[96:99], v[168:171]
  v_mfma_f32_16x16x32_bf16 v[172:175], v[52:55], v[100:103], v[172:175]
  ds_read_b64_tr_b16 v[76:77], v31 offset:2048
  ds_read_b64_tr_b16 v[78:79], v31 offset:6144
  s_waitcnt lgkmcnt(10)
  v_mfma_f32_16x16x32_bf16 v[176:179], v[56:59], v[80:83], v[176:179]
  s_add_u32 m0, s33, 16384
  s_add_u32 s46, s37, 14336
  buffer_load_dwordx4 v8, s[20:23], s37 offen offset:0 lds
  v_mfma_f32_16x16x32_bf16 v[180:183], v[56:59], v[84:87], v[180:183]
  v_mfma_f32_16x16x32_bf16 v[184:187], v[56:59], v[88:91], v[184:187]
  v_mfma_f32_16x16x32_bf16 v[188:191], v[56:59], v[92:95], v[188:191]
  buffer_load_dwordx4 v9, s[20:23], s37 offen offset:1024 lds
  v_mfma_f32_16x16x32_bf16 v[192:195], v[56:59], v[96:99], v[192:195]
  v_mfma_f32_16x16x32_bf16 v[196:199], v[56:59], v[100:103], v[196:199]
  s_waitcnt lgkmcnt(8)
  v_mfma_f32_16x16x32_bf16 v[200:203], v[60:63], v[80:83], v[200:203]
  buffer_load_dwordx4 v10, s[20:23], s37 offen offset:2048 lds
  v_mfma_f32_16x16x32_bf16 v[204:207], v[60:63], v[84:87], v[204:207]
  v_mfma_f32_16x16x32_bf16 a[224:227], v[60:63], v[88:91], a[224:227]
  v_mfma_f32_16x16x32_bf16 a[228:231], v[60:63], v[92:95], a[228:231]
  buffer_load_dwordx4 v11, s[20:23], s37 offen offset:3072 lds
  v_mfma_f32_16x16x32_bf16 a[232:235], v[60:63], v[96:99], a[232:235]
  v_mfma_f32_16x16x32_bf16 a[236:239], v[60:63], v[100:103], a[236:239]
  s_waitcnt lgkmcnt(6)
  v_mfma_f32_16x16x32_bf16 v[128:131], v[64:67], v[104:107], v[128:131]
  s_add_u32 m0, s33, 20480
  s_nop 0
  buffer_load_dwordx4 v8, s[20:23], s46 offen offset:0 lds
  v_mfma_f32_16x16x32_bf16 v[132:135], v[64:67], v[108:111], v[132:135]
  v_mfma_f32_16x16x32_bf16 v[136:139], v[64:67], v[112:115], v[136:139]
  v_mfma_f32_16x16x32_bf16 v[140:143], v[64:67], v[116:119], v[140:143]
  buffer_load_dwordx4 v9, s[20:23], s46 offen offset:1024 lds
  v_mfma_f32_16x16x32_bf16 v[144:147], v[64:67], v[120:123], v[144:147]
  v_mfma_f32_16x16x32_bf16 v[148:151], v[64:67], v[124:127], v[148:151]
  s_waitcnt lgkmcnt(4)
  v_mfma_f32_16x16x32_bf16 v[152:155], v[68:71], v[104:107], v[152:155]
  buffer_load_dwordx4 v10, s[20:23], s46 offen offset:2048 lds
  v_mfma_f32_16x16x32_bf16 v[156:159], v[68:71], v[108:111], v[156:159]
  v_mfma_f32_16x16x32_bf16 v[160:163], v[68:71], v[112:115], v[160:163]
  v_mfma_f32_16x16x32_bf16 v[164:167], v[68:71], v[116:119], v[164:167]
  buffer_load_dwordx4 v11, s[20:23], s46 offen offset:3072 lds
  s_add_u32 s37, s37, 28672
  s_cmp_eq_u32 s37, s38
  s_cselect_b32 s47, 229376, 0
  s_sub_u32 s37, s37, s47
  v_mfma_f32_16x16x32_bf16 v[168:171], v[68:71], v[120:123], v[168:171]
  v_mfma_f32_16x16x32_bf16 v[172:175], v[68:71], v[124:127], v[172:175]
  s_waitcnt lgkmcnt(2)
  v_mfma_f32_16x16x32_bf16 v[176:179], v[72:75], v[104:107], v[176:179]
  v_mfma_f32_16x16x32_bf16 v[180:183], v[72:75], v[108:111], v[180:183]
  v_mfma_f32_16x16x32_bf16 v[184:187], v[72:75], v[112:115], v[184:187]
  v_mfma_f32_16x16x32_bf16 v[188:191], v[72:75], v[116:119], v[188:191]
  v_mfma_f32_16x16x32_bf16 v[192:195], v[72:75], v[120:123], v[192:195]
  v_mfma_f32_16x16x32_bf16 v[196:199], v[72:75], v[124:127], v[196:199]
  s_waitcnt lgkmcnt(0)
  v_mfma_f32_16x16x32_bf16 v[200:203], v[76:79], v[104:107], v[200:203]
  s_add_u32 m0, s33, 0
  s_add_u32 s46, s37, 14336
  buffer_load_dwordx4 v8, s[20:23], s37 offen offset:0 lds
  v_mfma_f32_16x16x32_bf16 v[204:207], v[76:79], v[108:111], v[204:207]
  v_mfma_f32_16x16x32_bf16 a[224:227], v[76:79], v[112:115], a[224:227]
  v_mfma_f32_16x16x32_bf16 a[228:231], v[76:79], v[116:119], a[228:231]
  buffer_load_dwordx4 v9, s[20:23], s37 offen offset:1024 lds
  v_mfma_f32_16x16x32_bf16 a[232:235], v[76:79], v[120:123], a[232:235]
  v_mfma_f32_16x16x32_bf16 a[236:239], v[76:79], v[124:127], a[236:239]
  ds_read_b128 v[80:83], v3 offset:36864
  ds_read_b128 v[84:87], v3 offset:37888
  buffer_load_dwordx4 v10, s[20:23], s37 offen offset:2048 lds
  ds_read_b128 v[88:91], v3 offset:38912
  ds_read_b128 v[92:95], v3 offset:39936
  ds_read_b128 v[96:99], v3 offset:40960
  ds_read_b128 v[100:103], v3 offset:41984
  ds_read_b128 v[104:107], v3 offset:43008
  ds_read_b128 v[108:111], v3 offset:44032
  ds_read_b128 v[112:115], v3 offset:45056
  ds_read_b128 v[116:119], v3 offset:46080
  buffer_load_dwordx4 v11, s[20:23], s37 offen offset:3072 lds
  ds_read_b128 v[120:123], v3 offset:47104
  ds_read_b128 v[124:127], v3 offset:48128
  s_waitcnt lgkmcnt(0)
  s_add_u32 m0, s33, 4096
  s_nop 0
  buffer_load_dwordx4 v8, s[20:23], s46 offen offset:0 lds
  s_barrier
  buffer_load_dwordx4 v9, s[20:23], s46 offen offset:1024 lds
  s_waitcnt vmcnt(14)
  ds_read_b64_tr_b16 v[48:49], v28 offset:8192
  ds_read_b64_tr_b16 v[50:51], v28 offset:12288
  ds_read_b64_tr_b16 v[52:53], v29 offset:8192
  ds_read_b64_tr_b16 v[54:55], v29 offset:12288
  ds_read_b64_tr_b16 v[56:57], v30 offset:8192
  ds_read_b64_tr_b16 v[58:59], v30 offset:12288
  ds_read_b64_tr_b16 v[60:61], v31 offset:8192
  ds_read_b64_tr_b16 v[62:63], v31 offset:12288
  ds_read_b64_tr_b16 v[64:65], v28 offset:10240
  ds_read_b64_tr_b16 v[66:67], v28 offset:14336
  ds_read_b64_tr_b16 v[68:69], v29 offset:10240
  ds_read_b64_tr_b16 v[70:71], v29 offset:14336
  s_waitcnt lgkmcnt(10)
  v_mfma_f32_16x16x32_bf16 v[128:131], v[48:51], v[80:83], v[128:131]
  v_mfma_f32_16x16x32_bf16 v[132:135], v[48:51], v[84:87], v[132:135]
  v_mfma_f32_16x16x32_bf16 v[136:139], v[48:51], v[88:91], v[136:139]
  v_mfma_f32_16x16x32_bf16 v[140:143], v[48:51], v[92:95], v[140:143]
  v_mfma_f32_16x16x32_bf16 v[144:147], v[48:51], v[96:99], v[144:147]
  v_mfma_f32_16x16x32_bf16 v[148:151], v[48:51], v[100:103], v[148:151]
  ds_read_b64_tr_b16 v[72:73], v30 offset:10240
  ds_read_b64_tr_b16 v[74:75], v30 offset:14336
  s_waitcnt lgkmcnt(10)
  v_mfma_f32_16x16x32_bf16 v[152:155], v[52:55], v[80:83], v[152:155]
  v_mfma_f32_16x16x32_bf16 v[156:159], v[52:55], v[84:87], v[156:159]
  v_mfma_f32_16x16x32_bf16 v[160:163], v[52:55], v[88:91], v[160:163]
  v_mfma_f32_16x16x32_bf16 v[164:167], v[52:55], v[92:95], v[164:167]
  v_mfma_f32_16x16x32_bf16 v[168:171], v[52:55], v[96:99], v[168:171]
  v_mfma_f32_16x16x32_bf16 v[172:175], v[52:55], v[100:103], v[172:175]
  ds_read_b64_tr_b16 v[76:77], v31 offset:10240
  ds_read_b64_tr_b16 v[78:79], v31 offset:14336
  s_waitcnt lgkmcnt(10)
  v_mfma_f32_16x16x32_bf16 v[176:179], v[56:59], v[80:83], v[176:179]
  buffer_load_dwordx4 v10, s[20:23], s46 offen offset:2048 lds
  v_mfma_f32_16x16x32_bf16 v[180:183], v[56:59], v[84:87], v[180:183]
  v_mfma_f32_16x16x32_bf16 v[184:187], v[56:59], v[88:91], v[184:187]
  v_mfma_f32_16x16x32_bf16 v[188:191], v[56:59], v[92:95], v[188:191]
  buffer_load_dwordx4 v11, s[20:23], s46 offen offset:3072 lds
  s_add_u32 s37, s37, 28672
  s_cmp_eq_u32 s37, s38
  s_cselect_b32 s47, 229376, 0
  s_sub_u32 s37, s37, s47
  v_mfma_f32_16x16x32_bf16 v[192:195], v[56:59], v[96:99], v[192:195]
  v_mfma_f32_16x16x32_bf16 v[196:199], v[56:59], v[100:103], v[196:199]
  s_waitcnt lgkmcnt(8)
  v_mfma_f32_16x16x32_bf16 v[200:203], v[60:63], v[80:83], v[200:203]
  v_mfma_f32_16x16x32_bf16 v[204:207], v[60:63], v[84:87], v[204:207]
  v_mfma_f32_16x16x32_bf16 a[224:227], v[60:63], v[88:91], a[224:227]
  v_mfma_f32_16x16x32_bf16 a[228:231], v[60:63], v[92:95], a[228:231]
  v_mfma_f32_16x16x32_bf16 a[232:235], v[60:63], v[96:99], a[232:235]
  v_mfma_f32_16x16x32_bf16 a[236:239], v[60:63], v[100:103], a[236:239]
  s_waitcnt lgkmcnt(6)
  v_mfma_f32_16x16x32_bf16 v[128:131], v[64:67], v[104:107], v[128:131]
  v_mfma_f32_16x16x32_bf16 v[132:135], v[64:67], v[108:111], v[132:135]
  v_mfma_f32_16x16x32_bf16 v[136:139], v[64:67], v[112:115], v[136:139]
  v_mfma_f32_16x16x32_bf16 v[140:143], v[64:67], v[116:119], v[140:143]
  v_mfma_f32_16x16x32_bf16 v[144:147], v[64:67], v[120:123], v[144:147]
  v_mfma_f32_16x16x32_bf16 v[148:151], v[64:67], v[124:127], v[148:151]
  s_waitcnt lgkmcnt(4)
  v_mfma_f32_16x16x32_bf16 v[152:155], v[68:71], v[104:107], v[152:155]
  v_mfma_f32_16x16x32_bf16 v[156:159], v[68:71], v[108:111], v[156:159]
  v_mfma_f32_16x16x32_bf16 v[160:163], v[68:71], v[112:115], v[160:163]
  v_mfma_f32_16x16x32_bf16 v[164:167], v[68:71], v[116:119], v[164:167]
  v_mfma_f32_16x16x32_bf16 v[168:171], v[68:71], v[120:123], v[168:171]
  v_mfma_f32_16x16x32_bf16 v[172:175], v[68:71], v[124:127], v[172:175]
  s_waitcnt lgkmcnt(2)
  v_mfma_f32_16x16x32_bf16 v[176:179], v[72:75], v[104:107], v[176:179]
  v_mfma_f32_16x16x32_bf16 v[180:183], v[72:75], v[108:111], v[180:183]
  v_mfma_f32_16x16x32_bf16 v[184:187], v[72:75], v[112:115], v[184:187]
  v_mfma_f32_16x16x32_bf16 v[188:191], v[72:75], v[116:119], v[188:191]
  v_mfma_f32_16x16x32_bf16 v[192:195], v[72:75], v[120:123], v[192:195]
  v_mfma_f32_16x16x32_bf16 v[196:199], v[72:75], v[124:127], v[196:199]
  s_waitcnt lgkmcnt(0)
  v_mfma_f32_16x16x32_bf16 v[200:203], v[76:79], v[104:107], v[200:203]
  s_add_u32 m0, s33, 8192
  s_add_u32 s46, s37, 14336
  buffer_load_dwordx4 v8, s[20:23], s37 offen offset:0 lds
  v_mfma_f32_16x16x32_bf16 v[204:207], v[76:79], v[108:111], v[204:207]
  v_mfma_f32_16x16x32_bf16 a[224:227], v[76:79], v[112:115], a[224:227]
  v_mfma_f32_16x16x32_bf16 a[228:231], v[76:79], v[116:119], a[228:231]
  buffer_load_dwordx4 v9, s[20:23], s37 offen offset:1024 lds
  v_mfma_f32_16x16x32_bf16 a[232:235], v[76:79], v[120:123], a[232:235]
  v_mfma_f32_16x16x32_bf16 a[236:239], v[76:79], v[124:127], a[236:239]
  s_nop 2
  v_pk_mul_f32 v[128:129], v[128:129], v[16:17] op_sel_hi:[1,0]
  v_pk_mul_f32 v[130:131], v[130:131], v[16:17] op_sel_hi:[1,0]
  buffer_load_dwordx4 v10, s[20:23], s37 offen offset:2048 lds
  v_pk_mul_f32 v[152:153], v[152:153], v[16:17] op_sel_hi:[1,0]
  v_pk_mul_f32 v[154:155], v[154:155], v[16:17] op_sel_hi:[1,0]
  v_cvt_pk_bf16_f32 v128, v128, v129
  v_cvt_pk_bf16_f32 v129, v130, v131
  v_cvt_pk_bf16_f32 v130, v152, v153
  v_cvt_pk_bf16_f32 v131, v154, v155
  ds_write_b128 v15, v[128:131] offset:0
  v_pk_mul_f32 v[132:133], v[132:133], v[18:19] op_sel_hi:[1,0]
  buffer_load_dwordx4 v11, s[20:23], s37 offen offset:3072 lds
  v_pk_mul_f32 v[134:135], v[134:135], v[18:19] op_sel_hi:[1,0]
  v_pk_mul_f32 v[156:157], v[156:157], v[18:19] op_sel_hi:[1,0]
  v_pk_mul_f32 v[158:159], v[158:159], v[18:19] op_sel_hi:[1,0]
  v_cvt_pk_bf16_f32 v132, v132, v133
  v_cvt_pk_bf16_f32 v133, v134, v135
  v_cvt_pk_bf16_f32 v134, v156, v157
  v_cvt_pk_bf16_f32 v135, v158, v159
  ds_write_b128 v15, v[132:135] offset:1024
  s_add_u32 m0, s33, 12288
  s_nop 0
  buffer_load_dwordx4 v8, s[20:23], s46 offen offset:0 lds
  v_pk_mul_f32 v[136:137], v[136:137], v[20:21] op_sel_hi:[1,0]
  v_pk_mul_f32 v[138:139], v[138:139], v[20:21] op_sel_hi:[1,0]
  v_pk_mul_f32 v[160:161], v[160:161], v[20:21] op_sel_hi:[1,0]
  v_pk_mul_f32 v[162:163], v[162:163], v[20:21] op_sel_hi:[1,0]
  v_cvt_pk_bf16_f32 v136, v136, v137
  v_cvt_pk_bf16_f32 v137, v138, v139
  v_cvt_pk_bf16_f32 v138, v160, v161
  v_cvt_pk_bf16_f32 v139, v162, v163
  ds_write_b128 v15, v[136:139] offset:2048
  buffer_load_dwordx4 v9, s[20:23], s46 offen offset:1024 lds
  v_pk_mul_f32 v[140:141], v[140:141], v[22:23] op_sel_hi:[1,0]
  v_pk_mul_f32 v[142:143], v[142:143], v[22:23] op_sel_hi:[1,0]
  v_pk_mul_f32 v[164:165], v[164:165], v[22:23] op_sel_hi:[1,0]
  v_pk_mul_f32 v[166:167], v[166:167], v[22:23] op_sel_hi:[1,0]
  v_cvt_pk_bf16_f32 v140, v140, v141
  v_cvt_pk_bf16_f32 v141, v142, v143
  v_cvt_pk_bf16_f32 v142, v164, v165
  v_cvt_pk_bf16_f32 v143, v166, v167
  ds_write_b128 v15, v[140:143] offset:24576
  buffer_load_dwordx4 v10, s[20:23], s46 offen offset:2048 lds
  v_pk_mul_f32 v[144:145], v[144:145], v[24:25] op_sel_hi:[1,0]
  v_pk_mul_f32 v[146:147], v[146:147], v[24:25] op_sel_hi:[1,0]
  v_pk_mul_f32 v[168:169], v[168:169], v[24:25] op_sel_hi:[1,0]
  v_pk_mul_f32 v[170:171], v[170:171], v[24:25] op_sel_hi:[1,0]
  v_cvt_pk_bf16_f32 v144, v144, v145
  v_cvt_pk_bf16_f32 v145, v146, v147
  v_cvt_pk_bf16_f32 v146, v168, v169
  v_cvt_pk_bf16_f32 v147, v170, v171
  ds_write_b128 v15, v[144:147] offset:25600
  buffer_load_dwordx4 v11, s[20:23], s46 offen offset:3072 lds
  s_add_u32 s37, s37, 28672
  s_cmp_eq_u32 s37, s38
  s_cselect_b32 s47, 229376, 0
  s_sub_u32 s37, s37, s47
  v_pk_mul_f32 v[148:149], v[148:149], v[26:27] op_sel_hi:[1,0]
  v_pk_mul_f32 v[150:151], v[150:151], v[26:27] op_sel_hi:[1,0]
  v_pk_mul_f32 v[172:173], v[172:173], v[26:27] op_sel_hi:[1,0]
  v_pk_mul_f32 v[174:175], v[174:175], v[26:27] op_sel_hi:[1,0]
  v_cvt_pk_bf16_f32 v148, v148, v149
  v_cvt_pk_bf16_f32 v149, v150, v151
  v_cvt_pk_bf16_f32 v150, v172, v173
  v_cvt_pk_bf16_f32 v151, v174, v175
  ds_write_b128 v15, v[148:151] offset:26624
  v_pk_mul_f32 v[176:177], v[176:177], v[16:17] op_sel_hi:[1,0]
  v_pk_mul_f32 v[178:179], v[178:179], v[16:17] op_sel_hi:[1,0]
  v_pk_mul_f32 v[200:201], v[200:201], v[16:17] op_sel_hi:[1,0]
  v_pk_mul_f32 v[202:203], v[202:203], v[16:17] op_sel_hi:[1,0]
  v_cvt_pk_bf16_f32 v176, v176, v177
  v_cvt_pk_bf16_f32 v177, v178, v179
  v_cvt_pk_bf16_f32 v178, v200, v201
  v_cvt_pk_bf16_f32 v179, v202, v203
  ds_write_b128 v15, v[176:179] offset:3072
  v_pk_mul_f32 v[180:181], v[180:181], v[18:19] op_sel_hi:[1,0]
  v_pk_mul_f32 v[182:183], v[182:183], v[18:19] op_sel_hi:[1,0]
  v_pk_mul_f32 v[204:205], v[204:205], v[18:19] op_sel_hi:[1,0]
  v_pk_mul_f32 v[206:207], v[206:207], v[18:19] op_sel_hi:[1,0]
  v_cvt_pk_bf16_f32 v180, v180, v181
  v_cvt_pk_bf16_f32 v181, v182, v183
  v_cvt_pk_bf16_f32 v182, v204, v205
  v_cvt_pk_bf16_f32 v183, v206, v207
  ds_write_b128 v15, v[180:183] offset:4096
  v_accvgpr_read_b32 v208, a224
  v_accvgpr_read_b32 v209, a225
  v_accvgpr_read_b32 v210, a226
  v_accvgpr_read_b32 v211, a227
  v_pk_mul_f32 v[184:185], v[184:185], v[20:21] op_sel_hi:[1,0]
  v_pk_mul_f32 v[186:187], v[186:187], v[20:21] op_sel_hi:[1,0]
  v_pk_mul_f32 v[208:209], v[208:209], v[20:21] op_sel_hi:[1,0]
  v_pk_mul_f32 v[210:211], v[210:211], v[20:21] op_sel_hi:[1,0]
  v_cvt_pk_bf16_f32 v184, v184, v185
  v_cvt_pk_bf16_f32 v185, v186, v187
  v_cvt_pk_bf16_f32 v186, v208, v209
  v_cvt_pk_bf16_f32 v187, v210, v211
  ds_write_b128 v15, v[184:187] offset:5120
  v_accvgpr_read_b32 v212, a228
  v_accvgpr_read_b32 v213, a229
  v_accvgpr_read_b32 v214, a230
  v_accvgpr_read_b32 v215, a231
  v_pk_mul_f32 v[188:189], v[188:189], v[22:23] op_sel_hi:[1,0]
  v_pk_mul_f32 v[190:191], v[190:191], v[22:23] op_sel_hi:[1,0]
  v_pk_mul_f32 v[212:213], v[212:213], v[22:23] op_sel_hi:[1,0]
  v_pk_mul_f32 v[214:215], v[214:215], v[22:23] op_sel_hi:[1,0]
  v_cvt_pk_bf16_f32 v188, v188, v189
  v_cvt_pk_bf16_f32 v189, v190, v191
  v_cvt_pk_bf16_f32 v190, v212, v213
  v_cvt_pk_bf16_f32 v191, v214, v215
  ds_write_b128 v15, v[188:191] offset:27648
  v_accvgpr_read_b32 v216, a232
  v_accvgpr_read_b32 v217, a233
  v_accvgpr_read_b32 v218, a234
  v_accvgpr_read_b32 v219, a235
  v_pk_mul_f32 v[192:193], v[192:193], v[24:25] op_sel_hi:[1,0]
  v_pk_mul_f32 v[194:195], v[194:195], v[24:25] op_sel_hi:[1,0]
  v_pk_mul_f32 v[216:217], v[216:217], v[24:25] op_sel_hi:[1,0]
  v_pk_mul_f32 v[218:219], v[218:219], v[24:25] op_sel_hi:[1,0]
  v_cvt_pk_bf16_f32 v192, v192, v193
  v_cvt_pk_bf16_f32 v193, v194, v195
  v_cvt_pk_bf16_f32 v194, v216, v217
  v_cvt_pk_bf16_f32 v195, v218, v219
  ds_write_b128 v15, v[192:195] offset:28672
  v_accvgpr_read_b32 v220, a236
  v_accvgpr_read_b32 v221, a237
  v_accvgpr_read_b32 v222, a238
  v_accvgpr_read_b32 v223, a239
  v_pk_mul_f32 v[196:197], v[196:197], v[26:27] op_sel_hi:[1,0]
  v_pk_mul_f32 v[198:199], v[198:199], v[26:27] op_sel_hi:[1,0]
  v_pk_mul_f32 v[220:221], v[220:221], v[26:27] op_sel_hi:[1,0]
  v_pk_mul_f32 v[222:223], v[222:223], v[26:27] op_sel_hi:[1,0]
  v_cvt_pk_bf16_f32 v196, v196, v197
  v_cvt_pk_bf16_f32 v197, v198, v199
  v_cvt_pk_bf16_f32 v198, v220, v221
  v_cvt_pk_bf16_f32 v199, v222, v223
  ds_write_b128 v15, v[196:199] offset:29696
  s_waitcnt lgkmcnt(0)
  s_barrier
  s_waitcnt vmcnt(16)
  ds_read_b128 v[112:115], v36 offset:24576
  ds_read_b64_tr_b16 v[48:49], v12 offset:16384
  ds_read_b64_tr_b16 v[50:51], v12 offset:20480
  ds_read_b128 v[116:119], v36 offset:25600
  ds_read_b64_tr_b16 v[52:53], v12 offset:16416
  ds_read_b64_tr_b16 v[54:55], v12 offset:20512
  ds_read_b128 v[120:123], v36 offset:26624
  ds_read_b128 v[124:127], v36 offset:0
  ds_read_b128 v[128:131], v36 offset:1024
  ds_read_b128 v[132:135], v36 offset:2048
  ds_read_b64_tr_b16 v[56:57], v12 offset:16448
  ds_read_b64_tr_b16 v[58:59], v12 offset:20544
  ds_read_b64_tr_b16 v[60:61], v12 offset:16480
  ds_read_b64_tr_b16 v[62:63], v12 offset:20576
  ds_read_b64_tr_b16 v[64:65], v12 offset:16512
  ds_read_b64_tr_b16 v[66:67], v12 offset:20608
  ds_read_b64_tr_b16 v[68:69], v12 offset:16544
  ds_read_b64_tr_b16 v[70:71], v12 offset:20640
  ds_read_b64_tr_b16 v[72:73], v12 offset:16576
  ds_read_b64_tr_b16 v[74:75], v12 offset:20672
  s_waitcnt lgkmcnt(0)
  v_mfma_f32_16x16x32_bf16 v[160:163], a[0:3], v[124:127], 0
  s_add_u32 m0, s33, 16384
  s_add_u32 s46, s37, 14336
  buffer_load_dwordx4 v8, s[20:23], s37 offen offset:0 lds
  s_waitcnt vmcnt(9)
  v_mfma_f32_16x16x32_bf16 v[164:167], a[0:3], v[128:131], 0
  ds_read_b128 v[136:139], v37 offset:24576
  v_mfma_f32_16x16x32_bf16 v[168:171], a[0:3], v[132:135], 0
  ds_read_b64_tr_b16 v[80:81], v12 offset:0
  buffer_load_dwordx4 v9, s[20:23], s37 offen offset:1024 lds
  v_mfma_f32_16x16x32_bf16 v[172:175], a[32:35], v[124:127], 0
  ds_read_b64_tr_b16 v[82:83], v12 offset:4096
  v_mfma_f32_16x16x32_bf16 v[176:179], a[32:35], v[128:131], 0
  ds_read_b128 v[140:143], v37 offset:25600
  buffer_load_dwordx4 v10, s[20:23], s37 offen offset:2048 lds
  v_mfma_f32_16x16x32_bf16 v[180:183], a[32:35], v[132:135], 0
  ds_read_b64_tr_b16 v[84:85], v12 offset:32
  v_mfma_f32_16x16x32_bf16 v[160:163], v[48:51], v[112:115], v[160:163]
  ds_read_b64_tr_b16 v[86:87], v12 offset:4128
  buffer_load_dwordx4 v11, s[20:23], s37 offen offset:3072 lds
  v_mfma_f32_16x16x32_bf16 v[164:167], v[48:51], v[116:119], v[164:167]
  ds_read_b128 v[144:147], v37 offset:26624
  v_mfma_f32_16x16x32_bf16 v[168:171], v[48:51], v[120:123], v[168:171]
  ds_read_b128 v[148:151], v37 offset:0
  s_add_u32 m0, s33, 20480
  s_nop 0
  buffer_load_dwordx4 v8, s[20:23], s46 offen offset:0 lds
  v_mfma_f32_16x16x32_bf16 v[172:175], v[52:55], v[112:115], v[172:175]
  ds_read_b128 v[152:155], v37 offset:1024
  v_mfma_f32_16x16x32_bf16 v[176:179], v[52:55], v[116:119], v[176:179]
  ds_read_b128 v[156:159], v37 offset:2048
  buffer_load_dwordx4 v9, s[20:23], s46 offen offset:1024 lds
  v_mfma_f32_16x16x32_bf16 v[180:183], v[52:55], v[120:123], v[180:183]
  v_mfma_f32_16x16x32_bf16 v[184:187], v[56:59], v[112:115], 0
  ds_read_b64_tr_b16 v[88:89], v12 offset:64
  v_mfma_f32_16x16x32_bf16 v[188:191], v[56:59], v[116:119], 0
  buffer_load_dwordx4 v10, s[20:23], s46 offen offset:2048 lds
  ds_read_b64_tr_b16 v[90:91], v12 offset:4160
  v_mfma_f32_16x16x32_bf16 v[192:195], v[56:59], v[120:123], 0
  ds_read_b64_tr_b16 v[92:93], v12 offset:96
  v_mfma_f32_16x16x32_bf16 v[196:199], v[60:63], v[112:115], 0
  buffer_load_dwordx4 v11, s[20:23], s46 offen offset:3072 lds
  s_add_u32 s37, s37, 28672
  s_cmp_eq_u32 s37, s38
  s_cselect_b32 s47, 229376, 0
  s_sub_u32 s37, s37, s47
  ds_read_b64_tr_b16 v[94:95], v12 offset:4192
  v_mfma_f32_16x16x32_bf16 v[200:203], v[60:63], v[116:119], 0
  ds_read_b64_tr_b16 v[96:97], v12 offset:128
  v_mfma_f32_16x16x32_bf16 v[204:207], v[60:63], v[120:123], 0
  ds_read_b64_tr_b16 v[98:99], v12 offset:4224
  v_mfma_f32_16x16x32_bf16 v[208:211], v[64:67], v[112:115], 0
  ds_read_b64_tr_b16 v[100:101], v12 offset:160
  v_mfma_f32_16x16x32_bf16 v[212:215], v[64:67], v[116:119], 0
  ds_read_b64_tr_b16 v[102:103], v12 offset:4256
  v_mfma_f32_16x16x32_bf16 v[216:219], v[64:67], v[120:123], 0
  ds_read_b64_tr_b16 v[104:105], v12 offset:192
  v_mfma_f32_16x16x32_bf16 v[220:223], v[68:71], v[112:115], 0
  ds_read_b64_tr_b16 v[106:107], v12 offset:4288
  v_mfma_f32_16x16x32_bf16 v[224:227], v[68:71], v[116:119], 0
  v_mfma_f32_16x16x32_bf16 v[228:231], v[68:71], v[120:123], 0
  v_mfma_f32_16x16x32_bf16 v[232:235], v[72:75], v[112:115], 0
  v_mfma_f32_16x16x32_bf16 v[236:239], v[72:75], v[116:119], 0
  v_mfma_f32_16x16x32_bf16 v[240:243], v[72:75], v[120:123], 0
  s_waitcnt lgkmcnt(0)
  v_mfma_f32_16x16x32_bf16 v[160:163], a[4:7], v[148:151], v[160:163]
  s_add_u32 m0, s33, 0
  s_add_u32 s46, s37, 14336
  buffer_load_dwordx4 v8, s[20:23], s37 offen offset:0 lds
  s_waitcnt vmcnt(9)
  v_mfma_f32_16x16x32_bf16 v[164:167], a[4:7], v[152:155], v[164:167]
  ds_read_b128 v[112:115], v38 offset:24576
  v_mfma_f32_16x16x32_bf16 v[168:171], a[4:7], v[156:159], v[168:171]
  ds_read_b64_tr_b16 v[48:49], v12 offset:8192
  buffer_load_dwordx4 v9, s[20:23], s37 offen offset:1024 lds
  v_mfma_f32_16x16x32_bf16 v[172:175], a[36:39], v[148:151], v[172:175]
  ds_read_b64_tr_b16 v[50:51], v12 offset:12288
  v_mfma_f32_16x16x32_bf16 v[176:179], a[36:39], v[152:155], v[176:179]
  ds_read_b128 v[116:119], v38 offset:25600
  buffer_load_dwordx4 v10, s[20:23], s37 offen offset:2048 lds
  v_mfma_f32_16x16x32_bf16 v[180:183], a[36:39], v[156:159], v[180:183]
  ds_read_b64_tr_b16 v[52:53], v12 offset:8224
  v_mfma_f32_16x16x32_bf16 v[160:163], v[80:83], v[136:139], v[160:163]
  ds_read_b64_tr_b16 v[54:55], v12 offset:12320
  buffer_load_dwordx4 v11, s[20:23], s37 offen offset:3072 lds
  v_mfma_f32_16x16x32_bf16 v[164:167], v[80:83], v[140:143], v[164:167]
  ds_read_b128 v[120:123], v38 offset:26624
  v_mfma_f32_16x16x32_bf16 v[168:171], v[80:83], v[144:147], v[168:171]
  ds_read_b128 v[124:127], v38 offset:0
  s_add_u32 m0, s33, 4096
  s_nop 0
  buffer_load_dwordx4 v8, s[20:23], s46 offen offset:0 lds
  v_mfma_f32_16x16x32_bf16 v[172:175], v[84:87], v[136:139], v[172:175]
  ds_read_b128 v[128:131], v38 offset:1024
  v_mfma_f32_16x16x32_bf16 v[176:179], v[84:87], v[140:143], v[176:179]
  ds_read_b128 v[132:135], v38 offset:2048
  buffer_load_dwordx4 v9, s[20:23], s46 offen offset:1024 lds
  v_mfma_f32_16x16x32_bf16 v[180:183], v[84:87], v[144:147], v[180:183]
  v_mfma_f32_16x16x32_bf16 v[184:187], v[88:91], v[136:139], v[184:187]
  ds_read_b64_tr_b16 v[56:57], v12 offset:8256
  v_mfma_f32_16x16x32_bf16 v[188:191], v[88:91], v[140:143], v[188:191]
  buffer_load_dwordx4 v10, s[20:23], s46 offen offset:2048 lds
  ds_read_b64_tr_b16 v[58:59], v12 offset:12352
  v_mfma_f32_16x16x32_bf16 v[192:195], v[88:91], v[144:147], v[192:195]
  ds_read_b64_tr_b16 v[60:61], v12 offset:8288
  v_mfma_f32_16x16x32_bf16 v[196:199], v[92:95], v[136:139], v[196:199]
  buffer_load_dwordx4 v11, s[20:23], s46 offen offset:3072 lds
  s_add_u32 s37, s37, 28672
  s_cmp_eq_u32 s37, s38
  s_cselect_b32 s47, 229376, 0
  s_sub_u32 s37, s37, s47
  ds_read_b64_tr_b16 v[62:63], v12 offset:12384
  v_mfma_f32_16x16x32_bf16 v[200:203], v[92:95], v[140:143], v[200:203]
  ds_read_b64_tr_b16 v[64:65], v12 offset:8320
  v_mfma_f32_16x16x32_bf16 v[204:207], v[92:95], v[144:147], v[204:207]
  ds_read_b64_tr_b16 v[66:67], v12 offset:12416
  v_mfma_f32_16x16x32_bf16 v[208:211], v[96:99], v[136:139], v[208:211]
  ds_read_b64_tr_b16 v[68:69], v12 offset:8352
  v_mfma_f32_16x16x32_bf16 v[212:215], v[96:99], v[140:143], v[212:215]
  ds_read_b64_tr_b16 v[70:71], v12 offset:12448
  v_mfma_f32_16x16x32_bf16 v[216:219], v[96:99], v[144:147], v[216:219]
  ds_read_b64_tr_b16 v[72:73], v12 offset:8384
  v_mfma_f32_16x16x32_bf16 v[220:223], v[100:103], v[136:139], v[220:223]
  ds_read_b64_tr_b16 v[74:75], v12 offset:12480
  v_mfma_f32_16x16x32_bf16 v[224:227], v[100:103], v[140:143], v[224:227]
  v_mfma_f32_16x16x32_bf16 v[228:231], v[100:103], v[144:147], v[228:231]
  v_mfma_f32_16x16x32_bf16 v[232:235], v[104:107], v[136:139], v[232:235]
  v_mfma_f32_16x16x32_bf16 v[236:239], v[104:107], v[140:143], v[236:239]
  v_mfma_f32_16x16x32_bf16 v[240:243], v[104:107], v[144:147], v[240:243]
  s_waitcnt lgkmcnt(0)
  v_mfma_f32_16x16x32_bf16 v[160:163], a[8:11], v[124:127], v[160:163]
  s_add_u32 m0, s33, 8192
  s_add_u32 s46, s37, 14336
  buffer_load_dwordx4 v8, s[20:23], s37 offen offset:0 lds
  s_waitcnt vmcnt(9)
  v_mfma_f32_16x16x32_bf16 v[164:167], a[8:11], v[128:131], v[164:167]
  ds_read_b128 v[136:139], v39 offset:24576
  v_mfma_f32_16x16x32_bf16 v[168:171], a[8:11], v[132:135], v[168:171]
  ds_read_b64_tr_b16 v[80:81], v12 offset:16384
  buffer_load_dwordx4 v9, s[20:23], s37 offen offset:1024 lds
  v_mfma_f32_16x16x32_bf16 v[172:175], a[40:43], v[124:127], v[172:175]
  ds_read_b64_tr_b16 v[82:83], v12 offset:20480
  v_mfma_f32_16x16x32_bf16 v[176:179], a[40:43], v[128:131], v[176:179]
  ds_read_b128 v[140:143], v39 offset:25600
  buffer_load_dwordx4 v10, s[20:23], s37 offen offset:2048 lds
  v_mfma_f32_16x16x32_bf16 v[180:183], a[40:43], v[132:135], v[180:183]
  ds_read_b64_tr_b16 v[84:85], v12 offset:16416
  v_mfma_f32_16x16x32_bf16 v[160:163], v[48:51], v[112:115], v[160:163]
  ds_read_b64_tr_b16 v[86:87], v12 offset:20512
  buffer_load_dwordx4 v11, s[20:23], s37 offen offset:3072 lds
  v_mfma_f32_16x16x32_bf16 v[164:167], v[48:51], v[116:119], v[164:167]
  ds_read_b128 v[144:147], v39 offset:26624
  v_mfma_f32_16x16x32_bf16 v[168:171], v[48:51], v[120:123], v[168:171]
  ds_read_b128 v[148:151], v39 offset:0
  s_add_u32 m0, s33, 12288
  s_nop 0
  buffer_load_dwordx4 v8, s[20:23], s46 offen offset:0 lds
  v_mfma_f32_16x16x32_bf16 v[172:175], v[52:55], v[112:115], v[172:175]
  ds_read_b128 v[152:155], v39 offset:1024
  v_mfma_f32_16x16x32_bf16 v[176:179], v[52:55], v[116:119], v[176:179]
  ds_read_b128 v[156:159], v39 offset:2048
  buffer_load_dwordx4 v9, s[20:23], s46 offen offset:1024 lds
  v_mfma_f32_16x16x32_bf16 v[180:183], v[52:55], v[120:123], v[180:183]
  v_mfma_f32_16x16x32_bf16 v[184:187], v[56:59], v[112:115], v[184:187]
  ds_read_b64_tr_b16 v[88:89], v12 offset:16448
  v_mfma_f32_16x16x32_bf16 v[188:191], v[56:59], v[116:119], v[188:191]
  buffer_load_dwordx4 v10, s[20:23], s46 offen offset:2048 lds
  ds_read_b64_tr_b16 v[90:91], v12 offset:20544
  v_mfma_f32_16x16x32_bf16 v[192:195], v[56:59], v[120:123], v[192:195]
  ds_read_b64_tr_b16 v[92:93], v12 offset:16480
  v_mfma_f32_16x16x32_bf16 v[196:199], v[60:63], v[112:115], v[196:199]
  buffer_load_dwordx4 v11, s[20:23], s46 offen offset:3072 lds
  s_add_u32 s37, s37, 28672
  s_cmp_eq_u32 s37, s38
  s_cselect_b32 s47, 229376, 0
  s_sub_u32 s37, s37, s47
  ds_read_b64_tr_b16 v[94:95], v12 offset:20576
  v_mfma_f32_16x16x32_bf16 v[200:203], v[60:63], v[116:119], v[200:203]
  ds_read_b64_tr_b16 v[96:97], v12 offset:16512
  v_mfma_f32_16x16x32_bf16 v[204:207], v[60:63], v[120:123], v[204:207]
  ds_read_b64_tr_b16 v[98:99], v12 offset:20608
  v_mfma_f32_16x16x32_bf16 v[208:211], v[64:67], v[112:115], v[208:211]
  ds_read_b64_tr_b16 v[100:101], v12 offset:16544
  v_mfma_f32_16x16x32_bf16 v[212:215], v[64:67], v[116:119], v[212:215]
  ds_read_b64_tr_b16 v[102:103], v12 offset:20640
  v_mfma_f32_16x16x32_bf16 v[216:219], v[64:67], v[120:123], v[216:219]
  ds_read_b64_tr_b16 v[104:105], v12 offset:16576
  v_mfma_f32_16x16x32_bf16 v[220:223], v[68:71], v[112:115], v[220:223]
  ds_read_b64_tr_b16 v[106:107], v12 offset:20672
  v_mfma_f32_16x16x32_bf16 v[224:227], v[68:71], v[116:119], v[224:227]
  v_mfma_f32_16x16x32_bf16 v[228:231], v[68:71], v[120:123], v[228:231]
  v_mfma_f32_16x16x32_bf16 v[232:235], v[72:75], v[112:115], v[232:235]
  v_mfma_f32_16x16x32_bf16 v[236:239], v[72:75], v[116:119], v[236:239]
  v_mfma_f32_16x16x32_bf16 v[240:243], v[72:75], v[120:123], v[240:243]
  s_waitcnt lgkmcnt(0)
  v_mfma_f32_16x16x32_bf16 v[160:163], a[12:15], v[148:151], v[160:163]
  s_add_u32 m0, s33, 16384
  s_add_u32 s46, s37, 14336
  buffer_load_dwordx4 v8, s[20:23], s37 offen offset:0 lds
  s_waitcnt vmcnt(9)
  v_mfma_f32_16x16x32_bf16 v[164:167], a[12:15], v[152:155], v[164:167]
  ds_read_b128 v[112:115], v40 offset:24576
  v_mfma_f32_16x16x32_bf16 v[168:171], a[12:15], v[156:159], v[168:171]
  ds_read_b64_tr_b16 v[48:49], v12 offset:0
  buffer_load_dwordx4 v9, s[20:23], s37 offen offset:1024 lds
  v_mfma_f32_16x16x32_bf16 v[172:175], a[44:47], v[148:151], v[172:175]
  ds_read_b64_tr_b16 v[50:51], v12 offset:4096
  v_mfma_f32_16x16x32_bf16 v[176:179], a[44:47], v[152:155], v[176:179]
  ds_read_b128 v[116:119], v40 offset:25600
  buffer_load_dwordx4 v10, s[20:23], s37 offen offset:2048 lds
  v_mfma_f32_16x16x32_bf16 v[180:183], a[44:47], v[156:159], v[180:183]
  ds_read_b64_tr_b16 v[52:53], v12 offset:32
  v_mfma_f32_16x16x32_bf16 v[160:163], v[80:83], v[136:139], v[160:163]
  ds_read_b64_tr_b16 v[54:55], v12 offset:4128
  buffer_load_dwordx4 v11, s[20:23], s37 offen offset:3072 lds
  v_mfma_f32_16x16x32_bf16 v[164:167], v[80:83], v[140:143], v[164:167]
  ds_read_b128 v[120:123], v40 offset:26624
  v_mfma_f32_16x16x32_bf16 v[168:171], v[80:83], v[144:147], v[168:171]
  ds_read_b128 v[124:127], v40 offset:0
  s_add_u32 m0, s33, 20480
  s_nop 0
  buffer_load_dwordx4 v8, s[20:23], s46 offen offset:0 lds
  v_mfma_f32_16x16x32_bf16 v[172:175], v[84:87], v[136:139], v[172:175]
  ds_read_b128 v[128:131], v40 offset:1024
  v_mfma_f32_16x16x32_bf16 v[176:179], v[84:87], v[140:143], v[176:179]
  ds_read_b128 v[132:135], v40 offset:2048
  buffer_load_dwordx4 v9, s[20:23], s46 offen offset:1024 lds
  v_mfma_f32_16x16x32_bf16 v[180:183], v[84:87], v[144:147], v[180:183]
  v_mfma_f32_16x16x32_bf16 v[184:187], v[88:91], v[136:139], v[184:187]
  ds_read_b64_tr_b16 v[56:57], v12 offset:64
  v_mfma_f32_16x16x32_bf16 v[188:191], v[88:91], v[140:143], v[188:191]
  buffer_load_dwordx4 v10, s[20:23], s46 offen offset:2048 lds
  ds_read_b64_tr_b16 v[58:59], v12 offset:4160
  v_mfma_f32_16x16x32_bf16 v[192:195], v[88:91], v[144:147], v[192:195]
  ds_read_b64_tr_b16 v[60:61], v12 offset:96
  v_mfma_f32_16x16x32_bf16 v[196:199], v[92:95], v[136:139], v[196:199]
  buffer_load_dwordx4 v11, s[20:23], s46 offen offset:3072 lds
  s_add_u32 s37, s37, 28672
  s_cmp_eq_u32 s37, s38
  s_cselect_b32 s47, 229376, 0
  s_sub_u32 s37, s37, s47
  ds_read_b64_tr_b16 v[62:63], v12 offset:4192
  v_mfma_f32_16x16x32_bf16 v[200:203], v[92:95], v[140:143], v[200:203]
  ds_read_b64_tr_b16 v[64:65], v12 offset:128
  v_mfma_f32_16x16x32_bf16 v[204:207], v[92:95], v[144:147], v[204:207]
  ds_read_b64_tr_b16 v[66:67], v12 offset:4224
  v_mfma_f32_16x16x32_bf16 v[208:211], v[96:99], v[136:139], v[208:211]
  ds_read_b64_tr_b16 v[68:69], v12 offset:160
  v_mfma_f32_16x16x32_bf16 v[212:215], v[96:99], v[140:143], v[212:215]
  ds_read_b64_tr_b16 v[70:71], v12 offset:4256
  v_mfma_f32_16x16x32_bf16 v[216:219], v[96:99], v[144:147], v[216:219]
  ds_read_b64_tr_b16 v[72:73], v12 offset:192
  v_mfma_f32_16x16x32_bf16 v[220:223], v[100:103], v[136:139], v[220:223]
  ds_read_b64_tr_b16 v[74:75], v12 offset:4288
  v_mfma_f32_16x16x32_bf16 v[224:227], v[100:103], v[140:143], v[224:227]
  v_mfma_f32_16x16x32_bf16 v[228:231], v[100:103], v[144:147], v[228:231]
  v_mfma_f32_16x16x32_bf16 v[232:235], v[104:107], v[136:139], v[232:235]
  v_mfma_f32_16x16x32_bf16 v[236:239], v[104:107], v[140:143], v[236:239]
  v_mfma_f32_16x16x32_bf16 v[240:243], v[104:107], v[144:147], v[240:243]
  s_waitcnt lgkmcnt(0)
  v_mfma_f32_16x16x32_bf16 v[160:163], a[16:19], v[124:127], v[160:163]
  s_add_u32 m0, s33, 0
  s_add_u32 s46, s37, 14336
  buffer_load_dwordx4 v8, s[20:23], s37 offen offset:0 lds
  s_waitcnt vmcnt(9)
  v_mfma_f32_16x16x32_bf16 v[164:167], a[16:19], v[128:131], v[164:167]
  ds_read_b128 v[136:139], v41 offset:24576
  v_mfma_f32_16x16x32_bf16 v[168:171], a[16:19], v[132:135], v[168:171]
  ds_read_b64_tr_b16 v[80:81], v12 offset:8192
  buffer_load_dwordx4 v9, s[20:23], s37 offen offset:1024 lds
  v_mfma_f32_16x16x32_bf16 v[172:175], a[48:51], v[124:127], v[172:175]
  ds_read_b64_tr_b16 v[82:83], v12 offset:12288
  v_mfma_f32_16x16x32_bf16 v[176:179], a[48:51], v[128:131], v[176:179]
  ds_read_b128 v[140:143], v41 offset:25600
  buffer_load_dwordx4 v10, s[20:23], s37 offen offset:2048 lds
  v_mfma_f32_16x16x32_bf16 v[180:183], a[48:51], v[132:135], v[180:183]
  ds_read_b64_tr_b16 v[84:85], v12 offset:8224
  v_mfma_f32_16x16x32_bf16 v[160:163], v[48:51], v[112:115], v[160:163]
  ds_read_b64_tr_b16 v[86:87], v12 offset:12320
  buffer_load_dwordx4 v11, s[20:23], s37 offen offset:3072 lds
  v_mfma_f32_16x16x32_bf16 v[164:167], v[48:51], v[116:119], v[164:167]
  ds_read_b128 v[144:147], v41 offset:26624
  v_mfma_f32_16x16x32_bf16 v[168:171], v[48:51], v[120:123], v[168:171]
  ds_read_b128 v[148:151], v41 offset:0
  s_add_u32 m0, s33, 4096
  s_nop 0
  buffer_load_dwordx4 v8, s[20:23], s46 offen offset:0 lds
  v_mfma_f32_16x16x32_bf16 v[172:175], v[52:55], v[112:115], v[172:175]
  ds_read_b128 v[152:155], v41 offset:1024
  v_mfma_f32_16x16x32_bf16 v[176:179], v[52:55], v[116:119], v[176:179]
  ds_read_b128 v[156:159], v41 offset:2048
  buffer_load_dwordx4 v9, s[20:23], s46 offen offset:1024 lds
  v_mfma_f32_16x16x32_bf16 v[180:183], v[52:55], v[120:123], v[180:183]
  v_mfma_f32_16x16x32_bf16 v[184:187], v[56:59], v[112:115], v[184:187]
  ds_read_b64_tr_b16 v[88:89], v12 offset:8256
  v_mfma_f32_16x16x32_bf16 v[188:191], v[56:59], v[116:119], v[188:191]
  buffer_load_dwordx4 v10, s[20:23], s46 offen offset:2048 lds
  ds_read_b64_tr_b16 v[90:91], v12 offset:12352
  v_mfma_f32_16x16x32_bf16 v[192:195], v[56:59], v[120:123], v[192:195]
  ds_read_b64_tr_b16 v[92:93], v12 offset:8288
  v_mfma_f32_16x16x32_bf16 v[196:199], v[60:63], v[112:115], v[196:199]
  buffer_load_dwordx4 v11, s[20:23], s46 offen offset:3072 lds
  s_add_u32 s37, s37, 28672
  s_cmp_eq_u32 s37, s38
  s_cselect_b32 s47, 229376, 0
  s_sub_u32 s37, s37, s47
  s_add_u32 s37, s37, 229376
  s_add_u32 s38, s38, 229376
  ds_read_b64_tr_b16 v[94:95], v12 offset:12384
  v_mfma_f32_16x16x32_bf16 v[200:203], v[60:63], v[116:119], v[200:203]
  ds_read_b64_tr_b16 v[96:97], v12 offset:8320
  v_mfma_f32_16x16x32_bf16 v[204:207], v[60:63], v[120:123], v[204:207]
  ds_read_b64_tr_b16 v[98:99], v12 offset:12416
  v_mfma_f32_16x16x32_bf16 v[208:211], v[64:67], v[112:115], v[208:211]
  ds_read_b64_tr_b16 v[100:101], v12 offset:8352
  v_mfma_f32_16x16x32_bf16 v[212:215], v[64:67], v[116:119], v[212:215]
  ds_read_b64_tr_b16 v[102:103], v12 offset:12448
  v_mfma_f32_16x16x32_bf16 v[216:219], v[64:67], v[120:123], v[216:219]
  ds_read_b64_tr_b16 v[104:105], v12 offset:8384
  v_mfma_f32_16x16x32_bf16 v[220:223], v[68:71], v[112:115], v[220:223]
  ds_read_b64_tr_b16 v[106:107], v12 offset:12480
  v_mfma_f32_16x16x32_bf16 v[224:227], v[68:71], v[116:119], v[224:227]
  v_mfma_f32_16x16x32_bf16 v[228:231], v[68:71], v[120:123], v[228:231]
  v_mfma_f32_16x16x32_bf16 v[232:235], v[72:75], v[112:115], v[232:235]
  v_mfma_f32_16x16x32_bf16 v[236:239], v[72:75], v[116:119], v[236:239]
  v_mfma_f32_16x16x32_bf16 v[240:243], v[72:75], v[120:123], v[240:243]
  s_waitcnt lgkmcnt(0)
  s_lshr_b32 s39, s5, 1
  s_lshl_b32 s39, s39, 4
  s_and_b32 s40, s5, 1
  s_add_u32 s39, s39, s40
  s_lshl_b32 s40, s3, 1
  s_add_u32 s39, s39, s40
  s_add_u32 s39, s39, 128
  s_lshl_b32 s39, s39, 18
  s_add_u32 s39, s39, 229376
  s_add_u32 s52, s78, s39
  s_addc_u32 s53, s79, 0
  s_mov_b32 s54, 32768
  s_mov_b32 s55, 0x20000
  v_lshlrev_b32 v44, 4, v0
  s_mov_b32 m0, 150528
  s_mul_i32 s40, s32, 8192
  buffer_load_dwordx4 v44, s[52:55], s40 offen offset:0 lds
  buffer_load_dwordx4 v44, s[52:55], s40 offen offset:1024 lds
  buffer_load_dwordx4 v44, s[52:55], s40 offen offset:2048 lds
  buffer_load_dwordx4 v44, s[52:55], s40 offen offset:3072 lds
  s_add_u32 s40, s40, 4096
  buffer_load_dwordx4 v44, s[52:55], s40 offen offset:0 lds
  buffer_load_dwordx4 v44, s[52:55], s40 offen offset:1024 lds
  buffer_load_dwordx4 v44, s[52:55], s40 offen offset:2048 lds
  buffer_load_dwordx4 v44, s[52:55], s40 offen offset:3072 lds
  v_mfma_f32_16x16x32_bf16 v[160:163], a[20:23], v[148:151], v[160:163]
  s_waitcnt vmcnt(16)
  v_mfma_f32_16x16x32_bf16 v[164:167], a[20:23], v[152:155], v[164:167]
  ds_read_b128 v[112:115], v42 offset:24576
  v_mfma_f32_16x16x32_bf16 v[168:171], a[20:23], v[156:159], v[168:171]
  ds_read_b64_tr_b16 v[48:49], v12 offset:16384
  v_mfma_f32_16x16x32_bf16 v[172:175], a[52:55], v[148:151], v[172:175]
  ds_read_b64_tr_b16 v[50:51], v12 offset:20480
  v_mfma_f32_16x16x32_bf16 v[176:179], a[52:55], v[152:155], v[176:179]
  ds_read_b128 v[116:119], v42 offset:25600
  v_mfma_f32_16x16x32_bf16 v[180:183], a[52:55], v[156:159], v[180:183]
  ds_read_b64_tr_b16 v[52:53], v12 offset:16416
  v_mfma_f32_16x16x32_bf16 v[160:163], v[80:83], v[136:139], v[160:163]
  ds_read_b64_tr_b16 v[54:55], v12 offset:20512
  v_mfma_f32_16x16x32_bf16 v[164:167], v[80:83], v[140:143], v[164:167]
  ds_read_b128 v[120:123], v42 offset:26624
  v_mfma_f32_16x16x32_bf16 v[168:171], v[80:83], v[144:147], v[168:171]
  ds_read_b128 v[124:127], v42 offset:0
  v_mfma_f32_16x16x32_bf16 v[172:175], v[84:87], v[136:139], v[172:175]
  ds_read_b128 v[128:131], v42 offset:1024
  v_mfma_f32_16x16x32_bf16 v[176:179], v[84:87], v[140:143], v[176:179]
  ds_read_b128 v[132:135], v42 offset:2048
  v_mfma_f32_16x16x32_bf16 v[180:183], v[84:87], v[144:147], v[180:183]
  v_mfma_f32_16x16x32_bf16 v[184:187], v[88:91], v[136:139], v[184:187]
  ds_read_b64_tr_b16 v[56:57], v12 offset:16448
  v_mfma_f32_16x16x32_bf16 v[188:191], v[88:91], v[140:143], v[188:191]
  ds_read_b64_tr_b16 v[58:59], v12 offset:20544
  v_mfma_f32_16x16x32_bf16 v[192:195], v[88:91], v[144:147], v[192:195]
  ds_read_b64_tr_b16 v[60:61], v12 offset:16480
  v_mfma_f32_16x16x32_bf16 v[196:199], v[92:95], v[136:139], v[196:199]
  ds_read_b64_tr_b16 v[62:63], v12 offset:20576
  v_mfma_f32_16x16x32_bf16 v[200:203], v[92:95], v[140:143], v[200:203]
  ds_read_b64_tr_b16 v[64:65], v12 offset:16512
  v_mfma_f32_16x16x32_bf16 v[204:207], v[92:95], v[144:147], v[204:207]
  ds_read_b64_tr_b16 v[66:67], v12 offset:20608
  v_mfma_f32_16x16x32_bf16 v[208:211], v[96:99], v[136:139], v[208:211]
  ds_read_b64_tr_b16 v[68:69], v12 offset:16544
  v_mfma_f32_16x16x32_bf16 v[212:215], v[96:99], v[140:143], v[212:215]
  ds_read_b64_tr_b16 v[70:71], v12 offset:20640
  v_mfma_f32_16x16x32_bf16 v[216:219], v[96:99], v[144:147], v[216:219]
  ds_read_b64_tr_b16 v[72:73], v12 offset:16576
  v_mfma_f32_16x16x32_bf16 v[220:223], v[100:103], v[136:139], v[220:223]
  ds_read_b64_tr_b16 v[74:75], v12 offset:20672
  v_mfma_f32_16x16x32_bf16 v[224:227], v[100:103], v[140:143], v[224:227]
  v_mfma_f32_16x16x32_bf16 v[228:231], v[100:103], v[144:147], v[228:231]
  v_mfma_f32_16x16x32_bf16 v[232:235], v[104:107], v[136:139], v[232:235]
  v_mfma_f32_16x16x32_bf16 v[236:239], v[104:107], v[140:143], v[236:239]
  v_mfma_f32_16x16x32_bf16 v[240:243], v[104:107], v[144:147], v[240:243]
  s_waitcnt lgkmcnt(0)
  s_lshr_b32 s39, s5, 1
  s_lshl_b32 s39, s39, 4
  s_and_b32 s40, s5, 1
  s_add_u32 s39, s39, s40
  s_lshl_b32 s40, s3, 1
  s_add_u32 s39, s39, s40
  s_add_u32 s39, s39, 128
  s_lshl_b32 s39, s39, 18
  s_add_u32 s39, s39, 196608
  s_add_u32 s52, s78, s39
  s_addc_u32 s53, s79, 0
  s_mov_b32 s54, 32768
  s_mov_b32 s55, 0x20000
  v_lshlrev_b32 v44, 4, v0
  s_mov_b32 m0, 150528
  s_mul_i32 s40, s32, 8192
  buffer_load_dwordx4 v44, s[52:55], s40 offen offset:0 lds
  buffer_load_dwordx4 v44, s[52:55], s40 offen offset:1024 lds
  buffer_load_dwordx4 v44, s[52:55], s40 offen offset:2048 lds
  buffer_load_dwordx4 v44, s[52:55], s40 offen offset:3072 lds
  s_add_u32 s40, s40, 4096
  buffer_load_dwordx4 v44, s[52:55], s40 offen offset:0 lds
  buffer_load_dwordx4 v44, s[52:55], s40 offen offset:1024 lds
  buffer_load_dwordx4 v44, s[52:55], s40 offen offset:2048 lds
  buffer_load_dwordx4 v44, s[52:55], s40 offen offset:3072 lds
  v_mfma_f32_16x16x32_bf16 v[160:163], a[24:27], v[124:127], v[160:163]
  s_waitcnt vmcnt(16)
  v_mfma_f32_16x16x32_bf16 v[164:167], a[24:27], v[128:131], v[164:167]
  ds_read_b128 v[136:139], v43 offset:24576
  v_mfma_f32_16x16x32_bf16 v[168:171], a[24:27], v[132:135], v[168:171]
  ds_read_b64_tr_b16 v[80:81], v12 offset:0
  v_mfma_f32_16x16x32_bf16 v[172:175], a[56:59], v[124:127], v[172:175]
  ds_read_b64_tr_b16 v[82:83], v12 offset:4096
  v_mfma_f32_16x16x32_bf16 v[176:179], a[56:59], v[128:131], v[176:179]
  ds_read_b128 v[140:143], v43 offset:25600
  v_mfma_f32_16x16x32_bf16 v[180:183], a[56:59], v[132:135], v[180:183]
  ds_read_b64_tr_b16 v[84:85], v12 offset:32
  v_mfma_f32_16x16x32_bf16 v[160:163], v[48:51], v[112:115], v[160:163]
  ds_read_b64_tr_b16 v[86:87], v12 offset:4128
  v_mfma_f32_16x16x32_bf16 v[164:167], v[48:51], v[116:119], v[164:167]
  ds_read_b128 v[144:147], v43 offset:26624
  v_mfma_f32_16x16x32_bf16 v[168:171], v[48:51], v[120:123], v[168:171]
  ds_read_b128 v[148:151], v43 offset:0
  v_mfma_f32_16x16x32_bf16 v[172:175], v[52:55], v[112:115], v[172:175]
  ds_read_b128 v[152:155], v43 offset:1024
  v_mfma_f32_16x16x32_bf16 v[176:179], v[52:55], v[116:119], v[176:179]
  ds_read_b128 v[156:159], v43 offset:2048
  v_mfma_f32_16x16x32_bf16 v[180:183], v[52:55], v[120:123], v[180:183]
  v_mfma_f32_16x16x32_bf16 v[184:187], v[56:59], v[112:115], v[184:187]
  ds_read_b64_tr_b16 v[88:89], v12 offset:64
  v_mfma_f32_16x16x32_bf16 v[188:191], v[56:59], v[116:119], v[188:191]
  ds_read_b64_tr_b16 v[90:91], v12 offset:4160
  v_mfma_f32_16x16x32_bf16 v[192:195], v[56:59], v[120:123], v[192:195]
  ds_read_b64_tr_b16 v[92:93], v12 offset:96
  v_mfma_f32_16x16x32_bf16 v[196:199], v[60:63], v[112:115], v[196:199]
  ds_read_b64_tr_b16 v[94:95], v12 offset:4192
  v_mfma_f32_16x16x32_bf16 v[200:203], v[60:63], v[116:119], v[200:203]
  ds_read_b64_tr_b16 v[96:97], v12 offset:128
  v_mfma_f32_16x16x32_bf16 v[204:207], v[60:63], v[120:123], v[204:207]
  ds_read_b64_tr_b16 v[98:99], v12 offset:4224
  v_mfma_f32_16x16x32_bf16 v[208:211], v[64:67], v[112:115], v[208:211]
  ds_read_b64_tr_b16 v[100:101], v12 offset:160
  v_mfma_f32_16x16x32_bf16 v[212:215], v[64:67], v[116:119], v[212:215]
  ds_read_b64_tr_b16 v[102:103], v12 offset:4256
  v_mfma_f32_16x16x32_bf16 v[216:219], v[64:67], v[120:123], v[216:219]
  ds_read_b64_tr_b16 v[104:105], v12 offset:192
  v_mfma_f32_16x16x32_bf16 v[220:223], v[68:71], v[112:115], v[220:223]
  ds_read_b64_tr_b16 v[106:107], v12 offset:4288
  v_mfma_f32_16x16x32_bf16 v[224:227], v[68:71], v[116:119], v[224:227]
  v_mfma_f32_16x16x32_bf16 v[228:231], v[68:71], v[120:123], v[228:231]
  v_mfma_f32_16x16x32_bf16 v[232:235], v[72:75], v[112:115], v[232:235]
  v_mfma_f32_16x16x32_bf16 v[236:239], v[72:75], v[116:119], v[236:239]
  v_mfma_f32_16x16x32_bf16 v[240:243], v[72:75], v[120:123], v[240:243]
  s_waitcnt lgkmcnt(0)
  ds_read_b128 v[48:51], v36 offset:0
  ds_read_b128 v[52:55], v36 offset:1024
  ds_read_b128 v[56:59], v36 offset:2048
  ds_read_b128 v[60:63], v37 offset:0
  ds_read_b128 v[64:67], v37 offset:1024
  ds_read_b128 v[68:71], v37 offset:2048
  ds_read_b128 v[112:115], v38 offset:0
  ds_read_b128 v[116:119], v38 offset:1024
  ds_read_b128 v[120:123], v38 offset:2048
  ds_read_b128 v[244:247], v39 offset:0
  ds_read_b128 v[248:251], v39 offset:1024
  ds_read_b128 v[252:255], v39 offset:2048
  v_mfma_f32_16x16x32_bf16 v[160:163], a[28:31], v[148:151], v[160:163]
  v_mfma_f32_16x16x32_bf16 v[164:167], a[28:31], v[152:155], v[164:167]
  v_mfma_f32_16x16x32_bf16 v[168:171], a[28:31], v[156:159], v[168:171]
  v_mfma_f32_16x16x32_bf16 v[172:175], a[60:63], v[148:151], v[172:175]
  v_mfma_f32_16x16x32_bf16 v[176:179], a[60:63], v[152:155], v[176:179]
  v_mfma_f32_16x16x32_bf16 v[180:183], a[60:63], v[156:159], v[180:183]
  v_mfma_f32_16x16x32_bf16 v[160:163], v[80:83], v[136:139], v[160:163]
  v_mfma_f32_16x16x32_bf16 v[164:167], v[80:83], v[140:143], v[164:167]
  v_mfma_f32_16x16x32_bf16 v[168:171], v[80:83], v[144:147], v[168:171]
  v_mfma_f32_16x16x32_bf16 v[172:175], v[84:87], v[136:139], v[172:175]
  v_mfma_f32_16x16x32_bf16 v[176:179], v[84:87], v[140:143], v[176:179]
  v_mfma_f32_16x16x32_bf16 v[180:183], v[84:87], v[144:147], v[180:183]
  v_mfma_f32_16x16x32_bf16 v[184:187], v[88:91], v[136:139], v[184:187]
  v_mfma_f32_16x16x32_bf16 v[188:191], v[88:91], v[140:143], v[188:191]
  v_mfma_f32_16x16x32_bf16 v[192:195], v[88:91], v[144:147], v[192:195]
  v_mfma_f32_16x16x32_bf16 v[196:199], v[92:95], v[136:139], v[196:199]
  v_mfma_f32_16x16x32_bf16 v[200:203], v[92:95], v[140:143], v[200:203]
  v_mfma_f32_16x16x32_bf16 v[204:207], v[92:95], v[144:147], v[204:207]
  v_mfma_f32_16x16x32_bf16 v[208:211], v[96:99], v[136:139], v[208:211]
  v_mfma_f32_16x16x32_bf16 v[212:215], v[96:99], v[140:143], v[212:215]
  v_mfma_f32_16x16x32_bf16 v[216:219], v[96:99], v[144:147], v[216:219]
  v_mfma_f32_16x16x32_bf16 v[220:223], v[100:103], v[136:139], v[220:223]
  v_mfma_f32_16x16x32_bf16 v[224:227], v[100:103], v[140:143], v[224:227]
  v_mfma_f32_16x16x32_bf16 v[228:231], v[100:103], v[144:147], v[228:231]
  v_mfma_f32_16x16x32_bf16 v[232:235], v[104:107], v[136:139], v[232:235]
  v_mfma_f32_16x16x32_bf16 v[236:239], v[104:107], v[140:143], v[236:239]
  v_mfma_f32_16x16x32_bf16 v[240:243], v[104:107], v[144:147], v[240:243]
  s_mul_i32 s39, s32, 10752
  s_add_u32 s40, s39, 4096
  s_add_u32 s41, s39, 8192
  ds_read_b128 v[80:83], v40 offset:0
  ds_read_b128 v[84:87], v40 offset:1024
  ds_read_b128 v[88:91], v40 offset:2048
  ds_read_b128 v[92:95], v41 offset:0
  ds_read_b128 v[96:99], v41 offset:1024
  ds_read_b128 v[100:103], v41 offset:2048
  s_waitcnt lgkmcnt(6)
  v_mfma_f32_16x16x32_bf16 v[184:187], a[88:91], v[124:127], v[184:187]
  v_cvt_pk_bf16_f32 v160, v160, v161
  v_cvt_pk_bf16_f32 v161, v162, v163
  v_mfma_f32_16x16x32_bf16 v[188:191], a[88:91], v[128:131], v[188:191]
  v_cvt_pk_bf16_f32 v162, v172, v173
  v_cvt_pk_bf16_f32 v163, v174, v175
  v_mfma_f32_16x16x32_bf16 v[192:195], a[88:91], v[132:135], v[192:195]
  buffer_store_dwordx4 v[160:163], v33, s[28:31], s39 offen offset:0 sc1
  v_mfma_f32_16x16x32_bf16 v[196:199], a[120:123], v[124:127], v[196:199]
  v_mfma_f32_16x16x32_bf16 v[200:203], a[120:123], v[128:131], v[200:203]
  v_cvt_pk_bf16_f32 v164, v164, v165
  v_cvt_pk_bf16_f32 v165, v166, v167
  v_mfma_f32_16x16x32_bf16 v[204:207], a[120:123], v[132:135], v[204:207]
  v_cvt_pk_bf16_f32 v166, v176, v177
  v_cvt_pk_bf16_f32 v167, v178, v179
  v_mfma_f32_16x16x32_bf16 v[184:187], a[92:95], v[148:151], v[184:187]
  buffer_store_dwordx4 v[164:167], v33, s[28:31], s39 offen offset:1024 sc1
  v_mfma_f32_16x16x32_bf16 v[188:191], a[92:95], v[152:155], v[188:191]
  v_mfma_f32_16x16x32_bf16 v[192:195], a[92:95], v[156:159], v[192:195]
  v_cvt_pk_bf16_f32 v168, v168, v169
  v_cvt_pk_bf16_f32 v169, v170, v171
  v_mfma_f32_16x16x32_bf16 v[196:199], a[124:127], v[148:151], v[196:199]
  v_cvt_pk_bf16_f32 v170, v180, v181
  v_cvt_pk_bf16_f32 v171, v182, v183
  v_mfma_f32_16x16x32_bf16 v[200:203], a[124:127], v[152:155], v[200:203]
  buffer_store_dwordx4 v[168:171], v33, s[28:31], s39 offen offset:2048 sc1
  v_mfma_f32_16x16x32_bf16 v[204:207], a[124:127], v[156:159], v[204:207]
  v_mfma_f32_16x16x32_bf16 v[184:187], a[64:67], v[48:51], v[184:187]
  v_mfma_f32_16x16x32_bf16 v[188:191], a[64:67], v[52:55], v[188:191]
  v_mfma_f32_16x16x32_bf16 v[192:195], a[64:67], v[56:59], v[192:195]
  v_mfma_f32_16x16x32_bf16 v[196:199], a[96:99], v[48:51], v[196:199]
  v_mfma_f32_16x16x32_bf16 v[200:203], a[96:99], v[52:55], v[200:203]
  v_mfma_f32_16x16x32_bf16 v[204:207], a[96:99], v[56:59], v[204:207]
  v_mfma_f32_16x16x32_bf16 v[184:187], a[68:71], v[60:63], v[184:187]
  v_mfma_f32_16x16x32_bf16 v[188:191], a[68:71], v[64:67], v[188:191]
  v_mfma_f32_16x16x32_bf16 v[192:195], a[68:71], v[68:71], v[192:195]
  v_mfma_f32_16x16x32_bf16 v[196:199], a[100:103], v[60:63], v[196:199]
  v_mfma_f32_16x16x32_bf16 v[200:203], a[100:103], v[64:67], v[200:203]
  v_mfma_f32_16x16x32_bf16 v[204:207], a[100:103], v[68:71], v[204:207]
  v_mfma_f32_16x16x32_bf16 v[184:187], a[72:75], v[112:115], v[184:187]
  v_mfma_f32_16x16x32_bf16 v[188:191], a[72:75], v[116:119], v[188:191]
  v_mfma_f32_16x16x32_bf16 v[192:195], a[72:75], v[120:123], v[192:195]
  v_mfma_f32_16x16x32_bf16 v[196:199], a[104:107], v[112:115], v[196:199]
  v_mfma_f32_16x16x32_bf16 v[200:203], a[104:107], v[116:119], v[200:203]
  v_mfma_f32_16x16x32_bf16 v[204:207], a[104:107], v[120:123], v[204:207]
  v_mfma_f32_16x16x32_bf16 v[184:187], a[76:79], v[244:247], v[184:187]
  v_mfma_f32_16x16x32_bf16 v[188:191], a[76:79], v[248:251], v[188:191]
  v_mfma_f32_16x16x32_bf16 v[192:195], a[76:79], v[252:255], v[192:195]
  v_mfma_f32_16x16x32_bf16 v[196:199], a[108:111], v[244:247], v[196:199]
  v_mfma_f32_16x16x32_bf16 v[200:203], a[108:111], v[248:251], v[200:203]
  v_mfma_f32_16x16x32_bf16 v[204:207], a[108:111], v[252:255], v[204:207]
  s_waitcnt lgkmcnt(0)
  v_mfma_f32_16x16x32_bf16 v[184:187], a[80:83], v[80:83], v[184:187]
  v_mfma_f32_16x16x32_bf16 v[188:191], a[80:83], v[84:87], v[188:191]
  v_mfma_f32_16x16x32_bf16 v[192:195], a[80:83], v[88:91], v[192:195]
  v_mfma_f32_16x16x32_bf16 v[196:199], a[112:115], v[80:83], v[196:199]
  v_mfma_f32_16x16x32_bf16 v[200:203], a[112:115], v[84:87], v[200:203]
  v_mfma_f32_16x16x32_bf16 v[204:207], a[112:115], v[88:91], v[204:207]
  v_mfma_f32_16x16x32_bf16 v[184:187], a[84:87], v[92:95], v[184:187]
  v_mfma_f32_16x16x32_bf16 v[188:191], a[84:87], v[96:99], v[188:191]
  v_mfma_f32_16x16x32_bf16 v[192:195], a[84:87], v[100:103], v[192:195]
  v_mfma_f32_16x16x32_bf16 v[196:199], a[116:119], v[92:95], v[196:199]
  v_mfma_f32_16x16x32_bf16 v[200:203], a[116:119], v[96:99], v[200:203]
  v_mfma_f32_16x16x32_bf16 v[204:207], a[116:119], v[100:103], v[204:207]
  v_mfma_f32_16x16x32_bf16 v[208:211], a[152:155], v[124:127], v[208:211]
  v_mfma_f32_16x16x32_bf16 v[212:215], a[152:155], v[128:131], v[212:215]
  v_mfma_f32_16x16x32_bf16 v[216:219], a[152:155], v[132:135], v[216:219]
  v_mfma_f32_16x16x32_bf16 v[220:223], a[184:187], v[124:127], v[220:223]
  v_mfma_f32_16x16x32_bf16 v[224:227], a[184:187], v[128:131], v[224:227]
  v_mfma_f32_16x16x32_bf16 v[228:231], a[184:187], v[132:135], v[228:231]
  v_mfma_f32_16x16x32_bf16 v[208:211], a[156:159], v[148:151], v[208:211]
  v_mfma_f32_16x16x32_bf16 v[212:215], a[156:159], v[152:155], v[212:215]
  v_mfma_f32_16x16x32_bf16 v[216:219], a[156:159], v[156:159], v[216:219]
  v_mfma_f32_16x16x32_bf16 v[220:223], a[188:191], v[148:151], v[220:223]
  v_cvt_pk_bf16_f32 v184, v184, v185
  v_cvt_pk_bf16_f32 v185, v186, v187
  v_mfma_f32_16x16x32_bf16 v[224:227], a[188:191], v[152:155], v[224:227]
  v_cvt_pk_bf16_f32 v186, v196, v197
  v_cvt_pk_bf16_f32 v187, v198, v199
  v_mfma_f32_16x16x32_bf16 v[228:231], a[188:191], v[156:159], v[228:231]
  buffer_store_dwordx4 v[184:187], v33, s[28:31], s39 offen offset:3072 sc1
  v_mfma_f32_16x16x32_bf16 v[208:211], a[128:131], v[48:51], v[208:211]
  v_mfma_f32_16x16x32_bf16 v[212:215], a[128:131], v[52:55], v[212:215]
  v_cvt_pk_bf16_f32 v188, v188, v189
  v_cvt_pk_bf16_f32 v189, v190, v191
  v_mfma_f32_16x16x32_bf16 v[216:219], a[128:131], v[56:59], v[216:219]
  v_cvt_pk_bf16_f32 v190, v200, v201
  v_cvt_pk_bf16_f32 v191, v202, v203
  v_mfma_f32_16x16x32_bf16 v[220:223], a[160:163], v[48:51], v[220:223]
  buffer_store_dwordx4 v[188:191], v33, s[28:31], s40 offen offset:0 sc1
  v_mfma_f32_16x16x32_bf16 v[224:227], a[160:163], v[52:55], v[224:227]
  v_mfma_f32_16x16x32_bf16 v[228:231], a[160:163], v[56:59], v[228:231]
  v_cvt_pk_bf16_f32 v192, v192, v193
  v_cvt_pk_bf16_f32 v193, v194, v195
  v_mfma_f32_16x16x32_bf16 v[208:211], a[132:135], v[60:63], v[208:211]
  v_cvt_pk_bf16_f32 v194, v204, v205
  v_cvt_pk_bf16_f32 v195, v206, v207
  v_mfma_f32_16x16x32_bf16 v[212:215], a[132:135], v[64:67], v[212:215]
  buffer_store_dwordx4 v[192:195], v33, s[28:31], s40 offen offset:1024 sc1
  v_mfma_f32_16x16x32_bf16 v[216:219], a[132:135], v[68:71], v[216:219]
  v_mfma_f32_16x16x32_bf16 v[220:223], a[164:167], v[60:63], v[220:223]
  v_mfma_f32_16x16x32_bf16 v[224:227], a[164:167], v[64:67], v[224:227]
  v_mfma_f32_16x16x32_bf16 v[228:231], a[164:167], v[68:71], v[228:231]
  v_mfma_f32_16x16x32_bf16 v[208:211], a[136:139], v[112:115], v[208:211]
  v_mfma_f32_16x16x32_bf16 v[212:215], a[136:139], v[116:119], v[212:215]
  v_mfma_f32_16x16x32_bf16 v[216:219], a[136:139], v[120:123], v[216:219]
  v_mfma_f32_16x16x32_bf16 v[220:223], a[168:171], v[112:115], v[220:223]
  v_mfma_f32_16x16x32_bf16 v[224:227], a[168:171], v[116:119], v[224:227]
  v_mfma_f32_16x16x32_bf16 v[228:231], a[168:171], v[120:123], v[228:231]
  v_mfma_f32_16x16x32_bf16 v[208:211], a[140:143], v[244:247], v[208:211]
  v_mfma_f32_16x16x32_bf16 v[212:215], a[140:143], v[248:251], v[212:215]
  v_mfma_f32_16x16x32_bf16 v[216:219], a[140:143], v[252:255], v[216:219]
  v_mfma_f32_16x16x32_bf16 v[220:223], a[172:175], v[244:247], v[220:223]
  v_mfma_f32_16x16x32_bf16 v[224:227], a[172:175], v[248:251], v[224:227]
  v_mfma_f32_16x16x32_bf16 v[228:231], a[172:175], v[252:255], v[228:231]
  v_mfma_f32_16x16x32_bf16 v[208:211], a[144:147], v[80:83], v[208:211]
  v_mfma_f32_16x16x32_bf16 v[212:215], a[144:147], v[84:87], v[212:215]
  v_mfma_f32_16x16x32_bf16 v[216:219], a[144:147], v[88:91], v[216:219]
  v_mfma_f32_16x16x32_bf16 v[220:223], a[176:179], v[80:83], v[220:223]
  v_mfma_f32_16x16x32_bf16 v[224:227], a[176:179], v[84:87], v[224:227]
  v_mfma_f32_16x16x32_bf16 v[228:231], a[176:179], v[88:91], v[228:231]
  v_mfma_f32_16x16x32_bf16 v[208:211], a[148:151], v[92:95], v[208:211]
  v_mfma_f32_16x16x32_bf16 v[212:215], a[148:151], v[96:99], v[212:215]
  v_mfma_f32_16x16x32_bf16 v[216:219], a[148:151], v[100:103], v[216:219]
  v_mfma_f32_16x16x32_bf16 v[220:223], a[180:183], v[92:95], v[220:223]
  v_mfma_f32_16x16x32_bf16 v[224:227], a[180:183], v[96:99], v[224:227]
  v_mfma_f32_16x16x32_bf16 v[228:231], a[180:183], v[100:103], v[228:231]
  v_mfma_f32_16x16x32_bf16 v[232:235], a[216:219], v[124:127], v[232:235]
  v_mfma_f32_16x16x32_bf16 v[236:239], a[216:219], v[128:131], v[236:239]
  v_mfma_f32_16x16x32_bf16 v[240:243], a[216:219], v[132:135], v[240:243]
  v_mfma_f32_16x16x32_bf16 v[232:235], a[220:223], v[148:151], v[232:235]
  v_mfma_f32_16x16x32_bf16 v[236:239], a[220:223], v[152:155], v[236:239]
  v_mfma_f32_16x16x32_bf16 v[240:243], a[220:223], v[156:159], v[240:243]
  v_mfma_f32_16x16x32_bf16 v[232:235], a[192:195], v[48:51], v[232:235]
  v_mfma_f32_16x16x32_bf16 v[236:239], a[192:195], v[52:55], v[236:239]
  v_mfma_f32_16x16x32_bf16 v[240:243], a[192:195], v[56:59], v[240:243]
  v_mfma_f32_16x16x32_bf16 v[232:235], a[196:199], v[60:63], v[232:235]
  v_cvt_pk_bf16_f32 v208, v208, v209
  v_cvt_pk_bf16_f32 v209, v210, v211
  v_mfma_f32_16x16x32_bf16 v[236:239], a[196:199], v[64:67], v[236:239]
  v_cvt_pk_bf16_f32 v210, v220, v221
  v_cvt_pk_bf16_f32 v211, v222, v223
  v_mfma_f32_16x16x32_bf16 v[240:243], a[196:199], v[68:71], v[240:243]
  buffer_store_dwordx4 v[208:211], v33, s[28:31], s40 offen offset:2048 sc1
  v_mfma_f32_16x16x32_bf16 v[232:235], a[200:203], v[112:115], v[232:235]
  v_mfma_f32_16x16x32_bf16 v[236:239], a[200:203], v[116:119], v[236:239]
  v_cvt_pk_bf16_f32 v212, v212, v213
  v_cvt_pk_bf16_f32 v213, v214, v215
  v_mfma_f32_16x16x32_bf16 v[240:243], a[200:203], v[120:123], v[240:243]
  v_cvt_pk_bf16_f32 v214, v224, v225
  v_cvt_pk_bf16_f32 v215, v226, v227
  v_mfma_f32_16x16x32_bf16 v[232:235], a[204:207], v[244:247], v[232:235]
  buffer_store_dwordx4 v[212:215], v33, s[28:31], s40 offen offset:3072 sc1
  v_mfma_f32_16x16x32_bf16 v[236:239], a[204:207], v[248:251], v[236:239]
  v_mfma_f32_16x16x32_bf16 v[240:243], a[204:207], v[252:255], v[240:243]
  v_cvt_pk_bf16_f32 v216, v216, v217
  v_cvt_pk_bf16_f32 v217, v218, v219
  v_mfma_f32_16x16x32_bf16 v[232:235], a[208:211], v[80:83], v[232:235]
  v_cvt_pk_bf16_f32 v218, v228, v229
  v_cvt_pk_bf16_f32 v219, v230, v231
  v_mfma_f32_16x16x32_bf16 v[236:239], a[208:211], v[84:87], v[236:239]
  buffer_store_dwordx4 v[216:219], v33, s[28:31], s41 offen offset:0 sc1
  v_mfma_f32_16x16x32_bf16 v[240:243], a[208:211], v[88:91], v[240:243]
  v_mfma_f32_16x16x32_bf16 v[232:235], a[212:215], v[92:95], v[232:235]
  v_mfma_f32_16x16x32_bf16 v[236:239], a[212:215], v[96:99], v[236:239]
  v_mfma_f32_16x16x32_bf16 v[240:243], a[212:215], v[100:103], v[240:243]
  s_nop 7
  v_cvt_pk_bf16_f32 v232, v232, v233
  v_cvt_pk_bf16_f32 v233, v234, v235
  buffer_store_dwordx2 v[232:233], v35, s[28:31], s41 offen offset:1024 sc1
  v_cvt_pk_bf16_f32 v236, v236, v237
  v_cvt_pk_bf16_f32 v237, v238, v239
  buffer_store_dwordx2 v[236:237], v35, s[28:31], s41 offen offset:1536 sc1
  v_cvt_pk_bf16_f32 v240, v240, v241
  v_cvt_pk_bf16_f32 v241, v242, v243
  buffer_store_dwordx2 v[240:241], v35, s[28:31], s41 offen offset:2048 sc1
  s_mul_i32 s39, s5, 345088
  s_add_u32 s8, s58, s39
  s_addc_u32 s9, s59, 0
  s_mov_b32 s10, 345088
  s_mov_b32 s11, 0x20000
  s_mov_b32 s12, s92
  s_mov_b32 s13, s93
  s_mov_b32 s14, 1376256
  s_mov_b32 s15, 0x20000
  s_mov_b32 s45, 0xffff0000
  s_mov_b32 s4, 0x00003f80
  s_mov_b32 s42, 0x3f800000
  s_lshl_b32 s39, s5, 12
  s_add_u32 s39, s39, 20971520
  s_add_u32 s24, s58, s39
  s_addc_u32 s25, s59, 0
  s_mov_b32 s26, 64
  s_mov_b32 s27, 0x20000
  s_lshl_b32 s56, s3, 3
  s_mul_i32 s57, s5, 86016
  s_lshl_b32 s48, s3, 2
  s_add_u32 s48, s48, s32
  s_mul_i32 s52, s48, 57
  s_lshr_b32 s52, s52, 9
  s_mul_i32 s53, s52, 9
  s_sub_u32 s53, s48, s53
  s_mul_i32 s49, s52, 10752
  s_lshl_b32 s54, s53, 10
  s_add_u32 s49, s49, s54
  s_mul_i32 s54, s53, 86
  s_lshr_b32 s54, s54, 8
  s_mul_i32 s55, s54, 3
  s_sub_u32 s55, s53, s55
  s_mul_i32 s50, s52, 224
  s_lshl_b32 s54, s54, 6
  s_add_u32 s50, s50, s54
  s_mul_i32 s55, s55, 28672
  s_add_u32 s50, s50, s55
  s_add_u32 s50, s50, s57
  v_mul_u32_u24 v16, 1792, v1
  v_lshl_add_u32 v17, v2, 3, v16
  v_and_b32 v18, 1, v2
  v_lshl_add_u32 v16, v18, 5, v16
  v_lshrrev_b32 v18, 1, v2
  v_lshl_add_u32 v16, v18, 4, v16
  v_mov_b32 v46, s90
  v_mov_b32 v47, s91
  s_waitcnt vmcnt(0)
  s_barrier
  s_cmp_eq_u32 s32, 0
  s_cbranch_scc0 L_Ago
  s_mov_b64 exec, 1
  buffer_store_dwordx2 v[46:47], v35, s[24:27], s56 offen sc1
  s_mov_b64 exec, 0xff
  s_mov_b32 s51, 0
L_pollA:
  buffer_load_dwordx2 v[44:45], v35, s[24:27], 0 offen offset:0 sc1
  s_waitcnt vmcnt(0)
L_chkA:
  v_cmp_eq_u64 vcc, v[44:45], v[46:47]
  s_add_u32 s51, s51, 1
  s_nop 0
  s_cmp_eq_u32 vcc_lo, 0xff
  s_cbranch_scc1 L_polledA
  s_cmp_ge_u32 s51, 0x100000
  s_cbranch_scc1 L_polledA
  s_sleep 4
  s_branch L_pollA
L_polledA:
  s_mov_b64 exec, -1
L_Ago:
  s_barrier
  buffer_load_dwordx4 v[48:51], v33, s[8:11], s49 offen sc1
  s_add_u32 s49, s49, 43136
  buffer_load_dwordx4 v[52:55], v33, s[8:11], s49 offen sc1
  s_add_u32 s49, s49, 43136
  buffer_load_dwordx4 v[56:59], v33, s[8:11], s49 offen sc1
  s_add_u32 s49, s49, 43136
  buffer_load_dwordx4 v[60:63], v33, s[8:11], s49 offen sc1
  s_add_u32 s49, s49, 43136
  buffer_load_dwordx4 v[64:67], v33, s[8:11], s49 offen sc1
  s_add_u32 s49, s49, 43136
  buffer_load_dwordx4 v[68:71], v33, s[8:11], s49 offen sc1
  s_add_u32 s49, s49, 43136
  buffer_load_dwordx4 v[72:75], v33, s[8:11], s49 offen sc1
  s_add_u32 s49, s49, 43136
  buffer_load_dwordx4 v[76:79], v33, s[8:11], s49 offen sc1
  s_add_u32 s49, s49, 43136
  s_cmp_lt_u32 s48, 4
  s_cbranch_scc1 L_r2pair
  s_cmp_lt_u32 s48, 16
  s_cbranch_scc1 L_r2single
  s_waitcnt vmcnt(7)
  v_lshlrev_b32 v200, 16, v48
  v_and_b32 v201, s45, v48
  v_lshlrev_b32 v202, 16, v49
  v_and_b32 v203, s45, v49
  v_lshlrev_b32 v204, 16, v50
  v_and_b32 v205, s45, v50
  v_lshlrev_b32 v206, 16, v51
  v_and_b32 v207, s45, v51
  s_waitcnt vmcnt(6)
  v_dot2c_f32_bf16 v200, s4, v52
  v_dot2c_f32_bf16 v201, s42, v52
  v_dot2c_f32_bf16 v202, s4, v53
  v_dot2c_f32_bf16 v203, s42, v53
  v_dot2c_f32_bf16 v204, s4, v54
  v_dot2c_f32_bf16 v205, s42, v54
  v_dot2c_f32_bf16 v206, s4, v55
  v_dot2c_f32_bf16 v207, s42, v55
  s_waitcnt vmcnt(5)
  v_dot2c_f32_bf16 v200, s4, v56
  v_dot2c_f32_bf16 v201, s42, v56
  v_dot2c_f32_bf16 v202, s4, v57
  v_dot2c_f32_bf16 v203, s42, v57
  v_dot2c_f32_bf16 v204, s4, v58
  v_dot2c_f32_bf16 v205, s42, v58
  v_dot2c_f32_bf16 v206, s4, v59
  v_dot2c_f32_bf16 v207, s42, v59
  s_waitcnt vmcnt(4)
  v_dot2c_f32_bf16 v200, s4, v60
  v_dot2c_f32_bf16 v201, s42, v60
  v_dot2c_f32_bf16 v202, s4, v61
  v_dot2c_f32_bf16 v203, s42, v61
  v_dot2c_f32_bf16 v204, s4, v62
  v_dot2c_f32_bf16 v205, s42, v62
  v_dot2c_f32_bf16 v206, s4, v63
  v_dot2c_f32_bf16 v207, s42, v63
  s_waitcnt vmcnt(3)
  v_dot2c_f32_bf16 v200, s4, v64
  v_dot2c_f32_bf16 v201, s42, v64
  v_dot2c_f32_bf16 v202, s4, v65
  v_dot2c_f32_bf16 v203, s42, v65
  v_dot2c_f32_bf16 v204, s4, v66
  v_dot2c_f32_bf16 v205, s42, v66
  v_dot2c_f32_bf16 v206, s4, v67
  v_dot2c_f32_bf16 v207, s42, v67
  s_waitcnt vmcnt(2)
  v_dot2c_f32_bf16 v200, s4, v68
  v_dot2c_f32_bf16 v201, s42, v68
  v_dot2c_f32_bf16 v202, s4, v69
  v_dot2c_f32_bf16 v203, s42, v69
  v_dot2c_f32_bf16 v204, s4, v70
  v_dot2c_f32_bf16 v205, s42, v70
  v_dot2c_f32_bf16 v206, s4, v71
  v_dot2c_f32_bf16 v207, s42, v71
  s_waitcnt vmcnt(1)
  v_dot2c_f32_bf16 v200, s4, v72
  v_dot2c_f32_bf16 v201, s42, v72
  v_dot2c_f32_bf16 v202, s4, v73
  v_dot2c_f32_bf16 v203, s42, v73
  v_dot2c_f32_bf16 v204, s4, v74
  v_dot2c_f32_bf16 v205, s42, v74
  v_dot2c_f32_bf16 v206, s4, v75
  v_dot2c_f32_bf16 v207, s42, v75
  s_waitcnt vmcnt(0)
  v_dot2c_f32_bf16 v200, s4, v76
  v_dot2c_f32_bf16 v201, s42, v76
  v_dot2c_f32_bf16 v202, s4, v77
  v_dot2c_f32_bf16 v203, s42, v77
  v_dot2c_f32_bf16 v204, s4, v78
  v_dot2c_f32_bf16 v205, s42, v78
  v_dot2c_f32_bf16 v206, s4, v79
  v_dot2c_f32_bf16 v207, s42, v79
  s_nop 2
  v_cvt_pk_bf16_f32 v208, v200, v201
  v_cvt_pk_bf16_f32 v209, v202, v203
  v_cvt_pk_bf16_f32 v210, v204, v205
  v_cvt_pk_bf16_f32 v211, v206, v207
  s_nop 1
  v_permlane16_swap_b32 v208, v210
  v_permlane16_swap_b32 v209, v211
  s_nop 1
  buffer_store_dwordx4 v[208:211], v16, s[12:15], s50 offen
  s_branch L_fin
L_r2pair:
  s_add_u32 s48, s48, 32
  s_mul_i32 s52, s48, 57
  s_lshr_b32 s52, s52, 9
  s_mul_i32 s53, s52, 9
  s_sub_u32 s53, s48, s53
  s_mul_i32 s49, s52, 10752
  s_lshl_b32 s54, s53, 10
  s_add_u32 s49, s49, s54
  s_mul_i32 s54, s53, 86
  s_lshr_b32 s54, s54, 8
  s_mul_i32 s55, s54, 3
  s_sub_u32 s55, s53, s55
  s_mul_i32 s56, s52, 224
  s_lshl_b32 s54, s54, 6
  s_add_u32 s56, s56, s54
  s_mul_i32 s55, s55, 28672
  s_add_u32 s56, s56, s55
  s_add_u32 s56, s56, s57
  buffer_load_dwordx4 v[80:83], v33, s[8:11], s49 offen sc1
  s_add_u32 s49, s49, 43136
  buffer_load_dwordx4 v[84:87], v33, s[8:11], s49 offen sc1
  s_add_u32 s49, s49, 43136
  buffer_load_dwordx4 v[88:91], v33, s[8:11], s49 offen sc1
  s_add_u32 s49, s49, 43136
  buffer_load_dwordx4 v[92:95], v33, s[8:11], s49 offen sc1
  s_add_u32 s49, s49, 43136
  buffer_load_dwordx4 v[96:99], v33, s[8:11], s49 offen sc1
  s_add_u32 s49, s49, 43136
  buffer_load_dwordx4 v[100:103], v33, s[8:11], s49 offen sc1
  s_add_u32 s49, s49, 43136
  buffer_load_dwordx4 v[104:107], v33, s[8:11], s49 offen sc1
  s_add_u32 s49, s49, 43136
  buffer_load_dwordx4 v[108:111], v33, s[8:11], s49 offen sc1
  s_add_u32 s49, s49, 43136
  s_waitcnt vmcnt(15)
  v_lshlrev_b32 v200, 16, v48
  v_and_b32 v201, s45, v48
  v_lshlrev_b32 v202, 16, v49
  v_and_b32 v203, s45, v49
  v_lshlrev_b32 v204, 16, v50
  v_and_b32 v205, s45, v50
  v_lshlrev_b32 v206, 16, v51
  v_and_b32 v207, s45, v51
  s_waitcnt vmcnt(14)
  v_dot2c_f32_bf16 v200, s4, v52
  v_dot2c_f32_bf16 v201, s42, v52
  v_dot2c_f32_bf16 v202, s4, v53
  v_dot2c_f32_bf16 v203, s42, v53
  v_dot2c_f32_bf16 v204, s4, v54
  v_dot2c_f32_bf16 v205, s42, v54
  v_dot2c_f32_bf16 v206, s4, v55
  v_dot2c_f32_bf16 v207, s42, v55
  s_waitcnt vmcnt(13)
  v_dot2c_f32_bf16 v200, s4, v56
  v_dot2c_f32_bf16 v201, s42, v56
  v_dot2c_f32_bf16 v202, s4, v57
  v_dot2c_f32_bf16 v203, s42, v57
  v_dot2c_f32_bf16 v204, s4, v58
  v_dot2c_f32_bf16 v205, s42, v58
  v_dot2c_f32_bf16 v206, s4, v59
  v_dot2c_f32_bf16 v207, s42, v59
  s_waitcnt vmcnt(12)
  v_dot2c_f32_bf16 v200, s4, v60
  v_dot2c_f32_bf16 v201, s42, v60
  v_dot2c_f32_bf16 v202, s4, v61
  v_dot2c_f32_bf16 v203, s42, v61
  v_dot2c_f32_bf16 v204, s4, v62
  v_dot2c_f32_bf16 v205, s42, v62
  v_dot2c_f32_bf16 v206, s4, v63
  v_dot2c_f32_bf16 v207, s42, v63
  s_waitcnt vmcnt(11)
  v_dot2c_f32_bf16 v200, s4, v64
  v_dot2c_f32_bf16 v201, s42, v64
  v_dot2c_f32_bf16 v202, s4, v65
  v_dot2c_f32_bf16 v203, s42, v65
  v_dot2c_f32_bf16 v204, s4, v66
  v_dot2c_f32_bf16 v205, s42, v66
  v_dot2c_f32_bf16 v206, s4, v67
  v_dot2c_f32_bf16 v207, s42, v67
  s_waitcnt vmcnt(10)
  v_dot2c_f32_bf16 v200, s4, v68
  v_dot2c_f32_bf16 v201, s42, v68
  v_dot2c_f32_bf16 v202, s4, v69
  v_dot2c_f32_bf16 v203, s42, v69
  v_dot2c_f32_bf16 v204, s4, v70
  v_dot2c_f32_bf16 v205, s42, v70
  v_dot2c_f32_bf16 v206, s4, v71
  v_dot2c_f32_bf16 v207, s42, v71
  s_waitcnt vmcnt(9)
  v_dot2c_f32_bf16 v200, s4, v72
  v_dot2c_f32_bf16 v201, s42, v72
  v_dot2c_f32_bf16 v202, s4, v73
  v_dot2c_f32_bf16 v203, s42, v73
  v_dot2c_f32_bf16 v204, s4, v74
  v_dot2c_f32_bf16 v205, s42, v74
  v_dot2c_f32_bf16 v206, s4, v75
  v_dot2c_f32_bf16 v207, s42, v75
  s_waitcnt vmcnt(8)
  v_dot2c_f32_bf16 v200, s4, v76
  v_dot2c_f32_bf16 v201, s42, v76
  v_dot2c_f32_bf16 v202, s4, v77
  v_dot2c_f32_bf16 v203, s42, v77
  v_dot2c_f32_bf16 v204, s4, v78
  v_dot2c_f32_bf16 v205, s42, v78
  v_dot2c_f32_bf16 v206, s4, v79
  v_dot2c_f32_bf16 v207, s42, v79
  s_nop 2
  v_cvt_pk_bf16_f32 v208, v200, v201
  v_cvt_pk_bf16_f32 v209, v202, v203
  v_cvt_pk_bf16_f32 v210, v204, v205
  v_cvt_pk_bf16_f32 v211, v206, v207
  s_nop 1
  v_permlane16_swap_b32 v208, v210
  v_permlane16_swap_b32 v209, v211
  s_nop 1
  buffer_store_dwordx4 v[208:211], v16, s[12:15], s50 offen
  s_waitcnt vmcnt(8)
  v_lshlrev_b32 v216, 16, v80
  v_and_b32 v217, s45, v80
  v_lshlrev_b32 v218, 16, v81
  v_and_b32 v219, s45, v81
  v_lshlrev_b32 v220, 16, v82
  v_and_b32 v221, s45, v82
  v_lshlrev_b32 v222, 16, v83
  v_and_b32 v223, s45, v83
  s_waitcnt vmcnt(7)
  v_dot2c_f32_bf16 v216, s4, v84
  v_dot2c_f32_bf16 v217, s42, v84
  v_dot2c_f32_bf16 v218, s4, v85
  v_dot2c_f32_bf16 v219, s42, v85
  v_dot2c_f32_bf16 v220, s4, v86
  v_dot2c_f32_bf16 v221, s42, v86
  v_dot2c_f32_bf16 v222, s4, v87
  v_dot2c_f32_bf16 v223, s42, v87
  s_waitcnt vmcnt(6)
  v_dot2c_f32_bf16 v216, s4, v88
  v_dot2c_f32_bf16 v217, s42, v88
  v_dot2c_f32_bf16 v218, s4, v89
  v_dot2c_f32_bf16 v219, s42, v89
  v_dot2c_f32_bf16 v220, s4, v90
  v_dot2c_f32_bf16 v221, s42, v90
  v_dot2c_f32_bf16 v222, s4, v91
  v_dot2c_f32_bf16 v223, s42, v91
  s_waitcnt vmcnt(5)
  v_dot2c_f32_bf16 v216, s4, v92
  v_dot2c_f32_bf16 v217, s42, v92
  v_dot2c_f32_bf16 v218, s4, v93
  v_dot2c_f32_bf16 v219, s42, v93
  v_dot2c_f32_bf16 v220, s4, v94
  v_dot2c_f32_bf16 v221, s42, v94
  v_dot2c_f32_bf16 v222, s4, v95
  v_dot2c_f32_bf16 v223, s42, v95
  s_waitcnt vmcnt(4)
  v_dot2c_f32_bf16 v216, s4, v96
  v_dot2c_f32_bf16 v217, s42, v96
  v_dot2c_f32_bf16 v218, s4, v97
  v_dot2c_f32_bf16 v219, s42, v97
  v_dot2c_f32_bf16 v220, s4, v98
  v_dot2c_f32_bf16 v221, s42, v98
  v_dot2c_f32_bf16 v222, s4, v99
  v_dot2c_f32_bf16 v223, s42, v99
  s_waitcnt vmcnt(3)
  v_dot2c_f32_bf16 v216, s4, v100
  v_dot2c_f32_bf16 v217, s42, v100
  v_dot2c_f32_bf16 v218, s4, v101
  v_dot2c_f32_bf16 v219, s42, v101
  v_dot2c_f32_bf16 v220, s4, v102
  v_dot2c_f32_bf16 v221, s42, v102
  v_dot2c_f32_bf16 v222, s4, v103
  v_dot2c_f32_bf16 v223, s42, v103
  s_waitcnt vmcnt(2)
  v_dot2c_f32_bf16 v216, s4, v104
  v_dot2c_f32_bf16 v217, s42, v104
  v_dot2c_f32_bf16 v218, s4, v105
  v_dot2c_f32_bf16 v219, s42, v105
  v_dot2c_f32_bf16 v220, s4, v106
  v_dot2c_f32_bf16 v221, s42, v106
  v_dot2c_f32_bf16 v222, s4, v107
  v_dot2c_f32_bf16 v223, s42, v107
  s_waitcnt vmcnt(1)
  v_dot2c_f32_bf16 v216, s4, v108
  v_dot2c_f32_bf16 v217, s42, v108
  v_dot2c_f32_bf16 v218, s4, v109
  v_dot2c_f32_bf16 v219, s42, v109
  v_dot2c_f32_bf16 v220, s4, v110
  v_dot2c_f32_bf16 v221, s42, v110
  v_dot2c_f32_bf16 v222, s4, v111
  v_dot2c_f32_bf16 v223, s42, v111
  s_nop 2
  v_cvt_pk_bf16_f32 v224, v216, v217
  v_cvt_pk_bf16_f32 v225, v218, v219
  v_cvt_pk_bf16_f32 v226, v220, v221
  v_cvt_pk_bf16_f32 v227, v222, v223
  s_nop 1
  v_permlane16_swap_b32 v224, v226
  v_permlane16_swap_b32 v225, v227
  s_nop 1
  buffer_store_dwordx4 v[224:227], v16, s[12:15], s56 offen
  s_branch L_fin
L_r2single:
  s_sub_u32 s48, s48, 4
  s_mul_i32 s52, s48, 86
  s_lshr_b32 s52, s52, 8
  s_mul_i32 s53, s52, 3
  s_sub_u32 s53, s48, s53
  s_mul_i32 s49, s52, 10752
  s_lshl_b32 s54, s53, 9
  s_add_u32 s49, s49, s54
  s_add_u32 s49, s49, 9216
  s_mul_i32 s56, s52, 224
  s_mul_i32 s53, s53, 28672
  s_add_u32 s56, s56, s53
  s_add_u32 s56, s56, 192
  s_add_u32 s56, s56, s57
  buffer_load_dwordx2 v[80:81], v35, s[8:11], s49 offen sc1
  s_add_u32 s49, s49, 43136
  buffer_load_dwordx2 v[84:85], v35, s[8:11], s49 offen sc1
  s_add_u32 s49, s49, 43136
  buffer_load_dwordx2 v[88:89], v35, s[8:11], s49 offen sc1
  s_add_u32 s49, s49, 43136
  buffer_load_dwordx2 v[92:93], v35, s[8:11], s49 offen sc1
  s_add_u32 s49, s49, 43136
  buffer_load_dwordx2 v[96:97], v35, s[8:11], s49 offen sc1
  s_add_u32 s49, s49, 43136
  buffer_load_dwordx2 v[100:101], v35, s[8:11], s49 offen sc1
  s_add_u32 s49, s49, 43136
  buffer_load_dwordx2 v[104:105], v35, s[8:11], s49 offen sc1
  s_add_u32 s49, s49, 43136
  buffer_load_dwordx2 v[108:109], v35, s[8:11], s49 offen sc1
  s_add_u32 s49, s49, 43136
  s_waitcnt vmcnt(15)
  v_lshlrev_b32 v200, 16, v48
  v_and_b32 v201, s45, v48
  v_lshlrev_b32 v202, 16, v49
  v_and_b32 v203, s45, v49
  v_lshlrev_b32 v204, 16, v50
  v_and_b32 v205, s45, v50
  v_lshlrev_b32 v206, 16, v51
  v_and_b32 v207, s45, v51
  s_waitcnt vmcnt(14)
  v_dot2c_f32_bf16 v200, s4, v52
  v_dot2c_f32_bf16 v201, s42, v52
  v_dot2c_f32_bf16 v202, s4, v53
  v_dot2c_f32_bf16 v203, s42, v53
  v_dot2c_f32_bf16 v204, s4, v54
  v_dot2c_f32_bf16 v205, s42, v54
  v_dot2c_f32_bf16 v206, s4, v55
  v_dot2c_f32_bf16 v207, s42, v55
  s_waitcnt vmcnt(13)
  v_dot2c_f32_bf16 v200, s4, v56
  v_dot2c_f32_bf16 v201, s42, v56
  v_dot2c_f32_bf16 v202, s4, v57
  v_dot2c_f32_bf16 v203, s42, v57
  v_dot2c_f32_bf16 v204, s4, v58
  v_dot2c_f32_bf16 v205, s42, v58
  v_dot2c_f32_bf16 v206, s4, v59
  v_dot2c_f32_bf16 v207, s42, v59
  s_waitcnt vmcnt(12)
  v_dot2c_f32_bf16 v200, s4, v60
  v_dot2c_f32_bf16 v201, s42, v60
  v_dot2c_f32_bf16 v202, s4, v61
  v_dot2c_f32_bf16 v203, s42, v61
  v_dot2c_f32_bf16 v204, s4, v62
  v_dot2c_f32_bf16 v205, s42, v62
  v_dot2c_f32_bf16 v206, s4, v63
  v_dot2c_f32_bf16 v207, s42, v63
  s_waitcnt vmcnt(11)
  v_dot2c_f32_bf16 v200, s4, v64
  v_dot2c_f32_bf16 v201, s42, v64
  v_dot2c_f32_bf16 v202, s4, v65
  v_dot2c_f32_bf16 v203, s42, v65
  v_dot2c_f32_bf16 v204, s4, v66
  v_dot2c_f32_bf16 v205, s42, v66
  v_dot2c_f32_bf16 v206, s4, v67
  v_dot2c_f32_bf16 v207, s42, v67
  s_waitcnt vmcnt(10)
  v_dot2c_f32_bf16 v200, s4, v68
  v_dot2c_f32_bf16 v201, s42, v68
  v_dot2c_f32_bf16 v202, s4, v69
  v_dot2c_f32_bf16 v203, s42, v69
  v_dot2c_f32_bf16 v204, s4, v70
  v_dot2c_f32_bf16 v205, s42, v70
  v_dot2c_f32_bf16 v206, s4, v71
  v_dot2c_f32_bf16 v207, s42, v71
  s_waitcnt vmcnt(9)
  v_dot2c_f32_bf16 v200, s4, v72
  v_dot2c_f32_bf16 v201, s42, v72
  v_dot2c_f32_bf16 v202, s4, v73
  v_dot2c_f32_bf16 v203, s42, v73
  v_dot2c_f32_bf16 v204, s4, v74
  v_dot2c_f32_bf16 v205, s42, v74
  v_dot2c_f32_bf16 v206, s4, v75
  v_dot2c_f32_bf16 v207, s42, v75
  s_waitcnt vmcnt(8)
  v_dot2c_f32_bf16 v200, s4, v76
  v_dot2c_f32_bf16 v201, s42, v76
  v_dot2c_f32_bf16 v202, s4, v77
  v_dot2c_f32_bf16 v203, s42, v77
  v_dot2c_f32_bf16 v204, s4, v78
  v_dot2c_f32_bf16 v205, s42, v78
  v_dot2c_f32_bf16 v206, s4, v79
  v_dot2c_f32_bf16 v207, s42, v79
  s_nop 2
  v_cvt_pk_bf16_f32 v208, v200, v201
  v_cvt_pk_bf16_f32 v209, v202, v203
  v_cvt_pk_bf16_f32 v210, v204, v205
  v_cvt_pk_bf16_f32 v211, v206, v207
  s_nop 1
  v_permlane16_swap_b32 v208, v210
  v_permlane16_swap_b32 v209, v211
  s_nop 1
  buffer_store_dwordx4 v[208:211], v16, s[12:15], s50 offen
  s_waitcnt vmcnt(8)
  v_lshlrev_b32 v216, 16, v80
  v_and_b32 v217, s45, v80
  v_lshlrev_b32 v218, 16, v81
  v_and_b32 v219, s45, v81
  s_waitcnt vmcnt(7)
  v_dot2c_f32_bf16 v216, s4, v84
  v_dot2c_f32_bf16 v217, s42, v84
  v_dot2c_f32_bf16 v218, s4, v85
  v_dot2c_f32_bf16 v219, s42, v85
  s_waitcnt vmcnt(6)
  v_dot2c_f32_bf16 v216, s4, v88
  v_dot2c_f32_bf16 v217, s42, v88
  v_dot2c_f32_bf16 v218, s4, v89
  v_dot2c_f32_bf16 v219, s42, v89
  s_waitcnt vmcnt(5)
  v_dot2c_f32_bf16 v216, s4, v92
  v_dot2c_f32_bf16 v217, s42, v92
  v_dot2c_f32_bf16 v218, s4, v93
  v_dot2c_f32_bf16 v219, s42, v93
  s_waitcnt vmcnt(4)
  v_dot2c_f32_bf16 v216, s4, v96
  v_dot2c_f32_bf16 v217, s42, v96
  v_dot2c_f32_bf16 v218, s4, v97
  v_dot2c_f32_bf16 v219, s42, v97
  s_waitcnt vmcnt(3)
  v_dot2c_f32_bf16 v216, s4, v100
  v_dot2c_f32_bf16 v217, s42, v100
  v_dot2c_f32_bf16 v218, s4, v101
  v_dot2c_f32_bf16 v219, s42, v101
  s_waitcnt vmcnt(2)
  v_dot2c_f32_bf16 v216, s4, v104
  v_dot2c_f32_bf16 v217, s42, v104
  v_dot2c_f32_bf16 v218, s4, v105
  v_dot2c_f32_bf16 v219, s42, v105
  s_waitcnt vmcnt(1)
  v_dot2c_f32_bf16 v216, s4, v108
  v_dot2c_f32_bf16 v217, s42, v108
  v_dot2c_f32_bf16 v218, s4, v109
  v_dot2c_f32_bf16 v219, s42, v109
  s_nop 2
  v_cvt_pk_bf16_f32 v224, v216, v217
  v_cvt_pk_bf16_f32 v225, v218, v219
  s_nop 1
  buffer_store_dwordx2 v[224:225], v17, s[12:15], s56 offen
L_fin:
L_end:
  s_endpgm
.section .rodata,"a"
.p2align 6
.amdhsa_kernel concat_heads__gqa_block_cached__mha_block_cached__near_ridge_kernel
  .amdhsa_next_free_vgpr 512
  .amdhsa_next_free_sgpr 102
  .amdhsa_accum_offset 256
  .amdhsa_group_segment_fixed_size 0
  .amdhsa_kernarg_size 104
  .amdhsa_user_sgpr_count 2
  .amdhsa_user_sgpr_kernarg_segment_ptr 1
  .amdhsa_system_sgpr_workgroup_id_x 1
.end_amdhsa_kernel
```
